```python
import torch

def _softmax(x, axis=-1):
    return torch.softmax(x, dim=axis)

def _gelu(x):
    return torch.nn.functional.gelu(x, approximate='tanh')

def _silu(x):
    return torch.nn.functional.silu(x)

def _sigmoid(x):
    return torch.sigmoid(x)

def _layernorm(x, axis=-1, eps=1e-05):
    m = x.mean(dim=axis, keepdim=True)
    v = x.var(dim=axis, keepdim=True, unbiased=False)
    return (x - m) / torch.sqrt(v + eps)

def _scatter_add(tgt, idx, src, axis=0):
    return tgt.clone().index_add_(axis, idx, src)

def _segment_sum(src, seg, n):
    out = torch.zeros((n,) + src.shape[1:], dtype=src.dtype)
    return out.index_add_(0, seg, src)

def _pad(x, pw):
    flat = tuple((v for pair in reversed(pw) for v in pair))
    return torch.nn.functional.pad(x, flat)
kernel_name = 'sequential_preLN__memory_aug_recurrent_mem_tr__mixer_s_mlp__prompt'

def setup_inputs():

    _w = lambda a: (lambda t: t.to(torch.bfloat16) if t.is_floating_point() else t)(torch.as_tensor(a))

    def _A_setup():
        B, S, Dm = (1, 2048, 512)
        H, Dh = (32, 128)
        M, seg = (8, 32)
        seg = min(seg, S)
        S = S // seg * seg
        return {'x': _w((lambda *s: torch.randn(*s, dtype=torch.bfloat16) * 0.05)(B, S, Dm)), 'mem0': _w((lambda *s: torch.randn(*s, dtype=torch.bfloat16) * 0.2)(B, M, Dm)), 'Wq': _w((lambda *s: torch.randn(*s, dtype=torch.bfloat16) * 1.6)(Dm, H, Dh) * Dm ** (-0.5)), 'Wk': _w((lambda *s: torch.randn(*s, dtype=torch.bfloat16) * 1.6)(Dm, H, Dh) * Dm ** (-0.5)), 'Wv': _w((lambda *s: torch.randn(*s, dtype=torch.bfloat16) * 0.2)(Dm, H, Dh) * Dm ** (-0.5)), 'Wo': _w((lambda *s: torch.randn(*s, dtype=torch.bfloat16) * 0.2)(H, Dh, Dm) * (H * Dh) ** (-0.5)), 'seg_len': seg}
    _A_in = _A_setup()

    def _B_setup():
        B, S, D, F = (1, 2048, 512, 1792)
        return {'x': _w((lambda *s: torch.randn(*s, dtype=torch.bfloat16) * 0.05)(B, S, D)), 'w1': _w((lambda *s: torch.randn(*s, dtype=torch.bfloat16) * 0.8)(D, D) * D ** (-0.5)), 'w2': _w((lambda *s: torch.randn(*s, dtype=torch.bfloat16) * 0.8)(D, D) * D ** (-0.5)), 'w3': _w((lambda *s: torch.randn(*s, dtype=torch.bfloat16) * 0.8)(D, F) * D ** (-0.5)), 'w4': _w((lambda *s: torch.randn(*s, dtype=torch.bfloat16) * 0.8)(F, D) * F ** (-0.5))}
    _B_in = _B_setup()
    return {'A_x': _A_in['x'], 'A_mem0': _A_in['mem0'], 'A_Wq': _A_in['Wq'], 'A_Wk': _A_in['Wk'], 'A_Wv': _A_in['Wv'], 'A_Wo': _A_in['Wo'], 'A_seg_len': _A_in['seg_len'], 'B_x': _B_in['x'], 'B_w1': _B_in['w1'], 'B_w2': _B_in['w2'], 'B_w3': _B_in['w3'], 'B_w4': _B_in['w4']}

def reference(A_x, A_mem0, A_Wq, A_Wk, A_Wv, A_Wo, A_seg_len, B_x, B_w1, B_w2, B_w3, B_w4):

    def _A_ref(x, mem0, Wq, Wk, Wv, Wo, seg_len):
        B, S, Dm = x.shape
        H, Dh = (Wq.shape[1], Wq.shape[2])
        M = mem0.shape[1]
        scale = Dh ** (-0.5)
        n_seg = S // seg_len
        L = M + seg_len
        idx = torch.arange(L)
        mask = (idx[:, None] < M) | (idx[:, None] >= idx[None, :])
        mem = mem0
        outs = []
        for s in range(n_seg):
            xs = x[:, s * seg_len:(s + 1) * seg_len, :].clone()
            h = torch.concatenate([mem, xs], axis=1)
            q = torch.einsum('btd,dhe->bhte', h, Wq)
            k = torch.einsum('btd,dhe->bhte', h, Wk)
            v = torch.einsum('btd,dhe->bhte', h, Wv)
            scores = torch.einsum('bhqe,bhke->bhqk', q, k) * scale
            scores = torch.where(mask[None, None], scores, -1000000000.0)
            p = _softmax(scores, axis=-1)
            o = torch.einsum('bhqk,bhke->bhqe', p, v)
            o = torch.einsum('bhte,hed->btd', o, Wo)
            mem = o[:, :M, :].clone()
            outs.append(o[:, M:, :])
        return torch.concatenate(outs, axis=1)

    def _B_ref(x, w1, w2, w3, w4):
        B, S, D = x.shape
        h = _gelu(_layernorm(x, axis=-1) @ w1)
        c = D // 4
        g0 = _pad(h[:, :, 0 * c:1 * c], ((0, 0), (1, 0), (0, 0)))[:, :S, :]
        g1 = _pad(h[:, :, 1 * c:2 * c], ((0, 0), (0, 1), (0, 0)))[:, 1:, :]
        g2 = _pad(h[:, :, 2 * c:3 * c], ((0, 0), (2, 0), (0, 0)))[:, :S, :]
        g3 = _pad(h[:, :, 3 * c:], ((0, 0), (0, 2), (0, 0)))[:, 2:, :]
        hs = torch.concatenate([g0, g1, g2, g3], axis=-1) @ w2
        x1 = x + hs
        h2 = _gelu(_layernorm(x1, axis=-1) @ w3) @ w4
        return x1 + h2
    x = A_x
    h = x + _A_ref(_layernorm(x, axis=-1), A_mem0, A_Wq, A_Wk, A_Wv, A_Wo, A_seg_len)
    h2 = h + _B_ref(_layernorm(h, axis=-1), B_w1, B_w2, B_w3, B_w4)
    return h2
```

```asm
; @launch kernel=main_kernel grid=(256,1,1) block=(256,1,1) lds=163840
.amdgcn_target "amdgcn-amd-amdhsa--gfx950"
.text
.globl main_kernel
.p2align 8
.type main_kernel,@function
main_kernel:
    s_cmp_ge_u32 s2, 256
    s_cbranch_scc1 main_kernel_exit
    s_load_dwordx2 s[16:17], s[0:1], 104
    s_load_dwordx2 s[4:5], s[0:1], 112
    s_load_dwordx4 s[24:27], s[0:1], 16
    s_load_dwordx4 s[28:31], s[0:1], 32
    s_load_dwordx2 s[32:33], s[0:1], 8
    s_getreg_b32 s47, hwreg(HW_REG_XCC_ID, 0, 4)
    v_lshrrev_b32 v1, 6, v0
    s_nop 0
    v_readfirstlane_b32 s19, v1
    s_mov_b32 s21, 0x100000
    s_waitcnt lgkmcnt(0)
    s_mov_b32 s8, s4
    s_and_b32 s9, s5, 0xffff
    s_mov_b32 s10, 268435456
    s_mov_b32 s11, 0x00020000
    v_mov_b32 v5, 162176
    v_mov_b32 v2, s47
    v_lshlrev_b32 v2, 2, v2
    v_mov_b32 v3, 1
    s_cmp_lg_u32 s19, 0
    s_nop 0
    s_cbranch_scc1 Lna_2
    s_mov_b64 exec, 1
    global_atomic_add v4, v2, v3, s[16:17] sc0
    s_mov_b64 exec, -1
Lna_2:
    s_load_dwordx2 s[52:53], s[0:1], 0
    s_waitcnt lgkmcnt(0)
    s_mov_b32 s12, s52
    s_and_b32 s13, s53, 0xffff
    s_mov_b32 s14, 2097152
    s_mov_b32 s15, 0x00020000
    v_and_b32 v14, 63, v0
    s_lshl_b32 s52, s2, 3
    s_lshl_b32 s53, s19, 1
    s_add_u32 s52, s52, s53
    v_lshlrev_b32 v52, 4, v14
    s_lshl_b32 s53, s52, 10
    buffer_load_dwordx4 v[16:19], v52, s[12:15], s53 offen offset:0
    buffer_load_dwordx4 v[34:37], v52, s[12:15], s53 offen offset:1024
    s_add_u32 s43, s47, 1
    s_mov_b32 s18, -1
    v_mov_b32 v2, 192
    s_cmp_lg_u32 s19, 0
    s_nop 0
    s_cbranch_scc1 Lcas_5
    s_waitcnt vmcnt(2)
    v_readfirstlane_b32 s42, v4
    s_nop 0
    s_cmp_lg_u32 s42, 31
    s_nop 2
    s_cbranch_scc1 Lcas_5
    s_memrealtime s[44:45]
    s_waitcnt lgkmcnt(0)
    s_andn2_b32 s44, s44, 31
    s_or_b32 s44, s44, s43
    s_or_b32 s45, s45, 0x80000000
    v_mov_b32 v10, s44
    v_mov_b32 v11, s45
    v_mov_b32 v12, 0
    v_mov_b32 v13, 0
    s_mov_b64 exec, 1
    global_atomic_cmpswap_x2 v2, v[10:13], s[16:17]
    s_mov_b64 exec, -1
    s_waitcnt vmcnt(1)
Lcas_5:
    v_lshlrev_b32 v53, 8, v14
    s_lshr_b32 s53, s52, 4
    s_lshl_b32 s53, s53, 14
    s_and_b32 s54, s52, 15
    s_lshl_b32 s54, s54, 4
    s_add_u32 s53, s53, s54
    s_waitcnt vmcnt(1)
    v_lshlrev_b32 v20, 16, v16
    v_and_b32 v21, 0xffff0000, v16
    v_lshlrev_b32 v22, 16, v17
    v_and_b32 v23, 0xffff0000, v17
    v_lshlrev_b32 v24, 16, v18
    v_and_b32 v25, 0xffff0000, v18
    v_lshlrev_b32 v26, 16, v19
    v_and_b32 v27, 0xffff0000, v19
    v_pk_add_f32 v[28:29], v[20:21], v[22:23]
    v_pk_add_f32 v[30:31], v[24:25], v[26:27]
    v_pk_add_f32 v[28:29], v[28:29], v[30:31]
    v_add_f32 v28, v28, v29
    s_nop 1
    v_add_f32_dpp v28, v28, v28 quad_perm:[1,0,3,2] row_mask:0xf bank_mask:0xf
    s_nop 1
    v_add_f32_dpp v28, v28, v28 quad_perm:[2,3,0,1] row_mask:0xf bank_mask:0xf
    s_nop 1
    v_add_f32_dpp v28, v28, v28 row_half_mirror row_mask:0xf bank_mask:0xf
    s_nop 1
    v_add_f32_dpp v28, v28, v28 row_mirror row_mask:0xf bank_mask:0xf
    v_mov_b32 v30, v28
    s_nop 1
    v_permlane16_swap_b32 v28, v30
    v_add_f32 v28, v28, v30
    v_mov_b32 v30, v28
    s_nop 1
    v_permlane32_swap_b32 v28, v30
    v_add_f32 v28, v28, v30
    v_mul_f32 v32, 0x3b000000, v28
    v_pk_add_f32 v[30:31], v[20:21], v[32:33] op_sel_hi:[1,0] neg_lo:[0,1] neg_hi:[0,1]
    s_nop 0
    v_pk_mul_f32 v[28:29], v[30:31], v[30:31]
    v_pk_add_f32 v[30:31], v[22:23], v[32:33] op_sel_hi:[1,0] neg_lo:[0,1] neg_hi:[0,1]
    s_nop 0
    v_pk_fma_f32 v[28:29], v[30:31], v[30:31], v[28:29]
    v_pk_add_f32 v[30:31], v[24:25], v[32:33] op_sel_hi:[1,0] neg_lo:[0,1] neg_hi:[0,1]
    s_nop 0
    v_pk_fma_f32 v[28:29], v[30:31], v[30:31], v[28:29]
    v_pk_add_f32 v[30:31], v[26:27], v[32:33] op_sel_hi:[1,0] neg_lo:[0,1] neg_hi:[0,1]
    s_nop 0
    v_pk_fma_f32 v[28:29], v[30:31], v[30:31], v[28:29]
    v_add_f32 v28, v28, v29
    s_nop 1
    v_add_f32_dpp v28, v28, v28 quad_perm:[1,0,3,2] row_mask:0xf bank_mask:0xf
    s_nop 1
    v_add_f32_dpp v28, v28, v28 quad_perm:[2,3,0,1] row_mask:0xf bank_mask:0xf
    s_nop 1
    v_add_f32_dpp v28, v28, v28 row_half_mirror row_mask:0xf bank_mask:0xf
    s_nop 1
    v_add_f32_dpp v28, v28, v28 row_mirror row_mask:0xf bank_mask:0xf
    v_mov_b32 v30, v28
    s_nop 1
    v_permlane16_swap_b32 v28, v30
    v_add_f32 v28, v28, v30
    v_mov_b32 v30, v28
    s_nop 1
    v_permlane32_swap_b32 v28, v30
    v_add_f32 v28, v28, v30
    v_mul_f32 v54, 0x3b000000, v28
    v_cvt_pk_bf16_f32 v54, v54, v54
    v_and_b32 v54, 0xffff0000, v54
    v_add_f32 v54, 0x3727c5ac, v54
    v_cvt_pk_bf16_f32 v54, v54, v54
    v_and_b32 v54, 0xffff0000, v54
    v_sqrt_f32 v54, v54
    s_nop 0
    v_cvt_pk_bf16_f32 v54, v54, v54
    v_and_b32 v54, 0xffff0000, v54
    v_rcp_f32 v54, v54
    v_cvt_pk_bf16_f32 v32, v32, v32
    v_and_b32 v32, 0xffff0000, v32
    v_mov_b32 v28, v54
    v_pk_add_f32 v[20:21], v[20:21], v[32:33] op_sel_hi:[1,0] neg_lo:[0,1] neg_hi:[0,1]
    s_nop 0
    v_cvt_pk_bf16_f32 v30, v20, v21
    v_lshlrev_b32 v20, 16, v30
    v_and_b32 v21, 0xffff0000, v30
    v_pk_mul_f32 v[20:21], v[20:21], v[28:29] op_sel_hi:[1,0]
    v_pk_add_f32 v[22:23], v[22:23], v[32:33] op_sel_hi:[1,0] neg_lo:[0,1] neg_hi:[0,1]
    s_nop 0
    v_cvt_pk_bf16_f32 v31, v22, v23
    v_lshlrev_b32 v22, 16, v31
    v_and_b32 v23, 0xffff0000, v31
    v_pk_mul_f32 v[22:23], v[22:23], v[28:29] op_sel_hi:[1,0]
    v_pk_add_f32 v[24:25], v[24:25], v[32:33] op_sel_hi:[1,0] neg_lo:[0,1] neg_hi:[0,1]
    s_nop 0
    v_cvt_pk_bf16_f32 v30, v24, v25
    v_lshlrev_b32 v24, 16, v30
    v_and_b32 v25, 0xffff0000, v30
    v_pk_mul_f32 v[24:25], v[24:25], v[28:29] op_sel_hi:[1,0]
    v_pk_add_f32 v[26:27], v[26:27], v[32:33] op_sel_hi:[1,0] neg_lo:[0,1] neg_hi:[0,1]
    s_nop 0
    v_cvt_pk_bf16_f32 v31, v26, v27
    v_lshlrev_b32 v26, 16, v31
    v_and_b32 v27, 0xffff0000, v31
    v_pk_mul_f32 v[26:27], v[26:27], v[28:29] op_sel_hi:[1,0]
    v_cvt_pk_bf16_f32 v16, v20, v21
    v_cvt_pk_bf16_f32 v17, v22, v23
    v_cvt_pk_bf16_f32 v18, v24, v25
    v_cvt_pk_bf16_f32 v19, v26, v27
    v_mul_u32_u24 v52, 144, v14
    s_lshl_b32 s54, s19, 5
    v_add_u32 v52, s54, v52
    ds_write_b128 v52, v[16:19] offset:0
    s_waitcnt vmcnt(0)
    v_lshlrev_b32 v38, 16, v34
    v_and_b32 v39, 0xffff0000, v34
    v_lshlrev_b32 v40, 16, v35
    v_and_b32 v41, 0xffff0000, v35
    v_lshlrev_b32 v42, 16, v36
    v_and_b32 v43, 0xffff0000, v36
    v_lshlrev_b32 v44, 16, v37
    v_and_b32 v45, 0xffff0000, v37
    v_pk_add_f32 v[46:47], v[38:39], v[40:41]
    v_pk_add_f32 v[48:49], v[42:43], v[44:45]
    v_pk_add_f32 v[46:47], v[46:47], v[48:49]
    v_add_f32 v46, v46, v47
    s_nop 1
    v_add_f32_dpp v46, v46, v46 quad_perm:[1,0,3,2] row_mask:0xf bank_mask:0xf
    s_nop 1
    v_add_f32_dpp v46, v46, v46 quad_perm:[2,3,0,1] row_mask:0xf bank_mask:0xf
    s_nop 1
    v_add_f32_dpp v46, v46, v46 row_half_mirror row_mask:0xf bank_mask:0xf
    s_nop 1
    v_add_f32_dpp v46, v46, v46 row_mirror row_mask:0xf bank_mask:0xf
    v_mov_b32 v48, v46
    s_nop 1
    v_permlane16_swap_b32 v46, v48
    v_add_f32 v46, v46, v48
    v_mov_b32 v48, v46
    s_nop 1
    v_permlane32_swap_b32 v46, v48
    v_add_f32 v46, v46, v48
    v_mul_f32 v50, 0x3b000000, v46
    v_pk_add_f32 v[48:49], v[38:39], v[50:51] op_sel_hi:[1,0] neg_lo:[0,1] neg_hi:[0,1]
    s_nop 0
    v_pk_mul_f32 v[46:47], v[48:49], v[48:49]
    v_pk_add_f32 v[48:49], v[40:41], v[50:51] op_sel_hi:[1,0] neg_lo:[0,1] neg_hi:[0,1]
    s_nop 0
    v_pk_fma_f32 v[46:47], v[48:49], v[48:49], v[46:47]
    v_pk_add_f32 v[48:49], v[42:43], v[50:51] op_sel_hi:[1,0] neg_lo:[0,1] neg_hi:[0,1]
    s_nop 0
    v_pk_fma_f32 v[46:47], v[48:49], v[48:49], v[46:47]
    v_pk_add_f32 v[48:49], v[44:45], v[50:51] op_sel_hi:[1,0] neg_lo:[0,1] neg_hi:[0,1]
    s_nop 0
    v_pk_fma_f32 v[46:47], v[48:49], v[48:49], v[46:47]
    v_add_f32 v46, v46, v47
    s_nop 1
    v_add_f32_dpp v46, v46, v46 quad_perm:[1,0,3,2] row_mask:0xf bank_mask:0xf
    s_nop 1
    v_add_f32_dpp v46, v46, v46 quad_perm:[2,3,0,1] row_mask:0xf bank_mask:0xf
    s_nop 1
    v_add_f32_dpp v46, v46, v46 row_half_mirror row_mask:0xf bank_mask:0xf
    s_nop 1
    v_add_f32_dpp v46, v46, v46 row_mirror row_mask:0xf bank_mask:0xf
    v_mov_b32 v48, v46
    s_nop 1
    v_permlane16_swap_b32 v46, v48
    v_add_f32 v46, v46, v48
    v_mov_b32 v48, v46
    s_nop 1
    v_permlane32_swap_b32 v46, v48
    v_add_f32 v46, v46, v48
    v_mul_f32 v54, 0x3b000000, v46
    v_cvt_pk_bf16_f32 v54, v54, v54
    v_and_b32 v54, 0xffff0000, v54
    v_add_f32 v54, 0x3727c5ac, v54
    v_cvt_pk_bf16_f32 v54, v54, v54
    v_and_b32 v54, 0xffff0000, v54
    v_sqrt_f32 v54, v54
    s_nop 0
    v_cvt_pk_bf16_f32 v54, v54, v54
    v_and_b32 v54, 0xffff0000, v54
    v_rcp_f32 v54, v54
    v_cvt_pk_bf16_f32 v50, v50, v50
    v_and_b32 v50, 0xffff0000, v50
    v_mov_b32 v46, v54
    v_pk_add_f32 v[38:39], v[38:39], v[50:51] op_sel_hi:[1,0] neg_lo:[0,1] neg_hi:[0,1]
    s_nop 0
    v_cvt_pk_bf16_f32 v48, v38, v39
    v_lshlrev_b32 v38, 16, v48
    v_and_b32 v39, 0xffff0000, v48
    v_pk_mul_f32 v[38:39], v[38:39], v[46:47] op_sel_hi:[1,0]
    v_pk_add_f32 v[40:41], v[40:41], v[50:51] op_sel_hi:[1,0] neg_lo:[0,1] neg_hi:[0,1]
    s_nop 0
    v_cvt_pk_bf16_f32 v49, v40, v41
    v_lshlrev_b32 v40, 16, v49
    v_and_b32 v41, 0xffff0000, v49
    v_pk_mul_f32 v[40:41], v[40:41], v[46:47] op_sel_hi:[1,0]
    v_pk_add_f32 v[42:43], v[42:43], v[50:51] op_sel_hi:[1,0] neg_lo:[0,1] neg_hi:[0,1]
    s_nop 0
    v_cvt_pk_bf16_f32 v48, v42, v43
    v_lshlrev_b32 v42, 16, v48
    v_and_b32 v43, 0xffff0000, v48
    v_pk_mul_f32 v[42:43], v[42:43], v[46:47] op_sel_hi:[1,0]
    v_pk_add_f32 v[44:45], v[44:45], v[50:51] op_sel_hi:[1,0] neg_lo:[0,1] neg_hi:[0,1]
    s_nop 0
    v_cvt_pk_bf16_f32 v49, v44, v45
    v_lshlrev_b32 v44, 16, v49
    v_and_b32 v45, 0xffff0000, v49
    v_pk_mul_f32 v[44:45], v[44:45], v[46:47] op_sel_hi:[1,0]
    v_cvt_pk_bf16_f32 v34, v38, v39
    v_cvt_pk_bf16_f32 v35, v40, v41
    v_cvt_pk_bf16_f32 v36, v42, v43
    v_cvt_pk_bf16_f32 v37, v44, v45
    ds_write_b128 v52, v[34:37] offset:16
    v_lshrrev_b32 v52, 3, v14
    s_lshl_b32 s54, s19, 4
    v_add_u32 v52, s54, v52
    v_and_b32 v53, 7, v14
    v_lshlrev_b32 v53, 4, v53
    v_lshl_add_u32 v54, v52, 8, v53
    v_mul_u32_u24 v52, 144, v52
    v_add_u32 v52, v52, v53
    s_and_b32 s53, s53, 0xffffff80
    s_waitcnt lgkmcnt(0)
    s_barrier
    ds_read_b128 v[16:19], v52
    ds_read_b128 v[20:23], v52 offset:1152
    s_waitcnt lgkmcnt(1)
    buffer_store_dwordx4 v[16:19], v54, s[8:11], s53 offen sc1
    s_waitcnt lgkmcnt(0)
    buffer_store_dwordx4 v[20:23], v54, s[8:11], s53 offen offset:2048 sc1
    s_cmp_lg_u32 s19, 0
    s_nop 0
    s_cbranch_scc1 Lrole_1
    s_mov_b64 exec, 1
Lnocas_4:
    global_load_dwordx2 v[6:7], v2, s[16:17] sc1
    s_sub_u32 s21, s21, 1
    s_waitcnt vmcnt(0)
    v_readfirstlane_b32 s44, v6
    s_cmp_eq_u32 s21, 0
    s_nop 3
    s_cbranch_scc1 Lpub_3
    s_cmp_eq_u32 s44, 0
    s_cbranch_scc1 Lnocas_4
    s_and_b32 s44, s44, 31
    s_cmp_gt_u32 s43, s44
    s_cselect_b32 s45, 2, 1
    s_sub_u32 s45, s43, s45
    s_lshl_b32 s45, s45, 5
    s_add_u32 s45, s45, s42
    s_add_u32 s45, s45, 256
    s_cmp_eq_u32 s44, s43
    s_cselect_b32 s18, s42, s45
    s_cmp_ge_u32 s42, 32
    s_cselect_b32 s18, 0xffff, s18
Lpub_3:
    v_mov_b32 v4, s18
    ds_write_b32 v5, v4
    ds_write_b64 v5, v[6:7] offset:8
    s_mov_b64 exec, -1
    s_waitcnt lgkmcnt(0)
Lrole_1:
    s_waitcnt vmcnt(0)
    s_barrier
    ds_read_b32 v4, v5
    ds_read_b64 v[6:7], v5 offset:8
    s_waitcnt lgkmcnt(0)
    v_readfirstlane_b32 s18, v4
    v_readfirstlane_b32 s62, v6
    v_readfirstlane_b32 s63, v7
    s_cmp_lg_u32 s19, 0
    s_nop 3
    s_cbranch_scc1 Lsd_6
    s_lshl_b32 s52, s2, 7
    s_add_u32 s52, s52, 159383552
    v_mov_b64 v[8:9], v[6:7]
    v_lshlrev_b32 v10, 4, v14
    s_mov_b64 exec, 0xff
    buffer_store_dwordx4 v[6:9], v10, s[8:11], s52 offen sc1
    s_mov_b64 exec, -1
    s_nop 0
Lsd_6:
    s_cmp_ge_u32 s18, 32
    s_cbranch_scc1 main_kernel_worker
    v_and_b32 v100, 63, v0
    v_and_b32 v101, 15, v0
    v_lshrrev_b32 v102, 4, v100
    s_mov_b32 s40, 0x05040100
    s_mov_b32 s41, 0x07060302
    s_mov_b32 s38, 0x3e0293ee
    s_mov_b32 s39, 0x3e0293ee
    s_mov_b32 s48, 72351744
    s_mov_b32 s49, 72384512
    s_lshl_b32 s43, s19, 11
    s_and_b32 s44, s18, 3
    s_lshl_b32 s44, s44, 13
    s_add_u32 s43, s43, s44
    s_sub_u32 s43, s43, 131072
    s_add_u32 s60, s48, s43
    s_add_u32 s61, s49, s43
    s_mov_b32 s50, 71303168
    s_mov_b32 s51, 71827456
    v_mov_b32 v103, 0x44444444
    v_mov_b32 v104, 0xeeeeeeee
    v_cmp_gt_u32 vcc, 8, v101
    s_nop 1
    v_cndmask_b32 v8, v104, v103, vcc
    v_mov_b32 v16, 0x3f803f80
    v_mov_b32 v17, 0x3f803f80
    v_mov_b32 v18, 0x3f803f80
    v_mov_b32 v19, 0x3f803f80
    v_mov_b32 v20, 0
    v_mov_b32 v21, 0
    v_lshlrev_b32 v2, 4, v100
    v_add_u32 v3, 131072, v2
    v_and_b32 v103, 1, v102
    v_lshlrev_b32 v103, 2, v103
    v_lshrrev_b32 v104, 1, v102
    v_lshl_add_u32 v103, v104, 1, v103
    v_mul_u32_u24 v103, 544, v103
    v_lshl_add_u32 v103, v101, 4, v103
    s_lshl_b32 s43, s19, 2
    s_add_u32 s43, s43, 155648
    v_add_u32 v4, s43, v103
    v_and_b32 v107, 7, v101
    v_mul_u32_u24 v103, 544, v107
    v_lshl_add_u32 v103, v102, 4, v103
    v_add_u32 v5, 155648, v103
    v_mul_u32_u24 v103, 272, v107
    v_lshl_add_u32 v103, v102, 4, v103
    v_add_u32 v6, 160000, v103
    v_lshlrev_b32 v103, 7, v102
    v_lshl_add_u32 v103, v107, 4, v103
    v_add_u32 v7, 131072, v103
    s_lshl_b32 s43, s19, 15
    v_add_u32 v9, s43, v2
    v_lshrrev_b32 v103, 3, v101
    v_lshl_add_u32 v103, v103, 2, v102
    s_lshl_b32 s43, s19, 3
    v_add_u32 v103, s43, v103
    v_lshlrev_b32 v103, 11, v103
    v_lshl_add_u32 v103, v107, 3, v103
    s_lshl_b32 s43, s18, 6
    v_add_u32 v10, s43, v103
    s_lshl_b32 s43, s18, 11
    s_lshl_b32 s44, s19, 16
    s_add_u32 s43, s43, s44
    v_add_u32 v11, s43, v2
    s_mov_b32 s64, 71303168
    s_mov_b32 s65, 71368704
    s_mov_b32 s66, 71434240
    s_mov_b32 s67, 71499776
    v_lshrrev_b32 v103, 2, v101
    v_and_b32 v104, 3, v101
    v_lshl_add_u32 v103, v104, 2, v103
    v_and_b32 v104, 1, v103
    v_lshlrev_b32 v104, 4, v104
    v_mov_b32 v105, 0x3f80
    v_lshlrev_b32 v104, v104, v105
    v_lshrrev_b32 v103, 1, v103
    v_cmp_eq_u32 vcc, 0, v103
    s_nop 1
    v_cndmask_b32 v116, 0, v104, vcc
    v_cmp_eq_u32 vcc, 1, v103
    s_nop 1
    v_cndmask_b32 v117, 0, v104, vcc
    v_cmp_eq_u32 vcc, 2, v103
    s_nop 1
    v_cndmask_b32 v118, 0, v104, vcc
    v_cmp_eq_u32 vcc, 3, v103
    s_nop 1
    v_cndmask_b32 v119, 0, v104, vcc
    s_lshr_b32 s43, s18, 4
    s_lshl_b32 s44, s19, 1
    s_add_u32 s43, s43, s44
    s_lshl_b32 s43, s43, 10
    s_bfe_u32 s44, s18, 0x20001
    s_lshl_b32 s44, s44, 7
    s_add_u32 s43, s43, s44
    s_bfe_u32 s44, s18, 0x10003
    s_lshl_b32 s44, s44, 9
    s_add_u32 s43, s43, s44
    s_and_b32 s44, s18, 1
    s_lshl_b32 s44, s44, 6
    s_add_u32 s43, s43, s44
    v_lshlrev_b32 v103, 4, v102
    v_and_b32 v104, 3, v101
    v_lshl_add_u32 v103, v104, 2, v103
    v_add_u32 v103, s43, v103
    v_lshrrev_b32 v104, 2, v101
    v_lshl_add_u32 v103, v104, 13, v103
    v_cmp_gt_u32 vcc, 4, v104
    v_mov_b32 v105, 0x40000000
    s_nop 0
    v_cndmask_b32 v12, v105, v103, vcc
    s_lshl_b32 s43, s18, 20
    s_lshl_b32 s44, s19, 11
    s_add_u32 s43, s43, s44
    v_add_u32 v13, s43, v2
    s_lshl_b32 s43, s18, 19
    s_lshl_b32 s44, s19, 10
    s_add_u32 s43, s43, s44
    v_add_u32 v14, s43, v2
    v_mov_b32 v24, -1
    v_mov_b32 v25, -1
    v_mov_b32 v26, -1
    v_mov_b32 v27, -1
    buffer_store_dwordx4 v[24:27], v11, s[8:11], s50 offen offset:0
    buffer_store_dwordx4 v[24:27], v11, s[8:11], s50 offen offset:1024
    buffer_store_dword v24, v12, s[8:11], s48 offen
    buffer_store_dword v24, v12, s[8:11], s49 offen
    s_mov_b32 s12, s30
    s_and_b32 s13, s31, 0xffff
    s_mov_b32 s14, 4194304
    s_mov_b32 s15, 0x00020000
    v_lshlrev_b32 v112, 14, v102
    v_lshl_add_u32 v112, v101, 4, v112
    s_lshl_b32 s43, s18, 17
    s_lshl_b32 s44, s19, 8
    s_add_u32 s43, s43, s44
    v_add_u32 v112, s43, v112
    v_and_b32 v103, 1, v102
    v_lshlrev_b32 v103, 5, v103
    v_lshrrev_b32 v104, 1, v102
    v_lshl_add_u32 v103, v104, 2, v103
    v_lshlrev_b32 v103, 13, v103
    v_lshl_add_u32 v103, v101, 4, v103
    s_lshl_b32 s43, s18, 8
    s_lshr_b32 s44, s19, 1
    s_lshl_b32 s44, s44, 19
    s_add_u32 s43, s43, s44
    s_and_b32 s44, s19, 1
    s_lshl_b32 s44, s44, 17
    s_add_u32 s43, s43, s44
    v_add_u32 v113, s43, v103
    s_lshr_b32 s43, s19, 1
    s_lshl_b32 s43, s43, 10
    s_and_b32 s44, s19, 1
    s_lshl_b32 s44, s44, 3
    s_add_u32 s43, s43, s44
    v_add_u32 v114, s43, v3
    s_lshl_b32 s43, s19, 12
    v_add_u32 v115, s43, v3
    s_mov_b32 s52, s32
    s_and_b32 s53, s33, 0xffff
    s_mov_b32 s54, 8192
    s_mov_b32 s55, 0x00020000
    v_lshlrev_b32 v120, 10, v107
    v_lshrrev_b32 v104, 1, v102
    v_lshl_add_u32 v120, v104, 7, v120
    v_and_b32 v104, 1, v102
    v_lshl_add_u32 v120, v104, 3, v120
    s_lshl_b32 s43, s19, 1
    v_add_u32 v120, s43, v120
    s_mov_b32 s6, 4194304
    s_mov_b32 s7, 0x00020000
    s_and_b32 s45, s18, 3
    s_mov_b32 s4, s24
    s_and_b32 s5, s25, 0xffff
    s_mov_b32 s43, 0
    buffer_load_dwordx4 v[32:35], v113, s[4:7], s43 offen
    s_mov_b32 s43, 65536
    buffer_load_dwordx4 v[36:39], v113, s[4:7], s43 offen
    s_mov_b32 s43, 1048576
    buffer_load_dwordx4 v[40:43], v113, s[4:7], s43 offen
    s_mov_b32 s43, 1114112
    buffer_load_dwordx4 v[44:47], v113, s[4:7], s43 offen
    s_mov_b32 s43, 2097152
    buffer_load_dwordx4 v[48:51], v113, s[4:7], s43 offen
    s_mov_b32 s43, 2162688
    buffer_load_dwordx4 v[52:55], v113, s[4:7], s43 offen
    s_mov_b32 s43, 3145728
    buffer_load_dwordx4 v[56:59], v113, s[4:7], s43 offen
    s_mov_b32 s43, 3211264
    buffer_load_dwordx4 v[60:63], v113, s[4:7], s43 offen
    s_mov_b32 s43, 8192
    buffer_load_dwordx4 v[64:67], v113, s[4:7], s43 offen
    s_mov_b32 s43, 73728
    buffer_load_dwordx4 v[68:71], v113, s[4:7], s43 offen
    s_mov_b32 s43, 1056768
    buffer_load_dwordx4 v[72:75], v113, s[4:7], s43 offen
    s_mov_b32 s43, 1122304
    buffer_load_dwordx4 v[76:79], v113, s[4:7], s43 offen
    s_mov_b32 s43, 2105344
    buffer_load_dwordx4 v[80:83], v113, s[4:7], s43 offen
    s_mov_b32 s43, 2170880
    buffer_load_dwordx4 v[84:87], v113, s[4:7], s43 offen
    s_mov_b32 s43, 3153920
    buffer_load_dwordx4 v[88:91], v113, s[4:7], s43 offen
    s_mov_b32 s43, 3219456
    buffer_load_dwordx4 v[92:95], v113, s[4:7], s43 offen
    s_mov_b32 s43, 16384
    buffer_load_dwordx4 v[128:131], v113, s[4:7], s43 offen
    s_mov_b32 s43, 81920
    buffer_load_dwordx4 v[132:135], v113, s[4:7], s43 offen
    s_mov_b32 s43, 1064960
    buffer_load_dwordx4 v[136:139], v113, s[4:7], s43 offen
    s_mov_b32 s43, 1130496
    buffer_load_dwordx4 v[140:143], v113, s[4:7], s43 offen
    s_mov_b32 s43, 2113536
    buffer_load_dwordx4 v[144:147], v113, s[4:7], s43 offen
    s_mov_b32 s43, 2179072
    buffer_load_dwordx4 v[148:151], v113, s[4:7], s43 offen
    s_mov_b32 s43, 3162112
    buffer_load_dwordx4 v[152:155], v113, s[4:7], s43 offen
    s_mov_b32 s43, 3227648
    buffer_load_dwordx4 v[156:159], v113, s[4:7], s43 offen
    s_mov_b32 s43, 24576
    buffer_load_dwordx4 v[160:163], v113, s[4:7], s43 offen
    s_mov_b32 s43, 90112
    buffer_load_dwordx4 v[164:167], v113, s[4:7], s43 offen
    s_mov_b32 s43, 1073152
    buffer_load_dwordx4 v[168:171], v113, s[4:7], s43 offen
    s_mov_b32 s43, 1138688
    buffer_load_dwordx4 v[172:175], v113, s[4:7], s43 offen
    s_mov_b32 s43, 2121728
    buffer_load_dwordx4 v[176:179], v113, s[4:7], s43 offen
    s_mov_b32 s43, 2187264
    buffer_load_dwordx4 v[180:183], v113, s[4:7], s43 offen
    s_mov_b32 s43, 3170304
    buffer_load_dwordx4 v[184:187], v113, s[4:7], s43 offen
    s_mov_b32 s43, 3235840
    buffer_load_dwordx4 v[188:191], v113, s[4:7], s43 offen
    s_mov_b32 s4, s26
    s_and_b32 s5, s27, 0xffff
    s_mov_b32 s43, 0
    buffer_load_dwordx4 v[192:195], v113, s[4:7], s43 offen
    s_mov_b32 s43, 65536
    buffer_load_dwordx4 v[196:199], v113, s[4:7], s43 offen
    s_mov_b32 s43, 1048576
    buffer_load_dwordx4 v[200:203], v113, s[4:7], s43 offen
    s_mov_b32 s43, 1114112
    buffer_load_dwordx4 v[204:207], v113, s[4:7], s43 offen
    s_mov_b32 s43, 2097152
    buffer_load_dwordx4 v[208:211], v113, s[4:7], s43 offen
    s_mov_b32 s43, 2162688
    buffer_load_dwordx4 v[212:215], v113, s[4:7], s43 offen
    s_mov_b32 s43, 3145728
    buffer_load_dwordx4 v[216:219], v113, s[4:7], s43 offen
    s_mov_b32 s43, 3211264
    buffer_load_dwordx4 v[220:223], v113, s[4:7], s43 offen
    s_waitcnt vmcnt(40)
    s_barrier
    s_cmp_lg_u32 s19, 0
    s_cbranch_scc1 Larmed_7
    s_mov_b64 exec, 1
    v_mov_b32 v22, 132
    v_mov_b32 v23, 1
    global_atomic_add v22, v23, s[16:17]
    s_mov_b64 exec, -1
Larmed_7:
    s_mov_b32 s43, 8192
    buffer_load_dwordx4 v[224:227], v113, s[4:7], s43 offen
    s_mov_b32 s43, 73728
    buffer_load_dwordx4 v[228:231], v113, s[4:7], s43 offen
    s_mov_b32 s43, 1056768
    buffer_load_dwordx4 v[232:235], v113, s[4:7], s43 offen
    s_mov_b32 s43, 1122304
    buffer_load_dwordx4 v[236:239], v113, s[4:7], s43 offen
    s_mov_b32 s43, 2105344
    buffer_load_dwordx4 v[240:243], v113, s[4:7], s43 offen
    s_mov_b32 s43, 2170880
    buffer_load_dwordx4 v[244:247], v113, s[4:7], s43 offen
    s_mov_b32 s43, 3153920
    buffer_load_dwordx4 v[248:251], v113, s[4:7], s43 offen
    s_mov_b32 s43, 3219456
    buffer_load_dwordx4 v[252:255], v113, s[4:7], s43 offen
    s_waitcnt vmcnt(44)
    v_perm_b32 v24, v36, v32, s40
    v_perm_b32 v25, v36, v32, s41
    ds_write_b64 v114, v[24:25] offset:0
    v_perm_b32 v26, v44, v40, s40
    v_perm_b32 v27, v44, v40, s41
    ds_write_b64 v114, v[26:27] offset:2048
    v_perm_b32 v28, v37, v33, s40
    v_perm_b32 v29, v37, v33, s41
    ds_write_b64 v114, v[28:29] offset:4096
    v_perm_b32 v30, v45, v41, s40
    v_perm_b32 v31, v45, v41, s41
    ds_write_b64 v114, v[30:31] offset:6144
    v_perm_b32 v24, v38, v34, s40
    v_perm_b32 v25, v38, v34, s41
    ds_write_b64 v114, v[24:25] offset:8192
    v_perm_b32 v26, v46, v42, s40
    v_perm_b32 v27, v46, v42, s41
    ds_write_b64 v114, v[26:27] offset:10240
    v_perm_b32 v28, v39, v35, s40
    v_perm_b32 v29, v39, v35, s41
    ds_write_b64 v114, v[28:29] offset:12288
    v_perm_b32 v30, v47, v43, s40
    v_perm_b32 v31, v47, v43, s41
    ds_write_b64 v114, v[30:31] offset:14336
    s_waitcnt lgkmcnt(0)
    s_barrier
    ds_read_b128 a[0:3], v115 offset:0
    ds_read_b128 a[4:7], v115 offset:1024
    ds_read_b128 a[8:11], v115 offset:2048
    ds_read_b128 a[12:15], v115 offset:3072
    s_mov_b32 s43, 16384
    buffer_load_dwordx4 v[32:35], v113, s[4:7], s43 offen
    s_mov_b32 s43, 81920
    buffer_load_dwordx4 v[36:39], v113, s[4:7], s43 offen
    s_mov_b32 s43, 1064960
    buffer_load_dwordx4 v[40:43], v113, s[4:7], s43 offen
    s_mov_b32 s43, 1130496
    buffer_load_dwordx4 v[44:47], v113, s[4:7], s43 offen
    s_waitcnt vmcnt(44)
    v_perm_b32 v24, v52, v48, s40
    v_perm_b32 v25, v52, v48, s41
    ds_write_b64 v114, v[24:25] offset:16384
    v_perm_b32 v26, v60, v56, s40
    v_perm_b32 v27, v60, v56, s41
    ds_write_b64 v114, v[26:27] offset:18432
    v_perm_b32 v28, v53, v49, s40
    v_perm_b32 v29, v53, v49, s41
    ds_write_b64 v114, v[28:29] offset:20480
    v_perm_b32 v30, v61, v57, s40
    v_perm_b32 v31, v61, v57, s41
    ds_write_b64 v114, v[30:31] offset:22528
    v_perm_b32 v24, v54, v50, s40
    v_perm_b32 v25, v54, v50, s41
    ds_write_b64 v114, v[24:25] offset:24576
    v_perm_b32 v26, v62, v58, s40
    v_perm_b32 v27, v62, v58, s41
    ds_write_b64 v114, v[26:27] offset:26624
    v_perm_b32 v28, v55, v51, s40
    v_perm_b32 v29, v55, v51, s41
    ds_write_b64 v114, v[28:29] offset:28672
    v_perm_b32 v30, v63, v59, s40
    v_perm_b32 v31, v63, v59, s41
    ds_write_b64 v114, v[30:31] offset:30720
    s_waitcnt lgkmcnt(0)
    s_barrier
    ds_read_b128 a[16:19], v115 offset:16384
    ds_read_b128 a[20:23], v115 offset:17408
    ds_read_b128 a[24:27], v115 offset:18432
    ds_read_b128 a[28:31], v115 offset:19456
    s_mov_b32 s43, 2113536
    buffer_load_dwordx4 v[48:51], v113, s[4:7], s43 offen
    s_mov_b32 s43, 2179072
    buffer_load_dwordx4 v[52:55], v113, s[4:7], s43 offen
    s_mov_b32 s43, 3162112
    buffer_load_dwordx4 v[56:59], v113, s[4:7], s43 offen
    s_mov_b32 s43, 3227648
    buffer_load_dwordx4 v[60:63], v113, s[4:7], s43 offen
    s_waitcnt vmcnt(44)
    v_perm_b32 v24, v68, v64, s40
    v_perm_b32 v25, v68, v64, s41
    ds_write_b64 v114, v[24:25] offset:0
    v_perm_b32 v26, v76, v72, s40
    v_perm_b32 v27, v76, v72, s41
    ds_write_b64 v114, v[26:27] offset:2048
    v_perm_b32 v28, v69, v65, s40
    v_perm_b32 v29, v69, v65, s41
    ds_write_b64 v114, v[28:29] offset:4096
    v_perm_b32 v30, v77, v73, s40
    v_perm_b32 v31, v77, v73, s41
    ds_write_b64 v114, v[30:31] offset:6144
    v_perm_b32 v24, v70, v66, s40
    v_perm_b32 v25, v70, v66, s41
    ds_write_b64 v114, v[24:25] offset:8192
    v_perm_b32 v26, v78, v74, s40
    v_perm_b32 v27, v78, v74, s41
    ds_write_b64 v114, v[26:27] offset:10240
    v_perm_b32 v28, v71, v67, s40
    v_perm_b32 v29, v71, v67, s41
    ds_write_b64 v114, v[28:29] offset:12288
    v_perm_b32 v30, v79, v75, s40
    v_perm_b32 v31, v79, v75, s41
    ds_write_b64 v114, v[30:31] offset:14336
    s_waitcnt lgkmcnt(0)
    s_barrier
    ds_read_b128 a[32:35], v115 offset:0
    ds_read_b128 a[36:39], v115 offset:1024
    ds_read_b128 a[40:43], v115 offset:2048
    ds_read_b128 a[44:47], v115 offset:3072
    s_mov_b32 s43, 24576
    buffer_load_dwordx4 v[64:67], v113, s[4:7], s43 offen
    s_mov_b32 s43, 90112
    buffer_load_dwordx4 v[68:71], v113, s[4:7], s43 offen
    s_mov_b32 s43, 1073152
    buffer_load_dwordx4 v[72:75], v113, s[4:7], s43 offen
    s_mov_b32 s43, 1138688
    buffer_load_dwordx4 v[76:79], v113, s[4:7], s43 offen
    s_waitcnt vmcnt(44)
    v_perm_b32 v24, v84, v80, s40
    v_perm_b32 v25, v84, v80, s41
    ds_write_b64 v114, v[24:25] offset:16384
    v_perm_b32 v26, v92, v88, s40
    v_perm_b32 v27, v92, v88, s41
    ds_write_b64 v114, v[26:27] offset:18432
    v_perm_b32 v28, v85, v81, s40
    v_perm_b32 v29, v85, v81, s41
    ds_write_b64 v114, v[28:29] offset:20480
    v_perm_b32 v30, v93, v89, s40
    v_perm_b32 v31, v93, v89, s41
    ds_write_b64 v114, v[30:31] offset:22528
    v_perm_b32 v24, v86, v82, s40
    v_perm_b32 v25, v86, v82, s41
    ds_write_b64 v114, v[24:25] offset:24576
    v_perm_b32 v26, v94, v90, s40
    v_perm_b32 v27, v94, v90, s41
    ds_write_b64 v114, v[26:27] offset:26624
    v_perm_b32 v28, v87, v83, s40
    v_perm_b32 v29, v87, v83, s41
    ds_write_b64 v114, v[28:29] offset:28672
    v_perm_b32 v30, v95, v91, s40
    v_perm_b32 v31, v95, v91, s41
    ds_write_b64 v114, v[30:31] offset:30720
    s_waitcnt lgkmcnt(0)
    s_barrier
    ds_read_b128 a[48:51], v115 offset:16384
    ds_read_b128 a[52:55], v115 offset:17408
    ds_read_b128 a[56:59], v115 offset:18432
    ds_read_b128 a[60:63], v115 offset:19456
    s_mov_b32 s43, 2121728
    buffer_load_dwordx4 v[80:83], v113, s[4:7], s43 offen
    s_mov_b32 s43, 2187264
    buffer_load_dwordx4 v[84:87], v113, s[4:7], s43 offen
    s_mov_b32 s43, 3170304
    buffer_load_dwordx4 v[88:91], v113, s[4:7], s43 offen
    s_mov_b32 s43, 3235840
    buffer_load_dwordx4 v[92:95], v113, s[4:7], s43 offen
    s_waitcnt vmcnt(44)
    v_perm_b32 v24, v132, v128, s40
    v_perm_b32 v25, v132, v128, s41
    ds_write_b64 v114, v[24:25] offset:0
    v_perm_b32 v26, v140, v136, s40
    v_perm_b32 v27, v140, v136, s41
    ds_write_b64 v114, v[26:27] offset:2048
    v_perm_b32 v28, v133, v129, s40
    v_perm_b32 v29, v133, v129, s41
    ds_write_b64 v114, v[28:29] offset:4096
    v_perm_b32 v30, v141, v137, s40
    v_perm_b32 v31, v141, v137, s41
    ds_write_b64 v114, v[30:31] offset:6144
    v_perm_b32 v24, v134, v130, s40
    v_perm_b32 v25, v134, v130, s41
    ds_write_b64 v114, v[24:25] offset:8192
    v_perm_b32 v26, v142, v138, s40
    v_perm_b32 v27, v142, v138, s41
    ds_write_b64 v114, v[26:27] offset:10240
    v_perm_b32 v28, v135, v131, s40
    v_perm_b32 v29, v135, v131, s41
    ds_write_b64 v114, v[28:29] offset:12288
    v_perm_b32 v30, v143, v139, s40
    v_perm_b32 v31, v143, v139, s41
    ds_write_b64 v114, v[30:31] offset:14336
    s_waitcnt lgkmcnt(0)
    s_barrier
    ds_read_b128 a[64:67], v115 offset:0
    ds_read_b128 a[68:71], v115 offset:1024
    ds_read_b128 a[72:75], v115 offset:2048
    ds_read_b128 a[76:79], v115 offset:3072
    s_mov_b32 s43, 0
    buffer_load_dwordx4 v[128:131], v112, s[12:15], s43 offen
    s_mov_b32 s43, 1024
    buffer_load_dwordx4 v[132:135], v112, s[12:15], s43 offen
    s_mov_b32 s43, 2048
    buffer_load_dwordx4 v[136:139], v112, s[12:15], s43 offen
    s_mov_b32 s43, 3072
    buffer_load_dwordx4 v[140:143], v112, s[12:15], s43 offen
    s_waitcnt vmcnt(44)
    v_perm_b32 v24, v148, v144, s40
    v_perm_b32 v25, v148, v144, s41
    ds_write_b64 v114, v[24:25] offset:16384
    v_perm_b32 v26, v156, v152, s40
    v_perm_b32 v27, v156, v152, s41
    ds_write_b64 v114, v[26:27] offset:18432
    v_perm_b32 v28, v149, v145, s40
    v_perm_b32 v29, v149, v145, s41
    ds_write_b64 v114, v[28:29] offset:20480
    v_perm_b32 v30, v157, v153, s40
    v_perm_b32 v31, v157, v153, s41
    ds_write_b64 v114, v[30:31] offset:22528
    v_perm_b32 v24, v150, v146, s40
    v_perm_b32 v25, v150, v146, s41
    ds_write_b64 v114, v[24:25] offset:24576
    v_perm_b32 v26, v158, v154, s40
    v_perm_b32 v27, v158, v154, s41
    ds_write_b64 v114, v[26:27] offset:26624
    v_perm_b32 v28, v151, v147, s40
    v_perm_b32 v29, v151, v147, s41
    ds_write_b64 v114, v[28:29] offset:28672
    v_perm_b32 v30, v159, v155, s40
    v_perm_b32 v31, v159, v155, s41
    ds_write_b64 v114, v[30:31] offset:30720
    s_waitcnt lgkmcnt(0)
    s_barrier
    ds_read_b128 a[80:83], v115 offset:16384
    ds_read_b128 a[84:87], v115 offset:17408
    ds_read_b128 a[88:91], v115 offset:18432
    ds_read_b128 a[92:95], v115 offset:19456
    s_mov_b32 s43, 8192
    buffer_load_dwordx4 v[144:147], v112, s[12:15], s43 offen
    s_mov_b32 s43, 9216
    buffer_load_dwordx4 v[148:151], v112, s[12:15], s43 offen
    s_mov_b32 s43, 10240
    buffer_load_dwordx4 v[152:155], v112, s[12:15], s43 offen
    s_mov_b32 s43, 11264
    buffer_load_dwordx4 v[156:159], v112, s[12:15], s43 offen
    s_waitcnt vmcnt(44)
    v_perm_b32 v24, v164, v160, s40
    v_perm_b32 v25, v164, v160, s41
    ds_write_b64 v114, v[24:25] offset:0
    v_perm_b32 v26, v172, v168, s40
    v_perm_b32 v27, v172, v168, s41
    ds_write_b64 v114, v[26:27] offset:2048
    v_perm_b32 v28, v165, v161, s40
    v_perm_b32 v29, v165, v161, s41
    ds_write_b64 v114, v[28:29] offset:4096
    v_perm_b32 v30, v173, v169, s40
    v_perm_b32 v31, v173, v169, s41
    ds_write_b64 v114, v[30:31] offset:6144
    v_perm_b32 v24, v166, v162, s40
    v_perm_b32 v25, v166, v162, s41
    ds_write_b64 v114, v[24:25] offset:8192
    v_perm_b32 v26, v174, v170, s40
    v_perm_b32 v27, v174, v170, s41
    ds_write_b64 v114, v[26:27] offset:10240
    v_perm_b32 v28, v167, v163, s40
    v_perm_b32 v29, v167, v163, s41
    ds_write_b64 v114, v[28:29] offset:12288
    v_perm_b32 v30, v175, v171, s40
    v_perm_b32 v31, v175, v171, s41
    ds_write_b64 v114, v[30:31] offset:14336
    s_waitcnt lgkmcnt(0)
    s_barrier
    ds_read_b128 a[96:99], v115 offset:0
    ds_read_b128 a[100:103], v115 offset:1024
    ds_read_b128 a[104:107], v115 offset:2048
    ds_read_b128 a[108:111], v115 offset:3072
    s_mov_b32 s43, 65536
    buffer_load_dwordx4 v[160:163], v112, s[12:15], s43 offen
    s_mov_b32 s43, 66560
    buffer_load_dwordx4 v[164:167], v112, s[12:15], s43 offen
    s_mov_b32 s43, 67584
    buffer_load_dwordx4 v[168:171], v112, s[12:15], s43 offen
    s_mov_b32 s43, 68608
    buffer_load_dwordx4 v[172:175], v112, s[12:15], s43 offen
    s_waitcnt vmcnt(44)
    v_perm_b32 v24, v180, v176, s40
    v_perm_b32 v25, v180, v176, s41
    ds_write_b64 v114, v[24:25] offset:16384
    v_perm_b32 v26, v188, v184, s40
    v_perm_b32 v27, v188, v184, s41
    ds_write_b64 v114, v[26:27] offset:18432
    v_perm_b32 v28, v181, v177, s40
    v_perm_b32 v29, v181, v177, s41
    ds_write_b64 v114, v[28:29] offset:20480
    v_perm_b32 v30, v189, v185, s40
    v_perm_b32 v31, v189, v185, s41
    ds_write_b64 v114, v[30:31] offset:22528
    v_perm_b32 v24, v182, v178, s40
    v_perm_b32 v25, v182, v178, s41
    ds_write_b64 v114, v[24:25] offset:24576
    v_perm_b32 v26, v190, v186, s40
    v_perm_b32 v27, v190, v186, s41
    ds_write_b64 v114, v[26:27] offset:26624
    v_perm_b32 v28, v183, v179, s40
    v_perm_b32 v29, v183, v179, s41
    ds_write_b64 v114, v[28:29] offset:28672
    v_perm_b32 v30, v191, v187, s40
    v_perm_b32 v31, v191, v187, s41
    ds_write_b64 v114, v[30:31] offset:30720
    s_waitcnt lgkmcnt(0)
    s_barrier
    ds_read_b128 a[112:115], v115 offset:16384
    ds_read_b128 a[116:119], v115 offset:17408
    ds_read_b128 a[120:123], v115 offset:18432
    ds_read_b128 a[124:127], v115 offset:19456
    s_mov_b32 s43, 73728
    buffer_load_dwordx4 v[176:179], v112, s[12:15], s43 offen
    s_mov_b32 s43, 74752
    buffer_load_dwordx4 v[180:183], v112, s[12:15], s43 offen
    s_mov_b32 s43, 75776
    buffer_load_dwordx4 v[184:187], v112, s[12:15], s43 offen
    s_mov_b32 s43, 76800
    buffer_load_dwordx4 v[188:191], v112, s[12:15], s43 offen
    s_waitcnt vmcnt(44)
    v_perm_b32 v24, v196, v192, s40
    v_perm_b32 v25, v196, v192, s41
    ds_write_b64 v114, v[24:25] offset:0
    v_perm_b32 v26, v204, v200, s40
    v_perm_b32 v27, v204, v200, s41
    ds_write_b64 v114, v[26:27] offset:2048
    v_perm_b32 v28, v197, v193, s40
    v_perm_b32 v29, v197, v193, s41
    ds_write_b64 v114, v[28:29] offset:4096
    v_perm_b32 v30, v205, v201, s40
    v_perm_b32 v31, v205, v201, s41
    ds_write_b64 v114, v[30:31] offset:6144
    v_perm_b32 v24, v198, v194, s40
    v_perm_b32 v25, v198, v194, s41
    ds_write_b64 v114, v[24:25] offset:8192
    v_perm_b32 v26, v206, v202, s40
    v_perm_b32 v27, v206, v202, s41
    ds_write_b64 v114, v[26:27] offset:10240
    v_perm_b32 v28, v199, v195, s40
    v_perm_b32 v29, v199, v195, s41
    ds_write_b64 v114, v[28:29] offset:12288
    v_perm_b32 v30, v207, v203, s40
    v_perm_b32 v31, v207, v203, s41
    ds_write_b64 v114, v[30:31] offset:14336
    s_waitcnt lgkmcnt(0)
    s_barrier
    ds_read_b128 a[128:131], v115 offset:0
    ds_read_b128 a[132:135], v115 offset:1024
    ds_read_b128 a[136:139], v115 offset:2048
    ds_read_b128 a[140:143], v115 offset:3072
    s_mov_b32 s43, 4096
    buffer_load_dwordx4 v[192:195], v112, s[12:15], s43 offen
    s_mov_b32 s43, 5120
    buffer_load_dwordx4 v[196:199], v112, s[12:15], s43 offen
    s_mov_b32 s43, 6144
    buffer_load_dwordx4 v[200:203], v112, s[12:15], s43 offen
    s_mov_b32 s43, 7168
    buffer_load_dwordx4 v[204:207], v112, s[12:15], s43 offen
    s_waitcnt vmcnt(44)
    v_perm_b32 v24, v212, v208, s40
    v_perm_b32 v25, v212, v208, s41
    ds_write_b64 v114, v[24:25] offset:16384
    v_perm_b32 v26, v220, v216, s40
    v_perm_b32 v27, v220, v216, s41
    ds_write_b64 v114, v[26:27] offset:18432
    v_perm_b32 v28, v213, v209, s40
    v_perm_b32 v29, v213, v209, s41
    ds_write_b64 v114, v[28:29] offset:20480
    v_perm_b32 v30, v221, v217, s40
    v_perm_b32 v31, v221, v217, s41
    ds_write_b64 v114, v[30:31] offset:22528
    v_perm_b32 v24, v214, v210, s40
    v_perm_b32 v25, v214, v210, s41
    ds_write_b64 v114, v[24:25] offset:24576
    v_perm_b32 v26, v222, v218, s40
    v_perm_b32 v27, v222, v218, s41
    ds_write_b64 v114, v[26:27] offset:26624
    v_perm_b32 v28, v215, v211, s40
    v_perm_b32 v29, v215, v211, s41
    ds_write_b64 v114, v[28:29] offset:28672
    v_perm_b32 v30, v223, v219, s40
    v_perm_b32 v31, v223, v219, s41
    ds_write_b64 v114, v[30:31] offset:30720
    s_waitcnt lgkmcnt(0)
    s_barrier
    ds_read_b128 a[144:147], v115 offset:16384
    ds_read_b128 a[148:151], v115 offset:17408
    ds_read_b128 a[152:155], v115 offset:18432
    ds_read_b128 a[156:159], v115 offset:19456
    s_mov_b32 s43, 12288
    buffer_load_dwordx4 v[208:211], v112, s[12:15], s43 offen
    s_mov_b32 s43, 13312
    buffer_load_dwordx4 v[212:215], v112, s[12:15], s43 offen
    s_mov_b32 s43, 14336
    buffer_load_dwordx4 v[216:219], v112, s[12:15], s43 offen
    s_mov_b32 s43, 15360
    buffer_load_dwordx4 v[220:223], v112, s[12:15], s43 offen
    s_waitcnt vmcnt(44)
    v_perm_b32 v24, v228, v224, s40
    v_perm_b32 v25, v228, v224, s41
    ds_write_b64 v114, v[24:25] offset:0
    v_perm_b32 v26, v236, v232, s40
    v_perm_b32 v27, v236, v232, s41
    ds_write_b64 v114, v[26:27] offset:2048
    v_perm_b32 v28, v229, v225, s40
    v_perm_b32 v29, v229, v225, s41
    ds_write_b64 v114, v[28:29] offset:4096
    v_perm_b32 v30, v237, v233, s40
    v_perm_b32 v31, v237, v233, s41
    ds_write_b64 v114, v[30:31] offset:6144
    v_perm_b32 v24, v230, v226, s40
    v_perm_b32 v25, v230, v226, s41
    ds_write_b64 v114, v[24:25] offset:8192
    v_perm_b32 v26, v238, v234, s40
    v_perm_b32 v27, v238, v234, s41
    ds_write_b64 v114, v[26:27] offset:10240
    v_perm_b32 v28, v231, v227, s40
    v_perm_b32 v29, v231, v227, s41
    ds_write_b64 v114, v[28:29] offset:12288
    v_perm_b32 v30, v239, v235, s40
    v_perm_b32 v31, v239, v235, s41
    ds_write_b64 v114, v[30:31] offset:14336
    s_waitcnt lgkmcnt(0)
    s_barrier
    ds_read_b128 a[160:163], v115 offset:0
    ds_read_b128 a[164:167], v115 offset:1024
    ds_read_b128 a[168:171], v115 offset:2048
    ds_read_b128 a[172:175], v115 offset:3072
    s_mov_b32 s43, 69632
    buffer_load_dwordx4 v[224:227], v112, s[12:15], s43 offen
    s_mov_b32 s43, 70656
    buffer_load_dwordx4 v[228:231], v112, s[12:15], s43 offen
    s_mov_b32 s43, 71680
    buffer_load_dwordx4 v[232:235], v112, s[12:15], s43 offen
    s_mov_b32 s43, 72704
    buffer_load_dwordx4 v[236:239], v112, s[12:15], s43 offen
    s_waitcnt vmcnt(44)
    v_perm_b32 v24, v244, v240, s40
    v_perm_b32 v25, v244, v240, s41
    ds_write_b64 v114, v[24:25] offset:16384
    v_perm_b32 v26, v252, v248, s40
    v_perm_b32 v27, v252, v248, s41
    ds_write_b64 v114, v[26:27] offset:18432
    v_perm_b32 v28, v245, v241, s40
    v_perm_b32 v29, v245, v241, s41
    ds_write_b64 v114, v[28:29] offset:20480
    v_perm_b32 v30, v253, v249, s40
    v_perm_b32 v31, v253, v249, s41
    ds_write_b64 v114, v[30:31] offset:22528
    v_perm_b32 v24, v246, v242, s40
    v_perm_b32 v25, v246, v242, s41
    ds_write_b64 v114, v[24:25] offset:24576
    v_perm_b32 v26, v254, v250, s40
    v_perm_b32 v27, v254, v250, s41
    ds_write_b64 v114, v[26:27] offset:26624
    v_perm_b32 v28, v247, v243, s40
    v_perm_b32 v29, v247, v243, s41
    ds_write_b64 v114, v[28:29] offset:28672
    v_perm_b32 v30, v255, v251, s40
    v_perm_b32 v31, v255, v251, s41
    ds_write_b64 v114, v[30:31] offset:30720
    s_waitcnt lgkmcnt(0)
    s_barrier
    ds_read_b128 a[176:179], v115 offset:16384
    ds_read_b128 a[180:183], v115 offset:17408
    ds_read_b128 a[184:187], v115 offset:18432
    ds_read_b128 a[188:191], v115 offset:19456
    s_mov_b32 s43, 77824
    buffer_load_dwordx4 v[240:243], v112, s[12:15], s43 offen
    s_mov_b32 s43, 78848
    buffer_load_dwordx4 v[244:247], v112, s[12:15], s43 offen
    s_mov_b32 s43, 79872
    buffer_load_dwordx4 v[248:251], v112, s[12:15], s43 offen
    s_mov_b32 s43, 80896
    buffer_load_dwordx4 v[252:255], v112, s[12:15], s43 offen
    s_waitcnt vmcnt(44)
    v_perm_b32 v24, v36, v32, s40
    v_perm_b32 v25, v36, v32, s41
    ds_write_b64 v114, v[24:25] offset:0
    v_perm_b32 v26, v44, v40, s40
    v_perm_b32 v27, v44, v40, s41
    ds_write_b64 v114, v[26:27] offset:2048
    v_perm_b32 v28, v37, v33, s40
    v_perm_b32 v29, v37, v33, s41
    ds_write_b64 v114, v[28:29] offset:4096
    v_perm_b32 v30, v45, v41, s40
    v_perm_b32 v31, v45, v41, s41
    ds_write_b64 v114, v[30:31] offset:6144
    v_perm_b32 v24, v38, v34, s40
    v_perm_b32 v25, v38, v34, s41
    ds_write_b64 v114, v[24:25] offset:8192
    v_perm_b32 v26, v46, v42, s40
    v_perm_b32 v27, v46, v42, s41
    ds_write_b64 v114, v[26:27] offset:10240
    v_perm_b32 v28, v39, v35, s40
    v_perm_b32 v29, v39, v35, s41
    ds_write_b64 v114, v[28:29] offset:12288
    v_perm_b32 v30, v47, v43, s40
    v_perm_b32 v31, v47, v43, s41
    ds_write_b64 v114, v[30:31] offset:14336
    s_waitcnt lgkmcnt(0)
    s_barrier
    ds_read_b128 a[192:195], v115 offset:0
    ds_read_b128 a[196:199], v115 offset:1024
    ds_read_b128 a[200:203], v115 offset:2048
    ds_read_b128 a[204:207], v115 offset:3072
    s_mov_b32 s4, s28
    s_and_b32 s5, s29, 0xffff
    s_mov_b32 s43, 0
    buffer_load_dwordx4 v[32:35], v113, s[4:7], s43 offen
    s_mov_b32 s43, 65536
    buffer_load_dwordx4 v[36:39], v113, s[4:7], s43 offen
    s_mov_b32 s43, 1048576
    buffer_load_dwordx4 v[40:43], v113, s[4:7], s43 offen
    s_mov_b32 s43, 1114112
    buffer_load_dwordx4 v[44:47], v113, s[4:7], s43 offen
    s_waitcnt vmcnt(44)
    v_perm_b32 v24, v52, v48, s40
    v_perm_b32 v25, v52, v48, s41
    ds_write_b64 v114, v[24:25] offset:16384
    v_perm_b32 v26, v60, v56, s40
    v_perm_b32 v27, v60, v56, s41
    ds_write_b64 v114, v[26:27] offset:18432
    v_perm_b32 v28, v53, v49, s40
    v_perm_b32 v29, v53, v49, s41
    ds_write_b64 v114, v[28:29] offset:20480
    v_perm_b32 v30, v61, v57, s40
    v_perm_b32 v31, v61, v57, s41
    ds_write_b64 v114, v[30:31] offset:22528
    v_perm_b32 v24, v54, v50, s40
    v_perm_b32 v25, v54, v50, s41
    ds_write_b64 v114, v[24:25] offset:24576
    v_perm_b32 v26, v62, v58, s40
    v_perm_b32 v27, v62, v58, s41
    ds_write_b64 v114, v[26:27] offset:26624
    v_perm_b32 v28, v55, v51, s40
    v_perm_b32 v29, v55, v51, s41
    ds_write_b64 v114, v[28:29] offset:28672
    v_perm_b32 v30, v63, v59, s40
    v_perm_b32 v31, v63, v59, s41
    ds_write_b64 v114, v[30:31] offset:30720
    s_waitcnt lgkmcnt(0)
    s_barrier
    ds_read_b128 a[208:211], v115 offset:16384
    ds_read_b128 a[212:215], v115 offset:17408
    ds_read_b128 a[216:219], v115 offset:18432
    ds_read_b128 a[220:223], v115 offset:19456
    s_mov_b32 s43, 2097152
    buffer_load_dwordx4 v[48:51], v113, s[4:7], s43 offen
    s_mov_b32 s43, 2162688
    buffer_load_dwordx4 v[52:55], v113, s[4:7], s43 offen
    s_mov_b32 s43, 3145728
    buffer_load_dwordx4 v[56:59], v113, s[4:7], s43 offen
    s_mov_b32 s43, 3211264
    buffer_load_dwordx4 v[60:63], v113, s[4:7], s43 offen
    s_waitcnt vmcnt(44)
    v_perm_b32 v24, v68, v64, s40
    v_perm_b32 v25, v68, v64, s41
    ds_write_b64 v114, v[24:25] offset:0
    v_perm_b32 v26, v76, v72, s40
    v_perm_b32 v27, v76, v72, s41
    ds_write_b64 v114, v[26:27] offset:2048
    v_perm_b32 v28, v69, v65, s40
    v_perm_b32 v29, v69, v65, s41
    ds_write_b64 v114, v[28:29] offset:4096
    v_perm_b32 v30, v77, v73, s40
    v_perm_b32 v31, v77, v73, s41
    ds_write_b64 v114, v[30:31] offset:6144
    v_perm_b32 v24, v70, v66, s40
    v_perm_b32 v25, v70, v66, s41
    ds_write_b64 v114, v[24:25] offset:8192
    v_perm_b32 v26, v78, v74, s40
    v_perm_b32 v27, v78, v74, s41
    ds_write_b64 v114, v[26:27] offset:10240
    v_perm_b32 v28, v71, v67, s40
    v_perm_b32 v29, v71, v67, s41
    ds_write_b64 v114, v[28:29] offset:12288
    v_perm_b32 v30, v79, v75, s40
    v_perm_b32 v31, v79, v75, s41
    ds_write_b64 v114, v[30:31] offset:14336
    s_waitcnt lgkmcnt(0)
    s_barrier
    ds_read_b128 a[224:227], v115 offset:0
    ds_read_b128 a[228:231], v115 offset:1024
    ds_read_b128 a[232:235], v115 offset:2048
    ds_read_b128 a[236:239], v115 offset:3072
    s_mov_b32 s43, 8192
    buffer_load_dwordx4 v[64:67], v113, s[4:7], s43 offen
    s_mov_b32 s43, 73728
    buffer_load_dwordx4 v[68:71], v113, s[4:7], s43 offen
    s_mov_b32 s43, 1056768
    buffer_load_dwordx4 v[72:75], v113, s[4:7], s43 offen
    s_mov_b32 s43, 1122304
    buffer_load_dwordx4 v[76:79], v113, s[4:7], s43 offen
    s_waitcnt vmcnt(44)
    v_perm_b32 v24, v84, v80, s40
    v_perm_b32 v25, v84, v80, s41
    ds_write_b64 v114, v[24:25] offset:16384
    v_perm_b32 v26, v92, v88, s40
    v_perm_b32 v27, v92, v88, s41
    ds_write_b64 v114, v[26:27] offset:18432
    v_perm_b32 v28, v85, v81, s40
    v_perm_b32 v29, v85, v81, s41
    ds_write_b64 v114, v[28:29] offset:20480
    v_perm_b32 v30, v93, v89, s40
    v_perm_b32 v31, v93, v89, s41
    ds_write_b64 v114, v[30:31] offset:22528
    v_perm_b32 v24, v86, v82, s40
    v_perm_b32 v25, v86, v82, s41
    ds_write_b64 v114, v[24:25] offset:24576
    v_perm_b32 v26, v94, v90, s40
    v_perm_b32 v27, v94, v90, s41
    ds_write_b64 v114, v[26:27] offset:26624
    v_perm_b32 v28, v87, v83, s40
    v_perm_b32 v29, v87, v83, s41
    ds_write_b64 v114, v[28:29] offset:28672
    v_perm_b32 v30, v95, v91, s40
    v_perm_b32 v31, v95, v91, s41
    ds_write_b64 v114, v[30:31] offset:30720
    s_waitcnt lgkmcnt(0)
    s_barrier
    ds_read_b128 a[240:243], v115 offset:16384
    ds_read_b128 a[244:247], v115 offset:17408
    ds_read_b128 a[248:251], v115 offset:18432
    ds_read_b128 a[252:255], v115 offset:19456
    s_mov_b32 s43, 2105344
    buffer_load_dwordx4 v[80:83], v113, s[4:7], s43 offen
    s_mov_b32 s43, 2170880
    buffer_load_dwordx4 v[84:87], v113, s[4:7], s43 offen
    s_mov_b32 s43, 3153920
    buffer_load_dwordx4 v[88:91], v113, s[4:7], s43 offen
    s_mov_b32 s43, 3219456
    buffer_load_dwordx4 v[92:95], v113, s[4:7], s43 offen
    s_waitcnt vmcnt(44)
    v_perm_b32 v24, v132, v128, s40
    v_perm_b32 v25, v134, v130, s40
    ds_write_b64 v9, v[24:25] offset:0
    v_perm_b32 v26, v140, v136, s40
    v_perm_b32 v27, v142, v138, s40
    ds_write_b64 v9, v[26:27] offset:2048
    v_perm_b32 v28, v132, v128, s41
    v_perm_b32 v29, v134, v130, s41
    ds_write_b64 v9, v[28:29] offset:8192
    v_perm_b32 v30, v140, v136, s41
    v_perm_b32 v31, v142, v138, s41
    ds_write_b64 v9, v[30:31] offset:10240
    v_perm_b32 v24, v133, v129, s40
    v_perm_b32 v25, v135, v131, s40
    ds_write_b64 v9, v[24:25] offset:16384
    v_perm_b32 v26, v141, v137, s40
    v_perm_b32 v27, v143, v139, s40
    ds_write_b64 v9, v[26:27] offset:18432
    v_perm_b32 v28, v133, v129, s41
    v_perm_b32 v29, v135, v131, s41
    ds_write_b64 v9, v[28:29] offset:24576
    v_perm_b32 v30, v141, v137, s41
    v_perm_b32 v31, v143, v139, s41
    ds_write_b64 v9, v[30:31] offset:26624
    s_waitcnt vmcnt(40)
    v_perm_b32 v24, v148, v144, s40
    v_perm_b32 v25, v150, v146, s40
    ds_write_b64 v9, v[24:25] offset:8
    v_perm_b32 v26, v156, v152, s40
    v_perm_b32 v27, v158, v154, s40
    ds_write_b64 v9, v[26:27] offset:2056
    v_perm_b32 v28, v148, v144, s41
    v_perm_b32 v29, v150, v146, s41
    ds_write_b64 v9, v[28:29] offset:8200
    v_perm_b32 v30, v156, v152, s41
    v_perm_b32 v31, v158, v154, s41
    ds_write_b64 v9, v[30:31] offset:10248
    v_perm_b32 v24, v149, v145, s40
    v_perm_b32 v25, v151, v147, s40
    ds_write_b64 v9, v[24:25] offset:16392
    v_perm_b32 v26, v157, v153, s40
    v_perm_b32 v27, v159, v155, s40
    ds_write_b64 v9, v[26:27] offset:18440
    v_perm_b32 v28, v149, v145, s41
    v_perm_b32 v29, v151, v147, s41
    ds_write_b64 v9, v[28:29] offset:24584
    v_perm_b32 v30, v157, v153, s41
    v_perm_b32 v31, v159, v155, s41
    ds_write_b64 v9, v[30:31] offset:26632
    s_waitcnt vmcnt(36)
    v_perm_b32 v24, v164, v160, s40
    v_perm_b32 v25, v166, v162, s40
    ds_write_b64 v9, v[24:25] offset:1024
    v_perm_b32 v26, v172, v168, s40
    v_perm_b32 v27, v174, v170, s40
    ds_write_b64 v9, v[26:27] offset:3072
    v_perm_b32 v28, v164, v160, s41
    v_perm_b32 v29, v166, v162, s41
    ds_write_b64 v9, v[28:29] offset:9216
    v_perm_b32 v30, v172, v168, s41
    v_perm_b32 v31, v174, v170, s41
    ds_write_b64 v9, v[30:31] offset:11264
    v_perm_b32 v24, v165, v161, s40
    v_perm_b32 v25, v167, v163, s40
    ds_write_b64 v9, v[24:25] offset:17408
    v_perm_b32 v26, v173, v169, s40
    v_perm_b32 v27, v175, v171, s40
    ds_write_b64 v9, v[26:27] offset:19456
    v_perm_b32 v28, v165, v161, s41
    v_perm_b32 v29, v167, v163, s41
    ds_write_b64 v9, v[28:29] offset:25600
    v_perm_b32 v30, v173, v169, s41
    v_perm_b32 v31, v175, v171, s41
    ds_write_b64 v9, v[30:31] offset:27648
    s_waitcnt vmcnt(32)
    v_perm_b32 v24, v180, v176, s40
    v_perm_b32 v25, v182, v178, s40
    ds_write_b64 v9, v[24:25] offset:1032
    v_perm_b32 v26, v188, v184, s40
    v_perm_b32 v27, v190, v186, s40
    ds_write_b64 v9, v[26:27] offset:3080
    v_perm_b32 v28, v180, v176, s41
    v_perm_b32 v29, v182, v178, s41
    ds_write_b64 v9, v[28:29] offset:9224
    v_perm_b32 v30, v188, v184, s41
    v_perm_b32 v31, v190, v186, s41
    ds_write_b64 v9, v[30:31] offset:11272
    v_perm_b32 v24, v181, v177, s40
    v_perm_b32 v25, v183, v179, s40
    ds_write_b64 v9, v[24:25] offset:17416
    v_perm_b32 v26, v189, v185, s40
    v_perm_b32 v27, v191, v187, s40
    ds_write_b64 v9, v[26:27] offset:19464
    v_perm_b32 v28, v181, v177, s41
    v_perm_b32 v29, v183, v179, s41
    ds_write_b64 v9, v[28:29] offset:25608
    v_perm_b32 v30, v189, v185, s41
    v_perm_b32 v31, v191, v187, s41
    ds_write_b64 v9, v[30:31] offset:27656
    s_waitcnt vmcnt(28)
    v_perm_b32 v24, v196, v192, s40
    v_perm_b32 v25, v198, v194, s40
    ds_write_b64 v9, v[24:25] offset:4096
    v_perm_b32 v26, v204, v200, s40
    v_perm_b32 v27, v206, v202, s40
    ds_write_b64 v9, v[26:27] offset:6144
    v_perm_b32 v28, v196, v192, s41
    v_perm_b32 v29, v198, v194, s41
    ds_write_b64 v9, v[28:29] offset:12288
    v_perm_b32 v30, v204, v200, s41
    v_perm_b32 v31, v206, v202, s41
    ds_write_b64 v9, v[30:31] offset:14336
    v_perm_b32 v24, v197, v193, s40
    v_perm_b32 v25, v199, v195, s40
    ds_write_b64 v9, v[24:25] offset:20480
    v_perm_b32 v26, v205, v201, s40
    v_perm_b32 v27, v207, v203, s40
    ds_write_b64 v9, v[26:27] offset:22528
    v_perm_b32 v28, v197, v193, s41
    v_perm_b32 v29, v199, v195, s41
    ds_write_b64 v9, v[28:29] offset:28672
    v_perm_b32 v30, v205, v201, s41
    v_perm_b32 v31, v207, v203, s41
    ds_write_b64 v9, v[30:31] offset:30720
    s_mov_b32 s43, 16384
    buffer_load_dwordx4 v[192:195], v113, s[4:7], s43 offen
    s_mov_b32 s43, 81920
    buffer_load_dwordx4 v[196:199], v113, s[4:7], s43 offen
    s_mov_b32 s43, 1064960
    buffer_load_dwordx4 v[200:203], v113, s[4:7], s43 offen
    s_mov_b32 s43, 1130496
    buffer_load_dwordx4 v[204:207], v113, s[4:7], s43 offen
    s_waitcnt vmcnt(28)
    v_perm_b32 v24, v212, v208, s40
    v_perm_b32 v25, v214, v210, s40
    ds_write_b64 v9, v[24:25] offset:4104
    v_perm_b32 v26, v220, v216, s40
    v_perm_b32 v27, v222, v218, s40
    ds_write_b64 v9, v[26:27] offset:6152
    v_perm_b32 v28, v212, v208, s41
    v_perm_b32 v29, v214, v210, s41
    ds_write_b64 v9, v[28:29] offset:12296
    v_perm_b32 v30, v220, v216, s41
    v_perm_b32 v31, v222, v218, s41
    ds_write_b64 v9, v[30:31] offset:14344
    v_perm_b32 v24, v213, v209, s40
    v_perm_b32 v25, v215, v211, s40
    ds_write_b64 v9, v[24:25] offset:20488
    v_perm_b32 v26, v221, v217, s40
    v_perm_b32 v27, v223, v219, s40
    ds_write_b64 v9, v[26:27] offset:22536
    v_perm_b32 v28, v213, v209, s41
    v_perm_b32 v29, v215, v211, s41
    ds_write_b64 v9, v[28:29] offset:28680
    v_perm_b32 v30, v221, v217, s41
    v_perm_b32 v31, v223, v219, s41
    ds_write_b64 v9, v[30:31] offset:30728
    s_mov_b32 s43, 2113536
    buffer_load_dwordx4 v[208:211], v113, s[4:7], s43 offen
    s_mov_b32 s43, 2179072
    buffer_load_dwordx4 v[212:215], v113, s[4:7], s43 offen
    s_mov_b32 s43, 3162112
    buffer_load_dwordx4 v[216:219], v113, s[4:7], s43 offen
    s_mov_b32 s43, 3227648
    buffer_load_dwordx4 v[220:223], v113, s[4:7], s43 offen
    s_waitcnt vmcnt(28)
    v_perm_b32 v24, v228, v224, s40
    v_perm_b32 v25, v230, v226, s40
    ds_write_b64 v9, v[24:25] offset:5120
    v_perm_b32 v26, v236, v232, s40
    v_perm_b32 v27, v238, v234, s40
    ds_write_b64 v9, v[26:27] offset:7168
    v_perm_b32 v28, v228, v224, s41
    v_perm_b32 v29, v230, v226, s41
    ds_write_b64 v9, v[28:29] offset:13312
    v_perm_b32 v30, v236, v232, s41
    v_perm_b32 v31, v238, v234, s41
    ds_write_b64 v9, v[30:31] offset:15360
    v_perm_b32 v24, v229, v225, s40
    v_perm_b32 v25, v231, v227, s40
    ds_write_b64 v9, v[24:25] offset:21504
    v_perm_b32 v26, v237, v233, s40
    v_perm_b32 v27, v239, v235, s40
    ds_write_b64 v9, v[26:27] offset:23552
    v_perm_b32 v28, v229, v225, s41
    v_perm_b32 v29, v231, v227, s41
    ds_write_b64 v9, v[28:29] offset:29696
    v_perm_b32 v30, v237, v233, s41
    v_perm_b32 v31, v239, v235, s41
    ds_write_b64 v9, v[30:31] offset:31744
    s_mov_b32 s43, 24576
    buffer_load_dwordx4 v[224:227], v113, s[4:7], s43 offen
    s_mov_b32 s43, 90112
    buffer_load_dwordx4 v[228:231], v113, s[4:7], s43 offen
    s_mov_b32 s43, 1073152
    buffer_load_dwordx4 v[232:235], v113, s[4:7], s43 offen
    s_mov_b32 s43, 1138688
    buffer_load_dwordx4 v[236:239], v113, s[4:7], s43 offen
    s_waitcnt vmcnt(28)
    v_perm_b32 v24, v244, v240, s40
    v_perm_b32 v25, v246, v242, s40
    ds_write_b64 v9, v[24:25] offset:5128
    v_perm_b32 v26, v252, v248, s40
    v_perm_b32 v27, v254, v250, s40
    ds_write_b64 v9, v[26:27] offset:7176
    v_perm_b32 v28, v244, v240, s41
    v_perm_b32 v29, v246, v242, s41
    ds_write_b64 v9, v[28:29] offset:13320
    v_perm_b32 v30, v252, v248, s41
    v_perm_b32 v31, v254, v250, s41
    ds_write_b64 v9, v[30:31] offset:15368
    v_perm_b32 v24, v245, v241, s40
    v_perm_b32 v25, v247, v243, s40
    ds_write_b64 v9, v[24:25] offset:21512
    v_perm_b32 v26, v253, v249, s40
    v_perm_b32 v27, v255, v251, s40
    ds_write_b64 v9, v[26:27] offset:23560
    v_perm_b32 v28, v245, v241, s41
    v_perm_b32 v29, v247, v243, s41
    ds_write_b64 v9, v[28:29] offset:29704
    v_perm_b32 v30, v253, v249, s41
    v_perm_b32 v31, v255, v251, s41
    ds_write_b64 v9, v[30:31] offset:31752
    s_mov_b32 s43, 2121728
    buffer_load_dwordx4 v[240:243], v113, s[4:7], s43 offen
    s_mov_b32 s43, 2187264
    buffer_load_dwordx4 v[244:247], v113, s[4:7], s43 offen
    s_mov_b32 s43, 3170304
    buffer_load_dwordx4 v[248:251], v113, s[4:7], s43 offen
    s_mov_b32 s43, 3235840
    buffer_load_dwordx4 v[252:255], v113, s[4:7], s43 offen
    s_waitcnt vmcnt(28)
    v_perm_b32 v24, v36, v32, s40
    v_perm_b32 v25, v36, v32, s41
    ds_write_b64 v114, v[24:25] offset:0
    v_perm_b32 v26, v44, v40, s40
    v_perm_b32 v27, v44, v40, s41
    ds_write_b64 v114, v[26:27] offset:2048
    v_perm_b32 v28, v37, v33, s40
    v_perm_b32 v29, v37, v33, s41
    ds_write_b64 v114, v[28:29] offset:4096
    v_perm_b32 v30, v45, v41, s40
    v_perm_b32 v31, v45, v41, s41
    ds_write_b64 v114, v[30:31] offset:6144
    v_perm_b32 v24, v38, v34, s40
    v_perm_b32 v25, v38, v34, s41
    ds_write_b64 v114, v[24:25] offset:8192
    v_perm_b32 v26, v46, v42, s40
    v_perm_b32 v27, v46, v42, s41
    ds_write_b64 v114, v[26:27] offset:10240
    v_perm_b32 v28, v39, v35, s40
    v_perm_b32 v29, v39, v35, s41
    ds_write_b64 v114, v[28:29] offset:12288
    v_perm_b32 v30, v47, v43, s40
    v_perm_b32 v31, v47, v43, s41
    ds_write_b64 v114, v[30:31] offset:14336
    s_waitcnt lgkmcnt(0)
    s_barrier
    ds_read_b128 v[128:131], v115 offset:0
    ds_read_b128 v[132:135], v115 offset:1024
    ds_read_b128 v[136:139], v115 offset:2048
    ds_read_b128 v[140:143], v115 offset:3072
    s_waitcnt vmcnt(24)
    v_perm_b32 v24, v52, v48, s40
    v_perm_b32 v25, v52, v48, s41
    ds_write_b64 v114, v[24:25] offset:16384
    v_perm_b32 v26, v60, v56, s40
    v_perm_b32 v27, v60, v56, s41
    ds_write_b64 v114, v[26:27] offset:18432
    v_perm_b32 v28, v53, v49, s40
    v_perm_b32 v29, v53, v49, s41
    ds_write_b64 v114, v[28:29] offset:20480
    v_perm_b32 v30, v61, v57, s40
    v_perm_b32 v31, v61, v57, s41
    ds_write_b64 v114, v[30:31] offset:22528
    v_perm_b32 v24, v54, v50, s40
    v_perm_b32 v25, v54, v50, s41
    ds_write_b64 v114, v[24:25] offset:24576
    v_perm_b32 v26, v62, v58, s40
    v_perm_b32 v27, v62, v58, s41
    ds_write_b64 v114, v[26:27] offset:26624
    v_perm_b32 v28, v55, v51, s40
    v_perm_b32 v29, v55, v51, s41
    ds_write_b64 v114, v[28:29] offset:28672
    v_perm_b32 v30, v63, v59, s40
    v_perm_b32 v31, v63, v59, s41
    ds_write_b64 v114, v[30:31] offset:30720
    s_waitcnt lgkmcnt(0)
    s_barrier
    ds_read_b128 v[144:147], v115 offset:16384
    ds_read_b128 v[148:151], v115 offset:17408
    ds_read_b128 v[152:155], v115 offset:18432
    ds_read_b128 v[156:159], v115 offset:19456
    s_waitcnt vmcnt(20)
    v_perm_b32 v24, v68, v64, s40
    v_perm_b32 v25, v68, v64, s41
    ds_write_b64 v114, v[24:25] offset:0
    v_perm_b32 v26, v76, v72, s40
    v_perm_b32 v27, v76, v72, s41
    ds_write_b64 v114, v[26:27] offset:2048
    v_perm_b32 v28, v69, v65, s40
    v_perm_b32 v29, v69, v65, s41
    ds_write_b64 v114, v[28:29] offset:4096
    v_perm_b32 v30, v77, v73, s40
    v_perm_b32 v31, v77, v73, s41
    ds_write_b64 v114, v[30:31] offset:6144
    v_perm_b32 v24, v70, v66, s40
    v_perm_b32 v25, v70, v66, s41
    ds_write_b64 v114, v[24:25] offset:8192
    v_perm_b32 v26, v78, v74, s40
    v_perm_b32 v27, v78, v74, s41
    ds_write_b64 v114, v[26:27] offset:10240
    v_perm_b32 v28, v71, v67, s40
    v_perm_b32 v29, v71, v67, s41
    ds_write_b64 v114, v[28:29] offset:12288
    v_perm_b32 v30, v79, v75, s40
    v_perm_b32 v31, v79, v75, s41
    ds_write_b64 v114, v[30:31] offset:14336
    s_waitcnt lgkmcnt(0)
    s_barrier
    ds_read_b128 v[160:163], v115 offset:0
    ds_read_b128 v[164:167], v115 offset:1024
    ds_read_b128 v[168:171], v115 offset:2048
    ds_read_b128 v[172:175], v115 offset:3072
    s_waitcnt vmcnt(16)
    v_perm_b32 v24, v84, v80, s40
    v_perm_b32 v25, v84, v80, s41
    ds_write_b64 v114, v[24:25] offset:16384
    v_perm_b32 v26, v92, v88, s40
    v_perm_b32 v27, v92, v88, s41
    ds_write_b64 v114, v[26:27] offset:18432
    v_perm_b32 v28, v85, v81, s40
    v_perm_b32 v29, v85, v81, s41
    ds_write_b64 v114, v[28:29] offset:20480
    v_perm_b32 v30, v93, v89, s40
    v_perm_b32 v31, v93, v89, s41
    ds_write_b64 v114, v[30:31] offset:22528
    v_perm_b32 v24, v86, v82, s40
    v_perm_b32 v25, v86, v82, s41
    ds_write_b64 v114, v[24:25] offset:24576
    v_perm_b32 v26, v94, v90, s40
    v_perm_b32 v27, v94, v90, s41
    ds_write_b64 v114, v[26:27] offset:26624
    v_perm_b32 v28, v87, v83, s40
    v_perm_b32 v29, v87, v83, s41
    ds_write_b64 v114, v[28:29] offset:28672
    v_perm_b32 v30, v95, v91, s40
    v_perm_b32 v31, v95, v91, s41
    ds_write_b64 v114, v[30:31] offset:30720
    buffer_load_ushort v32, v120, s[52:55], 0 offen offset:0
    buffer_load_ushort v33, v120, s[52:55], 0 offen offset:16
    buffer_load_ushort v34, v120, s[52:55], 0 offen offset:32
    buffer_load_ushort v35, v120, s[52:55], 0 offen offset:48
    buffer_load_ushort v36, v120, s[52:55], 0 offen offset:64
    buffer_load_ushort v37, v120, s[52:55], 0 offen offset:80
    buffer_load_ushort v38, v120, s[52:55], 0 offen offset:96
    buffer_load_ushort v39, v120, s[52:55], 0 offen offset:112
    buffer_load_ushort v40, v120, s[52:55], 0 offen offset:256
    buffer_load_ushort v41, v120, s[52:55], 0 offen offset:272
    buffer_load_ushort v42, v120, s[52:55], 0 offen offset:288
    buffer_load_ushort v43, v120, s[52:55], 0 offen offset:304
    buffer_load_ushort v44, v120, s[52:55], 0 offen offset:320
    buffer_load_ushort v45, v120, s[52:55], 0 offen offset:336
    buffer_load_ushort v46, v120, s[52:55], 0 offen offset:352
    buffer_load_ushort v47, v120, s[52:55], 0 offen offset:368
    buffer_load_ushort v48, v120, s[52:55], 0 offen offset:512
    buffer_load_ushort v49, v120, s[52:55], 0 offen offset:528
    buffer_load_ushort v50, v120, s[52:55], 0 offen offset:544
    buffer_load_ushort v51, v120, s[52:55], 0 offen offset:560
    buffer_load_ushort v52, v120, s[52:55], 0 offen offset:576
    buffer_load_ushort v53, v120, s[52:55], 0 offen offset:592
    buffer_load_ushort v54, v120, s[52:55], 0 offen offset:608
    buffer_load_ushort v55, v120, s[52:55], 0 offen offset:624
    buffer_load_ushort v56, v120, s[52:55], 0 offen offset:768
    buffer_load_ushort v57, v120, s[52:55], 0 offen offset:784
    buffer_load_ushort v58, v120, s[52:55], 0 offen offset:800
    buffer_load_ushort v59, v120, s[52:55], 0 offen offset:816
    buffer_load_ushort v60, v120, s[52:55], 0 offen offset:832
    buffer_load_ushort v61, v120, s[52:55], 0 offen offset:848
    buffer_load_ushort v62, v120, s[52:55], 0 offen offset:864
    buffer_load_ushort v63, v120, s[52:55], 0 offen offset:880
    s_lshl_b32 s23, s18, 10
    s_add_u32 s23, s23, 159449088
    s_mov_b64 exec, 15
    v_lshlrev_b32 v0, 3, v2
    buffer_load_dwordx2 v[0:1], v0, s[8:11], s23 offen sc1
    s_mov_b64 exec, -1
    v_mov_b32 v122, 132
    global_load_dword v123, v122, s[16:17] sc1
    s_waitcnt lgkmcnt(0)
    s_barrier
    ds_read_b128 v[176:179], v115 offset:16384
    ds_read_b128 v[180:183], v115 offset:17408
    ds_read_b128 v[184:187], v115 offset:18432
    ds_read_b128 v[188:191], v115 offset:19456
    s_waitcnt vmcnt(46)
    v_perm_b32 v24, v196, v192, s40
    v_perm_b32 v25, v196, v192, s41
    ds_write_b64 v114, v[24:25] offset:0
    v_perm_b32 v26, v204, v200, s40
    v_perm_b32 v27, v204, v200, s41
    ds_write_b64 v114, v[26:27] offset:2048
    v_perm_b32 v28, v197, v193, s40
    v_perm_b32 v29, v197, v193, s41
    ds_write_b64 v114, v[28:29] offset:4096
    v_perm_b32 v30, v205, v201, s40
    v_perm_b32 v31, v205, v201, s41
    ds_write_b64 v114, v[30:31] offset:6144
    v_perm_b32 v24, v198, v194, s40
    v_perm_b32 v25, v198, v194, s41
    ds_write_b64 v114, v[24:25] offset:8192
    v_perm_b32 v26, v206, v202, s40
    v_perm_b32 v27, v206, v202, s41
    ds_write_b64 v114, v[26:27] offset:10240
    v_perm_b32 v28, v199, v195, s40
    v_perm_b32 v29, v199, v195, s41
    ds_write_b64 v114, v[28:29] offset:12288
    v_perm_b32 v30, v207, v203, s40
    v_perm_b32 v31, v207, v203, s41
    ds_write_b64 v114, v[30:31] offset:14336
    s_waitcnt lgkmcnt(0)
    s_barrier
    ds_read_b128 v[192:195], v115 offset:0
    ds_read_b128 v[196:199], v115 offset:1024
    ds_read_b128 v[200:203], v115 offset:2048
    ds_read_b128 v[204:207], v115 offset:3072
    s_waitcnt vmcnt(42)
    v_perm_b32 v24, v212, v208, s40
    v_perm_b32 v25, v212, v208, s41
    ds_write_b64 v114, v[24:25] offset:16384
    v_perm_b32 v26, v220, v216, s40
    v_perm_b32 v27, v220, v216, s41
    ds_write_b64 v114, v[26:27] offset:18432
    v_perm_b32 v28, v213, v209, s40
    v_perm_b32 v29, v213, v209, s41
    ds_write_b64 v114, v[28:29] offset:20480
    v_perm_b32 v30, v221, v217, s40
    v_perm_b32 v31, v221, v217, s41
    ds_write_b64 v114, v[30:31] offset:22528
    v_perm_b32 v24, v214, v210, s40
    v_perm_b32 v25, v214, v210, s41
    ds_write_b64 v114, v[24:25] offset:24576
    v_perm_b32 v26, v222, v218, s40
    v_perm_b32 v27, v222, v218, s41
    ds_write_b64 v114, v[26:27] offset:26624
    v_perm_b32 v28, v215, v211, s40
    v_perm_b32 v29, v215, v211, s41
    ds_write_b64 v114, v[28:29] offset:28672
    v_perm_b32 v30, v223, v219, s40
    v_perm_b32 v31, v223, v219, s41
    ds_write_b64 v114, v[30:31] offset:30720
    s_waitcnt lgkmcnt(0)
    s_barrier
    ds_read_b128 v[208:211], v115 offset:16384
    ds_read_b128 v[212:215], v115 offset:17408
    ds_read_b128 v[216:219], v115 offset:18432
    ds_read_b128 v[220:223], v115 offset:19456
    s_waitcnt vmcnt(38)
    v_perm_b32 v24, v228, v224, s40
    v_perm_b32 v25, v228, v224, s41
    ds_write_b64 v114, v[24:25] offset:0
    v_perm_b32 v26, v236, v232, s40
    v_perm_b32 v27, v236, v232, s41
    ds_write_b64 v114, v[26:27] offset:2048
    v_perm_b32 v28, v229, v225, s40
    v_perm_b32 v29, v229, v225, s41
    ds_write_b64 v114, v[28:29] offset:4096
    v_perm_b32 v30, v237, v233, s40
    v_perm_b32 v31, v237, v233, s41
    ds_write_b64 v114, v[30:31] offset:6144
    v_perm_b32 v24, v230, v226, s40
    v_perm_b32 v25, v230, v226, s41
    ds_write_b64 v114, v[24:25] offset:8192
    v_perm_b32 v26, v238, v234, s40
    v_perm_b32 v27, v238, v234, s41
    ds_write_b64 v114, v[26:27] offset:10240
    v_perm_b32 v28, v231, v227, s40
    v_perm_b32 v29, v231, v227, s41
    ds_write_b64 v114, v[28:29] offset:12288
    v_perm_b32 v30, v239, v235, s40
    v_perm_b32 v31, v239, v235, s41
    ds_write_b64 v114, v[30:31] offset:14336
    s_waitcnt lgkmcnt(0)
    s_barrier
    ds_read_b128 v[224:227], v115 offset:0
    ds_read_b128 v[228:231], v115 offset:1024
    ds_read_b128 v[232:235], v115 offset:2048
    ds_read_b128 v[236:239], v115 offset:3072
    s_waitcnt vmcnt(34)
    v_perm_b32 v24, v244, v240, s40
    v_perm_b32 v25, v244, v240, s41
    ds_write_b64 v114, v[24:25] offset:16384
    v_perm_b32 v26, v252, v248, s40
    v_perm_b32 v27, v252, v248, s41
    ds_write_b64 v114, v[26:27] offset:18432
    v_perm_b32 v28, v245, v241, s40
    v_perm_b32 v29, v245, v241, s41
    ds_write_b64 v114, v[28:29] offset:20480
    v_perm_b32 v30, v253, v249, s40
    v_perm_b32 v31, v253, v249, s41
    ds_write_b64 v114, v[30:31] offset:22528
    v_perm_b32 v24, v246, v242, s40
    v_perm_b32 v25, v246, v242, s41
    ds_write_b64 v114, v[24:25] offset:24576
    v_perm_b32 v26, v254, v250, s40
    v_perm_b32 v27, v254, v250, s41
    ds_write_b64 v114, v[26:27] offset:26624
    v_perm_b32 v28, v247, v243, s40
    v_perm_b32 v29, v247, v243, s41
    ds_write_b64 v114, v[28:29] offset:28672
    v_perm_b32 v30, v255, v251, s40
    v_perm_b32 v31, v255, v251, s41
    ds_write_b64 v114, v[30:31] offset:30720
    s_waitcnt lgkmcnt(0)
    s_barrier
    ds_read_b128 v[240:243], v115 offset:16384
    ds_read_b128 v[244:247], v115 offset:17408
    ds_read_b128 v[248:251], v115 offset:18432
    ds_read_b128 v[252:255], v115 offset:19456
    s_waitcnt vmcnt(0)
    v_lshl_or_b32 v96, v33, 16, v32
    v_lshl_or_b32 v97, v35, 16, v34
    v_lshl_or_b32 v98, v37, 16, v36
    v_lshl_or_b32 v99, v39, 16, v38
    v_lshl_or_b32 v100, v41, 16, v40
    v_lshl_or_b32 v101, v43, 16, v42
    v_lshl_or_b32 v102, v45, 16, v44
    v_lshl_or_b32 v103, v47, 16, v46
    v_lshl_or_b32 v104, v49, 16, v48
    v_lshl_or_b32 v105, v51, 16, v50
    v_lshl_or_b32 v106, v53, 16, v52
    v_lshl_or_b32 v107, v55, 16, v54
    v_lshl_or_b32 v108, v57, 16, v56
    v_lshl_or_b32 v109, v59, 16, v58
    v_lshl_or_b32 v110, v61, 16, v60
    v_lshl_or_b32 v111, v63, 16, v62
    s_waitcnt lgkmcnt(0)
    s_barrier
    ds_write_b128 v3, v[116:119] offset:31168
    s_lshl_b32 s22, s18, 7
    s_add_u32 s22, s22, 147062784
    s_mov_b64 exec, 15
    v_cmp_ne_u64 vcc, s[62:63], v[0:1]
    s_mov_b64 exec, -1
    s_nop 3
    s_cbranch_vccz Lk0_8
    s_mov_b64 exec, 15
Lkv_9:
    v_lshlrev_b32 v0, 3, v2
    buffer_load_dwordx2 v[0:1], v0, s[8:11], s23 offen sc1
    s_waitcnt vmcnt(0)
    v_cmp_ne_u64 vcc, s[62:63], v[0:1]
    s_nop 4
    s_cbranch_vccz Lkvd_10
    s_sleep 2
    s_sub_u32 s21, s21, 1
    s_cbranch_scc0 Lkv_9
    s_mov_b32 s21, 0
Lkvd_10:
    s_mov_b64 exec, -1
Lk0_8:
    v_readfirstlane_b32 s45, v123
    s_lshl_b32 s42, s19, 11
    s_add_u32 s42, s42, 139264
    s_mov_b32 m0, s42
    s_mov_b32 s34, 20971520
    s_mov_b32 s35, 20979712
    buffer_load_dwordx4 v13, s[8:11], s34 offen sc1 lds
    buffer_load_dwordx4 v13, s[8:11], s34 offen offset:1024 sc1 lds
    buffer_load_dwordx4 v[112:115], v13, s[8:11], s35 offen sc1
    buffer_load_dwordx4 v[116:119], v13, s[8:11], s35 offen offset:1024 sc1
    v_mov_b32 v22, 132
    s_cmp_ge_u32 s45, 32
    s_nop 0
    s_cbranch_scc1 Lawd_12
Law_11:
    global_load_dword v23, v22, s[16:17] sc1
    s_sub_u32 s21, s21, 1
    s_waitcnt vmcnt(0)
    v_readfirstlane_b32 s44, v23
    s_cmp_eq_u32 s21, 0
    s_nop 3
    s_cbranch_scc1 Lawd_12
    s_cmp_lt_u32 s44, 32
    s_cbranch_scc1 Law_11
Lawd_12:
    v_mov_b32 v22, v10
    v_mov_b32 v23, v11
    v_mov_b32 v10, v22
    v_mov_b32 v11, v23
    v_mov_b64 v[56:57], 0
    v_mov_b64 v[58:59], 0
    v_mov_b64 v[60:61], 0
    v_mov_b64 v[62:63], 0
    v_mov_b64 v[64:65], 0
    v_mov_b64 v[66:67], 0
    v_mov_b64 v[68:69], 0
    v_mov_b64 v[70:71], 0
    v_mov_b64 v[72:73], 0
    v_mov_b64 v[74:75], 0
    v_mov_b64 v[76:77], 0
    v_mov_b64 v[78:79], 0
    s_mov_b32 s20, 0
    s_mov_b32 s36, 54525952
    s_mov_b32 s37, 150994944
    s_mov_b32 s57, 0
    s_mov_b32 s58, 0
    s_mov_b32 s59, 0
    s_mov_b32 s56, 0
    s_mov_b32 s54, 0
    s_mov_b32 s52, 0
    v_mov_b32 v15, -1
    s_cmp_eq_u32 s19, 1
    s_nop 0
    s_cbranch_scc1 Lentry1_22
    s_cmp_eq_u32 s19, 2
    s_cbranch_scc1 Lentry2_23
    s_cmp_eq_u32 s19, 3
    s_cbranch_scc1 Lentry3_24
main_kernel_loop:
Lentry0_21:
    v_mov_b64 v[24:25], v[96:97]
    v_mov_b64 v[26:27], v[98:99]
    v_mov_b64 v[28:29], v[100:101]
    v_mov_b64 v[30:31], v[102:103]
    v_mov_b64 v[32:33], v[104:105]
    v_mov_b64 v[34:35], v[106:107]
    v_mov_b64 v[36:37], v[108:109]
    v_mov_b64 v[38:39], v[110:111]
    ds_write_b128 v7, v[24:27] offset:0
    ds_write_b128 v7, v[28:31] offset:512
    ds_write_b128 v7, v[32:35] offset:1024
    ds_write_b128 v7, v[36:39] offset:1536
    s_add_u32 s34, s34, 16384
    s_mov_b32 m0, 147456
    s_add_u32 s35, s35, 16384
    s_waitcnt vmcnt(0) lgkmcnt(0)
    s_branch Lb1_30
Lstep00_13:
    ds_write_b128 v3, v[88:91] offset:0
    ds_write_b128 v3, v[92:95] offset:1024
    s_add_u32 s34, s34, 16384
    s_mov_b32 m0, 147456
    s_add_u32 s35, s35, 16384
    s_waitcnt vmcnt(2)
    ds_read_b128 v[24:27], v7 offset:0
    ds_read_b128 v[28:31], v7 offset:512
    ds_read_b128 v[32:35], v7 offset:1024
    ds_read_b128 v[36:39], v7 offset:1536
    s_waitcnt lgkmcnt(4)
Lb1_30:
    s_barrier
    v_mov_b64 v[72:73], s[62:63]
    v_mov_b64 v[74:75], s[62:63]
    s_mov_b64 exec, 0xff
    buffer_store_dwordx4 v[72:75], v2, s[8:11], s22 offen sc1
    s_mov_b64 exec, -1
    s_add_u32 s22, s22, 4096
    ds_read_b128 v[40:43], v7 offset:2048
    ds_read_b128 v[44:47], v7 offset:2560
    s_waitcnt lgkmcnt(5)
    v_smfmac_f32_16x16x64_bf16 v[56:59], v[24:27], a[0:7], v8
    ds_read_b128 v[48:51], v7 offset:3072
    v_smfmac_f32_16x16x64_bf16 v[60:63], v[24:27], a[128:135], v8
    ds_read_b128 v[52:55], v7 offset:3584
    s_waitcnt lgkmcnt(6)
    v_smfmac_f32_16x16x64_bf16 v[56:59], v[28:31], a[8:15], v8
    ds_read_b128 v[80:83], v7 offset:4096
    v_smfmac_f32_16x16x64_bf16 v[60:63], v[28:31], a[136:143], v8
    ds_read_b128 v[84:87], v7 offset:4608
    s_waitcnt vmcnt(1)
    s_waitcnt lgkmcnt(6)
    v_smfmac_f32_16x16x64_bf16 v[56:59], v[32:35], a[16:23], v8
    ds_read_b128 v[88:91], v7 offset:5120
    v_smfmac_f32_16x16x64_bf16 v[60:63], v[32:35], a[144:151], v8
    ds_read_b128 v[92:95], v7 offset:5632
    v_smfmac_f32_16x16x64_bf16 v[56:59], v[36:39], a[24:31], v8
    v_smfmac_f32_16x16x64_bf16 v[60:63], v[36:39], a[152:159], v8
    s_waitcnt lgkmcnt(7)
    v_smfmac_f32_16x16x64_bf16 v[56:59], v[40:43], a[32:39], v8
    ds_read_b128 v[96:99], v7 offset:6144
    v_smfmac_f32_16x16x64_bf16 v[60:63], v[40:43], a[160:167], v8
    s_waitcnt lgkmcnt(7)
    v_smfmac_f32_16x16x64_bf16 v[56:59], v[44:47], a[40:47], v8
    ds_read_b128 v[100:103], v7 offset:6656
    v_smfmac_f32_16x16x64_bf16 v[60:63], v[44:47], a[168:175], v8
    s_waitcnt lgkmcnt(7)
    v_smfmac_f32_16x16x64_bf16 v[56:59], v[48:51], a[48:55], v8
    ds_read_b128 v[104:107], v7 offset:7168
    v_smfmac_f32_16x16x64_bf16 v[60:63], v[48:51], a[176:183], v8
    s_waitcnt lgkmcnt(7)
    v_smfmac_f32_16x16x64_bf16 v[56:59], v[52:55], a[56:63], v8
    ds_read_b128 v[108:111], v7 offset:7680
    v_smfmac_f32_16x16x64_bf16 v[60:63], v[52:55], a[184:191], v8
    s_waitcnt lgkmcnt(6)
    v_smfmac_f32_16x16x64_bf16 v[56:59], v[80:83], a[64:71], v8
    v_smfmac_f32_16x16x64_bf16 v[60:63], v[80:83], a[192:199], v8
    buffer_load_dwordx4 v13, s[8:11], s34 offen sc1 lds
    v_smfmac_f32_16x16x64_bf16 v[56:59], v[84:87], a[72:79], v8
    v_smfmac_f32_16x16x64_bf16 v[60:63], v[84:87], a[200:207], v8
    buffer_load_dwordx4 v13, s[8:11], s34 offen offset:1024 sc1 lds
    s_waitcnt lgkmcnt(4)
    v_smfmac_f32_16x16x64_bf16 v[56:59], v[88:91], a[80:87], v8
    v_smfmac_f32_16x16x64_bf16 v[60:63], v[88:91], a[208:215], v8
    buffer_load_dwordx4 v[120:123], v13, s[8:11], s35 offen sc1
    v_smfmac_f32_16x16x64_bf16 v[56:59], v[92:95], a[88:95], v8
    v_smfmac_f32_16x16x64_bf16 v[60:63], v[92:95], a[216:223], v8
    buffer_load_dwordx4 v[124:127], v13, s[8:11], s35 offen offset:1024 sc1
    s_waitcnt lgkmcnt(2)
    v_smfmac_f32_16x16x64_bf16 v[56:59], v[96:99], a[96:103], v8
    v_smfmac_f32_16x16x64_bf16 v[60:63], v[96:99], a[224:231], v8
    v_smfmac_f32_16x16x64_bf16 v[56:59], v[100:103], a[104:111], v8
    v_smfmac_f32_16x16x64_bf16 v[60:63], v[100:103], a[232:239], v8
    s_waitcnt lgkmcnt(0)
    v_smfmac_f32_16x16x64_bf16 v[56:59], v[104:107], a[112:119], v8
    v_smfmac_f32_16x16x64_bf16 v[60:63], v[104:107], a[240:247], v8
    v_smfmac_f32_16x16x64_bf16 v[56:59], v[108:111], a[120:127], v8
    v_smfmac_f32_16x16x64_bf16 v[60:63], v[108:111], a[248:255], v8
    v_smfmac_f32_16x16x64_bf16 v[64:67], v[96:99], v[224:231], v8
    s_nop 0
    v_smfmac_f32_16x16x64_bf16 v[64:67], v[100:103], v[232:239], v8
    s_nop 0
    v_smfmac_f32_16x16x64_bf16 v[64:67], v[104:107], v[240:247], v8
    ds_read_b128 v[96:99], v3 offset:8192
    ds_read_b128 v[100:103], v3 offset:9216
    v_permlane32_swap_b32 v56, v58
    v_permlane32_swap_b32 v57, v59
    v_permlane32_swap_b32 v60, v62
    v_permlane32_swap_b32 v61, v63
    v_cvt_pk_bf16_f32 v56, v56, v58
    v_cvt_pk_bf16_f32 v57, v57, v59
    ds_write2_b32 v4, v56, v57 offset0:0 offset1:136
    v_cvt_pk_bf16_f32 v60, v60, v62
    v_cvt_pk_bf16_f32 v61, v61, v63
    ds_write2_b32 v4, v60, v61 offset0:64 offset1:200
    v_smfmac_f32_16x16x64_bf16 v[64:67], v[108:111], v[248:255], v8
    ds_read_b128 v[104:107], v3 offset:10240
    v_smfmac_f32_16x16x64_bf16 v[64:67], v[80:83], v[192:199], v8
    ds_read_b128 v[108:111], v3 offset:11264
    v_smfmac_f32_16x16x64_bf16 v[64:67], v[84:87], v[200:207], v8
    v_smfmac_f32_16x16x64_bf16 v[64:67], v[88:91], v[208:215], v8
    v_smfmac_f32_16x16x64_bf16 v[64:67], v[92:95], v[216:223], v8
    s_waitcnt lgkmcnt(2)
    s_barrier
    ds_read_b128 v[80:83], v5 offset:0
    ds_read_b128 v[84:87], v5 offset:64
    v_smfmac_f32_16x16x64_bf16 v[64:67], v[24:27], v[128:135], v8
    ds_read_b128 v[88:91], v5 offset:128
    v_smfmac_f32_16x16x64_bf16 v[64:67], v[28:31], v[136:143], v8
    ds_read_b128 v[92:95], v5 offset:192
    v_smfmac_f32_16x16x64_bf16 v[64:67], v[32:35], v[144:151], v8
    ds_read_b128 v[24:27], v3 offset:12288
    v_smfmac_f32_16x16x64_bf16 v[64:67], v[36:39], v[152:159], v8
    ds_read_b128 v[28:31], v3 offset:13312
    s_waitcnt lgkmcnt(5)
    v_mfma_f32_16x16x32_bf16 v[56:59], v[96:99], v[80:83], 0
    ds_read_b128 v[32:35], v3 offset:14336
    s_waitcnt lgkmcnt(5)
    v_mfma_f32_16x16x32_bf16 v[56:59], v[100:103], v[84:87], v[56:59]
    ds_read_b128 v[36:39], v3 offset:15360
    v_smfmac_f32_16x16x64_bf16 v[64:67], v[40:43], v[160:167], v8
    s_waitcnt lgkmcnt(5)
    v_mfma_f32_16x16x32_bf16 v[56:59], v[104:107], v[88:91], v[56:59]
    ds_read_b128 v[40:43], v5 offset:256
    v_smfmac_f32_16x16x64_bf16 v[64:67], v[44:47], v[168:175], v8
    s_waitcnt lgkmcnt(5)
    v_mfma_f32_16x16x32_bf16 v[56:59], v[108:111], v[92:95], v[56:59]
    ds_read_b128 v[44:47], v5 offset:320
    v_smfmac_f32_16x16x64_bf16 v[64:67], v[48:51], v[176:183], v8
    ds_read_b128 v[96:99], v9 offset:12288
    v_smfmac_f32_16x16x64_bf16 v[64:67], v[52:55], v[184:191], v8
    ds_read_b128 v[48:51], v5 offset:384
    s_waitcnt lgkmcnt(4)
    v_mfma_f32_16x16x32_bf16 v[60:63], v[24:27], v[80:83], 0
    ds_read_b128 v[52:55], v5 offset:448
    v_mfma_f32_16x16x32_bf16 v[60:63], v[28:31], v[84:87], v[60:63]
    ds_read_b128 v[100:103], v9 offset:13312
    v_mfma_f32_16x16x32_bf16 v[60:63], v[32:35], v[88:91], v[60:63]
    ds_read_b128 v[104:107], v9 offset:14336
    v_mfma_f32_16x16x32_bf16 v[60:63], v[36:39], v[92:95], v[60:63]
    ds_read_b128 v[108:111], v9 offset:15360
    s_waitcnt lgkmcnt(3)
    v_mfma_f32_16x16x32_bf16 v[68:71], v[40:43], v[80:83], 0
    ds_read_b128 v[24:27], v9 offset:0
    v_max3_f32 v22, v56, v57, v58
    v_cvt_pk_bf16_f32 v64, v64, v65
    v_mfma_f32_16x16x32_bf16 v[68:71], v[44:47], v[84:87], v[68:71]
    ds_read_b128 v[28:31], v9 offset:1024
    v_cvt_pk_bf16_f32 v65, v66, v67
    buffer_store_dwordx4 v[40:43], v14, s[8:11], s36 offen sc1
    v_mfma_f32_16x16x32_bf16 v[68:71], v[48:51], v[88:91], v[68:71]
    ds_read_b128 v[32:35], v9 offset:2048
    v_lshrrev_b32 v72, 1, v14
    buffer_store_dwordx2 v[64:65], v72, s[8:11], s37 offen sc1
    v_mfma_f32_16x16x32_bf16 v[68:71], v[52:55], v[92:95], v[68:71]
    ds_read_b128 v[36:39], v9 offset:3072
    v_max3_f32 v23, v59, v60, v61
    v_max3_f32 v22, v22, v62, v63
    ds_read_b128 v[80:83], v9 offset:8192
    ds_read_b128 v[84:87], v9 offset:9216
    ds_read_b128 v[88:91], v9 offset:10240
    s_and_b32 s42, s20, 7
    s_cmp_lg_u32 s42, 6
    s_cbranch_scc1 Lkvn_31
    s_add_u32 s23, s23, 32768
    s_mov_b64 exec, 15
    v_lshlrev_b32 v0, 3, v2
    buffer_load_dwordx2 v[0:1], v0, s[8:11], s23 offen sc1
    s_mov_b64 exec, -1
Lkvn_31:
    s_nop 1
    v_max3_f32 v23, v23, v68, v69
    v_max3_f32 v22, v22, v70, v71
    v_max_f32 v22, v22, v23
    v_mov_b32 v23, v22
    ds_read_b128 v[92:95], v9 offset:11264
    ds_read_b128 v[40:43], v9 offset:4096
    v_permlane16_swap_b32 v22, v23
    v_max_f32 v22, v22, v23
    v_mov_b32 v23, v22
    s_nop 1
    s_nop 0
    v_permlane32_swap_b32 v22, v23
    v_max_f32 v22, v22, v23
    v_mul_f32 v22, s38, v22
    v_pk_fma_f32 v[56:57], v[56:57], s[38:39], v[22:23] op_sel_hi:[1,0,0] neg_lo:[0,0,1] neg_hi:[0,0,1]
    v_pk_fma_f32 v[58:59], v[58:59], s[38:39], v[22:23] op_sel_hi:[1,0,0] neg_lo:[0,0,1] neg_hi:[0,0,1]
    v_pk_fma_f32 v[60:61], v[60:61], s[38:39], v[22:23] op_sel_hi:[1,0,0] neg_lo:[0,0,1] neg_hi:[0,0,1]
    v_pk_fma_f32 v[62:63], v[62:63], s[38:39], v[22:23] op_sel_hi:[1,0,0] neg_lo:[0,0,1] neg_hi:[0,0,1]
    v_pk_fma_f32 v[68:69], v[68:69], s[38:39], v[22:23] op_sel_hi:[1,0,0] neg_lo:[0,0,1] neg_hi:[0,0,1]
    v_pk_fma_f32 v[70:71], v[70:71], s[38:39], v[22:23] op_sel_hi:[1,0,0] neg_lo:[0,0,1] neg_hi:[0,0,1]
    v_exp_f32 v56, v56
    v_exp_f32 v57, v57
    v_exp_f32 v58, v58
    v_exp_f32 v59, v59
    v_exp_f32 v60, v60
    v_exp_f32 v61, v61
    v_exp_f32 v62, v62
    v_exp_f32 v63, v63
    v_exp_f32 v68, v68
    v_exp_f32 v69, v69
    v_exp_f32 v70, v70
    v_exp_f32 v71, v71
    v_cvt_pk_bf16_f32 v56, v56, v57
    v_cvt_pk_bf16_f32 v57, v58, v59
    v_cvt_pk_bf16_f32 v58, v60, v61
    v_cvt_pk_bf16_f32 v59, v62, v63
    v_cvt_pk_bf16_f32 v68, v68, v69
    v_cvt_pk_bf16_f32 v69, v70, v71
    v_mfma_f32_16x16x32_bf16 v[76:79], v[16:19], v[56:59], 0
    s_mov_b32 exec_hi, 0
    v_mov_b64 v[20:21], v[68:69]
    v_mov_b64 v[68:69], 0
    s_mov_b32 exec_hi, -1
    ds_read_b128 v[44:47], v9 offset:5120
    v_mfma_f32_16x16x32_bf16 v[60:63], v[112:115], v[56:59], 0
    ds_read_b128 v[48:51], v9 offset:6144
    v_mfma_f32_16x16x32_bf16 v[72:75], v[116:119], v[56:59], 0
    ds_read_b128 v[52:55], v9 offset:7168
    v_mfma_f32_16x16x16_bf16 v[76:79], v[16:17], v[20:21], v[76:79]
    v_mov_b64 v[112:113], 0
    v_mov_b64 v[114:115], 0
    v_mfma_f32_16x16x16_bf16 v[60:63], v[64:65], v[20:21], v[60:63]
    v_mov_b64 v[116:117], 0
    v_mfma_f32_16x16x16_bf16 v[72:75], v[64:65], v[68:69], v[72:75]
    v_mov_b64 v[118:119], 0
    s_nop 1
    v_rcp_f32 v22, v76
    s_nop 1
    v_pk_mul_f32 v[60:61], v[60:61], v[22:23] op_sel_hi:[1,0]
    v_pk_mul_f32 v[62:63], v[62:63], v[22:23] op_sel_hi:[1,0]
    v_pk_mul_f32 v[72:73], v[72:73], v[22:23] op_sel_hi:[1,0]
    v_pk_mul_f32 v[74:75], v[74:75], v[22:23] op_sel_hi:[1,0]
    v_cvt_pk_bf16_f32 v56, v60, v72
    v_cvt_pk_bf16_f32 v57, v61, v73
    v_cvt_pk_bf16_f32 v58, v62, v74
    v_cvt_pk_bf16_f32 v59, v63, v75
    ds_write_b128 v6, v[56:59] offset:0
    v_mov_b64 v[60:61], 0
    v_mov_b64 v[62:63], 0
    s_waitcnt lgkmcnt(0)
    s_barrier
    ds_read_b128 v[64:67], v6 offset:0
    ds_read_b128 v[68:71], v6 offset:64
    ds_read_b128 v[72:75], v6 offset:128
    ds_read_b128 v[76:79], v6 offset:192
    v_mov_b64 v[56:57], 0
    v_mov_b64 v[58:59], 0
    s_waitcnt lgkmcnt(3)
    v_smfmac_f32_16x16x64_bf16 v[112:115], v[64:67], v[24:31], v8
    s_waitcnt lgkmcnt(2)
    v_smfmac_f32_16x16x64_bf16 v[112:115], v[68:71], v[32:39], v8
    ds_read_b128 v[24:27], v9 offset:16384
    s_waitcnt lgkmcnt(2)
    v_smfmac_f32_16x16x64_bf16 v[112:115], v[72:75], v[40:47], v8
    ds_read_b128 v[28:31], v9 offset:17408
    ds_read_b128 v[32:35], v9 offset:18432
    s_waitcnt lgkmcnt(3)
    v_smfmac_f32_16x16x64_bf16 v[112:115], v[76:79], v[48:55], v8
    ds_read_b128 v[36:39], v9 offset:19456
    v_smfmac_f32_16x16x64_bf16 v[116:119], v[64:67], v[80:87], v8
    ds_read_b128 v[40:43], v9 offset:20480
    ds_read_b128 v[44:47], v9 offset:21504
    v_smfmac_f32_16x16x64_bf16 v[116:119], v[68:71], v[88:95], v8
    ds_read_b128 v[48:51], v9 offset:22528
    v_smfmac_f32_16x16x64_bf16 v[116:119], v[72:75], v[96:103], v8
    ds_read_b128 v[52:55], v9 offset:23552
    ds_read_b128 v[80:83], v9 offset:24576
    v_smfmac_f32_16x16x64_bf16 v[116:119], v[76:79], v[104:111], v8
    ds_read_b128 v[84:87], v9 offset:25600
    v_cvt_pk_bf16_f32 v112, v112, v113
    v_cvt_pk_bf16_f32 v113, v114, v115
    s_waitcnt lgkmcnt(6)
    v_smfmac_f32_16x16x64_bf16 v[60:63], v[64:67], v[24:31], v8
    ds_read_b128 v[88:91], v9 offset:26624
    v_and_b32 v112, -2, v112
    buffer_store_dwordx2 v[112:113], v10, s[8:11], s64 offen
    v_smfmac_f32_16x16x64_bf16 v[60:63], v[68:71], v[32:39], v8
    ds_read_b128 v[92:95], v9 offset:27648
    ds_read_b128 v[96:99], v9 offset:28672
    s_waitcnt lgkmcnt(5)
    v_smfmac_f32_16x16x64_bf16 v[60:63], v[72:75], v[40:47], v8
    ds_read_b128 v[100:103], v9 offset:29696
    v_cvt_pk_bf16_f32 v116, v116, v117
    v_cvt_pk_bf16_f32 v117, v118, v119
    v_smfmac_f32_16x16x64_bf16 v[60:63], v[76:79], v[48:55], v8
    ds_read_b128 v[104:107], v9 offset:30720
    ds_read_b128 v[108:111], v9 offset:31744
    v_and_b32 v116, -2, v116
    buffer_store_dwordx2 v[116:117], v10, s[8:11], s65 offen
    s_waitcnt lgkmcnt(4)
    v_smfmac_f32_16x16x64_bf16 v[56:59], v[64:67], v[80:87], v8
    ds_read_b128 v[48:51], v3 offset:31168
    v_smfmac_f32_16x16x64_bf16 v[56:59], v[68:71], v[88:95], v8
    s_waitcnt lgkmcnt(1)
    v_smfmac_f32_16x16x64_bf16 v[56:59], v[72:75], v[96:103], v8
    v_cvt_pk_bf16_f32 v60, v60, v61
    v_cvt_pk_bf16_f32 v61, v62, v63
    v_smfmac_f32_16x16x64_bf16 v[56:59], v[76:79], v[104:111], v8
    v_and_b32 v60, -2, v60
    buffer_store_dwordx2 v[60:61], v10, s[8:11], s66 offen
    s_nop 5
    v_cvt_pk_bf16_f32 v56, v56, v57
    v_cvt_pk_bf16_f32 v57, v58, v59
    v_and_b32 v56, -2, v56
    buffer_store_dwordx2 v[56:57], v10, s[8:11], s67 offen
    v_mov_b64 v[64:65], 0
    v_mov_b64 v[66:67], 0
    v_mov_b64 v[60:61], 0
    v_mov_b64 v[62:63], 0
    v_mov_b64 v[58:59], 0
    v_mov_b64 v[56:57], 0
    s_waitcnt vmcnt(3)
    buffer_load_dwordx4 v[24:27], v11, s[8:11], s50 offen offset:0 sc1
    buffer_load_dwordx4 v[28:31], v11, s[8:11], s50 offen offset:1024 sc1
    s_waitcnt vmcnt(4)
    buffer_load_dwordx4 v[32:35], v11, s[8:11], s50 offen offset:0 sc1
    buffer_load_dwordx4 v[36:39], v11, s[8:11], s50 offen offset:1024 sc1
    s_waitcnt lgkmcnt(0)
Lp1_33:
    s_waitcnt vmcnt(2)
    v_mfma_f32_16x16x32_bf16 v[80:83], v[48:51], v[24:27], 0
    v_or3_b32 v88, v24, v26, v28
    v_mfma_f32_16x16x32_bf16 v[80:83], v[48:51], v[28:31], v[80:83]
    v_bitop3_b32 v88, v88, v30, 1 bitop3:0xa8
    v_cmp_ne_u32 vcc, 0, v88
    s_cbranch_vccz Lp1k_34
    s_nop 0
    s_mov_b64 exec, vcc
    buffer_load_dwordx4 v[24:27], v11, s[8:11], s50 offen offset:0 sc1
    buffer_load_dwordx4 v[28:31], v11, s[8:11], s50 offen offset:1024 sc1
    s_mov_b64 exec, -1
    s_waitcnt vmcnt(2)
    v_mfma_f32_16x16x32_bf16 v[80:83], v[48:51], v[32:35], 0
    v_or3_b32 v88, v32, v34, v36
    v_mfma_f32_16x16x32_bf16 v[80:83], v[48:51], v[36:39], v[80:83]
    v_bitop3_b32 v88, v88, v38, 1 bitop3:0xa8
    v_cmp_ne_u32 vcc, 0, v88
    s_cbranch_vccz Lp1k_35
    s_nop 0
    s_mov_b64 exec, vcc
    buffer_load_dwordx4 v[32:35], v11, s[8:11], s50 offen offset:0 sc1
    buffer_load_dwordx4 v[36:39], v11, s[8:11], s50 offen offset:1024 sc1
    s_mov_b64 exec, -1
    s_sub_u32 s21, s21, 1
    s_cbranch_scc0 Lp1_33
Lp1k_34:
Lp1k_35:
    buffer_store_dword v15, v12, s[8:11], s48 offen
    s_nop 3
    v_add_f32_dpp v80, v80, v80 row_ror:4 row_mask:0xf bank_mask:0xf
    v_add_f32_dpp v81, v81, v81 row_ror:4 row_mask:0xf bank_mask:0xf
    s_nop 0
    v_add_f32_dpp v80, v80, v80 row_ror:8 row_mask:0xf bank_mask:0xf
    v_add_f32_dpp v81, v81, v81 row_ror:8 row_mask:0xf bank_mask:0xf
    v_cvt_pk_bf16_f32 v83, v80, v81
    v_min_u32 v83, -2, v83
    buffer_store_dword v83, v12, s[8:11], s49 offen
    s_max_i32 s21, s21, 0
    s_add_u32 s20, s20, 1
    s_add_u32 s36, s36, 8192
    s_add_u32 s37, s37, 2048
    s_waitcnt vmcnt(1)
    buffer_load_dwordx4 v[88:91], v3, s[8:11], s61 offen offset:0 sc1
    buffer_load_dwordx4 v[92:95], v3, s[8:11], s61 offen offset:1024 sc1
    s_waitcnt vmcnt(2)
Lp2_36:
    buffer_load_dwordx4 v[88:91], v3, s[8:11], s61 offen offset:0 sc1
    buffer_load_dwordx4 v[92:95], v3, s[8:11], s61 offen offset:1024 sc1
    s_mov_b64 exec, -1
    s_waitcnt vmcnt(2)
    v_max3_u32 v80, v88, v89, v90
    v_max3_u32 v81, v91, v92, v93
    v_max3_u32 v80, v80, v94, v95
    v_max_u32 v80, v80, v81
    v_cmp_eq_u32 vcc, -1, v80
    s_nop 4
    s_cbranch_vccz Lstep01_14
    s_mov_b64 exec, vcc
    s_sub_u32 s21, s21, 1
    s_cbranch_scc0 Lp2_36
    s_mov_b64 exec, -1
    s_mov_b32 s21, 0
Lstep01_14:
    ds_write_b128 v3, v[88:91] offset:0
    ds_write_b128 v3, v[92:95] offset:1024
    s_add_u32 s34, s34, 16384
    s_mov_b32 m0, 139264
    s_add_u32 s35, s35, 16384
    s_waitcnt vmcnt(2)
    ds_read_b128 v[24:27], v7 offset:0
    ds_read_b128 v[28:31], v7 offset:512
    ds_read_b128 v[32:35], v7 offset:1024
    ds_read_b128 v[36:39], v7 offset:1536
    s_waitcnt lgkmcnt(4)
    s_barrier
    v_mov_b64 v[72:73], s[62:63]
    v_mov_b64 v[74:75], s[62:63]
    s_mov_b64 exec, 0xff
    buffer_store_dwordx4 v[72:75], v2, s[8:11], s22 offen sc1
    s_mov_b64 exec, -1
    s_add_u32 s22, s22, 4096
    s_and_b32 s42, s20, 7
    s_cmp_lg_u32 s42, 7
    s_cbranch_scc1 Lkvok_37
    s_cmp_eq_u32 s20, 63
    s_cbranch_scc1 Lkvok_37
    s_mov_b64 exec, 15
    v_cmp_ne_u64 vcc, s[62:63], v[0:1]
    s_mov_b64 exec, -1
    s_nop 3
    s_cbranch_vccz Lkvok_37
    s_mov_b64 exec, 15
Lkv_38:
    v_lshlrev_b32 v0, 3, v2
    buffer_load_dwordx2 v[0:1], v0, s[8:11], s23 offen sc1
    s_waitcnt vmcnt(0)
    v_cmp_ne_u64 vcc, s[62:63], v[0:1]
    s_nop 4
    s_cbranch_vccz Lkvd_39
    s_sleep 2
    s_sub_u32 s21, s21, 1
    s_cbranch_scc0 Lkv_38
    s_mov_b32 s21, 0
Lkvd_39:
    s_mov_b64 exec, -1
Lkvok_37:
    ds_read_b128 v[40:43], v7 offset:2048
    ds_read_b128 v[44:47], v7 offset:2560
    s_waitcnt lgkmcnt(5)
    v_smfmac_f32_16x16x64_bf16 v[56:59], v[24:27], a[0:7], v8
    ds_read_b128 v[48:51], v7 offset:3072
    v_smfmac_f32_16x16x64_bf16 v[60:63], v[24:27], a[128:135], v8
    ds_read_b128 v[52:55], v7 offset:3584
    s_waitcnt lgkmcnt(6)
    v_smfmac_f32_16x16x64_bf16 v[56:59], v[28:31], a[8:15], v8
    ds_read_b128 v[80:83], v7 offset:4096
    v_smfmac_f32_16x16x64_bf16 v[60:63], v[28:31], a[136:143], v8
    ds_read_b128 v[84:87], v7 offset:4608
    s_waitcnt vmcnt(1)
    s_waitcnt lgkmcnt(6)
    v_smfmac_f32_16x16x64_bf16 v[56:59], v[32:35], a[16:23], v8
    ds_read_b128 v[88:91], v7 offset:5120
    v_smfmac_f32_16x16x64_bf16 v[60:63], v[32:35], a[144:151], v8
    ds_read_b128 v[92:95], v7 offset:5632
    v_smfmac_f32_16x16x64_bf16 v[56:59], v[36:39], a[24:31], v8
    v_smfmac_f32_16x16x64_bf16 v[60:63], v[36:39], a[152:159], v8
    s_waitcnt lgkmcnt(7)
    v_smfmac_f32_16x16x64_bf16 v[56:59], v[40:43], a[32:39], v8
    ds_read_b128 v[96:99], v7 offset:6144
    v_smfmac_f32_16x16x64_bf16 v[60:63], v[40:43], a[160:167], v8
    s_waitcnt lgkmcnt(7)
    v_smfmac_f32_16x16x64_bf16 v[56:59], v[44:47], a[40:47], v8
    ds_read_b128 v[100:103], v7 offset:6656
    v_smfmac_f32_16x16x64_bf16 v[60:63], v[44:47], a[168:175], v8
    s_waitcnt lgkmcnt(7)
    v_smfmac_f32_16x16x64_bf16 v[56:59], v[48:51], a[48:55], v8
    ds_read_b128 v[104:107], v7 offset:7168
    v_smfmac_f32_16x16x64_bf16 v[60:63], v[48:51], a[176:183], v8
    s_waitcnt lgkmcnt(7)
    v_smfmac_f32_16x16x64_bf16 v[56:59], v[52:55], a[56:63], v8
    ds_read_b128 v[108:111], v7 offset:7680
    v_smfmac_f32_16x16x64_bf16 v[60:63], v[52:55], a[184:191], v8
    s_waitcnt lgkmcnt(6)
    v_smfmac_f32_16x16x64_bf16 v[56:59], v[80:83], a[64:71], v8
    v_smfmac_f32_16x16x64_bf16 v[60:63], v[80:83], a[192:199], v8
    buffer_load_dwordx4 v13, s[8:11], s34 offen sc1 lds
    v_smfmac_f32_16x16x64_bf16 v[56:59], v[84:87], a[72:79], v8
    v_smfmac_f32_16x16x64_bf16 v[60:63], v[84:87], a[200:207], v8
    buffer_load_dwordx4 v13, s[8:11], s34 offen offset:1024 sc1 lds
    s_waitcnt lgkmcnt(4)
    v_smfmac_f32_16x16x64_bf16 v[56:59], v[88:91], a[80:87], v8
    v_smfmac_f32_16x16x64_bf16 v[60:63], v[88:91], a[208:215], v8
    buffer_load_dwordx4 v[112:115], v13, s[8:11], s35 offen sc1
    v_smfmac_f32_16x16x64_bf16 v[56:59], v[92:95], a[88:95], v8
    v_smfmac_f32_16x16x64_bf16 v[60:63], v[92:95], a[216:223], v8
    buffer_load_dwordx4 v[116:119], v13, s[8:11], s35 offen offset:1024 sc1
    s_waitcnt lgkmcnt(2)
    v_smfmac_f32_16x16x64_bf16 v[56:59], v[96:99], a[96:103], v8
    v_smfmac_f32_16x16x64_bf16 v[60:63], v[96:99], a[224:231], v8
    v_smfmac_f32_16x16x64_bf16 v[56:59], v[100:103], a[104:111], v8
    v_smfmac_f32_16x16x64_bf16 v[60:63], v[100:103], a[232:239], v8
    s_waitcnt lgkmcnt(0)
    v_smfmac_f32_16x16x64_bf16 v[56:59], v[104:107], a[112:119], v8
    v_smfmac_f32_16x16x64_bf16 v[60:63], v[104:107], a[240:247], v8
    v_smfmac_f32_16x16x64_bf16 v[56:59], v[108:111], a[120:127], v8
    v_smfmac_f32_16x16x64_bf16 v[60:63], v[108:111], a[248:255], v8
    v_smfmac_f32_16x16x64_bf16 v[64:67], v[96:99], v[224:231], v8
    s_nop 0
    v_smfmac_f32_16x16x64_bf16 v[64:67], v[100:103], v[232:239], v8
    s_nop 0
    v_smfmac_f32_16x16x64_bf16 v[64:67], v[104:107], v[240:247], v8
    ds_read_b128 v[96:99], v3 offset:16384
    ds_read_b128 v[100:103], v3 offset:17408
    v_permlane32_swap_b32 v56, v58
    v_permlane32_swap_b32 v57, v59
    v_permlane32_swap_b32 v60, v62
    v_permlane32_swap_b32 v61, v63
    v_cvt_pk_bf16_f32 v56, v56, v58
    v_cvt_pk_bf16_f32 v57, v57, v59
    ds_write2_b32 v4, v56, v57 offset0:0 offset1:136
    v_cvt_pk_bf16_f32 v60, v60, v62
    v_cvt_pk_bf16_f32 v61, v61, v63
    ds_write2_b32 v4, v60, v61 offset0:64 offset1:200
    v_smfmac_f32_16x16x64_bf16 v[64:67], v[108:111], v[248:255], v8
    ds_read_b128 v[104:107], v3 offset:18432
    v_smfmac_f32_16x16x64_bf16 v[64:67], v[80:83], v[192:199], v8
    ds_read_b128 v[108:111], v3 offset:19456
    v_smfmac_f32_16x16x64_bf16 v[64:67], v[84:87], v[200:207], v8
    v_smfmac_f32_16x16x64_bf16 v[64:67], v[88:91], v[208:215], v8
    v_smfmac_f32_16x16x64_bf16 v[64:67], v[92:95], v[216:223], v8
    s_waitcnt lgkmcnt(2)
    s_barrier
    ds_read_b128 v[80:83], v5 offset:0
    ds_read_b128 v[84:87], v5 offset:64
    v_smfmac_f32_16x16x64_bf16 v[64:67], v[24:27], v[128:135], v8
    ds_read_b128 v[88:91], v5 offset:128
    v_smfmac_f32_16x16x64_bf16 v[64:67], v[28:31], v[136:143], v8
    ds_read_b128 v[92:95], v5 offset:192
    v_smfmac_f32_16x16x64_bf16 v[64:67], v[32:35], v[144:151], v8
    ds_read_b128 v[24:27], v3 offset:20480
    v_smfmac_f32_16x16x64_bf16 v[64:67], v[36:39], v[152:159], v8
    ds_read_b128 v[28:31], v3 offset:21504
    s_waitcnt lgkmcnt(5)
    v_mfma_f32_16x16x32_bf16 v[56:59], v[96:99], v[80:83], 0
    ds_read_b128 v[32:35], v3 offset:22528
    s_waitcnt lgkmcnt(5)
    v_mfma_f32_16x16x32_bf16 v[56:59], v[100:103], v[84:87], v[56:59]
    ds_read_b128 v[36:39], v3 offset:23552
    v_smfmac_f32_16x16x64_bf16 v[64:67], v[40:43], v[160:167], v8
    s_waitcnt lgkmcnt(5)
    v_mfma_f32_16x16x32_bf16 v[56:59], v[104:107], v[88:91], v[56:59]
    ds_read_b128 v[40:43], v5 offset:256
    v_smfmac_f32_16x16x64_bf16 v[64:67], v[44:47], v[168:175], v8
    s_waitcnt lgkmcnt(5)
    v_mfma_f32_16x16x32_bf16 v[56:59], v[108:111], v[92:95], v[56:59]
    ds_read_b128 v[44:47], v5 offset:320
    v_smfmac_f32_16x16x64_bf16 v[64:67], v[48:51], v[176:183], v8
    ds_read_b128 v[96:99], v9 offset:12288
    v_smfmac_f32_16x16x64_bf16 v[64:67], v[52:55], v[184:191], v8
    ds_read_b128 v[48:51], v5 offset:384
    s_waitcnt lgkmcnt(4)
    v_mfma_f32_16x16x32_bf16 v[60:63], v[24:27], v[80:83], 0
    ds_read_b128 v[52:55], v5 offset:448
    v_mfma_f32_16x16x32_bf16 v[60:63], v[28:31], v[84:87], v[60:63]
    ds_read_b128 v[100:103], v9 offset:13312
    v_mfma_f32_16x16x32_bf16 v[60:63], v[32:35], v[88:91], v[60:63]
    ds_read_b128 v[104:107], v9 offset:14336
    v_mfma_f32_16x16x32_bf16 v[60:63], v[36:39], v[92:95], v[60:63]
    ds_read_b128 v[108:111], v9 offset:15360
    s_waitcnt lgkmcnt(3)
    v_mfma_f32_16x16x32_bf16 v[68:71], v[40:43], v[80:83], 0
    ds_read_b128 v[24:27], v9 offset:0
    v_max3_f32 v22, v56, v57, v58
    v_cvt_pk_bf16_f32 v64, v64, v65
    v_mfma_f32_16x16x32_bf16 v[68:71], v[44:47], v[84:87], v[68:71]
    ds_read_b128 v[28:31], v9 offset:1024
    v_cvt_pk_bf16_f32 v65, v66, v67
    buffer_store_dwordx4 v[40:43], v14, s[8:11], s36 offen sc1
    v_mfma_f32_16x16x32_bf16 v[68:71], v[48:51], v[88:91], v[68:71]
    ds_read_b128 v[32:35], v9 offset:2048
    v_lshrrev_b32 v72, 1, v14
    buffer_store_dwordx2 v[64:65], v72, s[8:11], s37 offen sc1
    v_mfma_f32_16x16x32_bf16 v[68:71], v[52:55], v[92:95], v[68:71]
    ds_read_b128 v[36:39], v9 offset:3072
    v_max3_f32 v23, v59, v60, v61
    v_max3_f32 v22, v22, v62, v63
    ds_read_b128 v[80:83], v9 offset:8192
    ds_read_b128 v[84:87], v9 offset:9216
    ds_read_b128 v[88:91], v9 offset:10240
    s_cmp_eq_u32 s20, 63
    s_cbranch_scc1 Ldone_25
    s_nop 0
    v_max3_f32 v23, v23, v68, v69
    v_max3_f32 v22, v22, v70, v71
    v_max_f32 v22, v22, v23
    v_mov_b32 v23, v22
    ds_read_b128 v[92:95], v9 offset:11264
    ds_read_b128 v[40:43], v9 offset:4096
    v_permlane16_swap_b32 v22, v23
    v_max_f32 v22, v22, v23
    v_mov_b32 v23, v22
    s_nop 1
    s_nop 0
    v_permlane32_swap_b32 v22, v23
    v_max_f32 v22, v22, v23
    v_mul_f32 v22, s38, v22
    v_pk_fma_f32 v[56:57], v[56:57], s[38:39], v[22:23] op_sel_hi:[1,0,0] neg_lo:[0,0,1] neg_hi:[0,0,1]
    v_pk_fma_f32 v[58:59], v[58:59], s[38:39], v[22:23] op_sel_hi:[1,0,0] neg_lo:[0,0,1] neg_hi:[0,0,1]
    v_pk_fma_f32 v[60:61], v[60:61], s[38:39], v[22:23] op_sel_hi:[1,0,0] neg_lo:[0,0,1] neg_hi:[0,0,1]
    v_pk_fma_f32 v[62:63], v[62:63], s[38:39], v[22:23] op_sel_hi:[1,0,0] neg_lo:[0,0,1] neg_hi:[0,0,1]
    v_pk_fma_f32 v[68:69], v[68:69], s[38:39], v[22:23] op_sel_hi:[1,0,0] neg_lo:[0,0,1] neg_hi:[0,0,1]
    v_pk_fma_f32 v[70:71], v[70:71], s[38:39], v[22:23] op_sel_hi:[1,0,0] neg_lo:[0,0,1] neg_hi:[0,0,1]
    v_exp_f32 v56, v56
    v_exp_f32 v57, v57
    v_exp_f32 v58, v58
    v_exp_f32 v59, v59
    v_exp_f32 v60, v60
    v_exp_f32 v61, v61
    v_exp_f32 v62, v62
    v_exp_f32 v63, v63
    v_exp_f32 v68, v68
    v_exp_f32 v69, v69
    v_exp_f32 v70, v70
    v_exp_f32 v71, v71
    v_cvt_pk_bf16_f32 v56, v56, v57
    v_cvt_pk_bf16_f32 v57, v58, v59
    v_cvt_pk_bf16_f32 v58, v60, v61
    v_cvt_pk_bf16_f32 v59, v62, v63
    v_cvt_pk_bf16_f32 v68, v68, v69
    v_cvt_pk_bf16_f32 v69, v70, v71
    v_mfma_f32_16x16x32_bf16 v[76:79], v[16:19], v[56:59], 0
    s_mov_b32 exec_hi, 0
    v_mov_b64 v[20:21], v[68:69]
    v_mov_b64 v[68:69], 0
    s_mov_b32 exec_hi, -1
    ds_read_b128 v[44:47], v9 offset:5120
    v_mfma_f32_16x16x32_bf16 v[60:63], v[120:123], v[56:59], 0
    ds_read_b128 v[48:51], v9 offset:6144
    v_mfma_f32_16x16x32_bf16 v[72:75], v[124:127], v[56:59], 0
    ds_read_b128 v[52:55], v9 offset:7168
    v_mfma_f32_16x16x16_bf16 v[76:79], v[16:17], v[20:21], v[76:79]
    v_mov_b64 v[120:121], 0
    v_mov_b64 v[122:123], 0
    v_mfma_f32_16x16x16_bf16 v[60:63], v[64:65], v[20:21], v[60:63]
    v_mov_b64 v[124:125], 0
    v_mfma_f32_16x16x16_bf16 v[72:75], v[64:65], v[68:69], v[72:75]
    v_mov_b64 v[126:127], 0
    s_nop 1
    v_rcp_f32 v22, v76
    s_nop 1
    v_pk_mul_f32 v[60:61], v[60:61], v[22:23] op_sel_hi:[1,0]
    v_pk_mul_f32 v[62:63], v[62:63], v[22:23] op_sel_hi:[1,0]
    v_pk_mul_f32 v[72:73], v[72:73], v[22:23] op_sel_hi:[1,0]
    v_pk_mul_f32 v[74:75], v[74:75], v[22:23] op_sel_hi:[1,0]
    v_cvt_pk_bf16_f32 v56, v60, v72
    v_cvt_pk_bf16_f32 v57, v61, v73
    v_cvt_pk_bf16_f32 v58, v62, v74
    v_cvt_pk_bf16_f32 v59, v63, v75
    ds_write_b128 v6, v[56:59] offset:0
    v_mov_b64 v[60:61], 0
    v_mov_b64 v[62:63], 0
    s_waitcnt lgkmcnt(0)
    s_barrier
    ds_read_b128 v[64:67], v6 offset:0
    ds_read_b128 v[68:71], v6 offset:64
    ds_read_b128 v[72:75], v6 offset:128
    ds_read_b128 v[76:79], v6 offset:192
    v_mov_b64 v[56:57], 0
    v_mov_b64 v[58:59], 0
    s_waitcnt lgkmcnt(3)
    v_smfmac_f32_16x16x64_bf16 v[120:123], v[64:67], v[24:31], v8
    s_waitcnt lgkmcnt(2)
    v_smfmac_f32_16x16x64_bf16 v[120:123], v[68:71], v[32:39], v8
    ds_read_b128 v[24:27], v9 offset:16384
    s_waitcnt lgkmcnt(2)
    v_smfmac_f32_16x16x64_bf16 v[120:123], v[72:75], v[40:47], v8
    ds_read_b128 v[28:31], v9 offset:17408
    ds_read_b128 v[32:35], v9 offset:18432
    s_waitcnt lgkmcnt(3)
    v_smfmac_f32_16x16x64_bf16 v[120:123], v[76:79], v[48:55], v8
    ds_read_b128 v[36:39], v9 offset:19456
    v_smfmac_f32_16x16x64_bf16 v[124:127], v[64:67], v[80:87], v8
    ds_read_b128 v[40:43], v9 offset:20480
    ds_read_b128 v[44:47], v9 offset:21504
    v_smfmac_f32_16x16x64_bf16 v[124:127], v[68:71], v[88:95], v8
    ds_read_b128 v[48:51], v9 offset:22528
    v_smfmac_f32_16x16x64_bf16 v[124:127], v[72:75], v[96:103], v8
    ds_read_b128 v[52:55], v9 offset:23552
    ds_read_b128 v[80:83], v9 offset:24576
    v_smfmac_f32_16x16x64_bf16 v[124:127], v[76:79], v[104:111], v8
    ds_read_b128 v[84:87], v9 offset:25600
    v_cvt_pk_bf16_f32 v120, v120, v121
    v_cvt_pk_bf16_f32 v121, v122, v123
    s_waitcnt lgkmcnt(6)
    v_smfmac_f32_16x16x64_bf16 v[60:63], v[64:67], v[24:31], v8
    ds_read_b128 v[88:91], v9 offset:26624
    v_or_b32 v120, 1, v120
    buffer_store_dwordx2 v[120:121], v10, s[8:11], s64 offen
    v_smfmac_f32_16x16x64_bf16 v[60:63], v[68:71], v[32:39], v8
    ds_read_b128 v[92:95], v9 offset:27648
    ds_read_b128 v[96:99], v9 offset:28672
    s_waitcnt lgkmcnt(5)
    v_smfmac_f32_16x16x64_bf16 v[60:63], v[72:75], v[40:47], v8
    ds_read_b128 v[100:103], v9 offset:29696
    v_cvt_pk_bf16_f32 v124, v124, v125
    v_cvt_pk_bf16_f32 v125, v126, v127
    v_smfmac_f32_16x16x64_bf16 v[60:63], v[76:79], v[48:55], v8
    ds_read_b128 v[104:107], v9 offset:30720
    ds_read_b128 v[108:111], v9 offset:31744
    v_or_b32 v124, 1, v124
    buffer_store_dwordx2 v[124:125], v10, s[8:11], s65 offen
    s_waitcnt lgkmcnt(4)
    v_smfmac_f32_16x16x64_bf16 v[56:59], v[64:67], v[80:87], v8
    ds_read_b128 v[48:51], v3 offset:31168
    v_smfmac_f32_16x16x64_bf16 v[56:59], v[68:71], v[88:95], v8
    s_waitcnt lgkmcnt(1)
    v_smfmac_f32_16x16x64_bf16 v[56:59], v[72:75], v[96:103], v8
    v_cvt_pk_bf16_f32 v60, v60, v61
    v_cvt_pk_bf16_f32 v61, v62, v63
    v_smfmac_f32_16x16x64_bf16 v[56:59], v[76:79], v[104:111], v8
    v_or_b32 v60, 1, v60
    buffer_store_dwordx2 v[60:61], v10, s[8:11], s66 offen
    s_nop 5
    v_cvt_pk_bf16_f32 v56, v56, v57
    v_cvt_pk_bf16_f32 v57, v58, v59
    v_or_b32 v56, 1, v56
    buffer_store_dwordx2 v[56:57], v10, s[8:11], s67 offen
    v_mov_b64 v[64:65], 0
    v_mov_b64 v[66:67], 0
    v_mov_b64 v[60:61], 0
    v_mov_b64 v[62:63], 0
    v_mov_b64 v[58:59], 0
    v_mov_b64 v[56:57], 0
    s_waitcnt vmcnt(3)
    buffer_load_dwordx4 v[24:27], v11, s[8:11], s50 offen offset:0 sc1
    buffer_load_dwordx4 v[28:31], v11, s[8:11], s50 offen offset:1024 sc1
    s_waitcnt vmcnt(4)
    buffer_load_dwordx4 v[32:35], v11, s[8:11], s50 offen offset:0 sc1
    buffer_load_dwordx4 v[36:39], v11, s[8:11], s50 offen offset:1024 sc1
    s_waitcnt lgkmcnt(0)
Lp1_41:
    s_waitcnt vmcnt(2)
    v_mfma_f32_16x16x32_bf16 v[80:83], v[48:51], v[24:27], 0
    v_bitop3_b32 v88, v24, v26, v28 bitop3:0x80
    v_mfma_f32_16x16x32_bf16 v[80:83], v[48:51], v[28:31], v[80:83]
    v_bitop3_b32 v88, v88, v30, 1 bitop3:0x2a
    v_cmp_ne_u32 vcc, 0, v88
    s_cbranch_vccz Lp1k_42
    s_nop 0
    s_mov_b64 exec, vcc
    buffer_load_dwordx4 v[24:27], v11, s[8:11], s50 offen offset:0 sc1
    buffer_load_dwordx4 v[28:31], v11, s[8:11], s50 offen offset:1024 sc1
    s_mov_b64 exec, -1
    s_waitcnt vmcnt(2)
    v_mfma_f32_16x16x32_bf16 v[80:83], v[48:51], v[32:35], 0
    v_bitop3_b32 v88, v32, v34, v36 bitop3:0x80
    v_mfma_f32_16x16x32_bf16 v[80:83], v[48:51], v[36:39], v[80:83]
    v_bitop3_b32 v88, v88, v38, 1 bitop3:0x2a
    v_cmp_ne_u32 vcc, 0, v88
    s_cbranch_vccz Lp1k_43
    s_nop 0
    s_mov_b64 exec, vcc
    buffer_load_dwordx4 v[32:35], v11, s[8:11], s50 offen offset:0 sc1
    buffer_load_dwordx4 v[36:39], v11, s[8:11], s50 offen offset:1024 sc1
    s_mov_b64 exec, -1
    s_sub_u32 s21, s21, 1
    s_cbranch_scc0 Lp1_41
Lp1k_42:
Lp1k_43:
    buffer_store_dword v15, v12, s[8:11], s49 offen
    s_nop 3
    v_add_f32_dpp v80, v80, v80 row_ror:4 row_mask:0xf bank_mask:0xf
    v_add_f32_dpp v81, v81, v81 row_ror:4 row_mask:0xf bank_mask:0xf
    s_nop 0
    v_add_f32_dpp v80, v80, v80 row_ror:8 row_mask:0xf bank_mask:0xf
    v_add_f32_dpp v81, v81, v81 row_ror:8 row_mask:0xf bank_mask:0xf
    v_cvt_pk_bf16_f32 v83, v80, v81
    v_min_u32 v83, -2, v83
    buffer_store_dword v83, v12, s[8:11], s48 offen
    s_max_i32 s21, s21, 0
    s_add_u32 s20, s20, 1
    s_add_u32 s36, s36, 8192
    s_add_u32 s37, s37, 2048
    s_waitcnt vmcnt(1)
    buffer_load_dwordx4 v[88:91], v3, s[8:11], s60 offen offset:0 sc1
    buffer_load_dwordx4 v[92:95], v3, s[8:11], s60 offen offset:1024 sc1
    s_waitcnt vmcnt(2)
Lp2_44:
    buffer_load_dwordx4 v[88:91], v3, s[8:11], s60 offen offset:0 sc1
    buffer_load_dwordx4 v[92:95], v3, s[8:11], s60 offen offset:1024 sc1
    s_mov_b64 exec, -1
    s_waitcnt vmcnt(2)
    v_max3_u32 v80, v88, v89, v90
    v_max3_u32 v81, v91, v92, v93
    v_max3_u32 v80, v80, v94, v95
    v_max_u32 v80, v80, v81
    v_cmp_eq_u32 vcc, -1, v80
    s_nop 4
    s_cbranch_vccz Lstep00_13
    s_mov_b64 exec, vcc
    s_sub_u32 s21, s21, 1
    s_cbranch_scc0 Lp2_44
    s_mov_b64 exec, -1
    s_mov_b32 s21, 0
    s_branch Lstep00_13
Lentry1_22:
    v_mov_b64 v[24:25], v[96:97]
    v_mov_b64 v[26:27], v[98:99]
    v_mov_b64 v[28:29], v[100:101]
    v_mov_b64 v[30:31], v[102:103]
    v_mov_b64 v[32:33], v[104:105]
    v_mov_b64 v[34:35], v[106:107]
    v_mov_b64 v[36:37], v[108:109]
    v_mov_b64 v[38:39], v[110:111]
    ds_write_b128 v7, v[24:27] offset:2048
    ds_write_b128 v7, v[28:31] offset:2560
    ds_write_b128 v7, v[32:35] offset:3072
    ds_write_b128 v7, v[36:39] offset:3584
    s_add_u32 s34, s34, 16384
    s_mov_b32 m0, 149504
    s_add_u32 s35, s35, 16384
    s_waitcnt vmcnt(0) lgkmcnt(0)
    s_branch Lb1_45
Lstep10_15:
    ds_write_b128 v3, v[88:91] offset:2048
    ds_write_b128 v3, v[92:95] offset:3072
    s_add_u32 s34, s34, 16384
    s_mov_b32 m0, 149504
    s_add_u32 s35, s35, 16384
    s_waitcnt vmcnt(2)
    ds_read_b128 v[24:27], v7 offset:2048
    ds_read_b128 v[28:31], v7 offset:2560
    ds_read_b128 v[32:35], v7 offset:3072
    ds_read_b128 v[36:39], v7 offset:3584
    s_waitcnt lgkmcnt(4)
Lb1_45:
    s_barrier
    ds_read_b128 v[40:43], v7 offset:4096
    ds_read_b128 v[44:47], v7 offset:4608
    s_waitcnt lgkmcnt(5)
    v_smfmac_f32_16x16x64_bf16 v[56:59], v[24:27], a[32:39], v8
    ds_read_b128 v[48:51], v7 offset:5120
    v_smfmac_f32_16x16x64_bf16 v[60:63], v[24:27], a[160:167], v8
    ds_read_b128 v[52:55], v7 offset:5632
    s_waitcnt lgkmcnt(6)
    v_smfmac_f32_16x16x64_bf16 v[56:59], v[28:31], a[40:47], v8
    ds_read_b128 v[80:83], v7 offset:6144
    v_smfmac_f32_16x16x64_bf16 v[60:63], v[28:31], a[168:175], v8
    ds_read_b128 v[84:87], v7 offset:6656
    s_waitcnt vmcnt(0)
    s_waitcnt lgkmcnt(6)
    v_smfmac_f32_16x16x64_bf16 v[56:59], v[32:35], a[48:55], v8
    ds_read_b128 v[88:91], v7 offset:7168
    v_smfmac_f32_16x16x64_bf16 v[60:63], v[32:35], a[176:183], v8
    ds_read_b128 v[92:95], v7 offset:7680
    v_smfmac_f32_16x16x64_bf16 v[56:59], v[36:39], a[56:63], v8
    v_smfmac_f32_16x16x64_bf16 v[60:63], v[36:39], a[184:191], v8
    s_waitcnt lgkmcnt(7)
    v_smfmac_f32_16x16x64_bf16 v[56:59], v[40:43], a[64:71], v8
    ds_read_b128 v[96:99], v7 offset:0
    v_smfmac_f32_16x16x64_bf16 v[60:63], v[40:43], a[192:199], v8
    s_waitcnt lgkmcnt(7)
    v_smfmac_f32_16x16x64_bf16 v[56:59], v[44:47], a[72:79], v8
    ds_read_b128 v[100:103], v7 offset:512
    v_smfmac_f32_16x16x64_bf16 v[60:63], v[44:47], a[200:207], v8
    s_waitcnt lgkmcnt(7)
    v_smfmac_f32_16x16x64_bf16 v[56:59], v[48:51], a[80:87], v8
    ds_read_b128 v[104:107], v7 offset:1024
    v_smfmac_f32_16x16x64_bf16 v[60:63], v[48:51], a[208:215], v8
    s_waitcnt lgkmcnt(7)
    v_smfmac_f32_16x16x64_bf16 v[56:59], v[52:55], a[88:95], v8
    ds_read_b128 v[108:111], v7 offset:1536
    v_smfmac_f32_16x16x64_bf16 v[60:63], v[52:55], a[216:223], v8
    s_waitcnt lgkmcnt(6)
    v_smfmac_f32_16x16x64_bf16 v[56:59], v[80:83], a[96:103], v8
    v_smfmac_f32_16x16x64_bf16 v[60:63], v[80:83], a[224:231], v8
    buffer_load_dwordx4 v13, s[8:11], s34 offen sc1 lds
    v_smfmac_f32_16x16x64_bf16 v[56:59], v[84:87], a[104:111], v8
    v_smfmac_f32_16x16x64_bf16 v[60:63], v[84:87], a[232:239], v8
    buffer_load_dwordx4 v13, s[8:11], s34 offen offset:1024 sc1 lds
    s_waitcnt lgkmcnt(4)
    v_smfmac_f32_16x16x64_bf16 v[56:59], v[88:91], a[112:119], v8
    v_smfmac_f32_16x16x64_bf16 v[60:63], v[88:91], a[240:247], v8
    buffer_load_dwordx4 v[120:123], v13, s[8:11], s35 offen sc1
    v_smfmac_f32_16x16x64_bf16 v[56:59], v[92:95], a[120:127], v8
    v_smfmac_f32_16x16x64_bf16 v[60:63], v[92:95], a[248:255], v8
    buffer_load_dwordx4 v[124:127], v13, s[8:11], s35 offen offset:1024 sc1
    s_waitcnt lgkmcnt(2)
    v_smfmac_f32_16x16x64_bf16 v[56:59], v[96:99], a[0:7], v8
    v_smfmac_f32_16x16x64_bf16 v[60:63], v[96:99], a[128:135], v8
    v_smfmac_f32_16x16x64_bf16 v[56:59], v[100:103], a[8:15], v8
    v_smfmac_f32_16x16x64_bf16 v[60:63], v[100:103], a[136:143], v8
    s_waitcnt lgkmcnt(0)
    v_smfmac_f32_16x16x64_bf16 v[56:59], v[104:107], a[16:23], v8
    v_smfmac_f32_16x16x64_bf16 v[60:63], v[104:107], a[144:151], v8
    v_smfmac_f32_16x16x64_bf16 v[56:59], v[108:111], a[24:31], v8
    v_smfmac_f32_16x16x64_bf16 v[60:63], v[108:111], a[152:159], v8
    v_smfmac_f32_16x16x64_bf16 v[64:67], v[96:99], v[128:135], v8
    s_nop 0
    v_smfmac_f32_16x16x64_bf16 v[64:67], v[100:103], v[136:143], v8
    s_nop 0
    v_smfmac_f32_16x16x64_bf16 v[64:67], v[104:107], v[144:151], v8
    ds_read_b128 v[96:99], v3 offset:8192
    ds_read_b128 v[100:103], v3 offset:9216
    v_permlane32_swap_b32 v56, v58
    v_permlane32_swap_b32 v57, v59
    v_permlane32_swap_b32 v60, v62
    v_permlane32_swap_b32 v61, v63
    v_cvt_pk_bf16_f32 v56, v56, v58
    v_cvt_pk_bf16_f32 v57, v57, v59
    ds_write2_b32 v4, v56, v57 offset0:0 offset1:136
    v_cvt_pk_bf16_f32 v60, v60, v62
    v_cvt_pk_bf16_f32 v61, v61, v63
    ds_write2_b32 v4, v60, v61 offset0:64 offset1:200
    v_smfmac_f32_16x16x64_bf16 v[64:67], v[108:111], v[152:159], v8
    ds_read_b128 v[104:107], v3 offset:10240
    v_smfmac_f32_16x16x64_bf16 v[64:67], v[80:83], v[224:231], v8
    ds_read_b128 v[108:111], v3 offset:11264
    v_smfmac_f32_16x16x64_bf16 v[64:67], v[84:87], v[232:239], v8
    v_smfmac_f32_16x16x64_bf16 v[64:67], v[88:91], v[240:247], v8
    v_smfmac_f32_16x16x64_bf16 v[64:67], v[92:95], v[248:255], v8
    s_waitcnt lgkmcnt(2)
    s_barrier
    ds_read_b128 v[80:83], v5 offset:0
    ds_read_b128 v[84:87], v5 offset:64
    v_smfmac_f32_16x16x64_bf16 v[64:67], v[24:27], v[160:167], v8
    ds_read_b128 v[88:91], v5 offset:128
    v_smfmac_f32_16x16x64_bf16 v[64:67], v[28:31], v[168:175], v8
    ds_read_b128 v[92:95], v5 offset:192
    v_smfmac_f32_16x16x64_bf16 v[64:67], v[32:35], v[176:183], v8
    ds_read_b128 v[24:27], v3 offset:12288
    v_smfmac_f32_16x16x64_bf16 v[64:67], v[36:39], v[184:191], v8
    ds_read_b128 v[28:31], v3 offset:13312
    s_waitcnt lgkmcnt(5)
    v_mfma_f32_16x16x32_bf16 v[56:59], v[96:99], v[80:83], 0
    ds_read_b128 v[32:35], v3 offset:14336
    s_waitcnt lgkmcnt(5)
    v_mfma_f32_16x16x32_bf16 v[56:59], v[100:103], v[84:87], v[56:59]
    ds_read_b128 v[36:39], v3 offset:15360
    v_smfmac_f32_16x16x64_bf16 v[64:67], v[40:43], v[192:199], v8
    s_waitcnt lgkmcnt(5)
    v_mfma_f32_16x16x32_bf16 v[56:59], v[104:107], v[88:91], v[56:59]
    ds_read_b128 v[40:43], v5 offset:256
    v_smfmac_f32_16x16x64_bf16 v[64:67], v[44:47], v[200:207], v8
    s_waitcnt lgkmcnt(5)
    v_mfma_f32_16x16x32_bf16 v[56:59], v[108:111], v[92:95], v[56:59]
    ds_read_b128 v[44:47], v5 offset:320
    v_smfmac_f32_16x16x64_bf16 v[64:67], v[48:51], v[208:215], v8
    ds_read_b128 v[96:99], v9 offset:12288
    v_smfmac_f32_16x16x64_bf16 v[64:67], v[52:55], v[216:223], v8
    ds_read_b128 v[48:51], v5 offset:384
    s_waitcnt lgkmcnt(4)
    v_mfma_f32_16x16x32_bf16 v[60:63], v[24:27], v[80:83], 0
    ds_read_b128 v[52:55], v5 offset:448
    v_mfma_f32_16x16x32_bf16 v[60:63], v[28:31], v[84:87], v[60:63]
    ds_read_b128 v[100:103], v9 offset:13312
    v_mfma_f32_16x16x32_bf16 v[60:63], v[32:35], v[88:91], v[60:63]
    ds_read_b128 v[104:107], v9 offset:14336
    v_mfma_f32_16x16x32_bf16 v[60:63], v[36:39], v[92:95], v[60:63]
    ds_read_b128 v[108:111], v9 offset:15360
    s_waitcnt lgkmcnt(3)
    v_mfma_f32_16x16x32_bf16 v[68:71], v[40:43], v[80:83], 0
    ds_read_b128 v[24:27], v9 offset:0
    v_max3_f32 v22, v56, v57, v58
    v_cvt_pk_bf16_f32 v64, v64, v65
    v_mfma_f32_16x16x32_bf16 v[68:71], v[44:47], v[84:87], v[68:71]
    ds_read_b128 v[28:31], v9 offset:1024
    v_cvt_pk_bf16_f32 v65, v66, v67
    buffer_store_dwordx4 v[44:47], v14, s[8:11], s36 offen sc1
    v_mfma_f32_16x16x32_bf16 v[68:71], v[48:51], v[88:91], v[68:71]
    ds_read_b128 v[32:35], v9 offset:2048
    v_lshrrev_b32 v72, 1, v14
    buffer_store_dwordx2 v[64:65], v72, s[8:11], s37 offen sc1
    v_mfma_f32_16x16x32_bf16 v[68:71], v[52:55], v[92:95], v[68:71]
    ds_read_b128 v[36:39], v9 offset:3072
    v_max3_f32 v23, v59, v60, v61
    v_max3_f32 v22, v22, v62, v63
    ds_read_b128 v[80:83], v9 offset:8192
    ds_read_b128 v[84:87], v9 offset:9216
    ds_read_b128 v[88:91], v9 offset:10240
    s_and_b32 s42, s20, 7
    s_cmp_lg_u32 s42, 6
    s_cbranch_scc1 Lkvn_46
    s_add_u32 s23, s23, 32768
    s_mov_b64 exec, 15
    v_lshlrev_b32 v0, 3, v2
    buffer_load_dwordx2 v[0:1], v0, s[8:11], s23 offen sc1
    s_mov_b64 exec, -1
Lkvn_46:
    s_nop 1
    v_max3_f32 v23, v23, v68, v69
    v_max3_f32 v22, v22, v70, v71
    v_max_f32 v22, v22, v23
    v_mov_b32 v23, v22
    ds_read_b128 v[92:95], v9 offset:11264
    ds_read_b128 v[40:43], v9 offset:4096
    v_permlane16_swap_b32 v22, v23
    v_max_f32 v22, v22, v23
    v_mov_b32 v23, v22
    s_nop 1
    s_nop 0
    v_permlane32_swap_b32 v22, v23
    v_max_f32 v22, v22, v23
    v_mul_f32 v22, s38, v22
    v_pk_fma_f32 v[56:57], v[56:57], s[38:39], v[22:23] op_sel_hi:[1,0,0] neg_lo:[0,0,1] neg_hi:[0,0,1]
    v_pk_fma_f32 v[58:59], v[58:59], s[38:39], v[22:23] op_sel_hi:[1,0,0] neg_lo:[0,0,1] neg_hi:[0,0,1]
    v_pk_fma_f32 v[60:61], v[60:61], s[38:39], v[22:23] op_sel_hi:[1,0,0] neg_lo:[0,0,1] neg_hi:[0,0,1]
    v_pk_fma_f32 v[62:63], v[62:63], s[38:39], v[22:23] op_sel_hi:[1,0,0] neg_lo:[0,0,1] neg_hi:[0,0,1]
    v_pk_fma_f32 v[68:69], v[68:69], s[38:39], v[22:23] op_sel_hi:[1,0,0] neg_lo:[0,0,1] neg_hi:[0,0,1]
    v_pk_fma_f32 v[70:71], v[70:71], s[38:39], v[22:23] op_sel_hi:[1,0,0] neg_lo:[0,0,1] neg_hi:[0,0,1]
    v_exp_f32 v56, v56
    v_exp_f32 v57, v57
    v_exp_f32 v58, v58
    v_exp_f32 v59, v59
    v_exp_f32 v60, v60
    v_exp_f32 v61, v61
    v_exp_f32 v62, v62
    v_exp_f32 v63, v63
    v_exp_f32 v68, v68
    v_exp_f32 v69, v69
    v_exp_f32 v70, v70
    v_exp_f32 v71, v71
    v_cvt_pk_bf16_f32 v56, v56, v57
    v_cvt_pk_bf16_f32 v57, v58, v59
    v_cvt_pk_bf16_f32 v58, v60, v61
    v_cvt_pk_bf16_f32 v59, v62, v63
    v_cvt_pk_bf16_f32 v68, v68, v69
    v_cvt_pk_bf16_f32 v69, v70, v71
    v_mfma_f32_16x16x32_bf16 v[76:79], v[16:19], v[56:59], 0
    s_mov_b32 exec_hi, 0
    v_mov_b64 v[20:21], v[68:69]
    v_mov_b64 v[68:69], 0
    s_mov_b32 exec_hi, -1
    ds_read_b128 v[44:47], v9 offset:5120
    v_mfma_f32_16x16x32_bf16 v[60:63], v[112:115], v[56:59], 0
    ds_read_b128 v[48:51], v9 offset:6144
    v_mfma_f32_16x16x32_bf16 v[72:75], v[116:119], v[56:59], 0
    ds_read_b128 v[52:55], v9 offset:7168
    v_mfma_f32_16x16x16_bf16 v[76:79], v[16:17], v[20:21], v[76:79]
    v_mov_b64 v[112:113], 0
    v_mov_b64 v[114:115], 0
    v_mfma_f32_16x16x16_bf16 v[60:63], v[64:65], v[20:21], v[60:63]
    v_mov_b64 v[116:117], 0
    v_mfma_f32_16x16x16_bf16 v[72:75], v[64:65], v[68:69], v[72:75]
    v_mov_b64 v[118:119], 0
    s_nop 1
    v_rcp_f32 v22, v76
    s_nop 1
    v_pk_mul_f32 v[60:61], v[60:61], v[22:23] op_sel_hi:[1,0]
    v_pk_mul_f32 v[62:63], v[62:63], v[22:23] op_sel_hi:[1,0]
    v_pk_mul_f32 v[72:73], v[72:73], v[22:23] op_sel_hi:[1,0]
    v_pk_mul_f32 v[74:75], v[74:75], v[22:23] op_sel_hi:[1,0]
    v_cvt_pk_bf16_f32 v56, v60, v72
    v_cvt_pk_bf16_f32 v57, v61, v73
    v_cvt_pk_bf16_f32 v58, v62, v74
    v_cvt_pk_bf16_f32 v59, v63, v75
    ds_write_b128 v6, v[56:59] offset:64
    v_mov_b64 v[60:61], 0
    v_mov_b64 v[62:63], 0
    s_waitcnt lgkmcnt(0)
    s_barrier
    ds_read_b128 v[64:67], v6 offset:0
    ds_read_b128 v[68:71], v6 offset:64
    ds_read_b128 v[72:75], v6 offset:128
    ds_read_b128 v[76:79], v6 offset:192
    v_mov_b64 v[56:57], 0
    v_mov_b64 v[58:59], 0
    s_waitcnt lgkmcnt(3)
    v_smfmac_f32_16x16x64_bf16 v[112:115], v[64:67], v[24:31], v8
    s_waitcnt lgkmcnt(2)
    v_smfmac_f32_16x16x64_bf16 v[112:115], v[68:71], v[32:39], v8
    ds_read_b128 v[24:27], v9 offset:16384
    s_waitcnt lgkmcnt(2)
    v_smfmac_f32_16x16x64_bf16 v[112:115], v[72:75], v[40:47], v8
    ds_read_b128 v[28:31], v9 offset:17408
    ds_read_b128 v[32:35], v9 offset:18432
    s_waitcnt lgkmcnt(3)
    v_smfmac_f32_16x16x64_bf16 v[112:115], v[76:79], v[48:55], v8
    ds_read_b128 v[36:39], v9 offset:19456
    v_smfmac_f32_16x16x64_bf16 v[116:119], v[64:67], v[80:87], v8
    ds_read_b128 v[40:43], v9 offset:20480
    ds_read_b128 v[44:47], v9 offset:21504
    v_smfmac_f32_16x16x64_bf16 v[116:119], v[68:71], v[88:95], v8
    ds_read_b128 v[48:51], v9 offset:22528
    v_smfmac_f32_16x16x64_bf16 v[116:119], v[72:75], v[96:103], v8
    ds_read_b128 v[52:55], v9 offset:23552
    ds_read_b128 v[80:83], v9 offset:24576
    v_smfmac_f32_16x16x64_bf16 v[116:119], v[76:79], v[104:111], v8
    ds_read_b128 v[84:87], v9 offset:25600
    v_cvt_pk_bf16_f32 v112, v112, v113
    v_cvt_pk_bf16_f32 v113, v114, v115
    s_waitcnt lgkmcnt(6)
    v_smfmac_f32_16x16x64_bf16 v[60:63], v[64:67], v[24:31], v8
    ds_read_b128 v[88:91], v9 offset:26624
    v_and_b32 v112, -2, v112
    buffer_store_dwordx2 v[112:113], v10, s[8:11], s64 offen
    v_smfmac_f32_16x16x64_bf16 v[60:63], v[68:71], v[32:39], v8
    ds_read_b128 v[92:95], v9 offset:27648
    ds_read_b128 v[96:99], v9 offset:28672
    s_waitcnt lgkmcnt(5)
    v_smfmac_f32_16x16x64_bf16 v[60:63], v[72:75], v[40:47], v8
    ds_read_b128 v[100:103], v9 offset:29696
    v_cvt_pk_bf16_f32 v116, v116, v117
    v_cvt_pk_bf16_f32 v117, v118, v119
    v_smfmac_f32_16x16x64_bf16 v[60:63], v[76:79], v[48:55], v8
    ds_read_b128 v[104:107], v9 offset:30720
    ds_read_b128 v[108:111], v9 offset:31744
    v_and_b32 v116, -2, v116
    buffer_store_dwordx2 v[116:117], v10, s[8:11], s65 offen
    s_waitcnt lgkmcnt(4)
    v_smfmac_f32_16x16x64_bf16 v[56:59], v[64:67], v[80:87], v8
    ds_read_b128 v[48:51], v3 offset:31168
    v_smfmac_f32_16x16x64_bf16 v[56:59], v[68:71], v[88:95], v8
    s_waitcnt lgkmcnt(1)
    v_smfmac_f32_16x16x64_bf16 v[56:59], v[72:75], v[96:103], v8
    v_cvt_pk_bf16_f32 v60, v60, v61
    v_cvt_pk_bf16_f32 v61, v62, v63
    v_smfmac_f32_16x16x64_bf16 v[56:59], v[76:79], v[104:111], v8
    v_and_b32 v60, -2, v60
    buffer_store_dwordx2 v[60:61], v10, s[8:11], s66 offen
    s_nop 5
    v_cvt_pk_bf16_f32 v56, v56, v57
    v_cvt_pk_bf16_f32 v57, v58, v59
    v_and_b32 v56, -2, v56
    buffer_store_dwordx2 v[56:57], v10, s[8:11], s67 offen
    v_mov_b64 v[64:65], 0
    v_mov_b64 v[66:67], 0
    v_mov_b64 v[60:61], 0
    v_mov_b64 v[62:63], 0
    v_mov_b64 v[58:59], 0
    v_mov_b64 v[56:57], 0
    s_waitcnt vmcnt(2)
    buffer_load_dwordx4 v[24:27], v11, s[8:11], s50 offen offset:0 sc1
    buffer_load_dwordx4 v[28:31], v11, s[8:11], s50 offen offset:1024 sc1
    s_waitcnt vmcnt(3)
    buffer_load_dwordx4 v[32:35], v11, s[8:11], s50 offen offset:0 sc1
    buffer_load_dwordx4 v[36:39], v11, s[8:11], s50 offen offset:1024 sc1
    s_waitcnt lgkmcnt(0)
Lp1_48:
    s_waitcnt vmcnt(2)
    v_mfma_f32_16x16x32_bf16 v[80:83], v[48:51], v[24:27], 0
    v_or3_b32 v88, v24, v26, v28
    v_mfma_f32_16x16x32_bf16 v[80:83], v[48:51], v[28:31], v[80:83]
    v_bitop3_b32 v88, v88, v30, 1 bitop3:0xa8
    v_cmp_ne_u32 vcc, 0, v88
    s_cbranch_vccz Lp1k_49
    s_nop 0
    s_mov_b64 exec, vcc
    buffer_load_dwordx4 v[24:27], v11, s[8:11], s50 offen offset:0 sc1
    buffer_load_dwordx4 v[28:31], v11, s[8:11], s50 offen offset:1024 sc1
    s_mov_b64 exec, -1
    s_waitcnt vmcnt(2)
    v_mfma_f32_16x16x32_bf16 v[80:83], v[48:51], v[32:35], 0
    v_or3_b32 v88, v32, v34, v36
    v_mfma_f32_16x16x32_bf16 v[80:83], v[48:51], v[36:39], v[80:83]
    v_bitop3_b32 v88, v88, v38, 1 bitop3:0xa8
    v_cmp_ne_u32 vcc, 0, v88
    s_cbranch_vccz Lp1k_50
    s_nop 0
    s_mov_b64 exec, vcc
    buffer_load_dwordx4 v[32:35], v11, s[8:11], s50 offen offset:0 sc1
    buffer_load_dwordx4 v[36:39], v11, s[8:11], s50 offen offset:1024 sc1
    s_mov_b64 exec, -1
    s_sub_u32 s21, s21, 1
    s_cbranch_scc0 Lp1_48
Lp1k_49:
Lp1k_50:
    buffer_store_dword v15, v12, s[8:11], s48 offen
    s_nop 3
    v_add_f32_dpp v80, v80, v80 row_ror:4 row_mask:0xf bank_mask:0xf
    v_add_f32_dpp v81, v81, v81 row_ror:4 row_mask:0xf bank_mask:0xf
    s_nop 0
    v_add_f32_dpp v80, v80, v80 row_ror:8 row_mask:0xf bank_mask:0xf
    v_add_f32_dpp v81, v81, v81 row_ror:8 row_mask:0xf bank_mask:0xf
    v_cvt_pk_bf16_f32 v83, v80, v81
    v_min_u32 v83, -2, v83
    buffer_store_dword v83, v12, s[8:11], s49 offen
    s_max_i32 s21, s21, 0
    s_add_u32 s20, s20, 1
    s_add_u32 s36, s36, 8192
    s_add_u32 s37, s37, 2048
    s_waitcnt vmcnt(1)
    buffer_load_dwordx4 v[88:91], v3, s[8:11], s61 offen offset:0 sc1
    buffer_load_dwordx4 v[92:95], v3, s[8:11], s61 offen offset:1024 sc1
    s_waitcnt vmcnt(2)
Lp2_51:
    buffer_load_dwordx4 v[88:91], v3, s[8:11], s61 offen offset:0 sc1
    buffer_load_dwordx4 v[92:95], v3, s[8:11], s61 offen offset:1024 sc1
    s_mov_b64 exec, -1
    s_waitcnt vmcnt(2)
    v_max3_u32 v80, v88, v89, v90
    v_max3_u32 v81, v91, v92, v93
    v_max3_u32 v80, v80, v94, v95
    v_max_u32 v80, v80, v81
    v_cmp_eq_u32 vcc, -1, v80
    s_nop 4
    s_cbranch_vccz Lstep11_16
    s_mov_b64 exec, vcc
    s_sub_u32 s21, s21, 1
    s_cbranch_scc0 Lp2_51
    s_mov_b64 exec, -1
    s_mov_b32 s21, 0
Lstep11_16:
    ds_write_b128 v3, v[88:91] offset:2048
    ds_write_b128 v3, v[92:95] offset:3072
    s_add_u32 s34, s34, 16384
    s_mov_b32 m0, 141312
    s_add_u32 s35, s35, 16384
    s_waitcnt vmcnt(2)
    ds_read_b128 v[24:27], v7 offset:2048
    ds_read_b128 v[28:31], v7 offset:2560
    ds_read_b128 v[32:35], v7 offset:3072
    ds_read_b128 v[36:39], v7 offset:3584
    s_waitcnt lgkmcnt(4)
    s_barrier
    s_and_b32 s42, s20, 7
    s_cmp_lg_u32 s42, 7
    s_cbranch_scc1 Lkvok_52
    s_cmp_eq_u32 s20, 63
    s_cbranch_scc1 Lkvok_52
    s_mov_b64 exec, 15
    v_cmp_ne_u64 vcc, s[62:63], v[0:1]
    s_mov_b64 exec, -1
    s_nop 3
    s_cbranch_vccz Lkvok_52
    s_mov_b64 exec, 15
Lkv_53:
    v_lshlrev_b32 v0, 3, v2
    buffer_load_dwordx2 v[0:1], v0, s[8:11], s23 offen sc1
    s_waitcnt vmcnt(0)
    v_cmp_ne_u64 vcc, s[62:63], v[0:1]
    s_nop 4
    s_cbranch_vccz Lkvd_54
    s_sleep 2
    s_sub_u32 s21, s21, 1
    s_cbranch_scc0 Lkv_53
    s_mov_b32 s21, 0
Lkvd_54:
    s_mov_b64 exec, -1
Lkvok_52:
    ds_read_b128 v[40:43], v7 offset:4096
    ds_read_b128 v[44:47], v7 offset:4608
    s_waitcnt lgkmcnt(5)
    v_smfmac_f32_16x16x64_bf16 v[56:59], v[24:27], a[32:39], v8
    ds_read_b128 v[48:51], v7 offset:5120
    v_smfmac_f32_16x16x64_bf16 v[60:63], v[24:27], a[160:167], v8
    ds_read_b128 v[52:55], v7 offset:5632
    s_waitcnt lgkmcnt(6)
    v_smfmac_f32_16x16x64_bf16 v[56:59], v[28:31], a[40:47], v8
    ds_read_b128 v[80:83], v7 offset:6144
    v_smfmac_f32_16x16x64_bf16 v[60:63], v[28:31], a[168:175], v8
    ds_read_b128 v[84:87], v7 offset:6656
    s_waitcnt vmcnt(0)
    s_waitcnt lgkmcnt(6)
    v_smfmac_f32_16x16x64_bf16 v[56:59], v[32:35], a[48:55], v8
    ds_read_b128 v[88:91], v7 offset:7168
    v_smfmac_f32_16x16x64_bf16 v[60:63], v[32:35], a[176:183], v8
    ds_read_b128 v[92:95], v7 offset:7680
    v_smfmac_f32_16x16x64_bf16 v[56:59], v[36:39], a[56:63], v8
    v_smfmac_f32_16x16x64_bf16 v[60:63], v[36:39], a[184:191], v8
    s_waitcnt lgkmcnt(7)
    v_smfmac_f32_16x16x64_bf16 v[56:59], v[40:43], a[64:71], v8
    ds_read_b128 v[96:99], v7 offset:0
    v_smfmac_f32_16x16x64_bf16 v[60:63], v[40:43], a[192:199], v8
    s_waitcnt lgkmcnt(7)
    v_smfmac_f32_16x16x64_bf16 v[56:59], v[44:47], a[72:79], v8
    ds_read_b128 v[100:103], v7 offset:512
    v_smfmac_f32_16x16x64_bf16 v[60:63], v[44:47], a[200:207], v8
    s_waitcnt lgkmcnt(7)
    v_smfmac_f32_16x16x64_bf16 v[56:59], v[48:51], a[80:87], v8
    ds_read_b128 v[104:107], v7 offset:1024
    v_smfmac_f32_16x16x64_bf16 v[60:63], v[48:51], a[208:215], v8
    s_waitcnt lgkmcnt(7)
    v_smfmac_f32_16x16x64_bf16 v[56:59], v[52:55], a[88:95], v8
    ds_read_b128 v[108:111], v7 offset:1536
    v_smfmac_f32_16x16x64_bf16 v[60:63], v[52:55], a[216:223], v8
    s_waitcnt lgkmcnt(6)
    v_smfmac_f32_16x16x64_bf16 v[56:59], v[80:83], a[96:103], v8
    v_smfmac_f32_16x16x64_bf16 v[60:63], v[80:83], a[224:231], v8
    buffer_load_dwordx4 v13, s[8:11], s34 offen sc1 lds
    v_smfmac_f32_16x16x64_bf16 v[56:59], v[84:87], a[104:111], v8
    v_smfmac_f32_16x16x64_bf16 v[60:63], v[84:87], a[232:239], v8
    buffer_load_dwordx4 v13, s[8:11], s34 offen offset:1024 sc1 lds
    s_waitcnt lgkmcnt(4)
    v_smfmac_f32_16x16x64_bf16 v[56:59], v[88:91], a[112:119], v8
    v_smfmac_f32_16x16x64_bf16 v[60:63], v[88:91], a[240:247], v8
    buffer_load_dwordx4 v[112:115], v13, s[8:11], s35 offen sc1
    v_smfmac_f32_16x16x64_bf16 v[56:59], v[92:95], a[120:127], v8
    v_smfmac_f32_16x16x64_bf16 v[60:63], v[92:95], a[248:255], v8
    buffer_load_dwordx4 v[116:119], v13, s[8:11], s35 offen offset:1024 sc1
    s_waitcnt lgkmcnt(2)
    v_smfmac_f32_16x16x64_bf16 v[56:59], v[96:99], a[0:7], v8
    v_smfmac_f32_16x16x64_bf16 v[60:63], v[96:99], a[128:135], v8
    v_smfmac_f32_16x16x64_bf16 v[56:59], v[100:103], a[8:15], v8
    v_smfmac_f32_16x16x64_bf16 v[60:63], v[100:103], a[136:143], v8
    s_waitcnt lgkmcnt(0)
    v_smfmac_f32_16x16x64_bf16 v[56:59], v[104:107], a[16:23], v8
    v_smfmac_f32_16x16x64_bf16 v[60:63], v[104:107], a[144:151], v8
    v_smfmac_f32_16x16x64_bf16 v[56:59], v[108:111], a[24:31], v8
    v_smfmac_f32_16x16x64_bf16 v[60:63], v[108:111], a[152:159], v8
    v_smfmac_f32_16x16x64_bf16 v[64:67], v[96:99], v[128:135], v8
    s_nop 0
    v_smfmac_f32_16x16x64_bf16 v[64:67], v[100:103], v[136:143], v8
    s_nop 0
    v_smfmac_f32_16x16x64_bf16 v[64:67], v[104:107], v[144:151], v8
    ds_read_b128 v[96:99], v3 offset:16384
    ds_read_b128 v[100:103], v3 offset:17408
    v_permlane32_swap_b32 v56, v58
    v_permlane32_swap_b32 v57, v59
    v_permlane32_swap_b32 v60, v62
    v_permlane32_swap_b32 v61, v63
    v_cvt_pk_bf16_f32 v56, v56, v58
    v_cvt_pk_bf16_f32 v57, v57, v59
    ds_write2_b32 v4, v56, v57 offset0:0 offset1:136
    v_cvt_pk_bf16_f32 v60, v60, v62
    v_cvt_pk_bf16_f32 v61, v61, v63
    ds_write2_b32 v4, v60, v61 offset0:64 offset1:200
    v_smfmac_f32_16x16x64_bf16 v[64:67], v[108:111], v[152:159], v8
    ds_read_b128 v[104:107], v3 offset:18432
    v_smfmac_f32_16x16x64_bf16 v[64:67], v[80:83], v[224:231], v8
    ds_read_b128 v[108:111], v3 offset:19456
    v_smfmac_f32_16x16x64_bf16 v[64:67], v[84:87], v[232:239], v8
    v_smfmac_f32_16x16x64_bf16 v[64:67], v[88:91], v[240:247], v8
    v_smfmac_f32_16x16x64_bf16 v[64:67], v[92:95], v[248:255], v8
    s_waitcnt lgkmcnt(2)
    s_barrier
    ds_read_b128 v[80:83], v5 offset:0
    ds_read_b128 v[84:87], v5 offset:64
    v_smfmac_f32_16x16x64_bf16 v[64:67], v[24:27], v[160:167], v8
    ds_read_b128 v[88:91], v5 offset:128
    v_smfmac_f32_16x16x64_bf16 v[64:67], v[28:31], v[168:175], v8
    ds_read_b128 v[92:95], v5 offset:192
    v_smfmac_f32_16x16x64_bf16 v[64:67], v[32:35], v[176:183], v8
    ds_read_b128 v[24:27], v3 offset:20480
    v_smfmac_f32_16x16x64_bf16 v[64:67], v[36:39], v[184:191], v8
    ds_read_b128 v[28:31], v3 offset:21504
    s_waitcnt lgkmcnt(5)
    v_mfma_f32_16x16x32_bf16 v[56:59], v[96:99], v[80:83], 0
    ds_read_b128 v[32:35], v3 offset:22528
    s_waitcnt lgkmcnt(5)
    v_mfma_f32_16x16x32_bf16 v[56:59], v[100:103], v[84:87], v[56:59]
    ds_read_b128 v[36:39], v3 offset:23552
    v_smfmac_f32_16x16x64_bf16 v[64:67], v[40:43], v[192:199], v8
    s_waitcnt lgkmcnt(5)
    v_mfma_f32_16x16x32_bf16 v[56:59], v[104:107], v[88:91], v[56:59]
    ds_read_b128 v[40:43], v5 offset:256
    v_smfmac_f32_16x16x64_bf16 v[64:67], v[44:47], v[200:207], v8
    s_waitcnt lgkmcnt(5)
    v_mfma_f32_16x16x32_bf16 v[56:59], v[108:111], v[92:95], v[56:59]
    ds_read_b128 v[44:47], v5 offset:320
    v_smfmac_f32_16x16x64_bf16 v[64:67], v[48:51], v[208:215], v8
    ds_read_b128 v[96:99], v9 offset:12288
    v_smfmac_f32_16x16x64_bf16 v[64:67], v[52:55], v[216:223], v8
    ds_read_b128 v[48:51], v5 offset:384
    s_waitcnt lgkmcnt(4)
    v_mfma_f32_16x16x32_bf16 v[60:63], v[24:27], v[80:83], 0
    ds_read_b128 v[52:55], v5 offset:448
    v_mfma_f32_16x16x32_bf16 v[60:63], v[28:31], v[84:87], v[60:63]
    ds_read_b128 v[100:103], v9 offset:13312
    v_mfma_f32_16x16x32_bf16 v[60:63], v[32:35], v[88:91], v[60:63]
    ds_read_b128 v[104:107], v9 offset:14336
    v_mfma_f32_16x16x32_bf16 v[60:63], v[36:39], v[92:95], v[60:63]
    ds_read_b128 v[108:111], v9 offset:15360
    s_waitcnt lgkmcnt(3)
    v_mfma_f32_16x16x32_bf16 v[68:71], v[40:43], v[80:83], 0
    ds_read_b128 v[24:27], v9 offset:0
    v_max3_f32 v22, v56, v57, v58
    v_cvt_pk_bf16_f32 v64, v64, v65
    v_mfma_f32_16x16x32_bf16 v[68:71], v[44:47], v[84:87], v[68:71]
    ds_read_b128 v[28:31], v9 offset:1024
    v_cvt_pk_bf16_f32 v65, v66, v67
    buffer_store_dwordx4 v[44:47], v14, s[8:11], s36 offen sc1
    v_mfma_f32_16x16x32_bf16 v[68:71], v[48:51], v[88:91], v[68:71]
    ds_read_b128 v[32:35], v9 offset:2048
    v_lshrrev_b32 v72, 1, v14
    buffer_store_dwordx2 v[64:65], v72, s[8:11], s37 offen sc1
    v_mfma_f32_16x16x32_bf16 v[68:71], v[52:55], v[92:95], v[68:71]
    ds_read_b128 v[36:39], v9 offset:3072
    v_max3_f32 v23, v59, v60, v61
    v_max3_f32 v22, v22, v62, v63
    ds_read_b128 v[80:83], v9 offset:8192
    ds_read_b128 v[84:87], v9 offset:9216
    ds_read_b128 v[88:91], v9 offset:10240
    s_cmp_eq_u32 s20, 63
    s_cbranch_scc1 Ldone_25
    s_nop 0
    v_max3_f32 v23, v23, v68, v69
    v_max3_f32 v22, v22, v70, v71
    v_max_f32 v22, v22, v23
    v_mov_b32 v23, v22
    ds_read_b128 v[92:95], v9 offset:11264
    ds_read_b128 v[40:43], v9 offset:4096
    v_permlane16_swap_b32 v22, v23
    v_max_f32 v22, v22, v23
    v_mov_b32 v23, v22
    s_nop 1
    s_nop 0
    v_permlane32_swap_b32 v22, v23
    v_max_f32 v22, v22, v23
    v_mul_f32 v22, s38, v22
    v_pk_fma_f32 v[56:57], v[56:57], s[38:39], v[22:23] op_sel_hi:[1,0,0] neg_lo:[0,0,1] neg_hi:[0,0,1]
    v_pk_fma_f32 v[58:59], v[58:59], s[38:39], v[22:23] op_sel_hi:[1,0,0] neg_lo:[0,0,1] neg_hi:[0,0,1]
    v_pk_fma_f32 v[60:61], v[60:61], s[38:39], v[22:23] op_sel_hi:[1,0,0] neg_lo:[0,0,1] neg_hi:[0,0,1]
    v_pk_fma_f32 v[62:63], v[62:63], s[38:39], v[22:23] op_sel_hi:[1,0,0] neg_lo:[0,0,1] neg_hi:[0,0,1]
    v_pk_fma_f32 v[68:69], v[68:69], s[38:39], v[22:23] op_sel_hi:[1,0,0] neg_lo:[0,0,1] neg_hi:[0,0,1]
    v_pk_fma_f32 v[70:71], v[70:71], s[38:39], v[22:23] op_sel_hi:[1,0,0] neg_lo:[0,0,1] neg_hi:[0,0,1]
    v_exp_f32 v56, v56
    v_exp_f32 v57, v57
    v_exp_f32 v58, v58
    v_exp_f32 v59, v59
    v_exp_f32 v60, v60
    v_exp_f32 v61, v61
    v_exp_f32 v62, v62
    v_exp_f32 v63, v63
    v_exp_f32 v68, v68
    v_exp_f32 v69, v69
    v_exp_f32 v70, v70
    v_exp_f32 v71, v71
    v_cvt_pk_bf16_f32 v56, v56, v57
    v_cvt_pk_bf16_f32 v57, v58, v59
    v_cvt_pk_bf16_f32 v58, v60, v61
    v_cvt_pk_bf16_f32 v59, v62, v63
    v_cvt_pk_bf16_f32 v68, v68, v69
    v_cvt_pk_bf16_f32 v69, v70, v71
    v_mfma_f32_16x16x32_bf16 v[76:79], v[16:19], v[56:59], 0
    s_mov_b32 exec_hi, 0
    v_mov_b64 v[20:21], v[68:69]
    v_mov_b64 v[68:69], 0
    s_mov_b32 exec_hi, -1
    ds_read_b128 v[44:47], v9 offset:5120
    v_mfma_f32_16x16x32_bf16 v[60:63], v[120:123], v[56:59], 0
    ds_read_b128 v[48:51], v9 offset:6144
    v_mfma_f32_16x16x32_bf16 v[72:75], v[124:127], v[56:59], 0
    ds_read_b128 v[52:55], v9 offset:7168
    v_mfma_f32_16x16x16_bf16 v[76:79], v[16:17], v[20:21], v[76:79]
    v_mov_b64 v[120:121], 0
    v_mov_b64 v[122:123], 0
    v_mfma_f32_16x16x16_bf16 v[60:63], v[64:65], v[20:21], v[60:63]
    v_mov_b64 v[124:125], 0
    v_mfma_f32_16x16x16_bf16 v[72:75], v[64:65], v[68:69], v[72:75]
    v_mov_b64 v[126:127], 0
    s_nop 1
    v_rcp_f32 v22, v76
    s_nop 1
    v_pk_mul_f32 v[60:61], v[60:61], v[22:23] op_sel_hi:[1,0]
    v_pk_mul_f32 v[62:63], v[62:63], v[22:23] op_sel_hi:[1,0]
    v_pk_mul_f32 v[72:73], v[72:73], v[22:23] op_sel_hi:[1,0]
    v_pk_mul_f32 v[74:75], v[74:75], v[22:23] op_sel_hi:[1,0]
    v_cvt_pk_bf16_f32 v56, v60, v72
    v_cvt_pk_bf16_f32 v57, v61, v73
    v_cvt_pk_bf16_f32 v58, v62, v74
    v_cvt_pk_bf16_f32 v59, v63, v75
    ds_write_b128 v6, v[56:59] offset:64
    v_mov_b64 v[60:61], 0
    v_mov_b64 v[62:63], 0
    s_waitcnt lgkmcnt(0)
    s_barrier
    ds_read_b128 v[64:67], v6 offset:0
    ds_read_b128 v[68:71], v6 offset:64
    ds_read_b128 v[72:75], v6 offset:128
    ds_read_b128 v[76:79], v6 offset:192
    v_mov_b64 v[56:57], 0
    v_mov_b64 v[58:59], 0
    s_waitcnt lgkmcnt(3)
    v_smfmac_f32_16x16x64_bf16 v[120:123], v[64:67], v[24:31], v8
    s_waitcnt lgkmcnt(2)
    v_smfmac_f32_16x16x64_bf16 v[120:123], v[68:71], v[32:39], v8
    ds_read_b128 v[24:27], v9 offset:16384
    s_waitcnt lgkmcnt(2)
    v_smfmac_f32_16x16x64_bf16 v[120:123], v[72:75], v[40:47], v8
    ds_read_b128 v[28:31], v9 offset:17408
    ds_read_b128 v[32:35], v9 offset:18432
    s_waitcnt lgkmcnt(3)
    v_smfmac_f32_16x16x64_bf16 v[120:123], v[76:79], v[48:55], v8
    ds_read_b128 v[36:39], v9 offset:19456
    v_smfmac_f32_16x16x64_bf16 v[124:127], v[64:67], v[80:87], v8
    ds_read_b128 v[40:43], v9 offset:20480
    ds_read_b128 v[44:47], v9 offset:21504
    v_smfmac_f32_16x16x64_bf16 v[124:127], v[68:71], v[88:95], v8
    ds_read_b128 v[48:51], v9 offset:22528
    v_smfmac_f32_16x16x64_bf16 v[124:127], v[72:75], v[96:103], v8
    ds_read_b128 v[52:55], v9 offset:23552
    ds_read_b128 v[80:83], v9 offset:24576
    v_smfmac_f32_16x16x64_bf16 v[124:127], v[76:79], v[104:111], v8
    ds_read_b128 v[84:87], v9 offset:25600
    v_cvt_pk_bf16_f32 v120, v120, v121
    v_cvt_pk_bf16_f32 v121, v122, v123
    s_waitcnt lgkmcnt(6)
    v_smfmac_f32_16x16x64_bf16 v[60:63], v[64:67], v[24:31], v8
    ds_read_b128 v[88:91], v9 offset:26624
    v_or_b32 v120, 1, v120
    buffer_store_dwordx2 v[120:121], v10, s[8:11], s64 offen
    v_smfmac_f32_16x16x64_bf16 v[60:63], v[68:71], v[32:39], v8
    ds_read_b128 v[92:95], v9 offset:27648
    ds_read_b128 v[96:99], v9 offset:28672
    s_waitcnt lgkmcnt(5)
    v_smfmac_f32_16x16x64_bf16 v[60:63], v[72:75], v[40:47], v8
    ds_read_b128 v[100:103], v9 offset:29696
    v_cvt_pk_bf16_f32 v124, v124, v125
    v_cvt_pk_bf16_f32 v125, v126, v127
    v_smfmac_f32_16x16x64_bf16 v[60:63], v[76:79], v[48:55], v8
    ds_read_b128 v[104:107], v9 offset:30720
    ds_read_b128 v[108:111], v9 offset:31744
    v_or_b32 v124, 1, v124
    buffer_store_dwordx2 v[124:125], v10, s[8:11], s65 offen
    s_waitcnt lgkmcnt(4)
    v_smfmac_f32_16x16x64_bf16 v[56:59], v[64:67], v[80:87], v8
    ds_read_b128 v[48:51], v3 offset:31168
    v_smfmac_f32_16x16x64_bf16 v[56:59], v[68:71], v[88:95], v8
    s_waitcnt lgkmcnt(1)
    v_smfmac_f32_16x16x64_bf16 v[56:59], v[72:75], v[96:103], v8
    v_cvt_pk_bf16_f32 v60, v60, v61
    v_cvt_pk_bf16_f32 v61, v62, v63
    v_smfmac_f32_16x16x64_bf16 v[56:59], v[76:79], v[104:111], v8
    v_or_b32 v60, 1, v60
    buffer_store_dwordx2 v[60:61], v10, s[8:11], s66 offen
    s_nop 5
    v_cvt_pk_bf16_f32 v56, v56, v57
    v_cvt_pk_bf16_f32 v57, v58, v59
    v_or_b32 v56, 1, v56
    buffer_store_dwordx2 v[56:57], v10, s[8:11], s67 offen
    v_mov_b64 v[64:65], 0
    v_mov_b64 v[66:67], 0
    v_mov_b64 v[60:61], 0
    v_mov_b64 v[62:63], 0
    v_mov_b64 v[58:59], 0
    v_mov_b64 v[56:57], 0
    s_waitcnt vmcnt(2)
    buffer_load_dwordx4 v[24:27], v11, s[8:11], s50 offen offset:0 sc1
    buffer_load_dwordx4 v[28:31], v11, s[8:11], s50 offen offset:1024 sc1
    s_waitcnt vmcnt(3)
    buffer_load_dwordx4 v[32:35], v11, s[8:11], s50 offen offset:0 sc1
    buffer_load_dwordx4 v[36:39], v11, s[8:11], s50 offen offset:1024 sc1
    s_waitcnt lgkmcnt(0)
Lp1_56:
    s_waitcnt vmcnt(2)
    v_mfma_f32_16x16x32_bf16 v[80:83], v[48:51], v[24:27], 0
    v_bitop3_b32 v88, v24, v26, v28 bitop3:0x80
    v_mfma_f32_16x16x32_bf16 v[80:83], v[48:51], v[28:31], v[80:83]
    v_bitop3_b32 v88, v88, v30, 1 bitop3:0x2a
    v_cmp_ne_u32 vcc, 0, v88
    s_cbranch_vccz Lp1k_57
    s_nop 0
    s_mov_b64 exec, vcc
    buffer_load_dwordx4 v[24:27], v11, s[8:11], s50 offen offset:0 sc1
    buffer_load_dwordx4 v[28:31], v11, s[8:11], s50 offen offset:1024 sc1
    s_mov_b64 exec, -1
    s_waitcnt vmcnt(2)
    v_mfma_f32_16x16x32_bf16 v[80:83], v[48:51], v[32:35], 0
    v_bitop3_b32 v88, v32, v34, v36 bitop3:0x80
    v_mfma_f32_16x16x32_bf16 v[80:83], v[48:51], v[36:39], v[80:83]
    v_bitop3_b32 v88, v88, v38, 1 bitop3:0x2a
    v_cmp_ne_u32 vcc, 0, v88
    s_cbranch_vccz Lp1k_58
    s_nop 0
    s_mov_b64 exec, vcc
    buffer_load_dwordx4 v[32:35], v11, s[8:11], s50 offen offset:0 sc1
    buffer_load_dwordx4 v[36:39], v11, s[8:11], s50 offen offset:1024 sc1
    s_mov_b64 exec, -1
    s_sub_u32 s21, s21, 1
    s_cbranch_scc0 Lp1_56
Lp1k_57:
Lp1k_58:
    buffer_store_dword v15, v12, s[8:11], s49 offen
    s_nop 3
    v_add_f32_dpp v80, v80, v80 row_ror:4 row_mask:0xf bank_mask:0xf
    v_add_f32_dpp v81, v81, v81 row_ror:4 row_mask:0xf bank_mask:0xf
    s_nop 0
    v_add_f32_dpp v80, v80, v80 row_ror:8 row_mask:0xf bank_mask:0xf
    v_add_f32_dpp v81, v81, v81 row_ror:8 row_mask:0xf bank_mask:0xf
    v_cvt_pk_bf16_f32 v83, v80, v81
    v_min_u32 v83, -2, v83
    buffer_store_dword v83, v12, s[8:11], s48 offen
    s_max_i32 s21, s21, 0
    s_add_u32 s20, s20, 1
    s_add_u32 s36, s36, 8192
    s_add_u32 s37, s37, 2048
    s_waitcnt vmcnt(1)
    buffer_load_dwordx4 v[88:91], v3, s[8:11], s60 offen offset:0 sc1
    buffer_load_dwordx4 v[92:95], v3, s[8:11], s60 offen offset:1024 sc1
    s_waitcnt vmcnt(2)
Lp2_59:
    buffer_load_dwordx4 v[88:91], v3, s[8:11], s60 offen offset:0 sc1
    buffer_load_dwordx4 v[92:95], v3, s[8:11], s60 offen offset:1024 sc1
    s_mov_b64 exec, -1
    s_waitcnt vmcnt(2)
    v_max3_u32 v80, v88, v89, v90
    v_max3_u32 v81, v91, v92, v93
    v_max3_u32 v80, v80, v94, v95
    v_max_u32 v80, v80, v81
    v_cmp_eq_u32 vcc, -1, v80
    s_nop 4
    s_cbranch_vccz Lstep10_15
    s_mov_b64 exec, vcc
    s_sub_u32 s21, s21, 1
    s_cbranch_scc0 Lp2_59
    s_mov_b64 exec, -1
    s_mov_b32 s21, 0
    s_branch Lstep10_15
Lentry2_23:
    v_mov_b64 v[24:25], v[96:97]
    v_mov_b64 v[26:27], v[98:99]
    v_mov_b64 v[28:29], v[100:101]
    v_mov_b64 v[30:31], v[102:103]
    v_mov_b64 v[32:33], v[104:105]
    v_mov_b64 v[34:35], v[106:107]
    v_mov_b64 v[36:37], v[108:109]
    v_mov_b64 v[38:39], v[110:111]
    ds_write_b128 v7, v[24:27] offset:4096
    ds_write_b128 v7, v[28:31] offset:4608
    ds_write_b128 v7, v[32:35] offset:5120
    ds_write_b128 v7, v[36:39] offset:5632
    s_add_u32 s34, s34, 16384
    s_mov_b32 m0, 151552
    s_add_u32 s35, s35, 16384
    s_waitcnt vmcnt(0) lgkmcnt(0)
    s_branch Lb1_60
Lstep20_17:
    ds_write_b128 v3, v[88:91] offset:4096
    ds_write_b128 v3, v[92:95] offset:5120
    s_add_u32 s34, s34, 16384
    s_mov_b32 m0, 151552
    s_add_u32 s35, s35, 16384
    s_waitcnt vmcnt(2)
    ds_read_b128 v[24:27], v7 offset:4096
    ds_read_b128 v[28:31], v7 offset:4608
    ds_read_b128 v[32:35], v7 offset:5120
    ds_read_b128 v[36:39], v7 offset:5632
    s_waitcnt lgkmcnt(4)
Lb1_60:
    s_barrier
    ds_read_b128 v[40:43], v7 offset:6144
    ds_read_b128 v[44:47], v7 offset:6656
    s_waitcnt lgkmcnt(5)
    v_smfmac_f32_16x16x64_bf16 v[56:59], v[24:27], a[64:71], v8
    ds_read_b128 v[48:51], v7 offset:7168
    v_smfmac_f32_16x16x64_bf16 v[60:63], v[24:27], a[192:199], v8
    ds_read_b128 v[52:55], v7 offset:7680
    s_waitcnt lgkmcnt(6)
    v_smfmac_f32_16x16x64_bf16 v[56:59], v[28:31], a[72:79], v8
    ds_read_b128 v[80:83], v7 offset:0
    v_smfmac_f32_16x16x64_bf16 v[60:63], v[28:31], a[200:207], v8
    ds_read_b128 v[84:87], v7 offset:512
    s_waitcnt vmcnt(0)
    s_waitcnt lgkmcnt(6)
    v_smfmac_f32_16x16x64_bf16 v[56:59], v[32:35], a[80:87], v8
    ds_read_b128 v[88:91], v7 offset:1024
    v_smfmac_f32_16x16x64_bf16 v[60:63], v[32:35], a[208:215], v8
    ds_read_b128 v[92:95], v7 offset:1536
    v_smfmac_f32_16x16x64_bf16 v[56:59], v[36:39], a[88:95], v8
    v_smfmac_f32_16x16x64_bf16 v[60:63], v[36:39], a[216:223], v8
    s_waitcnt lgkmcnt(7)
    v_smfmac_f32_16x16x64_bf16 v[56:59], v[40:43], a[96:103], v8
    ds_read_b128 v[96:99], v7 offset:2048
    v_smfmac_f32_16x16x64_bf16 v[60:63], v[40:43], a[224:231], v8
    s_waitcnt lgkmcnt(7)
    v_smfmac_f32_16x16x64_bf16 v[56:59], v[44:47], a[104:111], v8
    ds_read_b128 v[100:103], v7 offset:2560
    v_smfmac_f32_16x16x64_bf16 v[60:63], v[44:47], a[232:239], v8
    s_waitcnt lgkmcnt(7)
    v_smfmac_f32_16x16x64_bf16 v[56:59], v[48:51], a[112:119], v8
    ds_read_b128 v[104:107], v7 offset:3072
    v_smfmac_f32_16x16x64_bf16 v[60:63], v[48:51], a[240:247], v8
    s_waitcnt lgkmcnt(7)
    v_smfmac_f32_16x16x64_bf16 v[56:59], v[52:55], a[120:127], v8
    ds_read_b128 v[108:111], v7 offset:3584
    v_smfmac_f32_16x16x64_bf16 v[60:63], v[52:55], a[248:255], v8
    s_waitcnt lgkmcnt(6)
    v_smfmac_f32_16x16x64_bf16 v[56:59], v[80:83], a[0:7], v8
    v_smfmac_f32_16x16x64_bf16 v[60:63], v[80:83], a[128:135], v8
    buffer_load_dwordx4 v13, s[8:11], s34 offen sc1 lds
    v_smfmac_f32_16x16x64_bf16 v[56:59], v[84:87], a[8:15], v8
    v_smfmac_f32_16x16x64_bf16 v[60:63], v[84:87], a[136:143], v8
    buffer_load_dwordx4 v13, s[8:11], s34 offen offset:1024 sc1 lds
    s_waitcnt lgkmcnt(4)
    v_smfmac_f32_16x16x64_bf16 v[56:59], v[88:91], a[16:23], v8
    v_smfmac_f32_16x16x64_bf16 v[60:63], v[88:91], a[144:151], v8
    buffer_load_dwordx4 v[120:123], v13, s[8:11], s35 offen sc1
    v_smfmac_f32_16x16x64_bf16 v[56:59], v[92:95], a[24:31], v8
    v_smfmac_f32_16x16x64_bf16 v[60:63], v[92:95], a[152:159], v8
    buffer_load_dwordx4 v[124:127], v13, s[8:11], s35 offen offset:1024 sc1
    s_waitcnt lgkmcnt(2)
    v_smfmac_f32_16x16x64_bf16 v[56:59], v[96:99], a[32:39], v8
    v_smfmac_f32_16x16x64_bf16 v[60:63], v[96:99], a[160:167], v8
    v_smfmac_f32_16x16x64_bf16 v[56:59], v[100:103], a[40:47], v8
    v_smfmac_f32_16x16x64_bf16 v[60:63], v[100:103], a[168:175], v8
    s_waitcnt lgkmcnt(0)
    v_smfmac_f32_16x16x64_bf16 v[56:59], v[104:107], a[48:55], v8
    v_smfmac_f32_16x16x64_bf16 v[60:63], v[104:107], a[176:183], v8
    v_smfmac_f32_16x16x64_bf16 v[56:59], v[108:111], a[56:63], v8
    v_smfmac_f32_16x16x64_bf16 v[60:63], v[108:111], a[184:191], v8
    v_smfmac_f32_16x16x64_bf16 v[64:67], v[96:99], v[160:167], v8
    s_nop 0
    v_smfmac_f32_16x16x64_bf16 v[64:67], v[100:103], v[168:175], v8
    s_nop 0
    v_smfmac_f32_16x16x64_bf16 v[64:67], v[104:107], v[176:183], v8
    ds_read_b128 v[96:99], v3 offset:8192
    ds_read_b128 v[100:103], v3 offset:9216
    v_permlane32_swap_b32 v56, v58
    v_permlane32_swap_b32 v57, v59
    v_permlane32_swap_b32 v60, v62
    v_permlane32_swap_b32 v61, v63
    v_cvt_pk_bf16_f32 v56, v56, v58
    v_cvt_pk_bf16_f32 v57, v57, v59
    ds_write2_b32 v4, v56, v57 offset0:0 offset1:136
    v_cvt_pk_bf16_f32 v60, v60, v62
    v_cvt_pk_bf16_f32 v61, v61, v63
    ds_write2_b32 v4, v60, v61 offset0:64 offset1:200
    v_smfmac_f32_16x16x64_bf16 v[64:67], v[108:111], v[184:191], v8
    ds_read_b128 v[104:107], v3 offset:10240
    v_smfmac_f32_16x16x64_bf16 v[64:67], v[80:83], v[128:135], v8
    ds_read_b128 v[108:111], v3 offset:11264
    v_smfmac_f32_16x16x64_bf16 v[64:67], v[84:87], v[136:143], v8
    v_smfmac_f32_16x16x64_bf16 v[64:67], v[88:91], v[144:151], v8
    v_smfmac_f32_16x16x64_bf16 v[64:67], v[92:95], v[152:159], v8
    s_waitcnt lgkmcnt(2)
    s_barrier
    ds_read_b128 v[80:83], v5 offset:0
    ds_read_b128 v[84:87], v5 offset:64
    v_smfmac_f32_16x16x64_bf16 v[64:67], v[24:27], v[192:199], v8
    ds_read_b128 v[88:91], v5 offset:128
    v_smfmac_f32_16x16x64_bf16 v[64:67], v[28:31], v[200:207], v8
    ds_read_b128 v[92:95], v5 offset:192
    v_smfmac_f32_16x16x64_bf16 v[64:67], v[32:35], v[208:215], v8
    ds_read_b128 v[24:27], v3 offset:12288
    v_smfmac_f32_16x16x64_bf16 v[64:67], v[36:39], v[216:223], v8
    ds_read_b128 v[28:31], v3 offset:13312
    s_waitcnt lgkmcnt(5)
    v_mfma_f32_16x16x32_bf16 v[56:59], v[96:99], v[80:83], 0
    ds_read_b128 v[32:35], v3 offset:14336
    s_waitcnt lgkmcnt(5)
    v_mfma_f32_16x16x32_bf16 v[56:59], v[100:103], v[84:87], v[56:59]
    ds_read_b128 v[36:39], v3 offset:15360
    v_smfmac_f32_16x16x64_bf16 v[64:67], v[40:43], v[224:231], v8
    s_waitcnt lgkmcnt(5)
    v_mfma_f32_16x16x32_bf16 v[56:59], v[104:107], v[88:91], v[56:59]
    ds_read_b128 v[40:43], v5 offset:256
    v_smfmac_f32_16x16x64_bf16 v[64:67], v[44:47], v[232:239], v8
    s_waitcnt lgkmcnt(5)
    v_mfma_f32_16x16x32_bf16 v[56:59], v[108:111], v[92:95], v[56:59]
    ds_read_b128 v[44:47], v5 offset:320
    v_smfmac_f32_16x16x64_bf16 v[64:67], v[48:51], v[240:247], v8
    ds_read_b128 v[96:99], v9 offset:12288
    v_smfmac_f32_16x16x64_bf16 v[64:67], v[52:55], v[248:255], v8
    ds_read_b128 v[48:51], v5 offset:384
    s_waitcnt lgkmcnt(4)
    v_mfma_f32_16x16x32_bf16 v[60:63], v[24:27], v[80:83], 0
    ds_read_b128 v[52:55], v5 offset:448
    v_mfma_f32_16x16x32_bf16 v[60:63], v[28:31], v[84:87], v[60:63]
    ds_read_b128 v[100:103], v9 offset:13312
    v_mfma_f32_16x16x32_bf16 v[60:63], v[32:35], v[88:91], v[60:63]
    ds_read_b128 v[104:107], v9 offset:14336
    v_mfma_f32_16x16x32_bf16 v[60:63], v[36:39], v[92:95], v[60:63]
    ds_read_b128 v[108:111], v9 offset:15360
    s_waitcnt lgkmcnt(3)
    v_mfma_f32_16x16x32_bf16 v[68:71], v[40:43], v[80:83], 0
    ds_read_b128 v[24:27], v9 offset:0
    v_max3_f32 v22, v56, v57, v58
    v_cvt_pk_bf16_f32 v64, v64, v65
    v_mfma_f32_16x16x32_bf16 v[68:71], v[44:47], v[84:87], v[68:71]
    ds_read_b128 v[28:31], v9 offset:1024
    v_cvt_pk_bf16_f32 v65, v66, v67
    buffer_store_dwordx4 v[48:51], v14, s[8:11], s36 offen sc1
    v_mfma_f32_16x16x32_bf16 v[68:71], v[48:51], v[88:91], v[68:71]
    ds_read_b128 v[32:35], v9 offset:2048
    v_lshrrev_b32 v72, 1, v14
    buffer_store_dwordx2 v[64:65], v72, s[8:11], s37 offen sc1
    v_mfma_f32_16x16x32_bf16 v[68:71], v[52:55], v[92:95], v[68:71]
    ds_read_b128 v[36:39], v9 offset:3072
    v_max3_f32 v23, v59, v60, v61
    v_max3_f32 v22, v22, v62, v63
    ds_read_b128 v[80:83], v9 offset:8192
    ds_read_b128 v[84:87], v9 offset:9216
    ds_read_b128 v[88:91], v9 offset:10240
    s_and_b32 s42, s20, 7
    s_cmp_lg_u32 s42, 6
    s_cbranch_scc1 Lkvn_61
    s_add_u32 s23, s23, 32768
    s_mov_b64 exec, 15
    v_lshlrev_b32 v0, 3, v2
    buffer_load_dwordx2 v[0:1], v0, s[8:11], s23 offen sc1
    s_mov_b64 exec, -1
Lkvn_61:
    s_nop 1
    v_max3_f32 v23, v23, v68, v69
    v_max3_f32 v22, v22, v70, v71
    v_max_f32 v22, v22, v23
    v_mov_b32 v23, v22
    ds_read_b128 v[92:95], v9 offset:11264
    ds_read_b128 v[40:43], v9 offset:4096
    v_permlane16_swap_b32 v22, v23
    v_max_f32 v22, v22, v23
    v_mov_b32 v23, v22
    s_nop 1
    s_nop 0
    v_permlane32_swap_b32 v22, v23
    v_max_f32 v22, v22, v23
    v_mul_f32 v22, s38, v22
    v_pk_fma_f32 v[56:57], v[56:57], s[38:39], v[22:23] op_sel_hi:[1,0,0] neg_lo:[0,0,1] neg_hi:[0,0,1]
    v_pk_fma_f32 v[58:59], v[58:59], s[38:39], v[22:23] op_sel_hi:[1,0,0] neg_lo:[0,0,1] neg_hi:[0,0,1]
    v_pk_fma_f32 v[60:61], v[60:61], s[38:39], v[22:23] op_sel_hi:[1,0,0] neg_lo:[0,0,1] neg_hi:[0,0,1]
    v_pk_fma_f32 v[62:63], v[62:63], s[38:39], v[22:23] op_sel_hi:[1,0,0] neg_lo:[0,0,1] neg_hi:[0,0,1]
    v_pk_fma_f32 v[68:69], v[68:69], s[38:39], v[22:23] op_sel_hi:[1,0,0] neg_lo:[0,0,1] neg_hi:[0,0,1]
    v_pk_fma_f32 v[70:71], v[70:71], s[38:39], v[22:23] op_sel_hi:[1,0,0] neg_lo:[0,0,1] neg_hi:[0,0,1]
    v_exp_f32 v56, v56
    v_exp_f32 v57, v57
    v_exp_f32 v58, v58
    v_exp_f32 v59, v59
    v_exp_f32 v60, v60
    v_exp_f32 v61, v61
    v_exp_f32 v62, v62
    v_exp_f32 v63, v63
    v_exp_f32 v68, v68
    v_exp_f32 v69, v69
    v_exp_f32 v70, v70
    v_exp_f32 v71, v71
    v_cvt_pk_bf16_f32 v56, v56, v57
    v_cvt_pk_bf16_f32 v57, v58, v59
    v_cvt_pk_bf16_f32 v58, v60, v61
    v_cvt_pk_bf16_f32 v59, v62, v63
    v_cvt_pk_bf16_f32 v68, v68, v69
    v_cvt_pk_bf16_f32 v69, v70, v71
    v_mfma_f32_16x16x32_bf16 v[76:79], v[16:19], v[56:59], 0
    s_mov_b32 exec_hi, 0
    v_mov_b64 v[20:21], v[68:69]
    v_mov_b64 v[68:69], 0
    s_mov_b32 exec_hi, -1
    ds_read_b128 v[44:47], v9 offset:5120
    v_mfma_f32_16x16x32_bf16 v[60:63], v[112:115], v[56:59], 0
    ds_read_b128 v[48:51], v9 offset:6144
    v_mfma_f32_16x16x32_bf16 v[72:75], v[116:119], v[56:59], 0
    ds_read_b128 v[52:55], v9 offset:7168
    v_mfma_f32_16x16x16_bf16 v[76:79], v[16:17], v[20:21], v[76:79]
    v_mov_b64 v[112:113], 0
    v_mov_b64 v[114:115], 0
    v_mfma_f32_16x16x16_bf16 v[60:63], v[64:65], v[20:21], v[60:63]
    v_mov_b64 v[116:117], 0
    v_mfma_f32_16x16x16_bf16 v[72:75], v[64:65], v[68:69], v[72:75]
    v_mov_b64 v[118:119], 0
    s_nop 1
    v_rcp_f32 v22, v76
    s_nop 1
    v_pk_mul_f32 v[60:61], v[60:61], v[22:23] op_sel_hi:[1,0]
    v_pk_mul_f32 v[62:63], v[62:63], v[22:23] op_sel_hi:[1,0]
    v_pk_mul_f32 v[72:73], v[72:73], v[22:23] op_sel_hi:[1,0]
    v_pk_mul_f32 v[74:75], v[74:75], v[22:23] op_sel_hi:[1,0]
    v_cvt_pk_bf16_f32 v56, v60, v72
    v_cvt_pk_bf16_f32 v57, v61, v73
    v_cvt_pk_bf16_f32 v58, v62, v74
    v_cvt_pk_bf16_f32 v59, v63, v75
    ds_write_b128 v6, v[56:59] offset:128
    v_mov_b64 v[60:61], 0
    v_mov_b64 v[62:63], 0
    s_waitcnt lgkmcnt(0)
    s_barrier
    ds_read_b128 v[64:67], v6 offset:0
    ds_read_b128 v[68:71], v6 offset:64
    ds_read_b128 v[72:75], v6 offset:128
    ds_read_b128 v[76:79], v6 offset:192
    v_mov_b64 v[56:57], 0
    v_mov_b64 v[58:59], 0
    s_waitcnt lgkmcnt(3)
    v_smfmac_f32_16x16x64_bf16 v[112:115], v[64:67], v[24:31], v8
    s_waitcnt lgkmcnt(2)
    v_smfmac_f32_16x16x64_bf16 v[112:115], v[68:71], v[32:39], v8
    ds_read_b128 v[24:27], v9 offset:16384
    s_waitcnt lgkmcnt(2)
    v_smfmac_f32_16x16x64_bf16 v[112:115], v[72:75], v[40:47], v8
    ds_read_b128 v[28:31], v9 offset:17408
    ds_read_b128 v[32:35], v9 offset:18432
    s_waitcnt lgkmcnt(3)
    v_smfmac_f32_16x16x64_bf16 v[112:115], v[76:79], v[48:55], v8
    ds_read_b128 v[36:39], v9 offset:19456
    v_smfmac_f32_16x16x64_bf16 v[116:119], v[64:67], v[80:87], v8
    ds_read_b128 v[40:43], v9 offset:20480
    ds_read_b128 v[44:47], v9 offset:21504
    v_smfmac_f32_16x16x64_bf16 v[116:119], v[68:71], v[88:95], v8
    ds_read_b128 v[48:51], v9 offset:22528
    v_smfmac_f32_16x16x64_bf16 v[116:119], v[72:75], v[96:103], v8
    ds_read_b128 v[52:55], v9 offset:23552
    ds_read_b128 v[80:83], v9 offset:24576
    v_smfmac_f32_16x16x64_bf16 v[116:119], v[76:79], v[104:111], v8
    ds_read_b128 v[84:87], v9 offset:25600
    v_cvt_pk_bf16_f32 v112, v112, v113
    v_cvt_pk_bf16_f32 v113, v114, v115
    s_waitcnt lgkmcnt(6)
    v_smfmac_f32_16x16x64_bf16 v[60:63], v[64:67], v[24:31], v8
    ds_read_b128 v[88:91], v9 offset:26624
    v_and_b32 v112, -2, v112
    buffer_store_dwordx2 v[112:113], v10, s[8:11], s64 offen
    v_smfmac_f32_16x16x64_bf16 v[60:63], v[68:71], v[32:39], v8
    ds_read_b128 v[92:95], v9 offset:27648
    ds_read_b128 v[96:99], v9 offset:28672
    s_waitcnt lgkmcnt(5)
    v_smfmac_f32_16x16x64_bf16 v[60:63], v[72:75], v[40:47], v8
    ds_read_b128 v[100:103], v9 offset:29696
    v_cvt_pk_bf16_f32 v116, v116, v117
    v_cvt_pk_bf16_f32 v117, v118, v119
    v_smfmac_f32_16x16x64_bf16 v[60:63], v[76:79], v[48:55], v8
    ds_read_b128 v[104:107], v9 offset:30720
    ds_read_b128 v[108:111], v9 offset:31744
    v_and_b32 v116, -2, v116
    buffer_store_dwordx2 v[116:117], v10, s[8:11], s65 offen
    s_waitcnt lgkmcnt(4)
    v_smfmac_f32_16x16x64_bf16 v[56:59], v[64:67], v[80:87], v8
    ds_read_b128 v[48:51], v3 offset:31168
    v_smfmac_f32_16x16x64_bf16 v[56:59], v[68:71], v[88:95], v8
    s_waitcnt lgkmcnt(1)
    v_smfmac_f32_16x16x64_bf16 v[56:59], v[72:75], v[96:103], v8
    v_cvt_pk_bf16_f32 v60, v60, v61
    v_cvt_pk_bf16_f32 v61, v62, v63
    v_smfmac_f32_16x16x64_bf16 v[56:59], v[76:79], v[104:111], v8
    v_and_b32 v60, -2, v60
    buffer_store_dwordx2 v[60:61], v10, s[8:11], s66 offen
    s_nop 5
    v_cvt_pk_bf16_f32 v56, v56, v57
    v_cvt_pk_bf16_f32 v57, v58, v59
    v_and_b32 v56, -2, v56
    buffer_store_dwordx2 v[56:57], v10, s[8:11], s67 offen
    v_mov_b64 v[64:65], 0
    v_mov_b64 v[66:67], 0
    v_mov_b64 v[60:61], 0
    v_mov_b64 v[62:63], 0
    v_mov_b64 v[58:59], 0
    v_mov_b64 v[56:57], 0
    s_waitcnt vmcnt(1)
    buffer_load_dwordx4 v[24:27], v11, s[8:11], s50 offen offset:0 sc1
    buffer_load_dwordx4 v[28:31], v11, s[8:11], s50 offen offset:1024 sc1
    s_waitcnt vmcnt(2)
    buffer_load_dwordx4 v[32:35], v11, s[8:11], s50 offen offset:0 sc1
    buffer_load_dwordx4 v[36:39], v11, s[8:11], s50 offen offset:1024 sc1
    s_waitcnt lgkmcnt(0)
Lp1_63:
    s_waitcnt vmcnt(2)
    v_mfma_f32_16x16x32_bf16 v[80:83], v[48:51], v[24:27], 0
    v_or3_b32 v88, v24, v26, v28
    v_mfma_f32_16x16x32_bf16 v[80:83], v[48:51], v[28:31], v[80:83]
    v_bitop3_b32 v88, v88, v30, 1 bitop3:0xa8
    v_cmp_ne_u32 vcc, 0, v88
    s_cbranch_vccz Lp1k_64
    s_nop 0
    s_mov_b64 exec, vcc
    buffer_load_dwordx4 v[24:27], v11, s[8:11], s50 offen offset:0 sc1
    buffer_load_dwordx4 v[28:31], v11, s[8:11], s50 offen offset:1024 sc1
    s_mov_b64 exec, -1
    s_waitcnt vmcnt(2)
    v_mfma_f32_16x16x32_bf16 v[80:83], v[48:51], v[32:35], 0
    v_or3_b32 v88, v32, v34, v36
    v_mfma_f32_16x16x32_bf16 v[80:83], v[48:51], v[36:39], v[80:83]
    v_bitop3_b32 v88, v88, v38, 1 bitop3:0xa8
    v_cmp_ne_u32 vcc, 0, v88
    s_cbranch_vccz Lp1k_65
    s_nop 0
    s_mov_b64 exec, vcc
    buffer_load_dwordx4 v[32:35], v11, s[8:11], s50 offen offset:0 sc1
    buffer_load_dwordx4 v[36:39], v11, s[8:11], s50 offen offset:1024 sc1
    s_mov_b64 exec, -1
    s_sub_u32 s21, s21, 1
    s_cbranch_scc0 Lp1_63
Lp1k_64:
Lp1k_65:
    buffer_store_dword v15, v12, s[8:11], s48 offen
    s_nop 3
    v_add_f32_dpp v80, v80, v80 row_ror:4 row_mask:0xf bank_mask:0xf
    v_add_f32_dpp v81, v81, v81 row_ror:4 row_mask:0xf bank_mask:0xf
    s_nop 0
    v_add_f32_dpp v80, v80, v80 row_ror:8 row_mask:0xf bank_mask:0xf
    v_add_f32_dpp v81, v81, v81 row_ror:8 row_mask:0xf bank_mask:0xf
    v_cvt_pk_bf16_f32 v83, v80, v81
    v_min_u32 v83, -2, v83
    buffer_store_dword v83, v12, s[8:11], s49 offen
    s_max_i32 s21, s21, 0
    s_add_u32 s20, s20, 1
    s_add_u32 s36, s36, 8192
    s_add_u32 s37, s37, 2048
    s_waitcnt vmcnt(1)
    buffer_load_dwordx4 v[88:91], v3, s[8:11], s61 offen offset:0 sc1
    buffer_load_dwordx4 v[92:95], v3, s[8:11], s61 offen offset:1024 sc1
    s_waitcnt vmcnt(2)
Lp2_66:
    buffer_load_dwordx4 v[88:91], v3, s[8:11], s61 offen offset:0 sc1
    buffer_load_dwordx4 v[92:95], v3, s[8:11], s61 offen offset:1024 sc1
    s_mov_b64 exec, -1
    s_waitcnt vmcnt(2)
    v_max3_u32 v80, v88, v89, v90
    v_max3_u32 v81, v91, v92, v93
    v_max3_u32 v80, v80, v94, v95
    v_max_u32 v80, v80, v81
    v_cmp_eq_u32 vcc, -1, v80
    s_nop 4
    s_cbranch_vccz Lstep21_18
    s_mov_b64 exec, vcc
    s_sub_u32 s21, s21, 1
    s_cbranch_scc0 Lp2_66
    s_mov_b64 exec, -1
    s_mov_b32 s21, 0
Lstep21_18:
    ds_write_b128 v3, v[88:91] offset:4096
    ds_write_b128 v3, v[92:95] offset:5120
    s_add_u32 s34, s34, 16384
    s_mov_b32 m0, 143360
    s_add_u32 s35, s35, 16384
    s_waitcnt vmcnt(2)
    ds_read_b128 v[24:27], v7 offset:4096
    ds_read_b128 v[28:31], v7 offset:4608
    ds_read_b128 v[32:35], v7 offset:5120
    ds_read_b128 v[36:39], v7 offset:5632
    s_waitcnt lgkmcnt(4)
    s_barrier
    s_and_b32 s42, s20, 7
    s_cmp_lg_u32 s42, 7
    s_cbranch_scc1 Lkvok_67
    s_cmp_eq_u32 s20, 63
    s_cbranch_scc1 Lkvok_67
    s_mov_b64 exec, 15
    v_cmp_ne_u64 vcc, s[62:63], v[0:1]
    s_mov_b64 exec, -1
    s_nop 3
    s_cbranch_vccz Lkvok_67
    s_mov_b64 exec, 15
Lkv_68:
    v_lshlrev_b32 v0, 3, v2
    buffer_load_dwordx2 v[0:1], v0, s[8:11], s23 offen sc1
    s_waitcnt vmcnt(0)
    v_cmp_ne_u64 vcc, s[62:63], v[0:1]
    s_nop 4
    s_cbranch_vccz Lkvd_69
    s_sleep 2
    s_sub_u32 s21, s21, 1
    s_cbranch_scc0 Lkv_68
    s_mov_b32 s21, 0
Lkvd_69:
    s_mov_b64 exec, -1
Lkvok_67:
    ds_read_b128 v[40:43], v7 offset:6144
    ds_read_b128 v[44:47], v7 offset:6656
    s_waitcnt lgkmcnt(5)
    v_smfmac_f32_16x16x64_bf16 v[56:59], v[24:27], a[64:71], v8
    ds_read_b128 v[48:51], v7 offset:7168
    v_smfmac_f32_16x16x64_bf16 v[60:63], v[24:27], a[192:199], v8
    ds_read_b128 v[52:55], v7 offset:7680
    s_waitcnt lgkmcnt(6)
    v_smfmac_f32_16x16x64_bf16 v[56:59], v[28:31], a[72:79], v8
    ds_read_b128 v[80:83], v7 offset:0
    v_smfmac_f32_16x16x64_bf16 v[60:63], v[28:31], a[200:207], v8
    ds_read_b128 v[84:87], v7 offset:512
    s_waitcnt vmcnt(0)
    s_waitcnt lgkmcnt(6)
    v_smfmac_f32_16x16x64_bf16 v[56:59], v[32:35], a[80:87], v8
    ds_read_b128 v[88:91], v7 offset:1024
    v_smfmac_f32_16x16x64_bf16 v[60:63], v[32:35], a[208:215], v8
    ds_read_b128 v[92:95], v7 offset:1536
    v_smfmac_f32_16x16x64_bf16 v[56:59], v[36:39], a[88:95], v8
    v_smfmac_f32_16x16x64_bf16 v[60:63], v[36:39], a[216:223], v8
    s_waitcnt lgkmcnt(7)
    v_smfmac_f32_16x16x64_bf16 v[56:59], v[40:43], a[96:103], v8
    ds_read_b128 v[96:99], v7 offset:2048
    v_smfmac_f32_16x16x64_bf16 v[60:63], v[40:43], a[224:231], v8
    s_waitcnt lgkmcnt(7)
    v_smfmac_f32_16x16x64_bf16 v[56:59], v[44:47], a[104:111], v8
    ds_read_b128 v[100:103], v7 offset:2560
    v_smfmac_f32_16x16x64_bf16 v[60:63], v[44:47], a[232:239], v8
    s_waitcnt lgkmcnt(7)
    v_smfmac_f32_16x16x64_bf16 v[56:59], v[48:51], a[112:119], v8
    ds_read_b128 v[104:107], v7 offset:3072
    v_smfmac_f32_16x16x64_bf16 v[60:63], v[48:51], a[240:247], v8
    s_waitcnt lgkmcnt(7)
    v_smfmac_f32_16x16x64_bf16 v[56:59], v[52:55], a[120:127], v8
    ds_read_b128 v[108:111], v7 offset:3584
    v_smfmac_f32_16x16x64_bf16 v[60:63], v[52:55], a[248:255], v8
    s_waitcnt lgkmcnt(6)
    v_smfmac_f32_16x16x64_bf16 v[56:59], v[80:83], a[0:7], v8
    v_smfmac_f32_16x16x64_bf16 v[60:63], v[80:83], a[128:135], v8
    buffer_load_dwordx4 v13, s[8:11], s34 offen sc1 lds
    v_smfmac_f32_16x16x64_bf16 v[56:59], v[84:87], a[8:15], v8
    v_smfmac_f32_16x16x64_bf16 v[60:63], v[84:87], a[136:143], v8
    buffer_load_dwordx4 v13, s[8:11], s34 offen offset:1024 sc1 lds
    s_waitcnt lgkmcnt(4)
    v_smfmac_f32_16x16x64_bf16 v[56:59], v[88:91], a[16:23], v8
    v_smfmac_f32_16x16x64_bf16 v[60:63], v[88:91], a[144:151], v8
    buffer_load_dwordx4 v[112:115], v13, s[8:11], s35 offen sc1
    v_smfmac_f32_16x16x64_bf16 v[56:59], v[92:95], a[24:31], v8
    v_smfmac_f32_16x16x64_bf16 v[60:63], v[92:95], a[152:159], v8
    buffer_load_dwordx4 v[116:119], v13, s[8:11], s35 offen offset:1024 sc1
    s_waitcnt lgkmcnt(2)
    v_smfmac_f32_16x16x64_bf16 v[56:59], v[96:99], a[32:39], v8
    v_smfmac_f32_16x16x64_bf16 v[60:63], v[96:99], a[160:167], v8
    v_smfmac_f32_16x16x64_bf16 v[56:59], v[100:103], a[40:47], v8
    v_smfmac_f32_16x16x64_bf16 v[60:63], v[100:103], a[168:175], v8
    s_waitcnt lgkmcnt(0)
    v_smfmac_f32_16x16x64_bf16 v[56:59], v[104:107], a[48:55], v8
    v_smfmac_f32_16x16x64_bf16 v[60:63], v[104:107], a[176:183], v8
    v_smfmac_f32_16x16x64_bf16 v[56:59], v[108:111], a[56:63], v8
    v_smfmac_f32_16x16x64_bf16 v[60:63], v[108:111], a[184:191], v8
    v_smfmac_f32_16x16x64_bf16 v[64:67], v[96:99], v[160:167], v8
    s_nop 0
    v_smfmac_f32_16x16x64_bf16 v[64:67], v[100:103], v[168:175], v8
    s_nop 0
    v_smfmac_f32_16x16x64_bf16 v[64:67], v[104:107], v[176:183], v8
    ds_read_b128 v[96:99], v3 offset:16384
    ds_read_b128 v[100:103], v3 offset:17408
    v_permlane32_swap_b32 v56, v58
    v_permlane32_swap_b32 v57, v59
    v_permlane32_swap_b32 v60, v62
    v_permlane32_swap_b32 v61, v63
    v_cvt_pk_bf16_f32 v56, v56, v58
    v_cvt_pk_bf16_f32 v57, v57, v59
    ds_write2_b32 v4, v56, v57 offset0:0 offset1:136
    v_cvt_pk_bf16_f32 v60, v60, v62
    v_cvt_pk_bf16_f32 v61, v61, v63
    ds_write2_b32 v4, v60, v61 offset0:64 offset1:200
    v_smfmac_f32_16x16x64_bf16 v[64:67], v[108:111], v[184:191], v8
    ds_read_b128 v[104:107], v3 offset:18432
    v_smfmac_f32_16x16x64_bf16 v[64:67], v[80:83], v[128:135], v8
    ds_read_b128 v[108:111], v3 offset:19456
    v_smfmac_f32_16x16x64_bf16 v[64:67], v[84:87], v[136:143], v8
    v_smfmac_f32_16x16x64_bf16 v[64:67], v[88:91], v[144:151], v8
    v_smfmac_f32_16x16x64_bf16 v[64:67], v[92:95], v[152:159], v8
    s_waitcnt lgkmcnt(2)
    s_barrier
    ds_read_b128 v[80:83], v5 offset:0
    ds_read_b128 v[84:87], v5 offset:64
    v_smfmac_f32_16x16x64_bf16 v[64:67], v[24:27], v[192:199], v8
    ds_read_b128 v[88:91], v5 offset:128
    v_smfmac_f32_16x16x64_bf16 v[64:67], v[28:31], v[200:207], v8
    ds_read_b128 v[92:95], v5 offset:192
    v_smfmac_f32_16x16x64_bf16 v[64:67], v[32:35], v[208:215], v8
    ds_read_b128 v[24:27], v3 offset:20480
    v_smfmac_f32_16x16x64_bf16 v[64:67], v[36:39], v[216:223], v8
    ds_read_b128 v[28:31], v3 offset:21504
    s_waitcnt lgkmcnt(5)
    v_mfma_f32_16x16x32_bf16 v[56:59], v[96:99], v[80:83], 0
    ds_read_b128 v[32:35], v3 offset:22528
    s_waitcnt lgkmcnt(5)
    v_mfma_f32_16x16x32_bf16 v[56:59], v[100:103], v[84:87], v[56:59]
    ds_read_b128 v[36:39], v3 offset:23552
    v_smfmac_f32_16x16x64_bf16 v[64:67], v[40:43], v[224:231], v8
    s_waitcnt lgkmcnt(5)
    v_mfma_f32_16x16x32_bf16 v[56:59], v[104:107], v[88:91], v[56:59]
    ds_read_b128 v[40:43], v5 offset:256
    v_smfmac_f32_16x16x64_bf16 v[64:67], v[44:47], v[232:239], v8
    s_waitcnt lgkmcnt(5)
    v_mfma_f32_16x16x32_bf16 v[56:59], v[108:111], v[92:95], v[56:59]
    ds_read_b128 v[44:47], v5 offset:320
    v_smfmac_f32_16x16x64_bf16 v[64:67], v[48:51], v[240:247], v8
    ds_read_b128 v[96:99], v9 offset:12288
    v_smfmac_f32_16x16x64_bf16 v[64:67], v[52:55], v[248:255], v8
    ds_read_b128 v[48:51], v5 offset:384
    s_waitcnt lgkmcnt(4)
    v_mfma_f32_16x16x32_bf16 v[60:63], v[24:27], v[80:83], 0
    ds_read_b128 v[52:55], v5 offset:448
    v_mfma_f32_16x16x32_bf16 v[60:63], v[28:31], v[84:87], v[60:63]
    ds_read_b128 v[100:103], v9 offset:13312
    v_mfma_f32_16x16x32_bf16 v[60:63], v[32:35], v[88:91], v[60:63]
    ds_read_b128 v[104:107], v9 offset:14336
    v_mfma_f32_16x16x32_bf16 v[60:63], v[36:39], v[92:95], v[60:63]
    ds_read_b128 v[108:111], v9 offset:15360
    s_waitcnt lgkmcnt(3)
    v_mfma_f32_16x16x32_bf16 v[68:71], v[40:43], v[80:83], 0
    ds_read_b128 v[24:27], v9 offset:0
    v_max3_f32 v22, v56, v57, v58
    v_cvt_pk_bf16_f32 v64, v64, v65
    v_mfma_f32_16x16x32_bf16 v[68:71], v[44:47], v[84:87], v[68:71]
    ds_read_b128 v[28:31], v9 offset:1024
    v_cvt_pk_bf16_f32 v65, v66, v67
    buffer_store_dwordx4 v[48:51], v14, s[8:11], s36 offen sc1
    v_mfma_f32_16x16x32_bf16 v[68:71], v[48:51], v[88:91], v[68:71]
    ds_read_b128 v[32:35], v9 offset:2048
    v_lshrrev_b32 v72, 1, v14
    buffer_store_dwordx2 v[64:65], v72, s[8:11], s37 offen sc1
    v_mfma_f32_16x16x32_bf16 v[68:71], v[52:55], v[92:95], v[68:71]
    ds_read_b128 v[36:39], v9 offset:3072
    v_max3_f32 v23, v59, v60, v61
    v_max3_f32 v22, v22, v62, v63
    ds_read_b128 v[80:83], v9 offset:8192
    ds_read_b128 v[84:87], v9 offset:9216
    ds_read_b128 v[88:91], v9 offset:10240
    s_cmp_eq_u32 s20, 63
    s_cbranch_scc1 Ldone_25
    s_nop 0
    v_max3_f32 v23, v23, v68, v69
    v_max3_f32 v22, v22, v70, v71
    v_max_f32 v22, v22, v23
    v_mov_b32 v23, v22
    ds_read_b128 v[92:95], v9 offset:11264
    ds_read_b128 v[40:43], v9 offset:4096
    v_permlane16_swap_b32 v22, v23
    v_max_f32 v22, v22, v23
    v_mov_b32 v23, v22
    s_nop 1
    s_nop 0
    v_permlane32_swap_b32 v22, v23
    v_max_f32 v22, v22, v23
    v_mul_f32 v22, s38, v22
    v_pk_fma_f32 v[56:57], v[56:57], s[38:39], v[22:23] op_sel_hi:[1,0,0] neg_lo:[0,0,1] neg_hi:[0,0,1]
    v_pk_fma_f32 v[58:59], v[58:59], s[38:39], v[22:23] op_sel_hi:[1,0,0] neg_lo:[0,0,1] neg_hi:[0,0,1]
    v_pk_fma_f32 v[60:61], v[60:61], s[38:39], v[22:23] op_sel_hi:[1,0,0] neg_lo:[0,0,1] neg_hi:[0,0,1]
    v_pk_fma_f32 v[62:63], v[62:63], s[38:39], v[22:23] op_sel_hi:[1,0,0] neg_lo:[0,0,1] neg_hi:[0,0,1]
    v_pk_fma_f32 v[68:69], v[68:69], s[38:39], v[22:23] op_sel_hi:[1,0,0] neg_lo:[0,0,1] neg_hi:[0,0,1]
    v_pk_fma_f32 v[70:71], v[70:71], s[38:39], v[22:23] op_sel_hi:[1,0,0] neg_lo:[0,0,1] neg_hi:[0,0,1]
    v_exp_f32 v56, v56
    v_exp_f32 v57, v57
    v_exp_f32 v58, v58
    v_exp_f32 v59, v59
    v_exp_f32 v60, v60
    v_exp_f32 v61, v61
    v_exp_f32 v62, v62
    v_exp_f32 v63, v63
    v_exp_f32 v68, v68
    v_exp_f32 v69, v69
    v_exp_f32 v70, v70
    v_exp_f32 v71, v71
    v_cvt_pk_bf16_f32 v56, v56, v57
    v_cvt_pk_bf16_f32 v57, v58, v59
    v_cvt_pk_bf16_f32 v58, v60, v61
    v_cvt_pk_bf16_f32 v59, v62, v63
    v_cvt_pk_bf16_f32 v68, v68, v69
    v_cvt_pk_bf16_f32 v69, v70, v71
    v_mfma_f32_16x16x32_bf16 v[76:79], v[16:19], v[56:59], 0
    s_mov_b32 exec_hi, 0
    v_mov_b64 v[20:21], v[68:69]
    v_mov_b64 v[68:69], 0
    s_mov_b32 exec_hi, -1
    ds_read_b128 v[44:47], v9 offset:5120
    v_mfma_f32_16x16x32_bf16 v[60:63], v[120:123], v[56:59], 0
    ds_read_b128 v[48:51], v9 offset:6144
    v_mfma_f32_16x16x32_bf16 v[72:75], v[124:127], v[56:59], 0
    ds_read_b128 v[52:55], v9 offset:7168
    v_mfma_f32_16x16x16_bf16 v[76:79], v[16:17], v[20:21], v[76:79]
    v_mov_b64 v[120:121], 0
    v_mov_b64 v[122:123], 0
    v_mfma_f32_16x16x16_bf16 v[60:63], v[64:65], v[20:21], v[60:63]
    v_mov_b64 v[124:125], 0
    v_mfma_f32_16x16x16_bf16 v[72:75], v[64:65], v[68:69], v[72:75]
    v_mov_b64 v[126:127], 0
    s_nop 1
    v_rcp_f32 v22, v76
    s_nop 1
    v_pk_mul_f32 v[60:61], v[60:61], v[22:23] op_sel_hi:[1,0]
    v_pk_mul_f32 v[62:63], v[62:63], v[22:23] op_sel_hi:[1,0]
    v_pk_mul_f32 v[72:73], v[72:73], v[22:23] op_sel_hi:[1,0]
    v_pk_mul_f32 v[74:75], v[74:75], v[22:23] op_sel_hi:[1,0]
    v_cvt_pk_bf16_f32 v56, v60, v72
    v_cvt_pk_bf16_f32 v57, v61, v73
    v_cvt_pk_bf16_f32 v58, v62, v74
    v_cvt_pk_bf16_f32 v59, v63, v75
    ds_write_b128 v6, v[56:59] offset:128
    v_mov_b64 v[60:61], 0
    v_mov_b64 v[62:63], 0
    s_waitcnt lgkmcnt(0)
    s_barrier
    ds_read_b128 v[64:67], v6 offset:0
    ds_read_b128 v[68:71], v6 offset:64
    ds_read_b128 v[72:75], v6 offset:128
    ds_read_b128 v[76:79], v6 offset:192
    v_mov_b64 v[56:57], 0
    v_mov_b64 v[58:59], 0
    s_waitcnt lgkmcnt(3)
    v_smfmac_f32_16x16x64_bf16 v[120:123], v[64:67], v[24:31], v8
    s_waitcnt lgkmcnt(2)
    v_smfmac_f32_16x16x64_bf16 v[120:123], v[68:71], v[32:39], v8
    ds_read_b128 v[24:27], v9 offset:16384
    s_waitcnt lgkmcnt(2)
    v_smfmac_f32_16x16x64_bf16 v[120:123], v[72:75], v[40:47], v8
    ds_read_b128 v[28:31], v9 offset:17408
    ds_read_b128 v[32:35], v9 offset:18432
    s_waitcnt lgkmcnt(3)
    v_smfmac_f32_16x16x64_bf16 v[120:123], v[76:79], v[48:55], v8
    ds_read_b128 v[36:39], v9 offset:19456
    v_smfmac_f32_16x16x64_bf16 v[124:127], v[64:67], v[80:87], v8
    ds_read_b128 v[40:43], v9 offset:20480
    ds_read_b128 v[44:47], v9 offset:21504
    v_smfmac_f32_16x16x64_bf16 v[124:127], v[68:71], v[88:95], v8
    ds_read_b128 v[48:51], v9 offset:22528
    v_smfmac_f32_16x16x64_bf16 v[124:127], v[72:75], v[96:103], v8
    ds_read_b128 v[52:55], v9 offset:23552
    ds_read_b128 v[80:83], v9 offset:24576
    v_smfmac_f32_16x16x64_bf16 v[124:127], v[76:79], v[104:111], v8
    ds_read_b128 v[84:87], v9 offset:25600
    v_cvt_pk_bf16_f32 v120, v120, v121
    v_cvt_pk_bf16_f32 v121, v122, v123
    s_waitcnt lgkmcnt(6)
    v_smfmac_f32_16x16x64_bf16 v[60:63], v[64:67], v[24:31], v8
    ds_read_b128 v[88:91], v9 offset:26624
    v_or_b32 v120, 1, v120
    buffer_store_dwordx2 v[120:121], v10, s[8:11], s64 offen
    v_smfmac_f32_16x16x64_bf16 v[60:63], v[68:71], v[32:39], v8
    ds_read_b128 v[92:95], v9 offset:27648
    ds_read_b128 v[96:99], v9 offset:28672
    s_waitcnt lgkmcnt(5)
    v_smfmac_f32_16x16x64_bf16 v[60:63], v[72:75], v[40:47], v8
    ds_read_b128 v[100:103], v9 offset:29696
    v_cvt_pk_bf16_f32 v124, v124, v125
    v_cvt_pk_bf16_f32 v125, v126, v127
    v_smfmac_f32_16x16x64_bf16 v[60:63], v[76:79], v[48:55], v8
    ds_read_b128 v[104:107], v9 offset:30720
    ds_read_b128 v[108:111], v9 offset:31744
    v_or_b32 v124, 1, v124
    buffer_store_dwordx2 v[124:125], v10, s[8:11], s65 offen
    s_waitcnt lgkmcnt(4)
    v_smfmac_f32_16x16x64_bf16 v[56:59], v[64:67], v[80:87], v8
    ds_read_b128 v[48:51], v3 offset:31168
    v_smfmac_f32_16x16x64_bf16 v[56:59], v[68:71], v[88:95], v8
    s_waitcnt lgkmcnt(1)
    v_smfmac_f32_16x16x64_bf16 v[56:59], v[72:75], v[96:103], v8
    v_cvt_pk_bf16_f32 v60, v60, v61
    v_cvt_pk_bf16_f32 v61, v62, v63
    v_smfmac_f32_16x16x64_bf16 v[56:59], v[76:79], v[104:111], v8
    v_or_b32 v60, 1, v60
    buffer_store_dwordx2 v[60:61], v10, s[8:11], s66 offen
    s_nop 5
    v_cvt_pk_bf16_f32 v56, v56, v57
    v_cvt_pk_bf16_f32 v57, v58, v59
    v_or_b32 v56, 1, v56
    buffer_store_dwordx2 v[56:57], v10, s[8:11], s67 offen
    v_mov_b64 v[64:65], 0
    v_mov_b64 v[66:67], 0
    v_mov_b64 v[60:61], 0
    v_mov_b64 v[62:63], 0
    v_mov_b64 v[58:59], 0
    v_mov_b64 v[56:57], 0
    s_waitcnt vmcnt(1)
    buffer_load_dwordx4 v[24:27], v11, s[8:11], s50 offen offset:0 sc1
    buffer_load_dwordx4 v[28:31], v11, s[8:11], s50 offen offset:1024 sc1
    s_waitcnt vmcnt(2)
    buffer_load_dwordx4 v[32:35], v11, s[8:11], s50 offen offset:0 sc1
    buffer_load_dwordx4 v[36:39], v11, s[8:11], s50 offen offset:1024 sc1
    s_waitcnt lgkmcnt(0)
Lp1_71:
    s_waitcnt vmcnt(2)
    v_mfma_f32_16x16x32_bf16 v[80:83], v[48:51], v[24:27], 0
    v_bitop3_b32 v88, v24, v26, v28 bitop3:0x80
    v_mfma_f32_16x16x32_bf16 v[80:83], v[48:51], v[28:31], v[80:83]
    v_bitop3_b32 v88, v88, v30, 1 bitop3:0x2a
    v_cmp_ne_u32 vcc, 0, v88
    s_cbranch_vccz Lp1k_72
    s_nop 0
    s_mov_b64 exec, vcc
    buffer_load_dwordx4 v[24:27], v11, s[8:11], s50 offen offset:0 sc1
    buffer_load_dwordx4 v[28:31], v11, s[8:11], s50 offen offset:1024 sc1
    s_mov_b64 exec, -1
    s_waitcnt vmcnt(2)
    v_mfma_f32_16x16x32_bf16 v[80:83], v[48:51], v[32:35], 0
    v_bitop3_b32 v88, v32, v34, v36 bitop3:0x80
    v_mfma_f32_16x16x32_bf16 v[80:83], v[48:51], v[36:39], v[80:83]
    v_bitop3_b32 v88, v88, v38, 1 bitop3:0x2a
    v_cmp_ne_u32 vcc, 0, v88
    s_cbranch_vccz Lp1k_73
    s_nop 0
    s_mov_b64 exec, vcc
    buffer_load_dwordx4 v[32:35], v11, s[8:11], s50 offen offset:0 sc1
    buffer_load_dwordx4 v[36:39], v11, s[8:11], s50 offen offset:1024 sc1
    s_mov_b64 exec, -1
    s_sub_u32 s21, s21, 1
    s_cbranch_scc0 Lp1_71
Lp1k_72:
Lp1k_73:
    buffer_store_dword v15, v12, s[8:11], s49 offen
    s_nop 3
    v_add_f32_dpp v80, v80, v80 row_ror:4 row_mask:0xf bank_mask:0xf
    v_add_f32_dpp v81, v81, v81 row_ror:4 row_mask:0xf bank_mask:0xf
    s_nop 0
    v_add_f32_dpp v80, v80, v80 row_ror:8 row_mask:0xf bank_mask:0xf
    v_add_f32_dpp v81, v81, v81 row_ror:8 row_mask:0xf bank_mask:0xf
    v_cvt_pk_bf16_f32 v83, v80, v81
    v_min_u32 v83, -2, v83
    buffer_store_dword v83, v12, s[8:11], s48 offen
    s_max_i32 s21, s21, 0
    s_add_u32 s20, s20, 1
    s_add_u32 s36, s36, 8192
    s_add_u32 s37, s37, 2048
    s_waitcnt vmcnt(1)
    buffer_load_dwordx4 v[88:91], v3, s[8:11], s60 offen offset:0 sc1
    buffer_load_dwordx4 v[92:95], v3, s[8:11], s60 offen offset:1024 sc1
    s_waitcnt vmcnt(2)
Lp2_74:
    buffer_load_dwordx4 v[88:91], v3, s[8:11], s60 offen offset:0 sc1
    buffer_load_dwordx4 v[92:95], v3, s[8:11], s60 offen offset:1024 sc1
    s_mov_b64 exec, -1
    s_waitcnt vmcnt(2)
    v_max3_u32 v80, v88, v89, v90
    v_max3_u32 v81, v91, v92, v93
    v_max3_u32 v80, v80, v94, v95
    v_max_u32 v80, v80, v81
    v_cmp_eq_u32 vcc, -1, v80
    s_nop 4
    s_cbranch_vccz Lstep20_17
    s_mov_b64 exec, vcc
    s_sub_u32 s21, s21, 1
    s_cbranch_scc0 Lp2_74
    s_mov_b64 exec, -1
    s_mov_b32 s21, 0
    s_branch Lstep20_17
Lentry3_24:
    v_mov_b64 v[24:25], v[96:97]
    v_mov_b64 v[26:27], v[98:99]
    v_mov_b64 v[28:29], v[100:101]
    v_mov_b64 v[30:31], v[102:103]
    v_mov_b64 v[32:33], v[104:105]
    v_mov_b64 v[34:35], v[106:107]
    v_mov_b64 v[36:37], v[108:109]
    v_mov_b64 v[38:39], v[110:111]
    ds_write_b128 v7, v[24:27] offset:6144
    ds_write_b128 v7, v[28:31] offset:6656
    ds_write_b128 v7, v[32:35] offset:7168
    ds_write_b128 v7, v[36:39] offset:7680
    s_add_u32 s34, s34, 16384
    s_mov_b32 m0, 153600
    s_add_u32 s35, s35, 16384
    s_waitcnt vmcnt(0) lgkmcnt(0)
    s_branch Lb1_75
Lstep30_19:
    ds_write_b128 v3, v[88:91] offset:6144
    ds_write_b128 v3, v[92:95] offset:7168
    s_add_u32 s34, s34, 16384
    s_mov_b32 m0, 153600
    s_add_u32 s35, s35, 16384
    s_waitcnt vmcnt(2)
    ds_read_b128 v[24:27], v7 offset:6144
    ds_read_b128 v[28:31], v7 offset:6656
    ds_read_b128 v[32:35], v7 offset:7168
    ds_read_b128 v[36:39], v7 offset:7680
    s_waitcnt lgkmcnt(4)
Lb1_75:
    s_barrier
    ds_read_b128 v[40:43], v7 offset:0
    ds_read_b128 v[44:47], v7 offset:512
    s_waitcnt lgkmcnt(5)
    v_smfmac_f32_16x16x64_bf16 v[56:59], v[24:27], a[96:103], v8
    ds_read_b128 v[48:51], v7 offset:1024
    v_smfmac_f32_16x16x64_bf16 v[60:63], v[24:27], a[224:231], v8
    ds_read_b128 v[52:55], v7 offset:1536
    s_waitcnt lgkmcnt(6)
    v_smfmac_f32_16x16x64_bf16 v[56:59], v[28:31], a[104:111], v8
    ds_read_b128 v[80:83], v7 offset:2048
    v_smfmac_f32_16x16x64_bf16 v[60:63], v[28:31], a[232:239], v8
    ds_read_b128 v[84:87], v7 offset:2560
    s_waitcnt vmcnt(0)
    s_waitcnt lgkmcnt(6)
    v_smfmac_f32_16x16x64_bf16 v[56:59], v[32:35], a[112:119], v8
    ds_read_b128 v[88:91], v7 offset:3072
    v_smfmac_f32_16x16x64_bf16 v[60:63], v[32:35], a[240:247], v8
    ds_read_b128 v[92:95], v7 offset:3584
    v_smfmac_f32_16x16x64_bf16 v[56:59], v[36:39], a[120:127], v8
    v_smfmac_f32_16x16x64_bf16 v[60:63], v[36:39], a[248:255], v8
    s_waitcnt lgkmcnt(7)
    v_smfmac_f32_16x16x64_bf16 v[56:59], v[40:43], a[0:7], v8
    ds_read_b128 v[96:99], v7 offset:4096
    v_smfmac_f32_16x16x64_bf16 v[60:63], v[40:43], a[128:135], v8
    s_waitcnt lgkmcnt(7)
    v_smfmac_f32_16x16x64_bf16 v[56:59], v[44:47], a[8:15], v8
    ds_read_b128 v[100:103], v7 offset:4608
    v_smfmac_f32_16x16x64_bf16 v[60:63], v[44:47], a[136:143], v8
    s_waitcnt lgkmcnt(7)
    v_smfmac_f32_16x16x64_bf16 v[56:59], v[48:51], a[16:23], v8
    ds_read_b128 v[104:107], v7 offset:5120
    v_smfmac_f32_16x16x64_bf16 v[60:63], v[48:51], a[144:151], v8
    s_waitcnt lgkmcnt(7)
    v_smfmac_f32_16x16x64_bf16 v[56:59], v[52:55], a[24:31], v8
    ds_read_b128 v[108:111], v7 offset:5632
    v_smfmac_f32_16x16x64_bf16 v[60:63], v[52:55], a[152:159], v8
    s_waitcnt lgkmcnt(6)
    v_smfmac_f32_16x16x64_bf16 v[56:59], v[80:83], a[32:39], v8
    v_smfmac_f32_16x16x64_bf16 v[60:63], v[80:83], a[160:167], v8
    buffer_load_dwordx4 v13, s[8:11], s34 offen sc1 lds
    v_smfmac_f32_16x16x64_bf16 v[56:59], v[84:87], a[40:47], v8
    v_smfmac_f32_16x16x64_bf16 v[60:63], v[84:87], a[168:175], v8
    buffer_load_dwordx4 v13, s[8:11], s34 offen offset:1024 sc1 lds
    s_waitcnt lgkmcnt(4)
    v_smfmac_f32_16x16x64_bf16 v[56:59], v[88:91], a[48:55], v8
    v_smfmac_f32_16x16x64_bf16 v[60:63], v[88:91], a[176:183], v8
    buffer_load_dwordx4 v[120:123], v13, s[8:11], s35 offen sc1
    v_smfmac_f32_16x16x64_bf16 v[56:59], v[92:95], a[56:63], v8
    v_smfmac_f32_16x16x64_bf16 v[60:63], v[92:95], a[184:191], v8
    buffer_load_dwordx4 v[124:127], v13, s[8:11], s35 offen offset:1024 sc1
    s_waitcnt lgkmcnt(2)
    v_smfmac_f32_16x16x64_bf16 v[56:59], v[96:99], a[64:71], v8
    v_smfmac_f32_16x16x64_bf16 v[60:63], v[96:99], a[192:199], v8
    v_smfmac_f32_16x16x64_bf16 v[56:59], v[100:103], a[72:79], v8
    v_smfmac_f32_16x16x64_bf16 v[60:63], v[100:103], a[200:207], v8
    s_waitcnt lgkmcnt(0)
    v_smfmac_f32_16x16x64_bf16 v[56:59], v[104:107], a[80:87], v8
    v_smfmac_f32_16x16x64_bf16 v[60:63], v[104:107], a[208:215], v8
    v_smfmac_f32_16x16x64_bf16 v[56:59], v[108:111], a[88:95], v8
    v_smfmac_f32_16x16x64_bf16 v[60:63], v[108:111], a[216:223], v8
    v_smfmac_f32_16x16x64_bf16 v[64:67], v[96:99], v[192:199], v8
    s_nop 0
    v_smfmac_f32_16x16x64_bf16 v[64:67], v[100:103], v[200:207], v8
    s_nop 0
    v_smfmac_f32_16x16x64_bf16 v[64:67], v[104:107], v[208:215], v8
    ds_read_b128 v[96:99], v3 offset:8192
    ds_read_b128 v[100:103], v3 offset:9216
    v_permlane32_swap_b32 v56, v58
    v_permlane32_swap_b32 v57, v59
    v_permlane32_swap_b32 v60, v62
    v_permlane32_swap_b32 v61, v63
    v_cvt_pk_bf16_f32 v56, v56, v58
    v_cvt_pk_bf16_f32 v57, v57, v59
    ds_write2_b32 v4, v56, v57 offset0:0 offset1:136
    v_cvt_pk_bf16_f32 v60, v60, v62
    v_cvt_pk_bf16_f32 v61, v61, v63
    ds_write2_b32 v4, v60, v61 offset0:64 offset1:200
    v_smfmac_f32_16x16x64_bf16 v[64:67], v[108:111], v[216:223], v8
    ds_read_b128 v[104:107], v3 offset:10240
    v_smfmac_f32_16x16x64_bf16 v[64:67], v[80:83], v[160:167], v8
    ds_read_b128 v[108:111], v3 offset:11264
    v_smfmac_f32_16x16x64_bf16 v[64:67], v[84:87], v[168:175], v8
    v_smfmac_f32_16x16x64_bf16 v[64:67], v[88:91], v[176:183], v8
    v_smfmac_f32_16x16x64_bf16 v[64:67], v[92:95], v[184:191], v8
    s_waitcnt lgkmcnt(2)
    s_barrier
    ds_read_b128 v[80:83], v5 offset:0
    ds_read_b128 v[84:87], v5 offset:64
    v_smfmac_f32_16x16x64_bf16 v[64:67], v[24:27], v[224:231], v8
    ds_read_b128 v[88:91], v5 offset:128
    v_smfmac_f32_16x16x64_bf16 v[64:67], v[28:31], v[232:239], v8
    ds_read_b128 v[92:95], v5 offset:192
    v_smfmac_f32_16x16x64_bf16 v[64:67], v[32:35], v[240:247], v8
    ds_read_b128 v[24:27], v3 offset:12288
    v_smfmac_f32_16x16x64_bf16 v[64:67], v[36:39], v[248:255], v8
    ds_read_b128 v[28:31], v3 offset:13312
    s_waitcnt lgkmcnt(5)
    v_mfma_f32_16x16x32_bf16 v[56:59], v[96:99], v[80:83], 0
    ds_read_b128 v[32:35], v3 offset:14336
    s_waitcnt lgkmcnt(5)
    v_mfma_f32_16x16x32_bf16 v[56:59], v[100:103], v[84:87], v[56:59]
    ds_read_b128 v[36:39], v3 offset:15360
    v_smfmac_f32_16x16x64_bf16 v[64:67], v[40:43], v[128:135], v8
    s_waitcnt lgkmcnt(5)
    v_mfma_f32_16x16x32_bf16 v[56:59], v[104:107], v[88:91], v[56:59]
    ds_read_b128 v[40:43], v5 offset:256
    v_smfmac_f32_16x16x64_bf16 v[64:67], v[44:47], v[136:143], v8
    s_waitcnt lgkmcnt(5)
    v_mfma_f32_16x16x32_bf16 v[56:59], v[108:111], v[92:95], v[56:59]
    ds_read_b128 v[44:47], v5 offset:320
    v_smfmac_f32_16x16x64_bf16 v[64:67], v[48:51], v[144:151], v8
    ds_read_b128 v[96:99], v9 offset:12288
    v_smfmac_f32_16x16x64_bf16 v[64:67], v[52:55], v[152:159], v8
    ds_read_b128 v[48:51], v5 offset:384
    s_waitcnt lgkmcnt(4)
    v_mfma_f32_16x16x32_bf16 v[60:63], v[24:27], v[80:83], 0
    ds_read_b128 v[52:55], v5 offset:448
    v_mfma_f32_16x16x32_bf16 v[60:63], v[28:31], v[84:87], v[60:63]
    ds_read_b128 v[100:103], v9 offset:13312
    v_mfma_f32_16x16x32_bf16 v[60:63], v[32:35], v[88:91], v[60:63]
    ds_read_b128 v[104:107], v9 offset:14336
    v_mfma_f32_16x16x32_bf16 v[60:63], v[36:39], v[92:95], v[60:63]
    ds_read_b128 v[108:111], v9 offset:15360
    s_waitcnt lgkmcnt(3)
    v_mfma_f32_16x16x32_bf16 v[68:71], v[40:43], v[80:83], 0
    ds_read_b128 v[24:27], v9 offset:0
    v_max3_f32 v22, v56, v57, v58
    v_cvt_pk_bf16_f32 v64, v64, v65
    v_mfma_f32_16x16x32_bf16 v[68:71], v[44:47], v[84:87], v[68:71]
    ds_read_b128 v[28:31], v9 offset:1024
    v_cvt_pk_bf16_f32 v65, v66, v67
    buffer_store_dwordx4 v[52:55], v14, s[8:11], s36 offen sc1
    v_mfma_f32_16x16x32_bf16 v[68:71], v[48:51], v[88:91], v[68:71]
    ds_read_b128 v[32:35], v9 offset:2048
    v_lshrrev_b32 v72, 1, v14
    buffer_store_dwordx2 v[64:65], v72, s[8:11], s37 offen sc1
    v_mfma_f32_16x16x32_bf16 v[68:71], v[52:55], v[92:95], v[68:71]
    ds_read_b128 v[36:39], v9 offset:3072
    v_max3_f32 v23, v59, v60, v61
    v_max3_f32 v22, v22, v62, v63
    ds_read_b128 v[80:83], v9 offset:8192
    ds_read_b128 v[84:87], v9 offset:9216
    ds_read_b128 v[88:91], v9 offset:10240
    s_and_b32 s42, s20, 7
    s_cmp_lg_u32 s42, 6
    s_cbranch_scc1 Lkvn_76
    s_add_u32 s23, s23, 32768
    s_mov_b64 exec, 15
    v_lshlrev_b32 v0, 3, v2
    buffer_load_dwordx2 v[0:1], v0, s[8:11], s23 offen sc1
    s_mov_b64 exec, -1
Lkvn_76:
    s_nop 1
    v_max3_f32 v23, v23, v68, v69
    v_max3_f32 v22, v22, v70, v71
    v_max_f32 v22, v22, v23
    v_mov_b32 v23, v22
    ds_read_b128 v[92:95], v9 offset:11264
    ds_read_b128 v[40:43], v9 offset:4096
    v_permlane16_swap_b32 v22, v23
    v_max_f32 v22, v22, v23
    v_mov_b32 v23, v22
    s_nop 1
    s_nop 0
    v_permlane32_swap_b32 v22, v23
    v_max_f32 v22, v22, v23
    v_mul_f32 v22, s38, v22
    v_pk_fma_f32 v[56:57], v[56:57], s[38:39], v[22:23] op_sel_hi:[1,0,0] neg_lo:[0,0,1] neg_hi:[0,0,1]
    v_pk_fma_f32 v[58:59], v[58:59], s[38:39], v[22:23] op_sel_hi:[1,0,0] neg_lo:[0,0,1] neg_hi:[0,0,1]
    v_pk_fma_f32 v[60:61], v[60:61], s[38:39], v[22:23] op_sel_hi:[1,0,0] neg_lo:[0,0,1] neg_hi:[0,0,1]
    v_pk_fma_f32 v[62:63], v[62:63], s[38:39], v[22:23] op_sel_hi:[1,0,0] neg_lo:[0,0,1] neg_hi:[0,0,1]
    v_pk_fma_f32 v[68:69], v[68:69], s[38:39], v[22:23] op_sel_hi:[1,0,0] neg_lo:[0,0,1] neg_hi:[0,0,1]
    v_pk_fma_f32 v[70:71], v[70:71], s[38:39], v[22:23] op_sel_hi:[1,0,0] neg_lo:[0,0,1] neg_hi:[0,0,1]
    v_exp_f32 v56, v56
    v_exp_f32 v57, v57
    v_exp_f32 v58, v58
    v_exp_f32 v59, v59
    v_exp_f32 v60, v60
    v_exp_f32 v61, v61
    v_exp_f32 v62, v62
    v_exp_f32 v63, v63
    v_exp_f32 v68, v68
    v_exp_f32 v69, v69
    v_exp_f32 v70, v70
    v_exp_f32 v71, v71
    v_cvt_pk_bf16_f32 v56, v56, v57
    v_cvt_pk_bf16_f32 v57, v58, v59
    v_cvt_pk_bf16_f32 v58, v60, v61
    v_cvt_pk_bf16_f32 v59, v62, v63
    v_cvt_pk_bf16_f32 v68, v68, v69
    v_cvt_pk_bf16_f32 v69, v70, v71
    v_mfma_f32_16x16x32_bf16 v[76:79], v[16:19], v[56:59], 0
    s_mov_b32 exec_hi, 0
    v_mov_b64 v[20:21], v[68:69]
    v_mov_b64 v[68:69], 0
    s_mov_b32 exec_hi, -1
    ds_read_b128 v[44:47], v9 offset:5120
    v_mfma_f32_16x16x32_bf16 v[60:63], v[112:115], v[56:59], 0
    ds_read_b128 v[48:51], v9 offset:6144
    v_mfma_f32_16x16x32_bf16 v[72:75], v[116:119], v[56:59], 0
    ds_read_b128 v[52:55], v9 offset:7168
    v_mfma_f32_16x16x16_bf16 v[76:79], v[16:17], v[20:21], v[76:79]
    v_mov_b64 v[112:113], 0
    v_mov_b64 v[114:115], 0
    v_mfma_f32_16x16x16_bf16 v[60:63], v[64:65], v[20:21], v[60:63]
    v_mov_b64 v[116:117], 0
    v_mfma_f32_16x16x16_bf16 v[72:75], v[64:65], v[68:69], v[72:75]
    v_mov_b64 v[118:119], 0
    s_nop 1
    v_rcp_f32 v22, v76
    s_nop 1
    v_pk_mul_f32 v[60:61], v[60:61], v[22:23] op_sel_hi:[1,0]
    v_pk_mul_f32 v[62:63], v[62:63], v[22:23] op_sel_hi:[1,0]
    v_pk_mul_f32 v[72:73], v[72:73], v[22:23] op_sel_hi:[1,0]
    v_pk_mul_f32 v[74:75], v[74:75], v[22:23] op_sel_hi:[1,0]
    v_cvt_pk_bf16_f32 v56, v60, v72
    v_cvt_pk_bf16_f32 v57, v61, v73
    v_cvt_pk_bf16_f32 v58, v62, v74
    v_cvt_pk_bf16_f32 v59, v63, v75
    ds_write_b128 v6, v[56:59] offset:192
    v_mov_b64 v[60:61], 0
    v_mov_b64 v[62:63], 0
    s_waitcnt lgkmcnt(0)
    s_barrier
    ds_read_b128 v[64:67], v6 offset:0
    ds_read_b128 v[68:71], v6 offset:64
    ds_read_b128 v[72:75], v6 offset:128
    ds_read_b128 v[76:79], v6 offset:192
    v_mov_b64 v[56:57], 0
    v_mov_b64 v[58:59], 0
    s_waitcnt lgkmcnt(3)
    v_smfmac_f32_16x16x64_bf16 v[112:115], v[64:67], v[24:31], v8
    s_waitcnt lgkmcnt(2)
    v_smfmac_f32_16x16x64_bf16 v[112:115], v[68:71], v[32:39], v8
    ds_read_b128 v[24:27], v9 offset:16384
    s_waitcnt lgkmcnt(2)
    v_smfmac_f32_16x16x64_bf16 v[112:115], v[72:75], v[40:47], v8
    ds_read_b128 v[28:31], v9 offset:17408
    ds_read_b128 v[32:35], v9 offset:18432
    s_waitcnt lgkmcnt(3)
    v_smfmac_f32_16x16x64_bf16 v[112:115], v[76:79], v[48:55], v8
    ds_read_b128 v[36:39], v9 offset:19456
    v_smfmac_f32_16x16x64_bf16 v[116:119], v[64:67], v[80:87], v8
    ds_read_b128 v[40:43], v9 offset:20480
    ds_read_b128 v[44:47], v9 offset:21504
    v_smfmac_f32_16x16x64_bf16 v[116:119], v[68:71], v[88:95], v8
    ds_read_b128 v[48:51], v9 offset:22528
    v_smfmac_f32_16x16x64_bf16 v[116:119], v[72:75], v[96:103], v8
    ds_read_b128 v[52:55], v9 offset:23552
    ds_read_b128 v[80:83], v9 offset:24576
    v_smfmac_f32_16x16x64_bf16 v[116:119], v[76:79], v[104:111], v8
    ds_read_b128 v[84:87], v9 offset:25600
    v_cvt_pk_bf16_f32 v112, v112, v113
    v_cvt_pk_bf16_f32 v113, v114, v115
    s_waitcnt lgkmcnt(6)
    v_smfmac_f32_16x16x64_bf16 v[60:63], v[64:67], v[24:31], v8
    ds_read_b128 v[88:91], v9 offset:26624
    v_and_b32 v112, -2, v112
    buffer_store_dwordx2 v[112:113], v10, s[8:11], s64 offen
    v_smfmac_f32_16x16x64_bf16 v[60:63], v[68:71], v[32:39], v8
    ds_read_b128 v[92:95], v9 offset:27648
    ds_read_b128 v[96:99], v9 offset:28672
    s_waitcnt lgkmcnt(5)
    v_smfmac_f32_16x16x64_bf16 v[60:63], v[72:75], v[40:47], v8
    ds_read_b128 v[100:103], v9 offset:29696
    v_cvt_pk_bf16_f32 v116, v116, v117
    v_cvt_pk_bf16_f32 v117, v118, v119
    v_smfmac_f32_16x16x64_bf16 v[60:63], v[76:79], v[48:55], v8
    ds_read_b128 v[104:107], v9 offset:30720
    ds_read_b128 v[108:111], v9 offset:31744
    v_and_b32 v116, -2, v116
    buffer_store_dwordx2 v[116:117], v10, s[8:11], s65 offen
    s_waitcnt lgkmcnt(4)
    v_smfmac_f32_16x16x64_bf16 v[56:59], v[64:67], v[80:87], v8
    ds_read_b128 v[48:51], v3 offset:31168
    v_smfmac_f32_16x16x64_bf16 v[56:59], v[68:71], v[88:95], v8
    s_waitcnt lgkmcnt(1)
    v_smfmac_f32_16x16x64_bf16 v[56:59], v[72:75], v[96:103], v8
    v_cvt_pk_bf16_f32 v60, v60, v61
    v_cvt_pk_bf16_f32 v61, v62, v63
    v_smfmac_f32_16x16x64_bf16 v[56:59], v[76:79], v[104:111], v8
    v_and_b32 v60, -2, v60
    buffer_store_dwordx2 v[60:61], v10, s[8:11], s66 offen
    s_nop 5
    v_cvt_pk_bf16_f32 v56, v56, v57
    v_cvt_pk_bf16_f32 v57, v58, v59
    v_and_b32 v56, -2, v56
    buffer_store_dwordx2 v[56:57], v10, s[8:11], s67 offen
    v_mov_b64 v[64:65], 0
    v_mov_b64 v[66:67], 0
    v_mov_b64 v[60:61], 0
    v_mov_b64 v[62:63], 0
    v_mov_b64 v[58:59], 0
    v_mov_b64 v[56:57], 0
    s_waitcnt vmcnt(0)
    buffer_load_dwordx4 v[24:27], v11, s[8:11], s50 offen offset:0 sc1
    buffer_load_dwordx4 v[28:31], v11, s[8:11], s50 offen offset:1024 sc1
    s_waitcnt vmcnt(2)
    buffer_load_dwordx4 v[32:35], v11, s[8:11], s50 offen offset:0 sc1
    buffer_load_dwordx4 v[36:39], v11, s[8:11], s50 offen offset:1024 sc1
    s_waitcnt lgkmcnt(0)
Lp1_78:
    s_waitcnt vmcnt(2)
    v_mfma_f32_16x16x32_bf16 v[80:83], v[48:51], v[24:27], 0
    v_or3_b32 v88, v24, v26, v28
    v_mfma_f32_16x16x32_bf16 v[80:83], v[48:51], v[28:31], v[80:83]
    v_bitop3_b32 v88, v88, v30, 1 bitop3:0xa8
    v_cmp_ne_u32 vcc, 0, v88
    s_cbranch_vccz Lp1k_79
    s_nop 0
    s_mov_b64 exec, vcc
    buffer_load_dwordx4 v[24:27], v11, s[8:11], s50 offen offset:0 sc1
    buffer_load_dwordx4 v[28:31], v11, s[8:11], s50 offen offset:1024 sc1
    s_mov_b64 exec, -1
    s_waitcnt vmcnt(2)
    v_mfma_f32_16x16x32_bf16 v[80:83], v[48:51], v[32:35], 0
    v_or3_b32 v88, v32, v34, v36
    v_mfma_f32_16x16x32_bf16 v[80:83], v[48:51], v[36:39], v[80:83]
    v_bitop3_b32 v88, v88, v38, 1 bitop3:0xa8
    v_cmp_ne_u32 vcc, 0, v88
    s_cbranch_vccz Lp1k_80
    s_nop 0
    s_mov_b64 exec, vcc
    buffer_load_dwordx4 v[32:35], v11, s[8:11], s50 offen offset:0 sc1
    buffer_load_dwordx4 v[36:39], v11, s[8:11], s50 offen offset:1024 sc1
    s_mov_b64 exec, -1
    s_sub_u32 s21, s21, 1
    s_cbranch_scc0 Lp1_78
Lp1k_79:
Lp1k_80:
    buffer_store_dword v15, v12, s[8:11], s48 offen
    s_nop 3
    v_add_f32_dpp v80, v80, v80 row_ror:4 row_mask:0xf bank_mask:0xf
    v_add_f32_dpp v81, v81, v81 row_ror:4 row_mask:0xf bank_mask:0xf
    s_nop 0
    v_add_f32_dpp v80, v80, v80 row_ror:8 row_mask:0xf bank_mask:0xf
    v_add_f32_dpp v81, v81, v81 row_ror:8 row_mask:0xf bank_mask:0xf
    v_cvt_pk_bf16_f32 v83, v80, v81
    v_min_u32 v83, -2, v83
    buffer_store_dword v83, v12, s[8:11], s49 offen
    s_max_i32 s21, s21, 0
    s_add_u32 s20, s20, 1
    s_add_u32 s36, s36, 8192
    s_add_u32 s37, s37, 2048
    s_waitcnt vmcnt(1)
    buffer_load_dwordx4 v[88:91], v3, s[8:11], s61 offen offset:0 sc1
    buffer_load_dwordx4 v[92:95], v3, s[8:11], s61 offen offset:1024 sc1
    s_waitcnt vmcnt(2)
Lp2_81:
    buffer_load_dwordx4 v[88:91], v3, s[8:11], s61 offen offset:0 sc1
    buffer_load_dwordx4 v[92:95], v3, s[8:11], s61 offen offset:1024 sc1
    s_mov_b64 exec, -1
    s_waitcnt vmcnt(2)
    v_max3_u32 v80, v88, v89, v90
    v_max3_u32 v81, v91, v92, v93
    v_max3_u32 v80, v80, v94, v95
    v_max_u32 v80, v80, v81
    v_cmp_eq_u32 vcc, -1, v80
    s_nop 4
    s_cbranch_vccz Lstep31_20
    s_mov_b64 exec, vcc
    s_sub_u32 s21, s21, 1
    s_cbranch_scc0 Lp2_81
    s_mov_b64 exec, -1
    s_mov_b32 s21, 0
Lstep31_20:
    ds_write_b128 v3, v[88:91] offset:6144
    ds_write_b128 v3, v[92:95] offset:7168
    s_add_u32 s34, s34, 16384
    s_mov_b32 m0, 145408
    s_add_u32 s35, s35, 16384
    s_waitcnt vmcnt(2)
    ds_read_b128 v[24:27], v7 offset:6144
    ds_read_b128 v[28:31], v7 offset:6656
    ds_read_b128 v[32:35], v7 offset:7168
    ds_read_b128 v[36:39], v7 offset:7680
    s_waitcnt lgkmcnt(4)
    s_barrier
    s_and_b32 s42, s20, 7
    s_cmp_lg_u32 s42, 7
    s_cbranch_scc1 Lkvok_82
    s_cmp_eq_u32 s20, 63
    s_cbranch_scc1 Lkvok_82
    s_mov_b64 exec, 15
    v_cmp_ne_u64 vcc, s[62:63], v[0:1]
    s_mov_b64 exec, -1
    s_nop 3
    s_cbranch_vccz Lkvok_82
    s_mov_b64 exec, 15
Lkv_83:
    v_lshlrev_b32 v0, 3, v2
    buffer_load_dwordx2 v[0:1], v0, s[8:11], s23 offen sc1
    s_waitcnt vmcnt(0)
    v_cmp_ne_u64 vcc, s[62:63], v[0:1]
    s_nop 4
    s_cbranch_vccz Lkvd_84
    s_sleep 2
    s_sub_u32 s21, s21, 1
    s_cbranch_scc0 Lkv_83
    s_mov_b32 s21, 0
Lkvd_84:
    s_mov_b64 exec, -1
Lkvok_82:
    ds_read_b128 v[40:43], v7 offset:0
    ds_read_b128 v[44:47], v7 offset:512
    s_waitcnt lgkmcnt(5)
    v_smfmac_f32_16x16x64_bf16 v[56:59], v[24:27], a[96:103], v8
    ds_read_b128 v[48:51], v7 offset:1024
    v_smfmac_f32_16x16x64_bf16 v[60:63], v[24:27], a[224:231], v8
    ds_read_b128 v[52:55], v7 offset:1536
    s_waitcnt lgkmcnt(6)
    v_smfmac_f32_16x16x64_bf16 v[56:59], v[28:31], a[104:111], v8
    ds_read_b128 v[80:83], v7 offset:2048
    v_smfmac_f32_16x16x64_bf16 v[60:63], v[28:31], a[232:239], v8
    ds_read_b128 v[84:87], v7 offset:2560
    s_waitcnt vmcnt(0)
    s_waitcnt lgkmcnt(6)
    v_smfmac_f32_16x16x64_bf16 v[56:59], v[32:35], a[112:119], v8
    ds_read_b128 v[88:91], v7 offset:3072
    v_smfmac_f32_16x16x64_bf16 v[60:63], v[32:35], a[240:247], v8
    ds_read_b128 v[92:95], v7 offset:3584
    v_smfmac_f32_16x16x64_bf16 v[56:59], v[36:39], a[120:127], v8
    v_smfmac_f32_16x16x64_bf16 v[60:63], v[36:39], a[248:255], v8
    s_waitcnt lgkmcnt(7)
    v_smfmac_f32_16x16x64_bf16 v[56:59], v[40:43], a[0:7], v8
    ds_read_b128 v[96:99], v7 offset:4096
    v_smfmac_f32_16x16x64_bf16 v[60:63], v[40:43], a[128:135], v8
    s_waitcnt lgkmcnt(7)
    v_smfmac_f32_16x16x64_bf16 v[56:59], v[44:47], a[8:15], v8
    ds_read_b128 v[100:103], v7 offset:4608
    v_smfmac_f32_16x16x64_bf16 v[60:63], v[44:47], a[136:143], v8
    s_waitcnt lgkmcnt(7)
    v_smfmac_f32_16x16x64_bf16 v[56:59], v[48:51], a[16:23], v8
    ds_read_b128 v[104:107], v7 offset:5120
    v_smfmac_f32_16x16x64_bf16 v[60:63], v[48:51], a[144:151], v8
    s_waitcnt lgkmcnt(7)
    v_smfmac_f32_16x16x64_bf16 v[56:59], v[52:55], a[24:31], v8
    ds_read_b128 v[108:111], v7 offset:5632
    v_smfmac_f32_16x16x64_bf16 v[60:63], v[52:55], a[152:159], v8
    s_waitcnt lgkmcnt(6)
    v_smfmac_f32_16x16x64_bf16 v[56:59], v[80:83], a[32:39], v8
    v_smfmac_f32_16x16x64_bf16 v[60:63], v[80:83], a[160:167], v8
    buffer_load_dwordx4 v13, s[8:11], s34 offen sc1 lds
    v_smfmac_f32_16x16x64_bf16 v[56:59], v[84:87], a[40:47], v8
    v_smfmac_f32_16x16x64_bf16 v[60:63], v[84:87], a[168:175], v8
    buffer_load_dwordx4 v13, s[8:11], s34 offen offset:1024 sc1 lds
    s_waitcnt lgkmcnt(4)
    v_smfmac_f32_16x16x64_bf16 v[56:59], v[88:91], a[48:55], v8
    v_smfmac_f32_16x16x64_bf16 v[60:63], v[88:91], a[176:183], v8
    buffer_load_dwordx4 v[112:115], v13, s[8:11], s35 offen sc1
    v_smfmac_f32_16x16x64_bf16 v[56:59], v[92:95], a[56:63], v8
    v_smfmac_f32_16x16x64_bf16 v[60:63], v[92:95], a[184:191], v8
    buffer_load_dwordx4 v[116:119], v13, s[8:11], s35 offen offset:1024 sc1
    s_waitcnt lgkmcnt(2)
    v_smfmac_f32_16x16x64_bf16 v[56:59], v[96:99], a[64:71], v8
    v_smfmac_f32_16x16x64_bf16 v[60:63], v[96:99], a[192:199], v8
    v_smfmac_f32_16x16x64_bf16 v[56:59], v[100:103], a[72:79], v8
    v_smfmac_f32_16x16x64_bf16 v[60:63], v[100:103], a[200:207], v8
    s_waitcnt lgkmcnt(0)
    v_smfmac_f32_16x16x64_bf16 v[56:59], v[104:107], a[80:87], v8
    v_smfmac_f32_16x16x64_bf16 v[60:63], v[104:107], a[208:215], v8
    v_smfmac_f32_16x16x64_bf16 v[56:59], v[108:111], a[88:95], v8
    v_smfmac_f32_16x16x64_bf16 v[60:63], v[108:111], a[216:223], v8
    v_smfmac_f32_16x16x64_bf16 v[64:67], v[96:99], v[192:199], v8
    s_nop 0
    v_smfmac_f32_16x16x64_bf16 v[64:67], v[100:103], v[200:207], v8
    s_nop 0
    v_smfmac_f32_16x16x64_bf16 v[64:67], v[104:107], v[208:215], v8
    ds_read_b128 v[96:99], v3 offset:16384
    ds_read_b128 v[100:103], v3 offset:17408
    v_permlane32_swap_b32 v56, v58
    v_permlane32_swap_b32 v57, v59
    v_permlane32_swap_b32 v60, v62
    v_permlane32_swap_b32 v61, v63
    v_cvt_pk_bf16_f32 v56, v56, v58
    v_cvt_pk_bf16_f32 v57, v57, v59
    ds_write2_b32 v4, v56, v57 offset0:0 offset1:136
    v_cvt_pk_bf16_f32 v60, v60, v62
    v_cvt_pk_bf16_f32 v61, v61, v63
    ds_write2_b32 v4, v60, v61 offset0:64 offset1:200
    v_smfmac_f32_16x16x64_bf16 v[64:67], v[108:111], v[216:223], v8
    ds_read_b128 v[104:107], v3 offset:18432
    v_smfmac_f32_16x16x64_bf16 v[64:67], v[80:83], v[160:167], v8
    ds_read_b128 v[108:111], v3 offset:19456
    v_smfmac_f32_16x16x64_bf16 v[64:67], v[84:87], v[168:175], v8
    v_smfmac_f32_16x16x64_bf16 v[64:67], v[88:91], v[176:183], v8
    v_smfmac_f32_16x16x64_bf16 v[64:67], v[92:95], v[184:191], v8
    s_waitcnt lgkmcnt(2)
    s_barrier
    ds_read_b128 v[80:83], v5 offset:0
    ds_read_b128 v[84:87], v5 offset:64
    v_smfmac_f32_16x16x64_bf16 v[64:67], v[24:27], v[224:231], v8
    ds_read_b128 v[88:91], v5 offset:128
    v_smfmac_f32_16x16x64_bf16 v[64:67], v[28:31], v[232:239], v8
    ds_read_b128 v[92:95], v5 offset:192
    v_smfmac_f32_16x16x64_bf16 v[64:67], v[32:35], v[240:247], v8
    ds_read_b128 v[24:27], v3 offset:20480
    v_smfmac_f32_16x16x64_bf16 v[64:67], v[36:39], v[248:255], v8
    ds_read_b128 v[28:31], v3 offset:21504
    s_waitcnt lgkmcnt(5)
    v_mfma_f32_16x16x32_bf16 v[56:59], v[96:99], v[80:83], 0
    ds_read_b128 v[32:35], v3 offset:22528
    s_waitcnt lgkmcnt(5)
    v_mfma_f32_16x16x32_bf16 v[56:59], v[100:103], v[84:87], v[56:59]
    ds_read_b128 v[36:39], v3 offset:23552
    v_smfmac_f32_16x16x64_bf16 v[64:67], v[40:43], v[128:135], v8
    s_waitcnt lgkmcnt(5)
    v_mfma_f32_16x16x32_bf16 v[56:59], v[104:107], v[88:91], v[56:59]
    ds_read_b128 v[40:43], v5 offset:256
    v_smfmac_f32_16x16x64_bf16 v[64:67], v[44:47], v[136:143], v8
    s_waitcnt lgkmcnt(5)
    v_mfma_f32_16x16x32_bf16 v[56:59], v[108:111], v[92:95], v[56:59]
    ds_read_b128 v[44:47], v5 offset:320
    v_smfmac_f32_16x16x64_bf16 v[64:67], v[48:51], v[144:151], v8
    ds_read_b128 v[96:99], v9 offset:12288
    v_smfmac_f32_16x16x64_bf16 v[64:67], v[52:55], v[152:159], v8
    ds_read_b128 v[48:51], v5 offset:384
    s_waitcnt lgkmcnt(4)
    v_mfma_f32_16x16x32_bf16 v[60:63], v[24:27], v[80:83], 0
    ds_read_b128 v[52:55], v5 offset:448
    v_mfma_f32_16x16x32_bf16 v[60:63], v[28:31], v[84:87], v[60:63]
    ds_read_b128 v[100:103], v9 offset:13312
    v_mfma_f32_16x16x32_bf16 v[60:63], v[32:35], v[88:91], v[60:63]
    ds_read_b128 v[104:107], v9 offset:14336
    v_mfma_f32_16x16x32_bf16 v[60:63], v[36:39], v[92:95], v[60:63]
    ds_read_b128 v[108:111], v9 offset:15360
    s_waitcnt lgkmcnt(3)
    v_mfma_f32_16x16x32_bf16 v[68:71], v[40:43], v[80:83], 0
    ds_read_b128 v[24:27], v9 offset:0
    v_max3_f32 v22, v56, v57, v58
    v_cvt_pk_bf16_f32 v64, v64, v65
    v_mfma_f32_16x16x32_bf16 v[68:71], v[44:47], v[84:87], v[68:71]
    ds_read_b128 v[28:31], v9 offset:1024
    v_cvt_pk_bf16_f32 v65, v66, v67
    buffer_store_dwordx4 v[52:55], v14, s[8:11], s36 offen sc1
    v_mfma_f32_16x16x32_bf16 v[68:71], v[48:51], v[88:91], v[68:71]
    ds_read_b128 v[32:35], v9 offset:2048
    v_lshrrev_b32 v72, 1, v14
    buffer_store_dwordx2 v[64:65], v72, s[8:11], s37 offen sc1
    v_mfma_f32_16x16x32_bf16 v[68:71], v[52:55], v[92:95], v[68:71]
    ds_read_b128 v[36:39], v9 offset:3072
    v_max3_f32 v23, v59, v60, v61
    v_max3_f32 v22, v22, v62, v63
    ds_read_b128 v[80:83], v9 offset:8192
    ds_read_b128 v[84:87], v9 offset:9216
    ds_read_b128 v[88:91], v9 offset:10240
    s_cmp_eq_u32 s20, 63
    s_cbranch_scc1 Ldone_25
    s_nop 0
    v_max3_f32 v23, v23, v68, v69
    v_max3_f32 v22, v22, v70, v71
    v_max_f32 v22, v22, v23
    v_mov_b32 v23, v22
    ds_read_b128 v[92:95], v9 offset:11264
    ds_read_b128 v[40:43], v9 offset:4096
    v_permlane16_swap_b32 v22, v23
    v_max_f32 v22, v22, v23
    v_mov_b32 v23, v22
    s_nop 1
    s_nop 0
    v_permlane32_swap_b32 v22, v23
    v_max_f32 v22, v22, v23
    v_mul_f32 v22, s38, v22
    v_pk_fma_f32 v[56:57], v[56:57], s[38:39], v[22:23] op_sel_hi:[1,0,0] neg_lo:[0,0,1] neg_hi:[0,0,1]
    v_pk_fma_f32 v[58:59], v[58:59], s[38:39], v[22:23] op_sel_hi:[1,0,0] neg_lo:[0,0,1] neg_hi:[0,0,1]
    v_pk_fma_f32 v[60:61], v[60:61], s[38:39], v[22:23] op_sel_hi:[1,0,0] neg_lo:[0,0,1] neg_hi:[0,0,1]
    v_pk_fma_f32 v[62:63], v[62:63], s[38:39], v[22:23] op_sel_hi:[1,0,0] neg_lo:[0,0,1] neg_hi:[0,0,1]
    v_pk_fma_f32 v[68:69], v[68:69], s[38:39], v[22:23] op_sel_hi:[1,0,0] neg_lo:[0,0,1] neg_hi:[0,0,1]
    v_pk_fma_f32 v[70:71], v[70:71], s[38:39], v[22:23] op_sel_hi:[1,0,0] neg_lo:[0,0,1] neg_hi:[0,0,1]
    v_exp_f32 v56, v56
    v_exp_f32 v57, v57
    v_exp_f32 v58, v58
    v_exp_f32 v59, v59
    v_exp_f32 v60, v60
    v_exp_f32 v61, v61
    v_exp_f32 v62, v62
    v_exp_f32 v63, v63
    v_exp_f32 v68, v68
    v_exp_f32 v69, v69
    v_exp_f32 v70, v70
    v_exp_f32 v71, v71
    v_cvt_pk_bf16_f32 v56, v56, v57
    v_cvt_pk_bf16_f32 v57, v58, v59
    v_cvt_pk_bf16_f32 v58, v60, v61
    v_cvt_pk_bf16_f32 v59, v62, v63
    v_cvt_pk_bf16_f32 v68, v68, v69
    v_cvt_pk_bf16_f32 v69, v70, v71
    v_mfma_f32_16x16x32_bf16 v[76:79], v[16:19], v[56:59], 0
    s_mov_b32 exec_hi, 0
    v_mov_b64 v[20:21], v[68:69]
    v_mov_b64 v[68:69], 0
    s_mov_b32 exec_hi, -1
    ds_read_b128 v[44:47], v9 offset:5120
    v_mfma_f32_16x16x32_bf16 v[60:63], v[120:123], v[56:59], 0
    ds_read_b128 v[48:51], v9 offset:6144
    v_mfma_f32_16x16x32_bf16 v[72:75], v[124:127], v[56:59], 0
    ds_read_b128 v[52:55], v9 offset:7168
    v_mfma_f32_16x16x16_bf16 v[76:79], v[16:17], v[20:21], v[76:79]
    v_mov_b64 v[120:121], 0
    v_mov_b64 v[122:123], 0
    v_mfma_f32_16x16x16_bf16 v[60:63], v[64:65], v[20:21], v[60:63]
    v_mov_b64 v[124:125], 0
    v_mfma_f32_16x16x16_bf16 v[72:75], v[64:65], v[68:69], v[72:75]
    v_mov_b64 v[126:127], 0
    s_nop 1
    v_rcp_f32 v22, v76
    s_nop 1
    v_pk_mul_f32 v[60:61], v[60:61], v[22:23] op_sel_hi:[1,0]
    v_pk_mul_f32 v[62:63], v[62:63], v[22:23] op_sel_hi:[1,0]
    v_pk_mul_f32 v[72:73], v[72:73], v[22:23] op_sel_hi:[1,0]
    v_pk_mul_f32 v[74:75], v[74:75], v[22:23] op_sel_hi:[1,0]
    v_cvt_pk_bf16_f32 v56, v60, v72
    v_cvt_pk_bf16_f32 v57, v61, v73
    v_cvt_pk_bf16_f32 v58, v62, v74
    v_cvt_pk_bf16_f32 v59, v63, v75
    ds_write_b128 v6, v[56:59] offset:192
    v_mov_b64 v[60:61], 0
    v_mov_b64 v[62:63], 0
    s_waitcnt lgkmcnt(0)
    s_barrier
    ds_read_b128 v[64:67], v6 offset:0
    ds_read_b128 v[68:71], v6 offset:64
    ds_read_b128 v[72:75], v6 offset:128
    ds_read_b128 v[76:79], v6 offset:192
    v_mov_b64 v[56:57], 0
    v_mov_b64 v[58:59], 0
    s_waitcnt lgkmcnt(3)
    v_smfmac_f32_16x16x64_bf16 v[120:123], v[64:67], v[24:31], v8
    s_waitcnt lgkmcnt(2)
    v_smfmac_f32_16x16x64_bf16 v[120:123], v[68:71], v[32:39], v8
    ds_read_b128 v[24:27], v9 offset:16384
    s_waitcnt lgkmcnt(2)
    v_smfmac_f32_16x16x64_bf16 v[120:123], v[72:75], v[40:47], v8
    ds_read_b128 v[28:31], v9 offset:17408
    ds_read_b128 v[32:35], v9 offset:18432
    s_waitcnt lgkmcnt(3)
    v_smfmac_f32_16x16x64_bf16 v[120:123], v[76:79], v[48:55], v8
    ds_read_b128 v[36:39], v9 offset:19456
    v_smfmac_f32_16x16x64_bf16 v[124:127], v[64:67], v[80:87], v8
    ds_read_b128 v[40:43], v9 offset:20480
    ds_read_b128 v[44:47], v9 offset:21504
    v_smfmac_f32_16x16x64_bf16 v[124:127], v[68:71], v[88:95], v8
    ds_read_b128 v[48:51], v9 offset:22528
    v_smfmac_f32_16x16x64_bf16 v[124:127], v[72:75], v[96:103], v8
    ds_read_b128 v[52:55], v9 offset:23552
    ds_read_b128 v[80:83], v9 offset:24576
    v_smfmac_f32_16x16x64_bf16 v[124:127], v[76:79], v[104:111], v8
    ds_read_b128 v[84:87], v9 offset:25600
    v_cvt_pk_bf16_f32 v120, v120, v121
    v_cvt_pk_bf16_f32 v121, v122, v123
    s_waitcnt lgkmcnt(6)
    v_smfmac_f32_16x16x64_bf16 v[60:63], v[64:67], v[24:31], v8
    ds_read_b128 v[88:91], v9 offset:26624
    v_or_b32 v120, 1, v120
    buffer_store_dwordx2 v[120:121], v10, s[8:11], s64 offen
    v_smfmac_f32_16x16x64_bf16 v[60:63], v[68:71], v[32:39], v8
    ds_read_b128 v[92:95], v9 offset:27648
    ds_read_b128 v[96:99], v9 offset:28672
    s_waitcnt lgkmcnt(5)
    v_smfmac_f32_16x16x64_bf16 v[60:63], v[72:75], v[40:47], v8
    ds_read_b128 v[100:103], v9 offset:29696
    v_cvt_pk_bf16_f32 v124, v124, v125
    v_cvt_pk_bf16_f32 v125, v126, v127
    v_smfmac_f32_16x16x64_bf16 v[60:63], v[76:79], v[48:55], v8
    ds_read_b128 v[104:107], v9 offset:30720
    ds_read_b128 v[108:111], v9 offset:31744
    v_or_b32 v124, 1, v124
    buffer_store_dwordx2 v[124:125], v10, s[8:11], s65 offen
    s_waitcnt lgkmcnt(4)
    v_smfmac_f32_16x16x64_bf16 v[56:59], v[64:67], v[80:87], v8
    ds_read_b128 v[48:51], v3 offset:31168
    v_smfmac_f32_16x16x64_bf16 v[56:59], v[68:71], v[88:95], v8
    s_waitcnt lgkmcnt(1)
    v_smfmac_f32_16x16x64_bf16 v[56:59], v[72:75], v[96:103], v8
    v_cvt_pk_bf16_f32 v60, v60, v61
    v_cvt_pk_bf16_f32 v61, v62, v63
    v_smfmac_f32_16x16x64_bf16 v[56:59], v[76:79], v[104:111], v8
    v_or_b32 v60, 1, v60
    buffer_store_dwordx2 v[60:61], v10, s[8:11], s66 offen
    s_nop 5
    v_cvt_pk_bf16_f32 v56, v56, v57
    v_cvt_pk_bf16_f32 v57, v58, v59
    v_or_b32 v56, 1, v56
    buffer_store_dwordx2 v[56:57], v10, s[8:11], s67 offen
    v_mov_b64 v[64:65], 0
    v_mov_b64 v[66:67], 0
    v_mov_b64 v[60:61], 0
    v_mov_b64 v[62:63], 0
    v_mov_b64 v[58:59], 0
    v_mov_b64 v[56:57], 0
    s_waitcnt vmcnt(0)
    buffer_load_dwordx4 v[24:27], v11, s[8:11], s50 offen offset:0 sc1
    buffer_load_dwordx4 v[28:31], v11, s[8:11], s50 offen offset:1024 sc1
    s_waitcnt vmcnt(2)
    buffer_load_dwordx4 v[32:35], v11, s[8:11], s50 offen offset:0 sc1
    buffer_load_dwordx4 v[36:39], v11, s[8:11], s50 offen offset:1024 sc1
    s_waitcnt lgkmcnt(0)
Lp1_86:
    s_waitcnt vmcnt(2)
    v_mfma_f32_16x16x32_bf16 v[80:83], v[48:51], v[24:27], 0
    v_bitop3_b32 v88, v24, v26, v28 bitop3:0x80
    v_mfma_f32_16x16x32_bf16 v[80:83], v[48:51], v[28:31], v[80:83]
    v_bitop3_b32 v88, v88, v30, 1 bitop3:0x2a
    v_cmp_ne_u32 vcc, 0, v88
    s_cbranch_vccz Lp1k_87
    s_nop 0
    s_mov_b64 exec, vcc
    buffer_load_dwordx4 v[24:27], v11, s[8:11], s50 offen offset:0 sc1
    buffer_load_dwordx4 v[28:31], v11, s[8:11], s50 offen offset:1024 sc1
    s_mov_b64 exec, -1
    s_waitcnt vmcnt(2)
    v_mfma_f32_16x16x32_bf16 v[80:83], v[48:51], v[32:35], 0
    v_bitop3_b32 v88, v32, v34, v36 bitop3:0x80
    v_mfma_f32_16x16x32_bf16 v[80:83], v[48:51], v[36:39], v[80:83]
    v_bitop3_b32 v88, v88, v38, 1 bitop3:0x2a
    v_cmp_ne_u32 vcc, 0, v88
    s_cbranch_vccz Lp1k_88
    s_nop 0
    s_mov_b64 exec, vcc
    buffer_load_dwordx4 v[32:35], v11, s[8:11], s50 offen offset:0 sc1
    buffer_load_dwordx4 v[36:39], v11, s[8:11], s50 offen offset:1024 sc1
    s_mov_b64 exec, -1
    s_sub_u32 s21, s21, 1
    s_cbranch_scc0 Lp1_86
Lp1k_87:
Lp1k_88:
    buffer_store_dword v15, v12, s[8:11], s49 offen
    s_nop 3
    v_add_f32_dpp v80, v80, v80 row_ror:4 row_mask:0xf bank_mask:0xf
    v_add_f32_dpp v81, v81, v81 row_ror:4 row_mask:0xf bank_mask:0xf
    s_nop 0
    v_add_f32_dpp v80, v80, v80 row_ror:8 row_mask:0xf bank_mask:0xf
    v_add_f32_dpp v81, v81, v81 row_ror:8 row_mask:0xf bank_mask:0xf
    v_cvt_pk_bf16_f32 v83, v80, v81
    v_min_u32 v83, -2, v83
    buffer_store_dword v83, v12, s[8:11], s48 offen
    s_max_i32 s21, s21, 0
    s_add_u32 s20, s20, 1
    s_add_u32 s36, s36, 8192
    s_add_u32 s37, s37, 2048
    s_waitcnt vmcnt(1)
    buffer_load_dwordx4 v[88:91], v3, s[8:11], s60 offen offset:0 sc1
    buffer_load_dwordx4 v[92:95], v3, s[8:11], s60 offen offset:1024 sc1
    s_waitcnt vmcnt(2)
Lp2_89:
    buffer_load_dwordx4 v[88:91], v3, s[8:11], s60 offen offset:0 sc1
    buffer_load_dwordx4 v[92:95], v3, s[8:11], s60 offen offset:1024 sc1
    s_mov_b64 exec, -1
    s_waitcnt vmcnt(2)
    v_max3_u32 v80, v88, v89, v90
    v_max3_u32 v81, v91, v92, v93
    v_max3_u32 v80, v80, v94, v95
    v_max_u32 v80, v80, v81
    v_cmp_eq_u32 vcc, -1, v80
    s_nop 4
    s_cbranch_vccz Lstep30_19
    s_mov_b64 exec, vcc
    s_sub_u32 s21, s21, 1
    s_cbranch_scc0 Lp2_89
    s_mov_b64 exec, -1
    s_mov_b32 s21, 0
    s_branch Lstep30_19
Ldone_25:
    s_nop 7
    s_waitcnt vmcnt(0) lgkmcnt(0)
    s_barrier
    s_cmp_lg_u32 s19, 0
    s_cbranch_scc1 Lmf_90
    v_mov_b64 v[72:73], s[62:63]
    v_mov_b64 v[74:75], s[62:63]
    s_mov_b64 exec, 0xff
    buffer_store_dwordx4 v[72:75], v2, s[8:11], s22 offen sc1
    s_mov_b64 exec, -1
    s_nop 0
Lmf_90:
    s_branch main_kernel_worker
main_kernel_worker:
    v_mbcnt_lo_u32_b32 v1, -1, 0
    v_mbcnt_hi_u32_b32 v1, -1, v1
    v_and_b32 v2, 15, v1
    v_lshrrev_b32 v3, 4, v1
    v_lshlrev_b32 v4, 4, v1
    v_add_u32 v5, 4096, v4
    v_lshlrev_b32 v6, 10, v3
    v_lshl_add_u32 v6, v2, 4, v6
    s_mov_b32 s68, 0x05040100
    s_mov_b32 s69, 0x07060302
    s_mov_b32 s64, 0
    s_getpc_b64 s[66:67]
Lpc_91:
    s_add_u32 s66, s66, main_kernel_table-Lpc_91
    s_addc_u32 s67, s67, 0
Lnext_92:
    v_mov_b32 v8, 163776
    s_cmp_lg_u32 s19, 0
    s_nop 0
    s_cbranch_scc1 Lgot_93
    s_mov_b64 exec, 1
    s_sub_u32 s24, s18, 256
    s_mov_b32 s18, 0xffff
    s_cmp_lt_u32 s24, 224
    s_cbranch_scc1 Lclaim_95
Lpull_94:
    v_mov_b32 v9, 128
    v_mov_b32 v10, 1
    global_atomic_add v11, v9, v10, s[16:17] sc0
    s_waitcnt vmcnt(0)
    v_readfirstlane_b32 s24, v11
    s_nop 0
    s_add_u32 s24, s24, 224
    s_cmp_lt_u32 s24, 712
    s_nop 1
    s_cbranch_scc1 Lpubl_96
    s_cmp_ge_u32 s24, 936
    s_cbranch_scc1 Lpubl_96
    s_sub_u32 s24, s24, 712
Lclaim_95:
    s_lshl_b32 s25, s24, 7
    s_add_u32 s25, s25, 160432128
    v_mov_b32 v10, s62
    v_mov_b32 v11, s63
    buffer_atomic_swap_x2 v[10:11], off, s[8:11], s25 sc0
    s_waitcnt vmcnt(0)
    v_cmp_eq_u64 vcc, s[62:63], v[10:11]
    s_nop 4
    s_cbranch_vccnz Lpull_94
Lpubl_96:
    v_mov_b32 v11, s24
    ds_write_b32 v8, v11
    s_mov_b64 exec, -1
    s_waitcnt lgkmcnt(0)
Lgot_93:
    s_barrier
    ds_read_b32 v9, v8
    s_waitcnt lgkmcnt(0)
    v_readfirstlane_b32 s4, v9
    s_barrier
    s_cmp_ge_u32 s4, 712
    s_nop 2
    s_cbranch_scc1 main_kernel_fin
    s_lshl_b32 s4, s4, 2
    s_load_dword s7, s[66:67], s4
    s_waitcnt lgkmcnt(0)
    s_and_b32 s4, s7, 15
    s_bfe_u32 s5, s7, 0x80004
    s_bfe_u32 s6, s7, 0x8000c
    s_bfe_u32 s7, s7, 0x80014
    s_cmp_eq_u32 s4, 2
    s_cbranch_scc1 Lh_98
    s_cmp_eq_u32 s4, 3
    s_cbranch_scc1 Lh_99
    s_cmp_eq_u32 s4, 4
    s_cbranch_scc1 Lh_100
    s_cmp_eq_u32 s4, 5
    s_cbranch_scc1 Lh_101
    s_cmp_eq_u32 s4, 6
    s_cbranch_scc1 Lh_102
    s_cmp_eq_u32 s4, 7
    s_cbranch_scc1 Lh_103
    s_cmp_eq_u32 s4, 8
    s_cbranch_scc1 Lh_104
    s_cmp_eq_u32 s4, 9
    s_cbranch_scc1 Lh_105
Lh_97:
    s_load_dwordx4 s[40:43], s[0:1], 16
    s_load_dwordx2 s[44:45], s[0:1], 32
    s_mov_b32 s14, 4194304
    s_mov_b32 s15, 0x00020000
    s_mov_b32 s34, 4194304
    s_mov_b32 s35, 0x00020000
    v_lshlrev_b32 v232, 11, v3
    v_lshl_add_u32 v232, v2, 4, v232
    v_add_u32 v233, 65536, v232
    v_lshlrev_b32 v7, 13, v3
    v_lshl_add_u32 v7, v2, 4, v7
    s_lshl_b32 s24, s19, 18
    v_add_u32 v7, s24, v7
    s_lshl_b32 s39, s19, 13
    s_lshl_b32 s47, s5, 2
    s_add_u32 s47, s47, s19
    s_lshl_b32 s47, s47, 1
    s_waitcnt lgkmcnt(0)
    s_lshr_b32 s26, s6, 5
    s_cmp_eq_u32 s26, 1
    s_cselect_b32 s12, s42, s40
    s_cselect_b32 s13, s43, s41
    s_cmp_eq_u32 s26, 2
    s_cselect_b32 s12, s44, s12
    s_cselect_b32 s13, s45, s13
    s_and_b32 s13, s13, 0xffff
    s_and_b32 s36, s6, 31
    s_lshl_b32 s36, s36, 8
    s_add_u32 m0, s39, 0
    s_add_u32 s38, s36, 0
    buffer_load_dwordx4 v7, s[12:15], s38 offen lds
    s_add_u32 m0, s39, 1024
    s_add_u32 s38, s36, 32768
    buffer_load_dwordx4 v7, s[12:15], s38 offen lds
    s_add_u32 m0, s39, 2048
    s_add_u32 s38, s36, 65536
    buffer_load_dwordx4 v7, s[12:15], s38 offen lds
    s_add_u32 m0, s39, 3072
    s_add_u32 s38, s36, 98304
    buffer_load_dwordx4 v7, s[12:15], s38 offen lds
    s_add_u32 m0, s39, 4096
    s_add_u32 s38, s36, 131072
    buffer_load_dwordx4 v7, s[12:15], s38 offen lds
    s_add_u32 m0, s39, 5120
    s_add_u32 s38, s36, 163840
    buffer_load_dwordx4 v7, s[12:15], s38 offen lds
    s_add_u32 m0, s39, 6144
    s_add_u32 s38, s36, 196608
    buffer_load_dwordx4 v7, s[12:15], s38 offen lds
    s_add_u32 m0, s39, 7168
    s_add_u32 s38, s36, 229376
    buffer_load_dwordx4 v7, s[12:15], s38 offen lds
    s_add_u32 m0, s39, 32768
    s_add_u32 s38, s36, 1048576
    buffer_load_dwordx4 v7, s[12:15], s38 offen lds
    s_add_u32 m0, s39, 33792
    s_add_u32 s38, s36, 1081344
    buffer_load_dwordx4 v7, s[12:15], s38 offen lds
    s_add_u32 m0, s39, 34816
    s_add_u32 s38, s36, 1114112
    buffer_load_dwordx4 v7, s[12:15], s38 offen lds
    s_add_u32 m0, s39, 35840
    s_add_u32 s38, s36, 1146880
    buffer_load_dwordx4 v7, s[12:15], s38 offen lds
    s_add_u32 m0, s39, 36864
    s_add_u32 s38, s36, 1179648
    buffer_load_dwordx4 v7, s[12:15], s38 offen lds
    s_add_u32 m0, s39, 37888
    s_add_u32 s38, s36, 1212416
    buffer_load_dwordx4 v7, s[12:15], s38 offen lds
    s_add_u32 m0, s39, 38912
    s_add_u32 s38, s36, 1245184
    buffer_load_dwordx4 v7, s[12:15], s38 offen lds
    s_add_u32 m0, s39, 39936
    s_add_u32 s38, s36, 1277952
    buffer_load_dwordx4 v7, s[12:15], s38 offen lds
    s_add_u32 m0, s39, 65536
    s_add_u32 s38, s36, 2097152
    buffer_load_dwordx4 v7, s[12:15], s38 offen lds
    s_add_u32 m0, s39, 66560
    s_add_u32 s38, s36, 2129920
    buffer_load_dwordx4 v7, s[12:15], s38 offen lds
    s_add_u32 m0, s39, 67584
    s_add_u32 s38, s36, 2162688
    buffer_load_dwordx4 v7, s[12:15], s38 offen lds
    s_add_u32 m0, s39, 68608
    s_add_u32 s38, s36, 2195456
    buffer_load_dwordx4 v7, s[12:15], s38 offen lds
    s_add_u32 m0, s39, 69632
    s_add_u32 s38, s36, 2228224
    buffer_load_dwordx4 v7, s[12:15], s38 offen lds
    s_add_u32 m0, s39, 70656
    s_add_u32 s38, s36, 2260992
    buffer_load_dwordx4 v7, s[12:15], s38 offen lds
    s_add_u32 m0, s39, 71680
    s_add_u32 s38, s36, 2293760
    buffer_load_dwordx4 v7, s[12:15], s38 offen lds
    s_add_u32 m0, s39, 72704
    s_add_u32 s38, s36, 2326528
    buffer_load_dwordx4 v7, s[12:15], s38 offen lds
    s_lshl_b32 s24, s5, 12
    s_add_u32 s24, s24, 159383552
    v_min_u32 v8, 31, v1
    v_mul_u32_u24 v8, 128, v8
    s_nop 1
Lw_106:
    buffer_load_dwordx2 v[10:11], v8, s[8:11], s24 offen sc1
    s_waitcnt vmcnt(0)
    v_cmp_ne_u64 vcc, s[62:63], v[10:11]
    s_nop 4
    s_cbranch_vccz Lwd_107
    s_sleep 2
    s_sub_u32 s21, s21, 1
    s_cbranch_scc0 Lw_106
    s_mov_b32 s21, 0
Lwd_107:
    s_lshl_b32 s24, s47, 15
    buffer_load_dwordx4 a[0:3], v4, s[8:11], s24 offen offset:0 sc1
    buffer_load_dwordx4 a[4:7], v4, s[8:11], s24 offen offset:1024 sc1
    buffer_load_dwordx4 a[8:11], v4, s[8:11], s24 offen offset:2048 sc1
    buffer_load_dwordx4 a[12:15], v4, s[8:11], s24 offen offset:3072 sc1
    s_add_u32 s24, s24, 4096
    buffer_load_dwordx4 a[16:19], v4, s[8:11], s24 offen offset:0 sc1
    buffer_load_dwordx4 a[20:23], v4, s[8:11], s24 offen offset:1024 sc1
    buffer_load_dwordx4 a[24:27], v4, s[8:11], s24 offen offset:2048 sc1
    buffer_load_dwordx4 a[28:31], v4, s[8:11], s24 offen offset:3072 sc1
    s_add_u32 s24, s24, 4096
    buffer_load_dwordx4 a[32:35], v4, s[8:11], s24 offen offset:0 sc1
    buffer_load_dwordx4 a[36:39], v4, s[8:11], s24 offen offset:1024 sc1
    buffer_load_dwordx4 a[40:43], v4, s[8:11], s24 offen offset:2048 sc1
    buffer_load_dwordx4 a[44:47], v4, s[8:11], s24 offen offset:3072 sc1
    s_add_u32 s24, s24, 4096
    buffer_load_dwordx4 a[48:51], v4, s[8:11], s24 offen offset:0 sc1
    buffer_load_dwordx4 a[52:55], v4, s[8:11], s24 offen offset:1024 sc1
    buffer_load_dwordx4 a[56:59], v4, s[8:11], s24 offen offset:2048 sc1
    buffer_load_dwordx4 a[60:63], v4, s[8:11], s24 offen offset:3072 sc1
    s_add_u32 s24, s24, 4096
    buffer_load_dwordx4 a[64:67], v4, s[8:11], s24 offen offset:0 sc1
    buffer_load_dwordx4 a[68:71], v4, s[8:11], s24 offen offset:1024 sc1
    buffer_load_dwordx4 a[72:75], v4, s[8:11], s24 offen offset:2048 sc1
    buffer_load_dwordx4 a[76:79], v4, s[8:11], s24 offen offset:3072 sc1
    s_add_u32 s24, s24, 4096
    buffer_load_dwordx4 a[80:83], v4, s[8:11], s24 offen offset:0 sc1
    buffer_load_dwordx4 a[84:87], v4, s[8:11], s24 offen offset:1024 sc1
    buffer_load_dwordx4 a[88:91], v4, s[8:11], s24 offen offset:2048 sc1
    buffer_load_dwordx4 a[92:95], v4, s[8:11], s24 offen offset:3072 sc1
    s_add_u32 s24, s24, 4096
    buffer_load_dwordx4 a[96:99], v4, s[8:11], s24 offen offset:0 sc1
    buffer_load_dwordx4 a[100:103], v4, s[8:11], s24 offen offset:1024 sc1
    buffer_load_dwordx4 a[104:107], v4, s[8:11], s24 offen offset:2048 sc1
    buffer_load_dwordx4 a[108:111], v4, s[8:11], s24 offen offset:3072 sc1
    s_add_u32 s24, s24, 4096
    buffer_load_dwordx4 a[112:115], v4, s[8:11], s24 offen offset:0 sc1
    buffer_load_dwordx4 a[116:119], v4, s[8:11], s24 offen offset:1024 sc1
    buffer_load_dwordx4 a[120:123], v4, s[8:11], s24 offen offset:2048 sc1
    buffer_load_dwordx4 a[124:127], v4, s[8:11], s24 offen offset:3072 sc1
    s_add_u32 s24, s24, 4096
    buffer_load_dwordx4 a[128:131], v4, s[8:11], s24 offen offset:0 sc1
    buffer_load_dwordx4 a[132:135], v4, s[8:11], s24 offen offset:1024 sc1
    buffer_load_dwordx4 a[136:139], v4, s[8:11], s24 offen offset:2048 sc1
    buffer_load_dwordx4 a[140:143], v4, s[8:11], s24 offen offset:3072 sc1
    s_add_u32 s24, s24, 4096
    buffer_load_dwordx4 a[144:147], v4, s[8:11], s24 offen offset:0 sc1
    buffer_load_dwordx4 a[148:151], v4, s[8:11], s24 offen offset:1024 sc1
    buffer_load_dwordx4 a[152:155], v4, s[8:11], s24 offen offset:2048 sc1
    buffer_load_dwordx4 a[156:159], v4, s[8:11], s24 offen offset:3072 sc1
    s_add_u32 s24, s24, 4096
    buffer_load_dwordx4 a[160:163], v4, s[8:11], s24 offen offset:0 sc1
    buffer_load_dwordx4 a[164:167], v4, s[8:11], s24 offen offset:1024 sc1
    buffer_load_dwordx4 a[168:171], v4, s[8:11], s24 offen offset:2048 sc1
    buffer_load_dwordx4 a[172:175], v4, s[8:11], s24 offen offset:3072 sc1
    s_add_u32 s24, s24, 4096
    buffer_load_dwordx4 a[176:179], v4, s[8:11], s24 offen offset:0 sc1
    buffer_load_dwordx4 a[180:183], v4, s[8:11], s24 offen offset:1024 sc1
    buffer_load_dwordx4 a[184:187], v4, s[8:11], s24 offen offset:2048 sc1
    buffer_load_dwordx4 a[188:191], v4, s[8:11], s24 offen offset:3072 sc1
    s_add_u32 s24, s24, 4096
    buffer_load_dwordx4 a[192:195], v4, s[8:11], s24 offen offset:0 sc1
    buffer_load_dwordx4 a[196:199], v4, s[8:11], s24 offen offset:1024 sc1
    buffer_load_dwordx4 a[200:203], v4, s[8:11], s24 offen offset:2048 sc1
    buffer_load_dwordx4 a[204:207], v4, s[8:11], s24 offen offset:3072 sc1
    s_add_u32 s24, s24, 4096
    buffer_load_dwordx4 a[208:211], v4, s[8:11], s24 offen offset:0 sc1
    buffer_load_dwordx4 a[212:215], v4, s[8:11], s24 offen offset:1024 sc1
    buffer_load_dwordx4 a[216:219], v4, s[8:11], s24 offen offset:2048 sc1
    buffer_load_dwordx4 a[220:223], v4, s[8:11], s24 offen offset:3072 sc1
    s_waitcnt vmcnt(36)
    s_add_u32 s24, s24, 4096
    buffer_load_dwordx4 a[224:227], v4, s[8:11], s24 offen offset:0 sc1
    buffer_load_dwordx4 a[228:231], v4, s[8:11], s24 offen offset:1024 sc1
    buffer_load_dwordx4 a[232:235], v4, s[8:11], s24 offen offset:2048 sc1
    buffer_load_dwordx4 a[236:239], v4, s[8:11], s24 offen offset:3072 sc1
    s_add_u32 s24, s24, 4096
    buffer_load_dwordx4 a[240:243], v4, s[8:11], s24 offen offset:0 sc1
    buffer_load_dwordx4 a[244:247], v4, s[8:11], s24 offen offset:1024 sc1
    buffer_load_dwordx4 a[248:251], v4, s[8:11], s24 offen offset:2048 sc1
    buffer_load_dwordx4 a[252:255], v4, s[8:11], s24 offen offset:3072 sc1
    s_add_u32 s24, s24, 4096
    s_waitcnt vmcnt(0)
    s_mov_b32 s48, s7
Lnt_108:
    s_add_u32 s46, s6, 32
    s_cmp_ge_u32 s46, 96
    s_cselect_b32 s26, 96, 0
    s_sub_u32 s46, s46, s26
    s_lshr_b32 s26, s46, 5
    s_cmp_eq_u32 s26, 1
    s_cselect_b32 s32, s42, s40
    s_cselect_b32 s33, s43, s41
    s_cmp_eq_u32 s26, 2
    s_cselect_b32 s32, s44, s32
    s_cselect_b32 s33, s45, s33
    s_and_b32 s33, s33, 0xffff
    s_and_b32 s37, s46, 31
    s_lshl_b32 s37, s37, 8
    s_cmp_gt_u32 s48, 1
    s_cselect_b32 s34, 4194304, 0
    s_lshr_b32 s26, s6, 5
    s_and_b32 s27, s6, 31
    s_cmp_eq_u32 s26, 2
    s_cbranch_scc1 Lv_111
    s_waitcnt vmcnt(32)
    s_barrier
    ds_read_b128 v[136:139], v232 offset:0
    ds_read_b128 v[140:143], v232 offset:256
    ds_read_b128 v[144:147], v232 offset:512
    ds_read_b128 v[148:151], v232 offset:768
    ds_read_b128 v[152:155], v232 offset:1024
    ds_read_b128 v[156:159], v232 offset:1280
    ds_read_b128 v[160:163], v232 offset:1536
    ds_read_b128 v[164:167], v232 offset:1792
    s_waitcnt lgkmcnt(0)
    v_perm_b32 v200, v140, v136, s68
    v_perm_b32 v201, v148, v144, s68
    v_perm_b32 v202, v156, v152, s68
    v_perm_b32 v203, v164, v160, s68
    s_nop 1
    v_mfma_f32_16x16x32_bf16 v[8:11], v[200:203], a[0:3], 0
    v_perm_b32 v204, v140, v136, s69
    v_perm_b32 v205, v148, v144, s69
    v_mfma_f32_16x16x32_bf16 v[40:43], v[200:203], a[64:67], 0
    v_perm_b32 v206, v156, v152, s69
    v_perm_b32 v207, v164, v160, s69
    v_mfma_f32_16x16x32_bf16 v[72:75], v[200:203], a[128:131], 0
    ds_read_b128 v[168:171], v232 offset:8192
    ds_read_b128 v[172:175], v232 offset:8448
    v_mfma_f32_16x16x32_bf16 v[104:107], v[200:203], a[192:195], 0
    ds_read_b128 v[176:179], v232 offset:8704
    ds_read_b128 v[180:183], v232 offset:8960
    v_mfma_f32_16x16x32_bf16 v[12:15], v[204:207], a[0:3], 0
    v_perm_b32 v208, v141, v137, s68
    v_perm_b32 v209, v149, v145, s68
    v_mfma_f32_16x16x32_bf16 v[44:47], v[204:207], a[64:67], 0
    v_perm_b32 v210, v157, v153, s68
    v_perm_b32 v211, v165, v161, s68
    v_mfma_f32_16x16x32_bf16 v[76:79], v[204:207], a[128:131], 0
    ds_read_b128 v[184:187], v232 offset:9216
    ds_read_b128 v[188:191], v232 offset:9472
    v_mfma_f32_16x16x32_bf16 v[108:111], v[204:207], a[192:195], 0
    ds_read_b128 v[192:195], v232 offset:9728
    ds_read_b128 v[196:199], v232 offset:9984
    v_mfma_f32_16x16x32_bf16 v[16:19], v[208:211], a[0:3], 0
    v_perm_b32 v212, v141, v137, s69
    v_perm_b32 v213, v149, v145, s69
    v_mfma_f32_16x16x32_bf16 v[48:51], v[208:211], a[64:67], 0
    v_perm_b32 v214, v157, v153, s69
    v_perm_b32 v215, v165, v161, s69
    v_mfma_f32_16x16x32_bf16 v[80:83], v[208:211], a[128:131], 0
    s_add_u32 m0, s39, 98304
    s_add_u32 s38, s36, 3145728
    v_mfma_f32_16x16x32_bf16 v[112:115], v[208:211], a[192:195], 0
    buffer_load_dwordx4 v7, s[12:15], s38 offen lds
    s_add_u32 m0, s39, 99328
    v_mfma_f32_16x16x32_bf16 v[20:23], v[212:215], a[0:3], 0
    v_perm_b32 v216, v142, v138, s68
    v_perm_b32 v217, v150, v146, s68
    v_mfma_f32_16x16x32_bf16 v[52:55], v[212:215], a[64:67], 0
    v_perm_b32 v218, v158, v154, s68
    v_perm_b32 v219, v166, v162, s68
    v_mfma_f32_16x16x32_bf16 v[84:87], v[212:215], a[128:131], 0
    s_add_u32 s38, s36, 3178496
    buffer_load_dwordx4 v7, s[12:15], s38 offen lds
    v_mfma_f32_16x16x32_bf16 v[116:119], v[212:215], a[192:195], 0
    s_add_u32 m0, s39, 100352
    s_add_u32 s38, s36, 3211264
    v_mfma_f32_16x16x32_bf16 v[24:27], v[216:219], a[0:3], 0
    v_perm_b32 v220, v142, v138, s69
    v_perm_b32 v221, v150, v146, s69
    v_mfma_f32_16x16x32_bf16 v[56:59], v[216:219], a[64:67], 0
    v_perm_b32 v222, v158, v154, s69
    v_perm_b32 v223, v166, v162, s69
    v_mfma_f32_16x16x32_bf16 v[88:91], v[216:219], a[128:131], 0
    buffer_load_dwordx4 v7, s[12:15], s38 offen lds
    s_add_u32 m0, s39, 101376
    v_mfma_f32_16x16x32_bf16 v[120:123], v[216:219], a[192:195], 0
    s_add_u32 s38, s36, 3244032
    buffer_load_dwordx4 v7, s[12:15], s38 offen lds
    v_mfma_f32_16x16x32_bf16 v[28:31], v[220:223], a[0:3], 0
    v_perm_b32 v224, v143, v139, s68
    v_perm_b32 v225, v151, v147, s68
    v_mfma_f32_16x16x32_bf16 v[60:63], v[220:223], a[64:67], 0
    v_perm_b32 v226, v159, v155, s68
    v_perm_b32 v227, v167, v163, s68
    v_mfma_f32_16x16x32_bf16 v[92:95], v[220:223], a[128:131], 0
    s_add_u32 m0, s39, 102400
    s_add_u32 s38, s36, 3276800
    v_mfma_f32_16x16x32_bf16 v[124:127], v[220:223], a[192:195], 0
    buffer_load_dwordx4 v7, s[12:15], s38 offen lds
    s_add_u32 m0, s39, 103424
    v_mfma_f32_16x16x32_bf16 v[32:35], v[224:227], a[0:3], 0
    v_perm_b32 v228, v143, v139, s69
    v_perm_b32 v229, v151, v147, s69
    v_mfma_f32_16x16x32_bf16 v[64:67], v[224:227], a[64:67], 0
    v_perm_b32 v230, v159, v155, s69
    v_perm_b32 v231, v167, v163, s69
    v_mfma_f32_16x16x32_bf16 v[96:99], v[224:227], a[128:131], 0
    s_add_u32 s38, s36, 3309568
    buffer_load_dwordx4 v7, s[12:15], s38 offen lds
    v_mfma_f32_16x16x32_bf16 v[128:131], v[224:227], a[192:195], 0
    s_add_u32 m0, s39, 104448
    s_add_u32 s38, s36, 3342336
    v_mfma_f32_16x16x32_bf16 v[36:39], v[228:231], a[0:3], 0
    buffer_load_dwordx4 v7, s[12:15], s38 offen lds
    s_add_u32 m0, s39, 105472
    v_mfma_f32_16x16x32_bf16 v[68:71], v[228:231], a[64:67], 0
    s_add_u32 s38, s36, 3375104
    buffer_load_dwordx4 v7, s[12:15], s38 offen lds
    v_mfma_f32_16x16x32_bf16 v[100:103], v[228:231], a[128:131], 0
    v_mfma_f32_16x16x32_bf16 v[132:135], v[228:231], a[192:195], 0
    s_waitcnt lgkmcnt(0)
    v_perm_b32 v200, v172, v168, s68
    v_perm_b32 v201, v180, v176, s68
    v_perm_b32 v202, v188, v184, s68
    v_perm_b32 v203, v196, v192, s68
    s_nop 1
    v_mfma_f32_16x16x32_bf16 v[8:11], v[200:203], a[4:7], v[8:11]
    v_perm_b32 v204, v172, v168, s69
    v_perm_b32 v205, v180, v176, s69
    v_mfma_f32_16x16x32_bf16 v[40:43], v[200:203], a[68:71], v[40:43]
    v_perm_b32 v206, v188, v184, s69
    v_perm_b32 v207, v196, v192, s69
    v_mfma_f32_16x16x32_bf16 v[72:75], v[200:203], a[132:135], v[72:75]
    ds_read_b128 v[136:139], v232 offset:16384
    ds_read_b128 v[140:143], v232 offset:16640
    v_mfma_f32_16x16x32_bf16 v[104:107], v[200:203], a[196:199], v[104:107]
    ds_read_b128 v[144:147], v232 offset:16896
    ds_read_b128 v[148:151], v232 offset:17152
    v_mfma_f32_16x16x32_bf16 v[12:15], v[204:207], a[4:7], v[12:15]
    v_perm_b32 v208, v173, v169, s68
    v_perm_b32 v209, v181, v177, s68
    v_mfma_f32_16x16x32_bf16 v[44:47], v[204:207], a[68:71], v[44:47]
    v_perm_b32 v210, v189, v185, s68
    v_perm_b32 v211, v197, v193, s68
    v_mfma_f32_16x16x32_bf16 v[76:79], v[204:207], a[132:135], v[76:79]
    ds_read_b128 v[152:155], v232 offset:17408
    ds_read_b128 v[156:159], v232 offset:17664
    v_mfma_f32_16x16x32_bf16 v[108:111], v[204:207], a[196:199], v[108:111]
    ds_read_b128 v[160:163], v232 offset:17920
    ds_read_b128 v[164:167], v232 offset:18176
    v_mfma_f32_16x16x32_bf16 v[16:19], v[208:211], a[4:7], v[16:19]
    v_perm_b32 v212, v173, v169, s69
    v_perm_b32 v213, v181, v177, s69
    v_mfma_f32_16x16x32_bf16 v[48:51], v[208:211], a[68:71], v[48:51]
    v_perm_b32 v214, v189, v185, s69
    v_perm_b32 v215, v197, v193, s69
    v_mfma_f32_16x16x32_bf16 v[80:83], v[208:211], a[132:135], v[80:83]
    v_mfma_f32_16x16x32_bf16 v[112:115], v[208:211], a[196:199], v[112:115]
    v_mfma_f32_16x16x32_bf16 v[20:23], v[212:215], a[4:7], v[20:23]
    v_perm_b32 v216, v174, v170, s68
    v_perm_b32 v217, v182, v178, s68
    v_mfma_f32_16x16x32_bf16 v[52:55], v[212:215], a[68:71], v[52:55]
    v_perm_b32 v218, v190, v186, s68
    v_perm_b32 v219, v198, v194, s68
    v_mfma_f32_16x16x32_bf16 v[84:87], v[212:215], a[132:135], v[84:87]
    v_mfma_f32_16x16x32_bf16 v[116:119], v[212:215], a[196:199], v[116:119]
    v_mfma_f32_16x16x32_bf16 v[24:27], v[216:219], a[4:7], v[24:27]
    v_perm_b32 v220, v174, v170, s69
    v_perm_b32 v221, v182, v178, s69
    v_mfma_f32_16x16x32_bf16 v[56:59], v[216:219], a[68:71], v[56:59]
    v_perm_b32 v222, v190, v186, s69
    v_perm_b32 v223, v198, v194, s69
    v_mfma_f32_16x16x32_bf16 v[88:91], v[216:219], a[132:135], v[88:91]
    v_mfma_f32_16x16x32_bf16 v[120:123], v[216:219], a[196:199], v[120:123]
    v_mfma_f32_16x16x32_bf16 v[28:31], v[220:223], a[4:7], v[28:31]
    v_perm_b32 v224, v175, v171, s68
    v_perm_b32 v225, v183, v179, s68
    v_mfma_f32_16x16x32_bf16 v[60:63], v[220:223], a[68:71], v[60:63]
    v_perm_b32 v226, v191, v187, s68
    v_perm_b32 v227, v199, v195, s68
    v_mfma_f32_16x16x32_bf16 v[92:95], v[220:223], a[132:135], v[92:95]
    v_mfma_f32_16x16x32_bf16 v[124:127], v[220:223], a[196:199], v[124:127]
    v_mfma_f32_16x16x32_bf16 v[32:35], v[224:227], a[4:7], v[32:35]
    v_perm_b32 v228, v175, v171, s69
    v_perm_b32 v229, v183, v179, s69
    v_mfma_f32_16x16x32_bf16 v[64:67], v[224:227], a[68:71], v[64:67]
    v_perm_b32 v230, v191, v187, s69
    v_perm_b32 v231, v199, v195, s69
    v_mfma_f32_16x16x32_bf16 v[96:99], v[224:227], a[132:135], v[96:99]
    v_mfma_f32_16x16x32_bf16 v[128:131], v[224:227], a[196:199], v[128:131]
    v_mfma_f32_16x16x32_bf16 v[36:39], v[228:231], a[4:7], v[36:39]
    v_mfma_f32_16x16x32_bf16 v[68:71], v[228:231], a[68:71], v[68:71]
    v_mfma_f32_16x16x32_bf16 v[100:103], v[228:231], a[132:135], v[100:103]
    v_mfma_f32_16x16x32_bf16 v[132:135], v[228:231], a[196:199], v[132:135]
    s_waitcnt lgkmcnt(0)
    v_perm_b32 v200, v140, v136, s68
    v_perm_b32 v201, v148, v144, s68
    v_perm_b32 v202, v156, v152, s68
    v_perm_b32 v203, v164, v160, s68
    s_nop 1
    v_mfma_f32_16x16x32_bf16 v[8:11], v[200:203], a[8:11], v[8:11]
    v_perm_b32 v204, v140, v136, s69
    v_perm_b32 v205, v148, v144, s69
    v_mfma_f32_16x16x32_bf16 v[40:43], v[200:203], a[72:75], v[40:43]
    v_perm_b32 v206, v156, v152, s69
    v_perm_b32 v207, v164, v160, s69
    v_mfma_f32_16x16x32_bf16 v[72:75], v[200:203], a[136:139], v[72:75]
    ds_read_b128 v[168:171], v232 offset:24576
    ds_read_b128 v[172:175], v232 offset:24832
    v_mfma_f32_16x16x32_bf16 v[104:107], v[200:203], a[200:203], v[104:107]
    ds_read_b128 v[176:179], v232 offset:25088
    ds_read_b128 v[180:183], v232 offset:25344
    v_mfma_f32_16x16x32_bf16 v[12:15], v[204:207], a[8:11], v[12:15]
    v_perm_b32 v208, v141, v137, s68
    v_perm_b32 v209, v149, v145, s68
    v_mfma_f32_16x16x32_bf16 v[44:47], v[204:207], a[72:75], v[44:47]
    v_perm_b32 v210, v157, v153, s68
    v_perm_b32 v211, v165, v161, s68
    v_mfma_f32_16x16x32_bf16 v[76:79], v[204:207], a[136:139], v[76:79]
    ds_read_b128 v[184:187], v232 offset:25600
    ds_read_b128 v[188:191], v232 offset:25856
    v_mfma_f32_16x16x32_bf16 v[108:111], v[204:207], a[200:203], v[108:111]
    ds_read_b128 v[192:195], v232 offset:26112
    ds_read_b128 v[196:199], v232 offset:26368
    v_mfma_f32_16x16x32_bf16 v[16:19], v[208:211], a[8:11], v[16:19]
    v_perm_b32 v212, v141, v137, s69
    v_perm_b32 v213, v149, v145, s69
    v_mfma_f32_16x16x32_bf16 v[48:51], v[208:211], a[72:75], v[48:51]
    v_perm_b32 v214, v157, v153, s69
    v_perm_b32 v215, v165, v161, s69
    v_mfma_f32_16x16x32_bf16 v[80:83], v[208:211], a[136:139], v[80:83]
    v_mfma_f32_16x16x32_bf16 v[112:115], v[208:211], a[200:203], v[112:115]
    v_mfma_f32_16x16x32_bf16 v[20:23], v[212:215], a[8:11], v[20:23]
    v_perm_b32 v216, v142, v138, s68
    v_perm_b32 v217, v150, v146, s68
    v_mfma_f32_16x16x32_bf16 v[52:55], v[212:215], a[72:75], v[52:55]
    v_perm_b32 v218, v158, v154, s68
    v_perm_b32 v219, v166, v162, s68
    v_mfma_f32_16x16x32_bf16 v[84:87], v[212:215], a[136:139], v[84:87]
    v_mfma_f32_16x16x32_bf16 v[116:119], v[212:215], a[200:203], v[116:119]
    v_mfma_f32_16x16x32_bf16 v[24:27], v[216:219], a[8:11], v[24:27]
    v_perm_b32 v220, v142, v138, s69
    v_perm_b32 v221, v150, v146, s69
    v_mfma_f32_16x16x32_bf16 v[56:59], v[216:219], a[72:75], v[56:59]
    v_perm_b32 v222, v158, v154, s69
    v_perm_b32 v223, v166, v162, s69
    v_mfma_f32_16x16x32_bf16 v[88:91], v[216:219], a[136:139], v[88:91]
    v_mfma_f32_16x16x32_bf16 v[120:123], v[216:219], a[200:203], v[120:123]
    v_mfma_f32_16x16x32_bf16 v[28:31], v[220:223], a[8:11], v[28:31]
    v_perm_b32 v224, v143, v139, s68
    v_perm_b32 v225, v151, v147, s68
    v_mfma_f32_16x16x32_bf16 v[60:63], v[220:223], a[72:75], v[60:63]
    v_perm_b32 v226, v159, v155, s68
    v_perm_b32 v227, v167, v163, s68
    v_mfma_f32_16x16x32_bf16 v[92:95], v[220:223], a[136:139], v[92:95]
    v_mfma_f32_16x16x32_bf16 v[124:127], v[220:223], a[200:203], v[124:127]
    v_mfma_f32_16x16x32_bf16 v[32:35], v[224:227], a[8:11], v[32:35]
    v_perm_b32 v228, v143, v139, s69
    v_perm_b32 v229, v151, v147, s69
    v_mfma_f32_16x16x32_bf16 v[64:67], v[224:227], a[72:75], v[64:67]
    v_perm_b32 v230, v159, v155, s69
    v_perm_b32 v231, v167, v163, s69
    v_mfma_f32_16x16x32_bf16 v[96:99], v[224:227], a[136:139], v[96:99]
    v_mfma_f32_16x16x32_bf16 v[128:131], v[224:227], a[200:203], v[128:131]
    v_mfma_f32_16x16x32_bf16 v[36:39], v[228:231], a[8:11], v[36:39]
    v_mfma_f32_16x16x32_bf16 v[68:71], v[228:231], a[72:75], v[68:71]
    v_mfma_f32_16x16x32_bf16 v[100:103], v[228:231], a[136:139], v[100:103]
    v_mfma_f32_16x16x32_bf16 v[132:135], v[228:231], a[200:203], v[132:135]
    s_waitcnt lgkmcnt(0)
    v_perm_b32 v200, v172, v168, s68
    v_perm_b32 v201, v180, v176, s68
    v_perm_b32 v202, v188, v184, s68
    v_perm_b32 v203, v196, v192, s68
    s_nop 1
    v_mfma_f32_16x16x32_bf16 v[8:11], v[200:203], a[12:15], v[8:11]
    v_perm_b32 v204, v172, v168, s69
    v_perm_b32 v205, v180, v176, s69
    v_mfma_f32_16x16x32_bf16 v[40:43], v[200:203], a[76:79], v[40:43]
    v_perm_b32 v206, v188, v184, s69
    v_perm_b32 v207, v196, v192, s69
    v_mfma_f32_16x16x32_bf16 v[72:75], v[200:203], a[140:143], v[72:75]
    v_mfma_f32_16x16x32_bf16 v[104:107], v[200:203], a[204:207], v[104:107]
    v_mfma_f32_16x16x32_bf16 v[12:15], v[204:207], a[12:15], v[12:15]
    v_perm_b32 v208, v173, v169, s68
    v_perm_b32 v209, v181, v177, s68
    v_mfma_f32_16x16x32_bf16 v[44:47], v[204:207], a[76:79], v[44:47]
    v_perm_b32 v210, v189, v185, s68
    v_perm_b32 v211, v197, v193, s68
    v_mfma_f32_16x16x32_bf16 v[76:79], v[204:207], a[140:143], v[76:79]
    v_mfma_f32_16x16x32_bf16 v[108:111], v[204:207], a[204:207], v[108:111]
    v_mfma_f32_16x16x32_bf16 v[16:19], v[208:211], a[12:15], v[16:19]
    v_perm_b32 v212, v173, v169, s69
    v_perm_b32 v213, v181, v177, s69
    v_mfma_f32_16x16x32_bf16 v[48:51], v[208:211], a[76:79], v[48:51]
    v_perm_b32 v214, v189, v185, s69
    v_perm_b32 v215, v197, v193, s69
    v_mfma_f32_16x16x32_bf16 v[80:83], v[208:211], a[140:143], v[80:83]
    v_mfma_f32_16x16x32_bf16 v[112:115], v[208:211], a[204:207], v[112:115]
    v_mfma_f32_16x16x32_bf16 v[20:23], v[212:215], a[12:15], v[20:23]
    v_perm_b32 v216, v174, v170, s68
    v_perm_b32 v217, v182, v178, s68
    v_mfma_f32_16x16x32_bf16 v[52:55], v[212:215], a[76:79], v[52:55]
    v_perm_b32 v218, v190, v186, s68
    v_perm_b32 v219, v198, v194, s68
    v_mfma_f32_16x16x32_bf16 v[84:87], v[212:215], a[140:143], v[84:87]
    v_mfma_f32_16x16x32_bf16 v[116:119], v[212:215], a[204:207], v[116:119]
    v_mfma_f32_16x16x32_bf16 v[24:27], v[216:219], a[12:15], v[24:27]
    v_perm_b32 v220, v174, v170, s69
    v_perm_b32 v221, v182, v178, s69
    v_mfma_f32_16x16x32_bf16 v[56:59], v[216:219], a[76:79], v[56:59]
    v_perm_b32 v222, v190, v186, s69
    v_perm_b32 v223, v198, v194, s69
    v_mfma_f32_16x16x32_bf16 v[88:91], v[216:219], a[140:143], v[88:91]
    v_mfma_f32_16x16x32_bf16 v[120:123], v[216:219], a[204:207], v[120:123]
    v_mfma_f32_16x16x32_bf16 v[28:31], v[220:223], a[12:15], v[28:31]
    v_perm_b32 v224, v175, v171, s68
    v_perm_b32 v225, v183, v179, s68
    v_mfma_f32_16x16x32_bf16 v[60:63], v[220:223], a[76:79], v[60:63]
    v_perm_b32 v226, v191, v187, s68
    v_perm_b32 v227, v199, v195, s68
    v_mfma_f32_16x16x32_bf16 v[92:95], v[220:223], a[140:143], v[92:95]
    v_mfma_f32_16x16x32_bf16 v[124:127], v[220:223], a[204:207], v[124:127]
    v_mfma_f32_16x16x32_bf16 v[32:35], v[224:227], a[12:15], v[32:35]
    v_perm_b32 v228, v175, v171, s69
    v_perm_b32 v229, v183, v179, s69
    v_mfma_f32_16x16x32_bf16 v[64:67], v[224:227], a[76:79], v[64:67]
    v_perm_b32 v230, v191, v187, s69
    v_perm_b32 v231, v199, v195, s69
    v_mfma_f32_16x16x32_bf16 v[96:99], v[224:227], a[140:143], v[96:99]
    v_mfma_f32_16x16x32_bf16 v[128:131], v[224:227], a[204:207], v[128:131]
    v_mfma_f32_16x16x32_bf16 v[36:39], v[228:231], a[12:15], v[36:39]
    v_mfma_f32_16x16x32_bf16 v[68:71], v[228:231], a[76:79], v[68:71]
    v_mfma_f32_16x16x32_bf16 v[100:103], v[228:231], a[140:143], v[100:103]
    v_mfma_f32_16x16x32_bf16 v[132:135], v[228:231], a[204:207], v[132:135]
    s_waitcnt vmcnt(16)
    s_barrier
    ds_read_b128 v[136:139], v232 offset:32768
    ds_read_b128 v[140:143], v232 offset:33024
    ds_read_b128 v[144:147], v232 offset:33280
    ds_read_b128 v[148:151], v232 offset:33536
    ds_read_b128 v[152:155], v232 offset:33792
    ds_read_b128 v[156:159], v232 offset:34048
    ds_read_b128 v[160:163], v232 offset:34304
    ds_read_b128 v[164:167], v232 offset:34560
    s_waitcnt lgkmcnt(0)
    v_perm_b32 v200, v140, v136, s68
    v_perm_b32 v201, v148, v144, s68
    v_perm_b32 v202, v156, v152, s68
    v_perm_b32 v203, v164, v160, s68
    s_nop 1
    v_mfma_f32_16x16x32_bf16 v[8:11], v[200:203], a[16:19], v[8:11]
    v_perm_b32 v204, v140, v136, s69
    v_perm_b32 v205, v148, v144, s69
    v_mfma_f32_16x16x32_bf16 v[40:43], v[200:203], a[80:83], v[40:43]
    v_perm_b32 v206, v156, v152, s69
    v_perm_b32 v207, v164, v160, s69
    v_mfma_f32_16x16x32_bf16 v[72:75], v[200:203], a[144:147], v[72:75]
    ds_read_b128 v[168:171], v232 offset:40960
    ds_read_b128 v[172:175], v232 offset:41216
    v_mfma_f32_16x16x32_bf16 v[104:107], v[200:203], a[208:211], v[104:107]
    ds_read_b128 v[176:179], v232 offset:41472
    ds_read_b128 v[180:183], v232 offset:41728
    v_mfma_f32_16x16x32_bf16 v[12:15], v[204:207], a[16:19], v[12:15]
    v_perm_b32 v208, v141, v137, s68
    v_perm_b32 v209, v149, v145, s68
    v_mfma_f32_16x16x32_bf16 v[44:47], v[204:207], a[80:83], v[44:47]
    v_perm_b32 v210, v157, v153, s68
    v_perm_b32 v211, v165, v161, s68
    v_mfma_f32_16x16x32_bf16 v[76:79], v[204:207], a[144:147], v[76:79]
    ds_read_b128 v[184:187], v232 offset:41984
    ds_read_b128 v[188:191], v232 offset:42240
    v_mfma_f32_16x16x32_bf16 v[108:111], v[204:207], a[208:211], v[108:111]
    ds_read_b128 v[192:195], v232 offset:42496
    ds_read_b128 v[196:199], v232 offset:42752
    v_mfma_f32_16x16x32_bf16 v[16:19], v[208:211], a[16:19], v[16:19]
    v_perm_b32 v212, v141, v137, s69
    v_perm_b32 v213, v149, v145, s69
    v_mfma_f32_16x16x32_bf16 v[48:51], v[208:211], a[80:83], v[48:51]
    v_perm_b32 v214, v157, v153, s69
    v_perm_b32 v215, v165, v161, s69
    v_mfma_f32_16x16x32_bf16 v[80:83], v[208:211], a[144:147], v[80:83]
    s_add_u32 m0, s39, 0
    s_add_u32 s38, s37, 0
    v_mfma_f32_16x16x32_bf16 v[112:115], v[208:211], a[208:211], v[112:115]
    buffer_load_dwordx4 v7, s[32:35], s38 offen lds
    s_add_u32 m0, s39, 1024
    v_mfma_f32_16x16x32_bf16 v[20:23], v[212:215], a[16:19], v[20:23]
    v_perm_b32 v216, v142, v138, s68
    v_perm_b32 v217, v150, v146, s68
    v_mfma_f32_16x16x32_bf16 v[52:55], v[212:215], a[80:83], v[52:55]
    v_perm_b32 v218, v158, v154, s68
    v_perm_b32 v219, v166, v162, s68
    v_mfma_f32_16x16x32_bf16 v[84:87], v[212:215], a[144:147], v[84:87]
    s_add_u32 s38, s37, 32768
    buffer_load_dwordx4 v7, s[32:35], s38 offen lds
    v_mfma_f32_16x16x32_bf16 v[116:119], v[212:215], a[208:211], v[116:119]
    s_add_u32 m0, s39, 2048
    s_add_u32 s38, s37, 65536
    v_mfma_f32_16x16x32_bf16 v[24:27], v[216:219], a[16:19], v[24:27]
    v_perm_b32 v220, v142, v138, s69
    v_perm_b32 v221, v150, v146, s69
    v_mfma_f32_16x16x32_bf16 v[56:59], v[216:219], a[80:83], v[56:59]
    v_perm_b32 v222, v158, v154, s69
    v_perm_b32 v223, v166, v162, s69
    v_mfma_f32_16x16x32_bf16 v[88:91], v[216:219], a[144:147], v[88:91]
    buffer_load_dwordx4 v7, s[32:35], s38 offen lds
    s_add_u32 m0, s39, 3072
    v_mfma_f32_16x16x32_bf16 v[120:123], v[216:219], a[208:211], v[120:123]
    s_add_u32 s38, s37, 98304
    buffer_load_dwordx4 v7, s[32:35], s38 offen lds
    v_mfma_f32_16x16x32_bf16 v[28:31], v[220:223], a[16:19], v[28:31]
    v_perm_b32 v224, v143, v139, s68
    v_perm_b32 v225, v151, v147, s68
    v_mfma_f32_16x16x32_bf16 v[60:63], v[220:223], a[80:83], v[60:63]
    v_perm_b32 v226, v159, v155, s68
    v_perm_b32 v227, v167, v163, s68
    v_mfma_f32_16x16x32_bf16 v[92:95], v[220:223], a[144:147], v[92:95]
    s_add_u32 m0, s39, 4096
    s_add_u32 s38, s37, 131072
    v_mfma_f32_16x16x32_bf16 v[124:127], v[220:223], a[208:211], v[124:127]
    buffer_load_dwordx4 v7, s[32:35], s38 offen lds
    s_add_u32 m0, s39, 5120
    v_mfma_f32_16x16x32_bf16 v[32:35], v[224:227], a[16:19], v[32:35]
    v_perm_b32 v228, v143, v139, s69
    v_perm_b32 v229, v151, v147, s69
    v_mfma_f32_16x16x32_bf16 v[64:67], v[224:227], a[80:83], v[64:67]
    v_perm_b32 v230, v159, v155, s69
    v_perm_b32 v231, v167, v163, s69
    v_mfma_f32_16x16x32_bf16 v[96:99], v[224:227], a[144:147], v[96:99]
    s_add_u32 s38, s37, 163840
    buffer_load_dwordx4 v7, s[32:35], s38 offen lds
    v_mfma_f32_16x16x32_bf16 v[128:131], v[224:227], a[208:211], v[128:131]
    s_add_u32 m0, s39, 6144
    s_add_u32 s38, s37, 196608
    v_mfma_f32_16x16x32_bf16 v[36:39], v[228:231], a[16:19], v[36:39]
    buffer_load_dwordx4 v7, s[32:35], s38 offen lds
    s_add_u32 m0, s39, 7168
    v_mfma_f32_16x16x32_bf16 v[68:71], v[228:231], a[80:83], v[68:71]
    s_add_u32 s38, s37, 229376
    buffer_load_dwordx4 v7, s[32:35], s38 offen lds
    v_mfma_f32_16x16x32_bf16 v[100:103], v[228:231], a[144:147], v[100:103]
    v_mfma_f32_16x16x32_bf16 v[132:135], v[228:231], a[208:211], v[132:135]
    s_waitcnt lgkmcnt(0)
    v_perm_b32 v200, v172, v168, s68
    v_perm_b32 v201, v180, v176, s68
    v_perm_b32 v202, v188, v184, s68
    v_perm_b32 v203, v196, v192, s68
    s_nop 1
    v_mfma_f32_16x16x32_bf16 v[8:11], v[200:203], a[20:23], v[8:11]
    v_perm_b32 v204, v172, v168, s69
    v_perm_b32 v205, v180, v176, s69
    v_mfma_f32_16x16x32_bf16 v[40:43], v[200:203], a[84:87], v[40:43]
    v_perm_b32 v206, v188, v184, s69
    v_perm_b32 v207, v196, v192, s69
    v_mfma_f32_16x16x32_bf16 v[72:75], v[200:203], a[148:151], v[72:75]
    ds_read_b128 v[136:139], v232 offset:49152
    ds_read_b128 v[140:143], v232 offset:49408
    v_mfma_f32_16x16x32_bf16 v[104:107], v[200:203], a[212:215], v[104:107]
    ds_read_b128 v[144:147], v232 offset:49664
    ds_read_b128 v[148:151], v232 offset:49920
    v_mfma_f32_16x16x32_bf16 v[12:15], v[204:207], a[20:23], v[12:15]
    v_perm_b32 v208, v173, v169, s68
    v_perm_b32 v209, v181, v177, s68
    v_mfma_f32_16x16x32_bf16 v[44:47], v[204:207], a[84:87], v[44:47]
    v_perm_b32 v210, v189, v185, s68
    v_perm_b32 v211, v197, v193, s68
    v_mfma_f32_16x16x32_bf16 v[76:79], v[204:207], a[148:151], v[76:79]
    ds_read_b128 v[152:155], v232 offset:50176
    ds_read_b128 v[156:159], v232 offset:50432
    v_mfma_f32_16x16x32_bf16 v[108:111], v[204:207], a[212:215], v[108:111]
    ds_read_b128 v[160:163], v232 offset:50688
    ds_read_b128 v[164:167], v232 offset:50944
    v_mfma_f32_16x16x32_bf16 v[16:19], v[208:211], a[20:23], v[16:19]
    v_perm_b32 v212, v173, v169, s69
    v_perm_b32 v213, v181, v177, s69
    v_mfma_f32_16x16x32_bf16 v[48:51], v[208:211], a[84:87], v[48:51]
    v_perm_b32 v214, v189, v185, s69
    v_perm_b32 v215, v197, v193, s69
    v_mfma_f32_16x16x32_bf16 v[80:83], v[208:211], a[148:151], v[80:83]
    v_mfma_f32_16x16x32_bf16 v[112:115], v[208:211], a[212:215], v[112:115]
    v_mfma_f32_16x16x32_bf16 v[20:23], v[212:215], a[20:23], v[20:23]
    v_perm_b32 v216, v174, v170, s68
    v_perm_b32 v217, v182, v178, s68
    v_mfma_f32_16x16x32_bf16 v[52:55], v[212:215], a[84:87], v[52:55]
    v_perm_b32 v218, v190, v186, s68
    v_perm_b32 v219, v198, v194, s68
    v_mfma_f32_16x16x32_bf16 v[84:87], v[212:215], a[148:151], v[84:87]
    v_mfma_f32_16x16x32_bf16 v[116:119], v[212:215], a[212:215], v[116:119]
    v_mfma_f32_16x16x32_bf16 v[24:27], v[216:219], a[20:23], v[24:27]
    v_perm_b32 v220, v174, v170, s69
    v_perm_b32 v221, v182, v178, s69
    v_mfma_f32_16x16x32_bf16 v[56:59], v[216:219], a[84:87], v[56:59]
    v_perm_b32 v222, v190, v186, s69
    v_perm_b32 v223, v198, v194, s69
    v_mfma_f32_16x16x32_bf16 v[88:91], v[216:219], a[148:151], v[88:91]
    v_mfma_f32_16x16x32_bf16 v[120:123], v[216:219], a[212:215], v[120:123]
    v_mfma_f32_16x16x32_bf16 v[28:31], v[220:223], a[20:23], v[28:31]
    v_perm_b32 v224, v175, v171, s68
    v_perm_b32 v225, v183, v179, s68
    v_mfma_f32_16x16x32_bf16 v[60:63], v[220:223], a[84:87], v[60:63]
    v_perm_b32 v226, v191, v187, s68
    v_perm_b32 v227, v199, v195, s68
    v_mfma_f32_16x16x32_bf16 v[92:95], v[220:223], a[148:151], v[92:95]
    v_mfma_f32_16x16x32_bf16 v[124:127], v[220:223], a[212:215], v[124:127]
    v_mfma_f32_16x16x32_bf16 v[32:35], v[224:227], a[20:23], v[32:35]
    v_perm_b32 v228, v175, v171, s69
    v_perm_b32 v229, v183, v179, s69
    v_mfma_f32_16x16x32_bf16 v[64:67], v[224:227], a[84:87], v[64:67]
    v_perm_b32 v230, v191, v187, s69
    v_perm_b32 v231, v199, v195, s69
    v_mfma_f32_16x16x32_bf16 v[96:99], v[224:227], a[148:151], v[96:99]
    v_mfma_f32_16x16x32_bf16 v[128:131], v[224:227], a[212:215], v[128:131]
    v_mfma_f32_16x16x32_bf16 v[36:39], v[228:231], a[20:23], v[36:39]
    v_mfma_f32_16x16x32_bf16 v[68:71], v[228:231], a[84:87], v[68:71]
    v_mfma_f32_16x16x32_bf16 v[100:103], v[228:231], a[148:151], v[100:103]
    v_mfma_f32_16x16x32_bf16 v[132:135], v[228:231], a[212:215], v[132:135]
    s_waitcnt lgkmcnt(0)
    v_perm_b32 v200, v140, v136, s68
    v_perm_b32 v201, v148, v144, s68
    v_perm_b32 v202, v156, v152, s68
    v_perm_b32 v203, v164, v160, s68
    s_nop 1
    v_mfma_f32_16x16x32_bf16 v[8:11], v[200:203], a[24:27], v[8:11]
    v_perm_b32 v204, v140, v136, s69
    v_perm_b32 v205, v148, v144, s69
    v_mfma_f32_16x16x32_bf16 v[40:43], v[200:203], a[88:91], v[40:43]
    v_perm_b32 v206, v156, v152, s69
    v_perm_b32 v207, v164, v160, s69
    v_mfma_f32_16x16x32_bf16 v[72:75], v[200:203], a[152:155], v[72:75]
    ds_read_b128 v[168:171], v232 offset:57344
    ds_read_b128 v[172:175], v232 offset:57600
    v_mfma_f32_16x16x32_bf16 v[104:107], v[200:203], a[216:219], v[104:107]
    ds_read_b128 v[176:179], v232 offset:57856
    ds_read_b128 v[180:183], v232 offset:58112
    v_mfma_f32_16x16x32_bf16 v[12:15], v[204:207], a[24:27], v[12:15]
    v_perm_b32 v208, v141, v137, s68
    v_perm_b32 v209, v149, v145, s68
    v_mfma_f32_16x16x32_bf16 v[44:47], v[204:207], a[88:91], v[44:47]
    v_perm_b32 v210, v157, v153, s68
    v_perm_b32 v211, v165, v161, s68
    v_mfma_f32_16x16x32_bf16 v[76:79], v[204:207], a[152:155], v[76:79]
    ds_read_b128 v[184:187], v232 offset:58368
    ds_read_b128 v[188:191], v232 offset:58624
    v_mfma_f32_16x16x32_bf16 v[108:111], v[204:207], a[216:219], v[108:111]
    ds_read_b128 v[192:195], v232 offset:58880
    ds_read_b128 v[196:199], v232 offset:59136
    v_mfma_f32_16x16x32_bf16 v[16:19], v[208:211], a[24:27], v[16:19]
    v_perm_b32 v212, v141, v137, s69
    v_perm_b32 v213, v149, v145, s69
    v_mfma_f32_16x16x32_bf16 v[48:51], v[208:211], a[88:91], v[48:51]
    v_perm_b32 v214, v157, v153, s69
    v_perm_b32 v215, v165, v161, s69
    v_mfma_f32_16x16x32_bf16 v[80:83], v[208:211], a[152:155], v[80:83]
    v_mfma_f32_16x16x32_bf16 v[112:115], v[208:211], a[216:219], v[112:115]
    v_mfma_f32_16x16x32_bf16 v[20:23], v[212:215], a[24:27], v[20:23]
    v_perm_b32 v216, v142, v138, s68
    v_perm_b32 v217, v150, v146, s68
    v_mfma_f32_16x16x32_bf16 v[52:55], v[212:215], a[88:91], v[52:55]
    v_perm_b32 v218, v158, v154, s68
    v_perm_b32 v219, v166, v162, s68
    v_mfma_f32_16x16x32_bf16 v[84:87], v[212:215], a[152:155], v[84:87]
    v_mfma_f32_16x16x32_bf16 v[116:119], v[212:215], a[216:219], v[116:119]
    v_mfma_f32_16x16x32_bf16 v[24:27], v[216:219], a[24:27], v[24:27]
    v_perm_b32 v220, v142, v138, s69
    v_perm_b32 v221, v150, v146, s69
    v_mfma_f32_16x16x32_bf16 v[56:59], v[216:219], a[88:91], v[56:59]
    v_perm_b32 v222, v158, v154, s69
    v_perm_b32 v223, v166, v162, s69
    v_mfma_f32_16x16x32_bf16 v[88:91], v[216:219], a[152:155], v[88:91]
    v_mfma_f32_16x16x32_bf16 v[120:123], v[216:219], a[216:219], v[120:123]
    v_mfma_f32_16x16x32_bf16 v[28:31], v[220:223], a[24:27], v[28:31]
    v_perm_b32 v224, v143, v139, s68
    v_perm_b32 v225, v151, v147, s68
    v_mfma_f32_16x16x32_bf16 v[60:63], v[220:223], a[88:91], v[60:63]
    v_perm_b32 v226, v159, v155, s68
    v_perm_b32 v227, v167, v163, s68
    v_mfma_f32_16x16x32_bf16 v[92:95], v[220:223], a[152:155], v[92:95]
    v_mfma_f32_16x16x32_bf16 v[124:127], v[220:223], a[216:219], v[124:127]
    v_mfma_f32_16x16x32_bf16 v[32:35], v[224:227], a[24:27], v[32:35]
    v_perm_b32 v228, v143, v139, s69
    v_perm_b32 v229, v151, v147, s69
    v_mfma_f32_16x16x32_bf16 v[64:67], v[224:227], a[88:91], v[64:67]
    v_perm_b32 v230, v159, v155, s69
    v_perm_b32 v231, v167, v163, s69
    v_mfma_f32_16x16x32_bf16 v[96:99], v[224:227], a[152:155], v[96:99]
    v_mfma_f32_16x16x32_bf16 v[128:131], v[224:227], a[216:219], v[128:131]
    v_mfma_f32_16x16x32_bf16 v[36:39], v[228:231], a[24:27], v[36:39]
    v_mfma_f32_16x16x32_bf16 v[68:71], v[228:231], a[88:91], v[68:71]
    v_mfma_f32_16x16x32_bf16 v[100:103], v[228:231], a[152:155], v[100:103]
    v_mfma_f32_16x16x32_bf16 v[132:135], v[228:231], a[216:219], v[132:135]
    s_waitcnt lgkmcnt(0)
    v_perm_b32 v200, v172, v168, s68
    v_perm_b32 v201, v180, v176, s68
    v_perm_b32 v202, v188, v184, s68
    v_perm_b32 v203, v196, v192, s68
    s_nop 1
    v_mfma_f32_16x16x32_bf16 v[8:11], v[200:203], a[28:31], v[8:11]
    v_perm_b32 v204, v172, v168, s69
    v_perm_b32 v205, v180, v176, s69
    v_mfma_f32_16x16x32_bf16 v[40:43], v[200:203], a[92:95], v[40:43]
    v_perm_b32 v206, v188, v184, s69
    v_perm_b32 v207, v196, v192, s69
    v_mfma_f32_16x16x32_bf16 v[72:75], v[200:203], a[156:159], v[72:75]
    v_mfma_f32_16x16x32_bf16 v[104:107], v[200:203], a[220:223], v[104:107]
    v_mfma_f32_16x16x32_bf16 v[12:15], v[204:207], a[28:31], v[12:15]
    v_perm_b32 v208, v173, v169, s68
    v_perm_b32 v209, v181, v177, s68
    v_mfma_f32_16x16x32_bf16 v[44:47], v[204:207], a[92:95], v[44:47]
    v_perm_b32 v210, v189, v185, s68
    v_perm_b32 v211, v197, v193, s68
    v_mfma_f32_16x16x32_bf16 v[76:79], v[204:207], a[156:159], v[76:79]
    v_mfma_f32_16x16x32_bf16 v[108:111], v[204:207], a[220:223], v[108:111]
    v_mfma_f32_16x16x32_bf16 v[16:19], v[208:211], a[28:31], v[16:19]
    v_perm_b32 v212, v173, v169, s69
    v_perm_b32 v213, v181, v177, s69
    v_mfma_f32_16x16x32_bf16 v[48:51], v[208:211], a[92:95], v[48:51]
    v_perm_b32 v214, v189, v185, s69
    v_perm_b32 v215, v197, v193, s69
    v_mfma_f32_16x16x32_bf16 v[80:83], v[208:211], a[156:159], v[80:83]
    v_mfma_f32_16x16x32_bf16 v[112:115], v[208:211], a[220:223], v[112:115]
    v_mfma_f32_16x16x32_bf16 v[20:23], v[212:215], a[28:31], v[20:23]
    v_perm_b32 v216, v174, v170, s68
    v_perm_b32 v217, v182, v178, s68
    v_mfma_f32_16x16x32_bf16 v[52:55], v[212:215], a[92:95], v[52:55]
    v_perm_b32 v218, v190, v186, s68
    v_perm_b32 v219, v198, v194, s68
    v_mfma_f32_16x16x32_bf16 v[84:87], v[212:215], a[156:159], v[84:87]
    v_mfma_f32_16x16x32_bf16 v[116:119], v[212:215], a[220:223], v[116:119]
    v_mfma_f32_16x16x32_bf16 v[24:27], v[216:219], a[28:31], v[24:27]
    v_perm_b32 v220, v174, v170, s69
    v_perm_b32 v221, v182, v178, s69
    v_mfma_f32_16x16x32_bf16 v[56:59], v[216:219], a[92:95], v[56:59]
    v_perm_b32 v222, v190, v186, s69
    v_perm_b32 v223, v198, v194, s69
    v_mfma_f32_16x16x32_bf16 v[88:91], v[216:219], a[156:159], v[88:91]
    v_mfma_f32_16x16x32_bf16 v[120:123], v[216:219], a[220:223], v[120:123]
    v_mfma_f32_16x16x32_bf16 v[28:31], v[220:223], a[28:31], v[28:31]
    v_perm_b32 v224, v175, v171, s68
    v_perm_b32 v225, v183, v179, s68
    v_mfma_f32_16x16x32_bf16 v[60:63], v[220:223], a[92:95], v[60:63]
    v_perm_b32 v226, v191, v187, s68
    v_perm_b32 v227, v199, v195, s68
    v_mfma_f32_16x16x32_bf16 v[92:95], v[220:223], a[156:159], v[92:95]
    v_mfma_f32_16x16x32_bf16 v[124:127], v[220:223], a[220:223], v[124:127]
    v_mfma_f32_16x16x32_bf16 v[32:35], v[224:227], a[28:31], v[32:35]
    v_perm_b32 v228, v175, v171, s69
    v_perm_b32 v229, v183, v179, s69
    v_mfma_f32_16x16x32_bf16 v[64:67], v[224:227], a[92:95], v[64:67]
    v_perm_b32 v230, v191, v187, s69
    v_perm_b32 v231, v199, v195, s69
    v_mfma_f32_16x16x32_bf16 v[96:99], v[224:227], a[156:159], v[96:99]
    v_mfma_f32_16x16x32_bf16 v[128:131], v[224:227], a[220:223], v[128:131]
    v_mfma_f32_16x16x32_bf16 v[36:39], v[228:231], a[28:31], v[36:39]
    v_mfma_f32_16x16x32_bf16 v[68:71], v[228:231], a[92:95], v[68:71]
    v_mfma_f32_16x16x32_bf16 v[100:103], v[228:231], a[156:159], v[100:103]
    v_mfma_f32_16x16x32_bf16 v[132:135], v[228:231], a[220:223], v[132:135]
    s_waitcnt vmcnt(16)
    s_barrier
    ds_read_b128 v[136:139], v233 offset:0
    ds_read_b128 v[140:143], v233 offset:256
    ds_read_b128 v[144:147], v233 offset:512
    ds_read_b128 v[148:151], v233 offset:768
    ds_read_b128 v[152:155], v233 offset:1024
    ds_read_b128 v[156:159], v233 offset:1280
    ds_read_b128 v[160:163], v233 offset:1536
    ds_read_b128 v[164:167], v233 offset:1792
    s_waitcnt lgkmcnt(0)
    v_perm_b32 v200, v140, v136, s68
    v_perm_b32 v201, v148, v144, s68
    v_perm_b32 v202, v156, v152, s68
    v_perm_b32 v203, v164, v160, s68
    s_nop 1
    v_mfma_f32_16x16x32_bf16 v[8:11], v[200:203], a[32:35], v[8:11]
    v_perm_b32 v204, v140, v136, s69
    v_perm_b32 v205, v148, v144, s69
    v_mfma_f32_16x16x32_bf16 v[40:43], v[200:203], a[96:99], v[40:43]
    v_perm_b32 v206, v156, v152, s69
    v_perm_b32 v207, v164, v160, s69
    v_mfma_f32_16x16x32_bf16 v[72:75], v[200:203], a[160:163], v[72:75]
    ds_read_b128 v[168:171], v233 offset:8192
    ds_read_b128 v[172:175], v233 offset:8448
    v_mfma_f32_16x16x32_bf16 v[104:107], v[200:203], a[224:227], v[104:107]
    ds_read_b128 v[176:179], v233 offset:8704
    ds_read_b128 v[180:183], v233 offset:8960
    v_mfma_f32_16x16x32_bf16 v[12:15], v[204:207], a[32:35], v[12:15]
    v_perm_b32 v208, v141, v137, s68
    v_perm_b32 v209, v149, v145, s68
    v_mfma_f32_16x16x32_bf16 v[44:47], v[204:207], a[96:99], v[44:47]
    v_perm_b32 v210, v157, v153, s68
    v_perm_b32 v211, v165, v161, s68
    v_mfma_f32_16x16x32_bf16 v[76:79], v[204:207], a[160:163], v[76:79]
    ds_read_b128 v[184:187], v233 offset:9216
    ds_read_b128 v[188:191], v233 offset:9472
    v_mfma_f32_16x16x32_bf16 v[108:111], v[204:207], a[224:227], v[108:111]
    ds_read_b128 v[192:195], v233 offset:9728
    ds_read_b128 v[196:199], v233 offset:9984
    v_mfma_f32_16x16x32_bf16 v[16:19], v[208:211], a[32:35], v[16:19]
    v_perm_b32 v212, v141, v137, s69
    v_perm_b32 v213, v149, v145, s69
    v_mfma_f32_16x16x32_bf16 v[48:51], v[208:211], a[96:99], v[48:51]
    v_perm_b32 v214, v157, v153, s69
    v_perm_b32 v215, v165, v161, s69
    v_mfma_f32_16x16x32_bf16 v[80:83], v[208:211], a[160:163], v[80:83]
    s_add_u32 m0, s39, 32768
    s_add_u32 s38, s37, 1048576
    v_mfma_f32_16x16x32_bf16 v[112:115], v[208:211], a[224:227], v[112:115]
    buffer_load_dwordx4 v7, s[32:35], s38 offen lds
    s_add_u32 m0, s39, 33792
    v_mfma_f32_16x16x32_bf16 v[20:23], v[212:215], a[32:35], v[20:23]
    v_perm_b32 v216, v142, v138, s68
    v_perm_b32 v217, v150, v146, s68
    v_mfma_f32_16x16x32_bf16 v[52:55], v[212:215], a[96:99], v[52:55]
    v_perm_b32 v218, v158, v154, s68
    v_perm_b32 v219, v166, v162, s68
    v_mfma_f32_16x16x32_bf16 v[84:87], v[212:215], a[160:163], v[84:87]
    s_add_u32 s38, s37, 1081344
    buffer_load_dwordx4 v7, s[32:35], s38 offen lds
    v_mfma_f32_16x16x32_bf16 v[116:119], v[212:215], a[224:227], v[116:119]
    s_add_u32 m0, s39, 34816
    s_add_u32 s38, s37, 1114112
    v_mfma_f32_16x16x32_bf16 v[24:27], v[216:219], a[32:35], v[24:27]
    v_perm_b32 v220, v142, v138, s69
    v_perm_b32 v221, v150, v146, s69
    v_mfma_f32_16x16x32_bf16 v[56:59], v[216:219], a[96:99], v[56:59]
    v_perm_b32 v222, v158, v154, s69
    v_perm_b32 v223, v166, v162, s69
    v_mfma_f32_16x16x32_bf16 v[88:91], v[216:219], a[160:163], v[88:91]
    buffer_load_dwordx4 v7, s[32:35], s38 offen lds
    s_add_u32 m0, s39, 35840
    v_mfma_f32_16x16x32_bf16 v[120:123], v[216:219], a[224:227], v[120:123]
    s_add_u32 s38, s37, 1146880
    buffer_load_dwordx4 v7, s[32:35], s38 offen lds
    v_mfma_f32_16x16x32_bf16 v[28:31], v[220:223], a[32:35], v[28:31]
    v_perm_b32 v224, v143, v139, s68
    v_perm_b32 v225, v151, v147, s68
    v_mfma_f32_16x16x32_bf16 v[60:63], v[220:223], a[96:99], v[60:63]
    v_perm_b32 v226, v159, v155, s68
    v_perm_b32 v227, v167, v163, s68
    v_mfma_f32_16x16x32_bf16 v[92:95], v[220:223], a[160:163], v[92:95]
    s_add_u32 m0, s39, 36864
    s_add_u32 s38, s37, 1179648
    v_mfma_f32_16x16x32_bf16 v[124:127], v[220:223], a[224:227], v[124:127]
    buffer_load_dwordx4 v7, s[32:35], s38 offen lds
    s_add_u32 m0, s39, 37888
    v_mfma_f32_16x16x32_bf16 v[32:35], v[224:227], a[32:35], v[32:35]
    v_perm_b32 v228, v143, v139, s69
    v_perm_b32 v229, v151, v147, s69
    v_mfma_f32_16x16x32_bf16 v[64:67], v[224:227], a[96:99], v[64:67]
    v_perm_b32 v230, v159, v155, s69
    v_perm_b32 v231, v167, v163, s69
    v_mfma_f32_16x16x32_bf16 v[96:99], v[224:227], a[160:163], v[96:99]
    s_add_u32 s38, s37, 1212416
    buffer_load_dwordx4 v7, s[32:35], s38 offen lds
    v_mfma_f32_16x16x32_bf16 v[128:131], v[224:227], a[224:227], v[128:131]
    s_add_u32 m0, s39, 38912
    s_add_u32 s38, s37, 1245184
    v_mfma_f32_16x16x32_bf16 v[36:39], v[228:231], a[32:35], v[36:39]
    buffer_load_dwordx4 v7, s[32:35], s38 offen lds
    s_add_u32 m0, s39, 39936
    v_mfma_f32_16x16x32_bf16 v[68:71], v[228:231], a[96:99], v[68:71]
    s_add_u32 s38, s37, 1277952
    buffer_load_dwordx4 v7, s[32:35], s38 offen lds
    v_mfma_f32_16x16x32_bf16 v[100:103], v[228:231], a[160:163], v[100:103]
    v_mfma_f32_16x16x32_bf16 v[132:135], v[228:231], a[224:227], v[132:135]
    s_waitcnt lgkmcnt(0)
    v_perm_b32 v200, v172, v168, s68
    v_perm_b32 v201, v180, v176, s68
    v_perm_b32 v202, v188, v184, s68
    v_perm_b32 v203, v196, v192, s68
    s_nop 1
    v_mfma_f32_16x16x32_bf16 v[8:11], v[200:203], a[36:39], v[8:11]
    v_perm_b32 v204, v172, v168, s69
    v_perm_b32 v205, v180, v176, s69
    v_mfma_f32_16x16x32_bf16 v[40:43], v[200:203], a[100:103], v[40:43]
    v_perm_b32 v206, v188, v184, s69
    v_perm_b32 v207, v196, v192, s69
    v_mfma_f32_16x16x32_bf16 v[72:75], v[200:203], a[164:167], v[72:75]
    ds_read_b128 v[136:139], v233 offset:16384
    ds_read_b128 v[140:143], v233 offset:16640
    v_mfma_f32_16x16x32_bf16 v[104:107], v[200:203], a[228:231], v[104:107]
    ds_read_b128 v[144:147], v233 offset:16896
    ds_read_b128 v[148:151], v233 offset:17152
    v_mfma_f32_16x16x32_bf16 v[12:15], v[204:207], a[36:39], v[12:15]
    v_perm_b32 v208, v173, v169, s68
    v_perm_b32 v209, v181, v177, s68
    v_mfma_f32_16x16x32_bf16 v[44:47], v[204:207], a[100:103], v[44:47]
    v_perm_b32 v210, v189, v185, s68
    v_perm_b32 v211, v197, v193, s68
    v_mfma_f32_16x16x32_bf16 v[76:79], v[204:207], a[164:167], v[76:79]
    ds_read_b128 v[152:155], v233 offset:17408
    ds_read_b128 v[156:159], v233 offset:17664
    v_mfma_f32_16x16x32_bf16 v[108:111], v[204:207], a[228:231], v[108:111]
    ds_read_b128 v[160:163], v233 offset:17920
    ds_read_b128 v[164:167], v233 offset:18176
    v_mfma_f32_16x16x32_bf16 v[16:19], v[208:211], a[36:39], v[16:19]
    v_perm_b32 v212, v173, v169, s69
    v_perm_b32 v213, v181, v177, s69
    v_mfma_f32_16x16x32_bf16 v[48:51], v[208:211], a[100:103], v[48:51]
    v_perm_b32 v214, v189, v185, s69
    v_perm_b32 v215, v197, v193, s69
    v_mfma_f32_16x16x32_bf16 v[80:83], v[208:211], a[164:167], v[80:83]
    v_mfma_f32_16x16x32_bf16 v[112:115], v[208:211], a[228:231], v[112:115]
    v_mfma_f32_16x16x32_bf16 v[20:23], v[212:215], a[36:39], v[20:23]
    v_perm_b32 v216, v174, v170, s68
    v_perm_b32 v217, v182, v178, s68
    v_mfma_f32_16x16x32_bf16 v[52:55], v[212:215], a[100:103], v[52:55]
    v_perm_b32 v218, v190, v186, s68
    v_perm_b32 v219, v198, v194, s68
    v_mfma_f32_16x16x32_bf16 v[84:87], v[212:215], a[164:167], v[84:87]
    v_mfma_f32_16x16x32_bf16 v[116:119], v[212:215], a[228:231], v[116:119]
    v_mfma_f32_16x16x32_bf16 v[24:27], v[216:219], a[36:39], v[24:27]
    v_perm_b32 v220, v174, v170, s69
    v_perm_b32 v221, v182, v178, s69
    v_mfma_f32_16x16x32_bf16 v[56:59], v[216:219], a[100:103], v[56:59]
    v_perm_b32 v222, v190, v186, s69
    v_perm_b32 v223, v198, v194, s69
    v_mfma_f32_16x16x32_bf16 v[88:91], v[216:219], a[164:167], v[88:91]
    v_mfma_f32_16x16x32_bf16 v[120:123], v[216:219], a[228:231], v[120:123]
    v_mfma_f32_16x16x32_bf16 v[28:31], v[220:223], a[36:39], v[28:31]
    v_perm_b32 v224, v175, v171, s68
    v_perm_b32 v225, v183, v179, s68
    v_mfma_f32_16x16x32_bf16 v[60:63], v[220:223], a[100:103], v[60:63]
    v_perm_b32 v226, v191, v187, s68
    v_perm_b32 v227, v199, v195, s68
    v_mfma_f32_16x16x32_bf16 v[92:95], v[220:223], a[164:167], v[92:95]
    v_mfma_f32_16x16x32_bf16 v[124:127], v[220:223], a[228:231], v[124:127]
    v_mfma_f32_16x16x32_bf16 v[32:35], v[224:227], a[36:39], v[32:35]
    v_perm_b32 v228, v175, v171, s69
    v_perm_b32 v229, v183, v179, s69
    v_mfma_f32_16x16x32_bf16 v[64:67], v[224:227], a[100:103], v[64:67]
    v_perm_b32 v230, v191, v187, s69
    v_perm_b32 v231, v199, v195, s69
    v_mfma_f32_16x16x32_bf16 v[96:99], v[224:227], a[164:167], v[96:99]
    v_mfma_f32_16x16x32_bf16 v[128:131], v[224:227], a[228:231], v[128:131]
    v_mfma_f32_16x16x32_bf16 v[36:39], v[228:231], a[36:39], v[36:39]
    v_mfma_f32_16x16x32_bf16 v[68:71], v[228:231], a[100:103], v[68:71]
    v_mfma_f32_16x16x32_bf16 v[100:103], v[228:231], a[164:167], v[100:103]
    v_mfma_f32_16x16x32_bf16 v[132:135], v[228:231], a[228:231], v[132:135]
    s_waitcnt lgkmcnt(0)
    v_perm_b32 v200, v140, v136, s68
    v_perm_b32 v201, v148, v144, s68
    v_perm_b32 v202, v156, v152, s68
    v_perm_b32 v203, v164, v160, s68
    s_nop 1
    v_mfma_f32_16x16x32_bf16 v[8:11], v[200:203], a[40:43], v[8:11]
    v_perm_b32 v204, v140, v136, s69
    v_perm_b32 v205, v148, v144, s69
    v_mfma_f32_16x16x32_bf16 v[40:43], v[200:203], a[104:107], v[40:43]
    v_perm_b32 v206, v156, v152, s69
    v_perm_b32 v207, v164, v160, s69
    v_mfma_f32_16x16x32_bf16 v[72:75], v[200:203], a[168:171], v[72:75]
    ds_read_b128 v[168:171], v233 offset:24576
    ds_read_b128 v[172:175], v233 offset:24832
    v_mfma_f32_16x16x32_bf16 v[104:107], v[200:203], a[232:235], v[104:107]
    ds_read_b128 v[176:179], v233 offset:25088
    ds_read_b128 v[180:183], v233 offset:25344
    v_mfma_f32_16x16x32_bf16 v[12:15], v[204:207], a[40:43], v[12:15]
    v_perm_b32 v208, v141, v137, s68
    v_perm_b32 v209, v149, v145, s68
    v_mfma_f32_16x16x32_bf16 v[44:47], v[204:207], a[104:107], v[44:47]
    v_perm_b32 v210, v157, v153, s68
    v_perm_b32 v211, v165, v161, s68
    v_mfma_f32_16x16x32_bf16 v[76:79], v[204:207], a[168:171], v[76:79]
    ds_read_b128 v[184:187], v233 offset:25600
    ds_read_b128 v[188:191], v233 offset:25856
    v_mfma_f32_16x16x32_bf16 v[108:111], v[204:207], a[232:235], v[108:111]
    ds_read_b128 v[192:195], v233 offset:26112
    ds_read_b128 v[196:199], v233 offset:26368
    v_mfma_f32_16x16x32_bf16 v[16:19], v[208:211], a[40:43], v[16:19]
    v_perm_b32 v212, v141, v137, s69
    v_perm_b32 v213, v149, v145, s69
    v_mfma_f32_16x16x32_bf16 v[48:51], v[208:211], a[104:107], v[48:51]
    v_perm_b32 v214, v157, v153, s69
    v_perm_b32 v215, v165, v161, s69
    v_mfma_f32_16x16x32_bf16 v[80:83], v[208:211], a[168:171], v[80:83]
    v_mfma_f32_16x16x32_bf16 v[112:115], v[208:211], a[232:235], v[112:115]
    v_mfma_f32_16x16x32_bf16 v[20:23], v[212:215], a[40:43], v[20:23]
    v_perm_b32 v216, v142, v138, s68
    v_perm_b32 v217, v150, v146, s68
    v_mfma_f32_16x16x32_bf16 v[52:55], v[212:215], a[104:107], v[52:55]
    v_perm_b32 v218, v158, v154, s68
    v_perm_b32 v219, v166, v162, s68
    v_mfma_f32_16x16x32_bf16 v[84:87], v[212:215], a[168:171], v[84:87]
    v_mfma_f32_16x16x32_bf16 v[116:119], v[212:215], a[232:235], v[116:119]
    v_mfma_f32_16x16x32_bf16 v[24:27], v[216:219], a[40:43], v[24:27]
    v_perm_b32 v220, v142, v138, s69
    v_perm_b32 v221, v150, v146, s69
    v_mfma_f32_16x16x32_bf16 v[56:59], v[216:219], a[104:107], v[56:59]
    v_perm_b32 v222, v158, v154, s69
    v_perm_b32 v223, v166, v162, s69
    v_mfma_f32_16x16x32_bf16 v[88:91], v[216:219], a[168:171], v[88:91]
    v_mfma_f32_16x16x32_bf16 v[120:123], v[216:219], a[232:235], v[120:123]
    v_mfma_f32_16x16x32_bf16 v[28:31], v[220:223], a[40:43], v[28:31]
    v_perm_b32 v224, v143, v139, s68
    v_perm_b32 v225, v151, v147, s68
    v_mfma_f32_16x16x32_bf16 v[60:63], v[220:223], a[104:107], v[60:63]
    v_perm_b32 v226, v159, v155, s68
    v_perm_b32 v227, v167, v163, s68
    v_mfma_f32_16x16x32_bf16 v[92:95], v[220:223], a[168:171], v[92:95]
    v_mfma_f32_16x16x32_bf16 v[124:127], v[220:223], a[232:235], v[124:127]
    v_mfma_f32_16x16x32_bf16 v[32:35], v[224:227], a[40:43], v[32:35]
    v_perm_b32 v228, v143, v139, s69
    v_perm_b32 v229, v151, v147, s69
    v_mfma_f32_16x16x32_bf16 v[64:67], v[224:227], a[104:107], v[64:67]
    v_perm_b32 v230, v159, v155, s69
    v_perm_b32 v231, v167, v163, s69
    v_mfma_f32_16x16x32_bf16 v[96:99], v[224:227], a[168:171], v[96:99]
    v_mfma_f32_16x16x32_bf16 v[128:131], v[224:227], a[232:235], v[128:131]
    v_mfma_f32_16x16x32_bf16 v[36:39], v[228:231], a[40:43], v[36:39]
    v_mfma_f32_16x16x32_bf16 v[68:71], v[228:231], a[104:107], v[68:71]
    v_mfma_f32_16x16x32_bf16 v[100:103], v[228:231], a[168:171], v[100:103]
    v_mfma_f32_16x16x32_bf16 v[132:135], v[228:231], a[232:235], v[132:135]
    s_waitcnt lgkmcnt(0)
    v_perm_b32 v200, v172, v168, s68
    v_perm_b32 v201, v180, v176, s68
    v_perm_b32 v202, v188, v184, s68
    v_perm_b32 v203, v196, v192, s68
    s_nop 1
    v_mfma_f32_16x16x32_bf16 v[8:11], v[200:203], a[44:47], v[8:11]
    v_perm_b32 v204, v172, v168, s69
    v_perm_b32 v205, v180, v176, s69
    v_mfma_f32_16x16x32_bf16 v[40:43], v[200:203], a[108:111], v[40:43]
    v_perm_b32 v206, v188, v184, s69
    v_perm_b32 v207, v196, v192, s69
    v_mfma_f32_16x16x32_bf16 v[72:75], v[200:203], a[172:175], v[72:75]
    v_mfma_f32_16x16x32_bf16 v[104:107], v[200:203], a[236:239], v[104:107]
    v_mfma_f32_16x16x32_bf16 v[12:15], v[204:207], a[44:47], v[12:15]
    v_perm_b32 v208, v173, v169, s68
    v_perm_b32 v209, v181, v177, s68
    v_mfma_f32_16x16x32_bf16 v[44:47], v[204:207], a[108:111], v[44:47]
    v_perm_b32 v210, v189, v185, s68
    v_perm_b32 v211, v197, v193, s68
    v_mfma_f32_16x16x32_bf16 v[76:79], v[204:207], a[172:175], v[76:79]
    v_mfma_f32_16x16x32_bf16 v[108:111], v[204:207], a[236:239], v[108:111]
    v_mfma_f32_16x16x32_bf16 v[16:19], v[208:211], a[44:47], v[16:19]
    v_perm_b32 v212, v173, v169, s69
    v_perm_b32 v213, v181, v177, s69
    v_mfma_f32_16x16x32_bf16 v[48:51], v[208:211], a[108:111], v[48:51]
    v_perm_b32 v214, v189, v185, s69
    v_perm_b32 v215, v197, v193, s69
    v_mfma_f32_16x16x32_bf16 v[80:83], v[208:211], a[172:175], v[80:83]
    v_mfma_f32_16x16x32_bf16 v[112:115], v[208:211], a[236:239], v[112:115]
    v_mfma_f32_16x16x32_bf16 v[20:23], v[212:215], a[44:47], v[20:23]
    v_perm_b32 v216, v174, v170, s68
    v_perm_b32 v217, v182, v178, s68
    v_mfma_f32_16x16x32_bf16 v[52:55], v[212:215], a[108:111], v[52:55]
    v_perm_b32 v218, v190, v186, s68
    v_perm_b32 v219, v198, v194, s68
    v_mfma_f32_16x16x32_bf16 v[84:87], v[212:215], a[172:175], v[84:87]
    v_mfma_f32_16x16x32_bf16 v[116:119], v[212:215], a[236:239], v[116:119]
    v_mfma_f32_16x16x32_bf16 v[24:27], v[216:219], a[44:47], v[24:27]
    v_perm_b32 v220, v174, v170, s69
    v_perm_b32 v221, v182, v178, s69
    v_mfma_f32_16x16x32_bf16 v[56:59], v[216:219], a[108:111], v[56:59]
    v_perm_b32 v222, v190, v186, s69
    v_perm_b32 v223, v198, v194, s69
    v_mfma_f32_16x16x32_bf16 v[88:91], v[216:219], a[172:175], v[88:91]
    v_mfma_f32_16x16x32_bf16 v[120:123], v[216:219], a[236:239], v[120:123]
    v_mfma_f32_16x16x32_bf16 v[28:31], v[220:223], a[44:47], v[28:31]
    v_perm_b32 v224, v175, v171, s68
    v_perm_b32 v225, v183, v179, s68
    v_mfma_f32_16x16x32_bf16 v[60:63], v[220:223], a[108:111], v[60:63]
    v_perm_b32 v226, v191, v187, s68
    v_perm_b32 v227, v199, v195, s68
    v_mfma_f32_16x16x32_bf16 v[92:95], v[220:223], a[172:175], v[92:95]
    v_mfma_f32_16x16x32_bf16 v[124:127], v[220:223], a[236:239], v[124:127]
    v_mfma_f32_16x16x32_bf16 v[32:35], v[224:227], a[44:47], v[32:35]
    v_perm_b32 v228, v175, v171, s69
    v_perm_b32 v229, v183, v179, s69
    v_mfma_f32_16x16x32_bf16 v[64:67], v[224:227], a[108:111], v[64:67]
    v_perm_b32 v230, v191, v187, s69
    v_perm_b32 v231, v199, v195, s69
    v_mfma_f32_16x16x32_bf16 v[96:99], v[224:227], a[172:175], v[96:99]
    v_mfma_f32_16x16x32_bf16 v[128:131], v[224:227], a[236:239], v[128:131]
    v_mfma_f32_16x16x32_bf16 v[36:39], v[228:231], a[44:47], v[36:39]
    v_mfma_f32_16x16x32_bf16 v[68:71], v[228:231], a[108:111], v[68:71]
    v_mfma_f32_16x16x32_bf16 v[100:103], v[228:231], a[172:175], v[100:103]
    v_mfma_f32_16x16x32_bf16 v[132:135], v[228:231], a[236:239], v[132:135]
    s_waitcnt vmcnt(16)
    s_barrier
    ds_read_b128 v[136:139], v233 offset:32768
    ds_read_b128 v[140:143], v233 offset:33024
    ds_read_b128 v[144:147], v233 offset:33280
    ds_read_b128 v[148:151], v233 offset:33536
    ds_read_b128 v[152:155], v233 offset:33792
    ds_read_b128 v[156:159], v233 offset:34048
    ds_read_b128 v[160:163], v233 offset:34304
    ds_read_b128 v[164:167], v233 offset:34560
    s_waitcnt lgkmcnt(0)
    v_perm_b32 v200, v140, v136, s68
    v_perm_b32 v201, v148, v144, s68
    v_perm_b32 v202, v156, v152, s68
    v_perm_b32 v203, v164, v160, s68
    s_nop 1
    v_mfma_f32_16x16x32_bf16 v[8:11], v[200:203], a[48:51], v[8:11]
    v_perm_b32 v204, v140, v136, s69
    v_perm_b32 v205, v148, v144, s69
    v_mfma_f32_16x16x32_bf16 v[40:43], v[200:203], a[112:115], v[40:43]
    v_perm_b32 v206, v156, v152, s69
    v_perm_b32 v207, v164, v160, s69
    v_mfma_f32_16x16x32_bf16 v[72:75], v[200:203], a[176:179], v[72:75]
    ds_read_b128 v[168:171], v233 offset:40960
    ds_read_b128 v[172:175], v233 offset:41216
    v_mfma_f32_16x16x32_bf16 v[104:107], v[200:203], a[240:243], v[104:107]
    ds_read_b128 v[176:179], v233 offset:41472
    ds_read_b128 v[180:183], v233 offset:41728
    v_mfma_f32_16x16x32_bf16 v[12:15], v[204:207], a[48:51], v[12:15]
    v_perm_b32 v208, v141, v137, s68
    v_perm_b32 v209, v149, v145, s68
    v_mfma_f32_16x16x32_bf16 v[44:47], v[204:207], a[112:115], v[44:47]
    v_perm_b32 v210, v157, v153, s68
    v_perm_b32 v211, v165, v161, s68
    v_mfma_f32_16x16x32_bf16 v[76:79], v[204:207], a[176:179], v[76:79]
    ds_read_b128 v[184:187], v233 offset:41984
    ds_read_b128 v[188:191], v233 offset:42240
    v_mfma_f32_16x16x32_bf16 v[108:111], v[204:207], a[240:243], v[108:111]
    ds_read_b128 v[192:195], v233 offset:42496
    ds_read_b128 v[196:199], v233 offset:42752
    v_mfma_f32_16x16x32_bf16 v[16:19], v[208:211], a[48:51], v[16:19]
    v_perm_b32 v212, v141, v137, s69
    v_perm_b32 v213, v149, v145, s69
    v_mfma_f32_16x16x32_bf16 v[48:51], v[208:211], a[112:115], v[48:51]
    v_perm_b32 v214, v157, v153, s69
    v_perm_b32 v215, v165, v161, s69
    v_mfma_f32_16x16x32_bf16 v[80:83], v[208:211], a[176:179], v[80:83]
    s_add_u32 m0, s39, 65536
    s_add_u32 s38, s37, 2097152
    v_mfma_f32_16x16x32_bf16 v[112:115], v[208:211], a[240:243], v[112:115]
    buffer_load_dwordx4 v7, s[32:35], s38 offen lds
    s_add_u32 m0, s39, 66560
    v_mfma_f32_16x16x32_bf16 v[20:23], v[212:215], a[48:51], v[20:23]
    v_perm_b32 v216, v142, v138, s68
    v_perm_b32 v217, v150, v146, s68
    v_mfma_f32_16x16x32_bf16 v[52:55], v[212:215], a[112:115], v[52:55]
    v_perm_b32 v218, v158, v154, s68
    v_perm_b32 v219, v166, v162, s68
    v_mfma_f32_16x16x32_bf16 v[84:87], v[212:215], a[176:179], v[84:87]
    s_add_u32 s38, s37, 2129920
    buffer_load_dwordx4 v7, s[32:35], s38 offen lds
    v_mfma_f32_16x16x32_bf16 v[116:119], v[212:215], a[240:243], v[116:119]
    s_add_u32 m0, s39, 67584
    s_add_u32 s38, s37, 2162688
    v_mfma_f32_16x16x32_bf16 v[24:27], v[216:219], a[48:51], v[24:27]
    v_perm_b32 v220, v142, v138, s69
    v_perm_b32 v221, v150, v146, s69
    v_mfma_f32_16x16x32_bf16 v[56:59], v[216:219], a[112:115], v[56:59]
    v_perm_b32 v222, v158, v154, s69
    v_perm_b32 v223, v166, v162, s69
    v_mfma_f32_16x16x32_bf16 v[88:91], v[216:219], a[176:179], v[88:91]
    buffer_load_dwordx4 v7, s[32:35], s38 offen lds
    s_add_u32 m0, s39, 68608
    v_mfma_f32_16x16x32_bf16 v[120:123], v[216:219], a[240:243], v[120:123]
    s_add_u32 s38, s37, 2195456
    buffer_load_dwordx4 v7, s[32:35], s38 offen lds
    v_mfma_f32_16x16x32_bf16 v[28:31], v[220:223], a[48:51], v[28:31]
    v_perm_b32 v224, v143, v139, s68
    v_perm_b32 v225, v151, v147, s68
    v_mfma_f32_16x16x32_bf16 v[60:63], v[220:223], a[112:115], v[60:63]
    v_perm_b32 v226, v159, v155, s68
    v_perm_b32 v227, v167, v163, s68
    v_mfma_f32_16x16x32_bf16 v[92:95], v[220:223], a[176:179], v[92:95]
    s_add_u32 m0, s39, 69632
    s_add_u32 s38, s37, 2228224
    v_mfma_f32_16x16x32_bf16 v[124:127], v[220:223], a[240:243], v[124:127]
    buffer_load_dwordx4 v7, s[32:35], s38 offen lds
    s_add_u32 m0, s39, 70656
    v_mfma_f32_16x16x32_bf16 v[32:35], v[224:227], a[48:51], v[32:35]
    v_perm_b32 v228, v143, v139, s69
    v_perm_b32 v229, v151, v147, s69
    v_mfma_f32_16x16x32_bf16 v[64:67], v[224:227], a[112:115], v[64:67]
    v_perm_b32 v230, v159, v155, s69
    v_perm_b32 v231, v167, v163, s69
    v_mfma_f32_16x16x32_bf16 v[96:99], v[224:227], a[176:179], v[96:99]
    s_add_u32 s38, s37, 2260992
    buffer_load_dwordx4 v7, s[32:35], s38 offen lds
    v_mfma_f32_16x16x32_bf16 v[128:131], v[224:227], a[240:243], v[128:131]
    s_add_u32 m0, s39, 71680
    s_add_u32 s38, s37, 2293760
    v_mfma_f32_16x16x32_bf16 v[36:39], v[228:231], a[48:51], v[36:39]
    buffer_load_dwordx4 v7, s[32:35], s38 offen lds
    s_add_u32 m0, s39, 72704
    v_mfma_f32_16x16x32_bf16 v[68:71], v[228:231], a[112:115], v[68:71]
    s_add_u32 s38, s37, 2326528
    buffer_load_dwordx4 v7, s[32:35], s38 offen lds
    v_mfma_f32_16x16x32_bf16 v[100:103], v[228:231], a[176:179], v[100:103]
    v_mfma_f32_16x16x32_bf16 v[132:135], v[228:231], a[240:243], v[132:135]
    s_waitcnt lgkmcnt(0)
    v_perm_b32 v200, v172, v168, s68
    v_perm_b32 v201, v180, v176, s68
    v_perm_b32 v202, v188, v184, s68
    v_perm_b32 v203, v196, v192, s68
    s_nop 1
    v_mfma_f32_16x16x32_bf16 v[8:11], v[200:203], a[52:55], v[8:11]
    v_perm_b32 v204, v172, v168, s69
    v_perm_b32 v205, v180, v176, s69
    v_mfma_f32_16x16x32_bf16 v[40:43], v[200:203], a[116:119], v[40:43]
    v_perm_b32 v206, v188, v184, s69
    v_perm_b32 v207, v196, v192, s69
    v_mfma_f32_16x16x32_bf16 v[72:75], v[200:203], a[180:183], v[72:75]
    ds_read_b128 v[136:139], v233 offset:49152
    ds_read_b128 v[140:143], v233 offset:49408
    v_mfma_f32_16x16x32_bf16 v[104:107], v[200:203], a[244:247], v[104:107]
    ds_read_b128 v[144:147], v233 offset:49664
    ds_read_b128 v[148:151], v233 offset:49920
    v_mfma_f32_16x16x32_bf16 v[12:15], v[204:207], a[52:55], v[12:15]
    v_perm_b32 v208, v173, v169, s68
    v_perm_b32 v209, v181, v177, s68
    v_mfma_f32_16x16x32_bf16 v[44:47], v[204:207], a[116:119], v[44:47]
    v_perm_b32 v210, v189, v185, s68
    v_perm_b32 v211, v197, v193, s68
    v_mfma_f32_16x16x32_bf16 v[76:79], v[204:207], a[180:183], v[76:79]
    ds_read_b128 v[152:155], v233 offset:50176
    ds_read_b128 v[156:159], v233 offset:50432
    v_mfma_f32_16x16x32_bf16 v[108:111], v[204:207], a[244:247], v[108:111]
    ds_read_b128 v[160:163], v233 offset:50688
    ds_read_b128 v[164:167], v233 offset:50944
    v_mfma_f32_16x16x32_bf16 v[16:19], v[208:211], a[52:55], v[16:19]
    v_perm_b32 v212, v173, v169, s69
    v_perm_b32 v213, v181, v177, s69
    v_mfma_f32_16x16x32_bf16 v[48:51], v[208:211], a[116:119], v[48:51]
    v_perm_b32 v214, v189, v185, s69
    v_perm_b32 v215, v197, v193, s69
    v_mfma_f32_16x16x32_bf16 v[80:83], v[208:211], a[180:183], v[80:83]
    v_mfma_f32_16x16x32_bf16 v[112:115], v[208:211], a[244:247], v[112:115]
    v_mfma_f32_16x16x32_bf16 v[20:23], v[212:215], a[52:55], v[20:23]
    v_perm_b32 v216, v174, v170, s68
    v_perm_b32 v217, v182, v178, s68
    v_mfma_f32_16x16x32_bf16 v[52:55], v[212:215], a[116:119], v[52:55]
    v_perm_b32 v218, v190, v186, s68
    v_perm_b32 v219, v198, v194, s68
    v_mfma_f32_16x16x32_bf16 v[84:87], v[212:215], a[180:183], v[84:87]
    v_mfma_f32_16x16x32_bf16 v[116:119], v[212:215], a[244:247], v[116:119]
    v_mfma_f32_16x16x32_bf16 v[24:27], v[216:219], a[52:55], v[24:27]
    v_perm_b32 v220, v174, v170, s69
    v_perm_b32 v221, v182, v178, s69
    v_mfma_f32_16x16x32_bf16 v[56:59], v[216:219], a[116:119], v[56:59]
    v_perm_b32 v222, v190, v186, s69
    v_perm_b32 v223, v198, v194, s69
    v_mfma_f32_16x16x32_bf16 v[88:91], v[216:219], a[180:183], v[88:91]
    v_mfma_f32_16x16x32_bf16 v[120:123], v[216:219], a[244:247], v[120:123]
    v_mfma_f32_16x16x32_bf16 v[28:31], v[220:223], a[52:55], v[28:31]
    v_perm_b32 v224, v175, v171, s68
    v_perm_b32 v225, v183, v179, s68
    v_mfma_f32_16x16x32_bf16 v[60:63], v[220:223], a[116:119], v[60:63]
    v_perm_b32 v226, v191, v187, s68
    v_perm_b32 v227, v199, v195, s68
    v_mfma_f32_16x16x32_bf16 v[92:95], v[220:223], a[180:183], v[92:95]
    v_mfma_f32_16x16x32_bf16 v[124:127], v[220:223], a[244:247], v[124:127]
    v_mfma_f32_16x16x32_bf16 v[32:35], v[224:227], a[52:55], v[32:35]
    v_perm_b32 v228, v175, v171, s69
    v_perm_b32 v229, v183, v179, s69
    v_mfma_f32_16x16x32_bf16 v[64:67], v[224:227], a[116:119], v[64:67]
    v_perm_b32 v230, v191, v187, s69
    v_perm_b32 v231, v199, v195, s69
    v_mfma_f32_16x16x32_bf16 v[96:99], v[224:227], a[180:183], v[96:99]
    v_mfma_f32_16x16x32_bf16 v[128:131], v[224:227], a[244:247], v[128:131]
    v_mfma_f32_16x16x32_bf16 v[36:39], v[228:231], a[52:55], v[36:39]
    v_mfma_f32_16x16x32_bf16 v[68:71], v[228:231], a[116:119], v[68:71]
    v_mfma_f32_16x16x32_bf16 v[100:103], v[228:231], a[180:183], v[100:103]
    v_mfma_f32_16x16x32_bf16 v[132:135], v[228:231], a[244:247], v[132:135]
    s_waitcnt lgkmcnt(0)
    v_perm_b32 v200, v140, v136, s68
    v_perm_b32 v201, v148, v144, s68
    v_perm_b32 v202, v156, v152, s68
    v_perm_b32 v203, v164, v160, s68
    s_nop 1
    v_mfma_f32_16x16x32_bf16 v[8:11], v[200:203], a[56:59], v[8:11]
    v_perm_b32 v204, v140, v136, s69
    v_perm_b32 v205, v148, v144, s69
    v_mfma_f32_16x16x32_bf16 v[40:43], v[200:203], a[120:123], v[40:43]
    v_perm_b32 v206, v156, v152, s69
    v_perm_b32 v207, v164, v160, s69
    v_mfma_f32_16x16x32_bf16 v[72:75], v[200:203], a[184:187], v[72:75]
    ds_read_b128 v[168:171], v233 offset:57344
    ds_read_b128 v[172:175], v233 offset:57600
    v_mfma_f32_16x16x32_bf16 v[104:107], v[200:203], a[248:251], v[104:107]
    ds_read_b128 v[176:179], v233 offset:57856
    ds_read_b128 v[180:183], v233 offset:58112
    v_mfma_f32_16x16x32_bf16 v[12:15], v[204:207], a[56:59], v[12:15]
    v_perm_b32 v208, v141, v137, s68
    v_perm_b32 v209, v149, v145, s68
    v_mfma_f32_16x16x32_bf16 v[44:47], v[204:207], a[120:123], v[44:47]
    v_perm_b32 v210, v157, v153, s68
    v_perm_b32 v211, v165, v161, s68
    v_mfma_f32_16x16x32_bf16 v[76:79], v[204:207], a[184:187], v[76:79]
    ds_read_b128 v[184:187], v233 offset:58368
    ds_read_b128 v[188:191], v233 offset:58624
    v_mfma_f32_16x16x32_bf16 v[108:111], v[204:207], a[248:251], v[108:111]
    ds_read_b128 v[192:195], v233 offset:58880
    ds_read_b128 v[196:199], v233 offset:59136
    v_mfma_f32_16x16x32_bf16 v[16:19], v[208:211], a[56:59], v[16:19]
    v_perm_b32 v212, v141, v137, s69
    v_perm_b32 v213, v149, v145, s69
    v_mfma_f32_16x16x32_bf16 v[48:51], v[208:211], a[120:123], v[48:51]
    v_perm_b32 v214, v157, v153, s69
    v_perm_b32 v215, v165, v161, s69
    v_mfma_f32_16x16x32_bf16 v[80:83], v[208:211], a[184:187], v[80:83]
    v_mfma_f32_16x16x32_bf16 v[112:115], v[208:211], a[248:251], v[112:115]
    v_mfma_f32_16x16x32_bf16 v[20:23], v[212:215], a[56:59], v[20:23]
    v_perm_b32 v216, v142, v138, s68
    v_perm_b32 v217, v150, v146, s68
    v_mfma_f32_16x16x32_bf16 v[52:55], v[212:215], a[120:123], v[52:55]
    v_perm_b32 v218, v158, v154, s68
    v_perm_b32 v219, v166, v162, s68
    v_mfma_f32_16x16x32_bf16 v[84:87], v[212:215], a[184:187], v[84:87]
    v_mfma_f32_16x16x32_bf16 v[116:119], v[212:215], a[248:251], v[116:119]
    v_mfma_f32_16x16x32_bf16 v[24:27], v[216:219], a[56:59], v[24:27]
    v_perm_b32 v220, v142, v138, s69
    v_perm_b32 v221, v150, v146, s69
    v_mfma_f32_16x16x32_bf16 v[56:59], v[216:219], a[120:123], v[56:59]
    v_perm_b32 v222, v158, v154, s69
    v_perm_b32 v223, v166, v162, s69
    v_mfma_f32_16x16x32_bf16 v[88:91], v[216:219], a[184:187], v[88:91]
    v_mfma_f32_16x16x32_bf16 v[120:123], v[216:219], a[248:251], v[120:123]
    v_mfma_f32_16x16x32_bf16 v[28:31], v[220:223], a[56:59], v[28:31]
    v_perm_b32 v224, v143, v139, s68
    v_perm_b32 v225, v151, v147, s68
    v_mfma_f32_16x16x32_bf16 v[60:63], v[220:223], a[120:123], v[60:63]
    v_perm_b32 v226, v159, v155, s68
    v_perm_b32 v227, v167, v163, s68
    v_mfma_f32_16x16x32_bf16 v[92:95], v[220:223], a[184:187], v[92:95]
    v_mfma_f32_16x16x32_bf16 v[124:127], v[220:223], a[248:251], v[124:127]
    v_mfma_f32_16x16x32_bf16 v[32:35], v[224:227], a[56:59], v[32:35]
    v_perm_b32 v228, v143, v139, s69
    v_perm_b32 v229, v151, v147, s69
    v_mfma_f32_16x16x32_bf16 v[64:67], v[224:227], a[120:123], v[64:67]
    v_perm_b32 v230, v159, v155, s69
    v_perm_b32 v231, v167, v163, s69
    v_mfma_f32_16x16x32_bf16 v[96:99], v[224:227], a[184:187], v[96:99]
    v_mfma_f32_16x16x32_bf16 v[128:131], v[224:227], a[248:251], v[128:131]
    v_mfma_f32_16x16x32_bf16 v[36:39], v[228:231], a[56:59], v[36:39]
    v_mfma_f32_16x16x32_bf16 v[68:71], v[228:231], a[120:123], v[68:71]
    v_mfma_f32_16x16x32_bf16 v[100:103], v[228:231], a[184:187], v[100:103]
    v_mfma_f32_16x16x32_bf16 v[132:135], v[228:231], a[248:251], v[132:135]
    s_waitcnt lgkmcnt(0)
    v_perm_b32 v200, v172, v168, s68
    v_perm_b32 v201, v180, v176, s68
    v_perm_b32 v202, v188, v184, s68
    v_perm_b32 v203, v196, v192, s68
    s_nop 1
    v_mfma_f32_16x16x32_bf16 v[8:11], v[200:203], a[60:63], v[8:11]
    v_perm_b32 v204, v172, v168, s69
    v_perm_b32 v205, v180, v176, s69
    v_mfma_f32_16x16x32_bf16 v[40:43], v[200:203], a[124:127], v[40:43]
    v_perm_b32 v206, v188, v184, s69
    v_perm_b32 v207, v196, v192, s69
    v_mfma_f32_16x16x32_bf16 v[72:75], v[200:203], a[188:191], v[72:75]
    v_mfma_f32_16x16x32_bf16 v[104:107], v[200:203], a[252:255], v[104:107]
    v_mfma_f32_16x16x32_bf16 v[12:15], v[204:207], a[60:63], v[12:15]
    v_perm_b32 v208, v173, v169, s68
    v_perm_b32 v209, v181, v177, s68
    v_mfma_f32_16x16x32_bf16 v[44:47], v[204:207], a[124:127], v[44:47]
    v_perm_b32 v210, v189, v185, s68
    v_perm_b32 v211, v197, v193, s68
    v_mfma_f32_16x16x32_bf16 v[76:79], v[204:207], a[188:191], v[76:79]
    v_mfma_f32_16x16x32_bf16 v[108:111], v[204:207], a[252:255], v[108:111]
    v_mfma_f32_16x16x32_bf16 v[16:19], v[208:211], a[60:63], v[16:19]
    v_perm_b32 v212, v173, v169, s69
    v_perm_b32 v213, v181, v177, s69
    v_mfma_f32_16x16x32_bf16 v[48:51], v[208:211], a[124:127], v[48:51]
    v_perm_b32 v214, v189, v185, s69
    v_perm_b32 v215, v197, v193, s69
    v_mfma_f32_16x16x32_bf16 v[80:83], v[208:211], a[188:191], v[80:83]
    v_mfma_f32_16x16x32_bf16 v[112:115], v[208:211], a[252:255], v[112:115]
    v_mfma_f32_16x16x32_bf16 v[20:23], v[212:215], a[60:63], v[20:23]
    v_perm_b32 v216, v174, v170, s68
    v_perm_b32 v217, v182, v178, s68
    v_mfma_f32_16x16x32_bf16 v[52:55], v[212:215], a[124:127], v[52:55]
    v_perm_b32 v218, v190, v186, s68
    v_perm_b32 v219, v198, v194, s68
    v_mfma_f32_16x16x32_bf16 v[84:87], v[212:215], a[188:191], v[84:87]
    v_mfma_f32_16x16x32_bf16 v[116:119], v[212:215], a[252:255], v[116:119]
    v_mfma_f32_16x16x32_bf16 v[24:27], v[216:219], a[60:63], v[24:27]
    v_perm_b32 v220, v174, v170, s69
    v_perm_b32 v221, v182, v178, s69
    v_mfma_f32_16x16x32_bf16 v[56:59], v[216:219], a[124:127], v[56:59]
    v_perm_b32 v222, v190, v186, s69
    v_perm_b32 v223, v198, v194, s69
    v_mfma_f32_16x16x32_bf16 v[88:91], v[216:219], a[188:191], v[88:91]
    v_mfma_f32_16x16x32_bf16 v[120:123], v[216:219], a[252:255], v[120:123]
    v_mfma_f32_16x16x32_bf16 v[28:31], v[220:223], a[60:63], v[28:31]
    v_perm_b32 v224, v175, v171, s68
    v_perm_b32 v225, v183, v179, s68
    v_mfma_f32_16x16x32_bf16 v[60:63], v[220:223], a[124:127], v[60:63]
    v_perm_b32 v226, v191, v187, s68
    v_perm_b32 v227, v199, v195, s68
    v_mfma_f32_16x16x32_bf16 v[92:95], v[220:223], a[188:191], v[92:95]
    v_mfma_f32_16x16x32_bf16 v[124:127], v[220:223], a[252:255], v[124:127]
    v_mfma_f32_16x16x32_bf16 v[32:35], v[224:227], a[60:63], v[32:35]
    v_perm_b32 v228, v175, v171, s69
    v_perm_b32 v229, v183, v179, s69
    v_mfma_f32_16x16x32_bf16 v[64:67], v[224:227], a[124:127], v[64:67]
    v_perm_b32 v230, v191, v187, s69
    v_perm_b32 v231, v199, v195, s69
    v_mfma_f32_16x16x32_bf16 v[96:99], v[224:227], a[188:191], v[96:99]
    v_mfma_f32_16x16x32_bf16 v[128:131], v[224:227], a[252:255], v[128:131]
    v_mfma_f32_16x16x32_bf16 v[36:39], v[228:231], a[60:63], v[36:39]
    v_mfma_f32_16x16x32_bf16 v[68:71], v[228:231], a[124:127], v[68:71]
    v_mfma_f32_16x16x32_bf16 v[100:103], v[228:231], a[188:191], v[100:103]
    v_mfma_f32_16x16x32_bf16 v[132:135], v[228:231], a[252:255], v[132:135]
    s_lshl_b32 s28, s27, 13
    s_lshl_b32 s29, s47, 18
    s_add_u32 s28, s28, s29
    s_add_u32 s28, s28, 4194304
    s_mov_b32 s30, 262144
    s_lshl_b32 s29, s27, 20
    s_lshl_b32 s31, s47, 14
    s_add_u32 s29, s29, s31
    s_add_u32 s29, s29, 20971520
    s_cmp_eq_u32 s26, 1
    s_cselect_b32 s28, s29, s28
    s_cselect_b32 s30, 16384, s30
    v_cvt_pk_bf16_f32 v200, v8, v12
    v_cvt_pk_bf16_f32 v201, v16, v20
    v_cvt_pk_bf16_f32 v202, v24, v28
    v_cvt_pk_bf16_f32 v203, v32, v36
    buffer_store_dwordx4 v[200:203], v6, s[8:11], s28 offen offset:0 sc1
    v_cvt_pk_bf16_f32 v204, v9, v13
    v_cvt_pk_bf16_f32 v205, v17, v21
    v_cvt_pk_bf16_f32 v206, v25, v29
    v_cvt_pk_bf16_f32 v207, v33, v37
    buffer_store_dwordx4 v[204:207], v6, s[8:11], s28 offen offset:256 sc1
    v_cvt_pk_bf16_f32 v208, v10, v14
    v_cvt_pk_bf16_f32 v209, v18, v22
    v_cvt_pk_bf16_f32 v210, v26, v30
    v_cvt_pk_bf16_f32 v211, v34, v38
    buffer_store_dwordx4 v[208:211], v6, s[8:11], s28 offen offset:512 sc1
    v_cvt_pk_bf16_f32 v212, v11, v15
    v_cvt_pk_bf16_f32 v213, v19, v23
    v_cvt_pk_bf16_f32 v214, v27, v31
    v_cvt_pk_bf16_f32 v215, v35, v39
    buffer_store_dwordx4 v[212:215], v6, s[8:11], s28 offen offset:768 sc1
    s_add_u32 s29, s28, 4096
    v_cvt_pk_bf16_f32 v216, v40, v44
    v_cvt_pk_bf16_f32 v217, v48, v52
    v_cvt_pk_bf16_f32 v218, v56, v60
    v_cvt_pk_bf16_f32 v219, v64, v68
    buffer_store_dwordx4 v[216:219], v6, s[8:11], s29 offen offset:0 sc1
    v_cvt_pk_bf16_f32 v220, v41, v45
    v_cvt_pk_bf16_f32 v221, v49, v53
    v_cvt_pk_bf16_f32 v222, v57, v61
    v_cvt_pk_bf16_f32 v223, v65, v69
    buffer_store_dwordx4 v[220:223], v6, s[8:11], s29 offen offset:256 sc1
    v_cvt_pk_bf16_f32 v224, v42, v46
    v_cvt_pk_bf16_f32 v225, v50, v54
    v_cvt_pk_bf16_f32 v226, v58, v62
    v_cvt_pk_bf16_f32 v227, v66, v70
    buffer_store_dwordx4 v[224:227], v6, s[8:11], s29 offen offset:512 sc1
    v_cvt_pk_bf16_f32 v228, v43, v47
    v_cvt_pk_bf16_f32 v229, v51, v55
    v_cvt_pk_bf16_f32 v230, v59, v63
    v_cvt_pk_bf16_f32 v231, v67, v71
    buffer_store_dwordx4 v[228:231], v6, s[8:11], s29 offen offset:768 sc1
    s_add_u32 s28, s28, s30
    v_cvt_pk_bf16_f32 v200, v72, v76
    v_cvt_pk_bf16_f32 v201, v80, v84
    v_cvt_pk_bf16_f32 v202, v88, v92
    v_cvt_pk_bf16_f32 v203, v96, v100
    buffer_store_dwordx4 v[200:203], v6, s[8:11], s28 offen offset:0 sc1
    v_cvt_pk_bf16_f32 v204, v73, v77
    v_cvt_pk_bf16_f32 v205, v81, v85
    v_cvt_pk_bf16_f32 v206, v89, v93
    v_cvt_pk_bf16_f32 v207, v97, v101
    buffer_store_dwordx4 v[204:207], v6, s[8:11], s28 offen offset:256 sc1
    v_cvt_pk_bf16_f32 v208, v74, v78
    v_cvt_pk_bf16_f32 v209, v82, v86
    v_cvt_pk_bf16_f32 v210, v90, v94
    v_cvt_pk_bf16_f32 v211, v98, v102
    buffer_store_dwordx4 v[208:211], v6, s[8:11], s28 offen offset:512 sc1
    v_cvt_pk_bf16_f32 v212, v75, v79
    v_cvt_pk_bf16_f32 v213, v83, v87
    v_cvt_pk_bf16_f32 v214, v91, v95
    v_cvt_pk_bf16_f32 v215, v99, v103
    buffer_store_dwordx4 v[212:215], v6, s[8:11], s28 offen offset:768 sc1
    s_add_u32 s29, s28, 4096
    v_cvt_pk_bf16_f32 v216, v104, v108
    v_cvt_pk_bf16_f32 v217, v112, v116
    v_cvt_pk_bf16_f32 v218, v120, v124
    v_cvt_pk_bf16_f32 v219, v128, v132
    buffer_store_dwordx4 v[216:219], v6, s[8:11], s29 offen offset:0 sc1
    v_cvt_pk_bf16_f32 v220, v105, v109
    v_cvt_pk_bf16_f32 v221, v113, v117
    v_cvt_pk_bf16_f32 v222, v121, v125
    v_cvt_pk_bf16_f32 v223, v129, v133
    buffer_store_dwordx4 v[220:223], v6, s[8:11], s29 offen offset:256 sc1
    v_cvt_pk_bf16_f32 v224, v106, v110
    v_cvt_pk_bf16_f32 v225, v114, v118
    v_cvt_pk_bf16_f32 v226, v122, v126
    v_cvt_pk_bf16_f32 v227, v130, v134
    buffer_store_dwordx4 v[224:227], v6, s[8:11], s29 offen offset:512 sc1
    v_cvt_pk_bf16_f32 v228, v107, v111
    v_cvt_pk_bf16_f32 v229, v115, v119
    v_cvt_pk_bf16_f32 v230, v123, v127
    v_cvt_pk_bf16_f32 v231, v131, v135
    buffer_store_dwordx4 v[228:231], v6, s[8:11], s29 offen offset:768 sc1
    s_nop 1
    s_branch Ltd_112
Lv_111:
    s_waitcnt vmcnt(32)
    s_barrier
    ds_read_b128 v[136:139], v232 offset:0
    ds_read_b128 v[140:143], v232 offset:256
    ds_read_b128 v[144:147], v232 offset:512
    ds_read_b128 v[148:151], v232 offset:768
    ds_read_b128 v[152:155], v232 offset:1024
    ds_read_b128 v[156:159], v232 offset:1280
    ds_read_b128 v[160:163], v232 offset:1536
    ds_read_b128 v[164:167], v232 offset:1792
    s_waitcnt lgkmcnt(0)
    v_perm_b32 v200, v140, v136, s68
    v_perm_b32 v201, v148, v144, s68
    v_perm_b32 v202, v156, v152, s68
    v_perm_b32 v203, v164, v160, s68
    s_nop 1
    v_mfma_f32_16x16x32_bf16 v[8:11], a[0:3], v[200:203], 0
    v_perm_b32 v204, v140, v136, s69
    v_perm_b32 v205, v148, v144, s69
    v_mfma_f32_16x16x32_bf16 v[40:43], a[64:67], v[200:203], 0
    v_perm_b32 v206, v156, v152, s69
    v_perm_b32 v207, v164, v160, s69
    v_mfma_f32_16x16x32_bf16 v[72:75], a[128:131], v[200:203], 0
    ds_read_b128 v[168:171], v232 offset:8192
    ds_read_b128 v[172:175], v232 offset:8448
    v_mfma_f32_16x16x32_bf16 v[104:107], a[192:195], v[200:203], 0
    ds_read_b128 v[176:179], v232 offset:8704
    ds_read_b128 v[180:183], v232 offset:8960
    v_mfma_f32_16x16x32_bf16 v[12:15], a[0:3], v[204:207], 0
    v_perm_b32 v208, v141, v137, s68
    v_perm_b32 v209, v149, v145, s68
    v_mfma_f32_16x16x32_bf16 v[44:47], a[64:67], v[204:207], 0
    v_perm_b32 v210, v157, v153, s68
    v_perm_b32 v211, v165, v161, s68
    v_mfma_f32_16x16x32_bf16 v[76:79], a[128:131], v[204:207], 0
    ds_read_b128 v[184:187], v232 offset:9216
    ds_read_b128 v[188:191], v232 offset:9472
    v_mfma_f32_16x16x32_bf16 v[108:111], a[192:195], v[204:207], 0
    ds_read_b128 v[192:195], v232 offset:9728
    ds_read_b128 v[196:199], v232 offset:9984
    v_mfma_f32_16x16x32_bf16 v[16:19], a[0:3], v[208:211], 0
    v_perm_b32 v212, v141, v137, s69
    v_perm_b32 v213, v149, v145, s69
    v_mfma_f32_16x16x32_bf16 v[48:51], a[64:67], v[208:211], 0
    v_perm_b32 v214, v157, v153, s69
    v_perm_b32 v215, v165, v161, s69
    v_mfma_f32_16x16x32_bf16 v[80:83], a[128:131], v[208:211], 0
    s_add_u32 m0, s39, 98304
    s_add_u32 s38, s36, 3145728
    v_mfma_f32_16x16x32_bf16 v[112:115], a[192:195], v[208:211], 0
    buffer_load_dwordx4 v7, s[12:15], s38 offen lds
    s_add_u32 m0, s39, 99328
    v_mfma_f32_16x16x32_bf16 v[20:23], a[0:3], v[212:215], 0
    v_perm_b32 v216, v142, v138, s68
    v_perm_b32 v217, v150, v146, s68
    v_mfma_f32_16x16x32_bf16 v[52:55], a[64:67], v[212:215], 0
    v_perm_b32 v218, v158, v154, s68
    v_perm_b32 v219, v166, v162, s68
    v_mfma_f32_16x16x32_bf16 v[84:87], a[128:131], v[212:215], 0
    s_add_u32 s38, s36, 3178496
    buffer_load_dwordx4 v7, s[12:15], s38 offen lds
    v_mfma_f32_16x16x32_bf16 v[116:119], a[192:195], v[212:215], 0
    s_add_u32 m0, s39, 100352
    s_add_u32 s38, s36, 3211264
    v_mfma_f32_16x16x32_bf16 v[24:27], a[0:3], v[216:219], 0
    v_perm_b32 v220, v142, v138, s69
    v_perm_b32 v221, v150, v146, s69
    v_mfma_f32_16x16x32_bf16 v[56:59], a[64:67], v[216:219], 0
    v_perm_b32 v222, v158, v154, s69
    v_perm_b32 v223, v166, v162, s69
    v_mfma_f32_16x16x32_bf16 v[88:91], a[128:131], v[216:219], 0
    buffer_load_dwordx4 v7, s[12:15], s38 offen lds
    s_add_u32 m0, s39, 101376
    v_mfma_f32_16x16x32_bf16 v[120:123], a[192:195], v[216:219], 0
    s_add_u32 s38, s36, 3244032
    buffer_load_dwordx4 v7, s[12:15], s38 offen lds
    v_mfma_f32_16x16x32_bf16 v[28:31], a[0:3], v[220:223], 0
    v_perm_b32 v224, v143, v139, s68
    v_perm_b32 v225, v151, v147, s68
    v_mfma_f32_16x16x32_bf16 v[60:63], a[64:67], v[220:223], 0
    v_perm_b32 v226, v159, v155, s68
    v_perm_b32 v227, v167, v163, s68
    v_mfma_f32_16x16x32_bf16 v[92:95], a[128:131], v[220:223], 0
    s_add_u32 m0, s39, 102400
    s_add_u32 s38, s36, 3276800
    v_mfma_f32_16x16x32_bf16 v[124:127], a[192:195], v[220:223], 0
    buffer_load_dwordx4 v7, s[12:15], s38 offen lds
    s_add_u32 m0, s39, 103424
    v_mfma_f32_16x16x32_bf16 v[32:35], a[0:3], v[224:227], 0
    v_perm_b32 v228, v143, v139, s69
    v_perm_b32 v229, v151, v147, s69
    v_mfma_f32_16x16x32_bf16 v[64:67], a[64:67], v[224:227], 0
    v_perm_b32 v230, v159, v155, s69
    v_perm_b32 v231, v167, v163, s69
    v_mfma_f32_16x16x32_bf16 v[96:99], a[128:131], v[224:227], 0
    s_add_u32 s38, s36, 3309568
    buffer_load_dwordx4 v7, s[12:15], s38 offen lds
    v_mfma_f32_16x16x32_bf16 v[128:131], a[192:195], v[224:227], 0
    s_add_u32 m0, s39, 104448
    s_add_u32 s38, s36, 3342336
    v_mfma_f32_16x16x32_bf16 v[36:39], a[0:3], v[228:231], 0
    buffer_load_dwordx4 v7, s[12:15], s38 offen lds
    s_add_u32 m0, s39, 105472
    v_mfma_f32_16x16x32_bf16 v[68:71], a[64:67], v[228:231], 0
    s_add_u32 s38, s36, 3375104
    buffer_load_dwordx4 v7, s[12:15], s38 offen lds
    v_mfma_f32_16x16x32_bf16 v[100:103], a[128:131], v[228:231], 0
    v_mfma_f32_16x16x32_bf16 v[132:135], a[192:195], v[228:231], 0
    s_waitcnt lgkmcnt(0)
    v_perm_b32 v200, v172, v168, s68
    v_perm_b32 v201, v180, v176, s68
    v_perm_b32 v202, v188, v184, s68
    v_perm_b32 v203, v196, v192, s68
    s_nop 1
    v_mfma_f32_16x16x32_bf16 v[8:11], a[4:7], v[200:203], v[8:11]
    v_perm_b32 v204, v172, v168, s69
    v_perm_b32 v205, v180, v176, s69
    v_mfma_f32_16x16x32_bf16 v[40:43], a[68:71], v[200:203], v[40:43]
    v_perm_b32 v206, v188, v184, s69
    v_perm_b32 v207, v196, v192, s69
    v_mfma_f32_16x16x32_bf16 v[72:75], a[132:135], v[200:203], v[72:75]
    ds_read_b128 v[136:139], v232 offset:16384
    ds_read_b128 v[140:143], v232 offset:16640
    v_mfma_f32_16x16x32_bf16 v[104:107], a[196:199], v[200:203], v[104:107]
    ds_read_b128 v[144:147], v232 offset:16896
    ds_read_b128 v[148:151], v232 offset:17152
    v_mfma_f32_16x16x32_bf16 v[12:15], a[4:7], v[204:207], v[12:15]
    v_perm_b32 v208, v173, v169, s68
    v_perm_b32 v209, v181, v177, s68
    v_mfma_f32_16x16x32_bf16 v[44:47], a[68:71], v[204:207], v[44:47]
    v_perm_b32 v210, v189, v185, s68
    v_perm_b32 v211, v197, v193, s68
    v_mfma_f32_16x16x32_bf16 v[76:79], a[132:135], v[204:207], v[76:79]
    ds_read_b128 v[152:155], v232 offset:17408
    ds_read_b128 v[156:159], v232 offset:17664
    v_mfma_f32_16x16x32_bf16 v[108:111], a[196:199], v[204:207], v[108:111]
    ds_read_b128 v[160:163], v232 offset:17920
    ds_read_b128 v[164:167], v232 offset:18176
    v_mfma_f32_16x16x32_bf16 v[16:19], a[4:7], v[208:211], v[16:19]
    v_perm_b32 v212, v173, v169, s69
    v_perm_b32 v213, v181, v177, s69
    v_mfma_f32_16x16x32_bf16 v[48:51], a[68:71], v[208:211], v[48:51]
    v_perm_b32 v214, v189, v185, s69
    v_perm_b32 v215, v197, v193, s69
    v_mfma_f32_16x16x32_bf16 v[80:83], a[132:135], v[208:211], v[80:83]
    v_mfma_f32_16x16x32_bf16 v[112:115], a[196:199], v[208:211], v[112:115]
    v_mfma_f32_16x16x32_bf16 v[20:23], a[4:7], v[212:215], v[20:23]
    v_perm_b32 v216, v174, v170, s68
    v_perm_b32 v217, v182, v178, s68
    v_mfma_f32_16x16x32_bf16 v[52:55], a[68:71], v[212:215], v[52:55]
    v_perm_b32 v218, v190, v186, s68
    v_perm_b32 v219, v198, v194, s68
    v_mfma_f32_16x16x32_bf16 v[84:87], a[132:135], v[212:215], v[84:87]
    v_mfma_f32_16x16x32_bf16 v[116:119], a[196:199], v[212:215], v[116:119]
    v_mfma_f32_16x16x32_bf16 v[24:27], a[4:7], v[216:219], v[24:27]
    v_perm_b32 v220, v174, v170, s69
    v_perm_b32 v221, v182, v178, s69
    v_mfma_f32_16x16x32_bf16 v[56:59], a[68:71], v[216:219], v[56:59]
    v_perm_b32 v222, v190, v186, s69
    v_perm_b32 v223, v198, v194, s69
    v_mfma_f32_16x16x32_bf16 v[88:91], a[132:135], v[216:219], v[88:91]
    v_mfma_f32_16x16x32_bf16 v[120:123], a[196:199], v[216:219], v[120:123]
    v_mfma_f32_16x16x32_bf16 v[28:31], a[4:7], v[220:223], v[28:31]
    v_perm_b32 v224, v175, v171, s68
    v_perm_b32 v225, v183, v179, s68
    v_mfma_f32_16x16x32_bf16 v[60:63], a[68:71], v[220:223], v[60:63]
    v_perm_b32 v226, v191, v187, s68
    v_perm_b32 v227, v199, v195, s68
    v_mfma_f32_16x16x32_bf16 v[92:95], a[132:135], v[220:223], v[92:95]
    v_mfma_f32_16x16x32_bf16 v[124:127], a[196:199], v[220:223], v[124:127]
    v_mfma_f32_16x16x32_bf16 v[32:35], a[4:7], v[224:227], v[32:35]
    v_perm_b32 v228, v175, v171, s69
    v_perm_b32 v229, v183, v179, s69
    v_mfma_f32_16x16x32_bf16 v[64:67], a[68:71], v[224:227], v[64:67]
    v_perm_b32 v230, v191, v187, s69
    v_perm_b32 v231, v199, v195, s69
    v_mfma_f32_16x16x32_bf16 v[96:99], a[132:135], v[224:227], v[96:99]
    v_mfma_f32_16x16x32_bf16 v[128:131], a[196:199], v[224:227], v[128:131]
    v_mfma_f32_16x16x32_bf16 v[36:39], a[4:7], v[228:231], v[36:39]
    v_mfma_f32_16x16x32_bf16 v[68:71], a[68:71], v[228:231], v[68:71]
    v_mfma_f32_16x16x32_bf16 v[100:103], a[132:135], v[228:231], v[100:103]
    v_mfma_f32_16x16x32_bf16 v[132:135], a[196:199], v[228:231], v[132:135]
    s_waitcnt lgkmcnt(0)
    v_perm_b32 v200, v140, v136, s68
    v_perm_b32 v201, v148, v144, s68
    v_perm_b32 v202, v156, v152, s68
    v_perm_b32 v203, v164, v160, s68
    s_nop 1
    v_mfma_f32_16x16x32_bf16 v[8:11], a[8:11], v[200:203], v[8:11]
    v_perm_b32 v204, v140, v136, s69
    v_perm_b32 v205, v148, v144, s69
    v_mfma_f32_16x16x32_bf16 v[40:43], a[72:75], v[200:203], v[40:43]
    v_perm_b32 v206, v156, v152, s69
    v_perm_b32 v207, v164, v160, s69
    v_mfma_f32_16x16x32_bf16 v[72:75], a[136:139], v[200:203], v[72:75]
    ds_read_b128 v[168:171], v232 offset:24576
    ds_read_b128 v[172:175], v232 offset:24832
    v_mfma_f32_16x16x32_bf16 v[104:107], a[200:203], v[200:203], v[104:107]
    ds_read_b128 v[176:179], v232 offset:25088
    ds_read_b128 v[180:183], v232 offset:25344
    v_mfma_f32_16x16x32_bf16 v[12:15], a[8:11], v[204:207], v[12:15]
    v_perm_b32 v208, v141, v137, s68
    v_perm_b32 v209, v149, v145, s68
    v_mfma_f32_16x16x32_bf16 v[44:47], a[72:75], v[204:207], v[44:47]
    v_perm_b32 v210, v157, v153, s68
    v_perm_b32 v211, v165, v161, s68
    v_mfma_f32_16x16x32_bf16 v[76:79], a[136:139], v[204:207], v[76:79]
    ds_read_b128 v[184:187], v232 offset:25600
    ds_read_b128 v[188:191], v232 offset:25856
    v_mfma_f32_16x16x32_bf16 v[108:111], a[200:203], v[204:207], v[108:111]
    ds_read_b128 v[192:195], v232 offset:26112
    ds_read_b128 v[196:199], v232 offset:26368
    v_mfma_f32_16x16x32_bf16 v[16:19], a[8:11], v[208:211], v[16:19]
    v_perm_b32 v212, v141, v137, s69
    v_perm_b32 v213, v149, v145, s69
    v_mfma_f32_16x16x32_bf16 v[48:51], a[72:75], v[208:211], v[48:51]
    v_perm_b32 v214, v157, v153, s69
    v_perm_b32 v215, v165, v161, s69
    v_mfma_f32_16x16x32_bf16 v[80:83], a[136:139], v[208:211], v[80:83]
    v_mfma_f32_16x16x32_bf16 v[112:115], a[200:203], v[208:211], v[112:115]
    v_mfma_f32_16x16x32_bf16 v[20:23], a[8:11], v[212:215], v[20:23]
    v_perm_b32 v216, v142, v138, s68
    v_perm_b32 v217, v150, v146, s68
    v_mfma_f32_16x16x32_bf16 v[52:55], a[72:75], v[212:215], v[52:55]
    v_perm_b32 v218, v158, v154, s68
    v_perm_b32 v219, v166, v162, s68
    v_mfma_f32_16x16x32_bf16 v[84:87], a[136:139], v[212:215], v[84:87]
    v_mfma_f32_16x16x32_bf16 v[116:119], a[200:203], v[212:215], v[116:119]
    v_mfma_f32_16x16x32_bf16 v[24:27], a[8:11], v[216:219], v[24:27]
    v_perm_b32 v220, v142, v138, s69
    v_perm_b32 v221, v150, v146, s69
    v_mfma_f32_16x16x32_bf16 v[56:59], a[72:75], v[216:219], v[56:59]
    v_perm_b32 v222, v158, v154, s69
    v_perm_b32 v223, v166, v162, s69
    v_mfma_f32_16x16x32_bf16 v[88:91], a[136:139], v[216:219], v[88:91]
    v_mfma_f32_16x16x32_bf16 v[120:123], a[200:203], v[216:219], v[120:123]
    v_mfma_f32_16x16x32_bf16 v[28:31], a[8:11], v[220:223], v[28:31]
    v_perm_b32 v224, v143, v139, s68
    v_perm_b32 v225, v151, v147, s68
    v_mfma_f32_16x16x32_bf16 v[60:63], a[72:75], v[220:223], v[60:63]
    v_perm_b32 v226, v159, v155, s68
    v_perm_b32 v227, v167, v163, s68
    v_mfma_f32_16x16x32_bf16 v[92:95], a[136:139], v[220:223], v[92:95]
    v_mfma_f32_16x16x32_bf16 v[124:127], a[200:203], v[220:223], v[124:127]
    v_mfma_f32_16x16x32_bf16 v[32:35], a[8:11], v[224:227], v[32:35]
    v_perm_b32 v228, v143, v139, s69
    v_perm_b32 v229, v151, v147, s69
    v_mfma_f32_16x16x32_bf16 v[64:67], a[72:75], v[224:227], v[64:67]
    v_perm_b32 v230, v159, v155, s69
    v_perm_b32 v231, v167, v163, s69
    v_mfma_f32_16x16x32_bf16 v[96:99], a[136:139], v[224:227], v[96:99]
    v_mfma_f32_16x16x32_bf16 v[128:131], a[200:203], v[224:227], v[128:131]
    v_mfma_f32_16x16x32_bf16 v[36:39], a[8:11], v[228:231], v[36:39]
    v_mfma_f32_16x16x32_bf16 v[68:71], a[72:75], v[228:231], v[68:71]
    v_mfma_f32_16x16x32_bf16 v[100:103], a[136:139], v[228:231], v[100:103]
    v_mfma_f32_16x16x32_bf16 v[132:135], a[200:203], v[228:231], v[132:135]
    s_waitcnt lgkmcnt(0)
    v_perm_b32 v200, v172, v168, s68
    v_perm_b32 v201, v180, v176, s68
    v_perm_b32 v202, v188, v184, s68
    v_perm_b32 v203, v196, v192, s68
    s_nop 1
    v_mfma_f32_16x16x32_bf16 v[8:11], a[12:15], v[200:203], v[8:11]
    v_perm_b32 v204, v172, v168, s69
    v_perm_b32 v205, v180, v176, s69
    v_mfma_f32_16x16x32_bf16 v[40:43], a[76:79], v[200:203], v[40:43]
    v_perm_b32 v206, v188, v184, s69
    v_perm_b32 v207, v196, v192, s69
    v_mfma_f32_16x16x32_bf16 v[72:75], a[140:143], v[200:203], v[72:75]
    v_mfma_f32_16x16x32_bf16 v[104:107], a[204:207], v[200:203], v[104:107]
    v_mfma_f32_16x16x32_bf16 v[12:15], a[12:15], v[204:207], v[12:15]
    v_perm_b32 v208, v173, v169, s68
    v_perm_b32 v209, v181, v177, s68
    v_mfma_f32_16x16x32_bf16 v[44:47], a[76:79], v[204:207], v[44:47]
    v_perm_b32 v210, v189, v185, s68
    v_perm_b32 v211, v197, v193, s68
    v_mfma_f32_16x16x32_bf16 v[76:79], a[140:143], v[204:207], v[76:79]
    v_mfma_f32_16x16x32_bf16 v[108:111], a[204:207], v[204:207], v[108:111]
    v_mfma_f32_16x16x32_bf16 v[16:19], a[12:15], v[208:211], v[16:19]
    v_perm_b32 v212, v173, v169, s69
    v_perm_b32 v213, v181, v177, s69
    v_mfma_f32_16x16x32_bf16 v[48:51], a[76:79], v[208:211], v[48:51]
    v_perm_b32 v214, v189, v185, s69
    v_perm_b32 v215, v197, v193, s69
    v_mfma_f32_16x16x32_bf16 v[80:83], a[140:143], v[208:211], v[80:83]
    v_mfma_f32_16x16x32_bf16 v[112:115], a[204:207], v[208:211], v[112:115]
    v_mfma_f32_16x16x32_bf16 v[20:23], a[12:15], v[212:215], v[20:23]
    v_perm_b32 v216, v174, v170, s68
    v_perm_b32 v217, v182, v178, s68
    v_mfma_f32_16x16x32_bf16 v[52:55], a[76:79], v[212:215], v[52:55]
    v_perm_b32 v218, v190, v186, s68
    v_perm_b32 v219, v198, v194, s68
    v_mfma_f32_16x16x32_bf16 v[84:87], a[140:143], v[212:215], v[84:87]
    v_mfma_f32_16x16x32_bf16 v[116:119], a[204:207], v[212:215], v[116:119]
    v_mfma_f32_16x16x32_bf16 v[24:27], a[12:15], v[216:219], v[24:27]
    v_perm_b32 v220, v174, v170, s69
    v_perm_b32 v221, v182, v178, s69
    v_mfma_f32_16x16x32_bf16 v[56:59], a[76:79], v[216:219], v[56:59]
    v_perm_b32 v222, v190, v186, s69
    v_perm_b32 v223, v198, v194, s69
    v_mfma_f32_16x16x32_bf16 v[88:91], a[140:143], v[216:219], v[88:91]
    v_mfma_f32_16x16x32_bf16 v[120:123], a[204:207], v[216:219], v[120:123]
    v_mfma_f32_16x16x32_bf16 v[28:31], a[12:15], v[220:223], v[28:31]
    v_perm_b32 v224, v175, v171, s68
    v_perm_b32 v225, v183, v179, s68
    v_mfma_f32_16x16x32_bf16 v[60:63], a[76:79], v[220:223], v[60:63]
    v_perm_b32 v226, v191, v187, s68
    v_perm_b32 v227, v199, v195, s68
    v_mfma_f32_16x16x32_bf16 v[92:95], a[140:143], v[220:223], v[92:95]
    v_mfma_f32_16x16x32_bf16 v[124:127], a[204:207], v[220:223], v[124:127]
    v_mfma_f32_16x16x32_bf16 v[32:35], a[12:15], v[224:227], v[32:35]
    v_perm_b32 v228, v175, v171, s69
    v_perm_b32 v229, v183, v179, s69
    v_mfma_f32_16x16x32_bf16 v[64:67], a[76:79], v[224:227], v[64:67]
    v_perm_b32 v230, v191, v187, s69
    v_perm_b32 v231, v199, v195, s69
    v_mfma_f32_16x16x32_bf16 v[96:99], a[140:143], v[224:227], v[96:99]
    v_mfma_f32_16x16x32_bf16 v[128:131], a[204:207], v[224:227], v[128:131]
    v_mfma_f32_16x16x32_bf16 v[36:39], a[12:15], v[228:231], v[36:39]
    v_mfma_f32_16x16x32_bf16 v[68:71], a[76:79], v[228:231], v[68:71]
    v_mfma_f32_16x16x32_bf16 v[100:103], a[140:143], v[228:231], v[100:103]
    v_mfma_f32_16x16x32_bf16 v[132:135], a[204:207], v[228:231], v[132:135]
    s_waitcnt vmcnt(16)
    s_barrier
    ds_read_b128 v[136:139], v232 offset:32768
    ds_read_b128 v[140:143], v232 offset:33024
    ds_read_b128 v[144:147], v232 offset:33280
    ds_read_b128 v[148:151], v232 offset:33536
    ds_read_b128 v[152:155], v232 offset:33792
    ds_read_b128 v[156:159], v232 offset:34048
    ds_read_b128 v[160:163], v232 offset:34304
    ds_read_b128 v[164:167], v232 offset:34560
    s_waitcnt lgkmcnt(0)
    v_perm_b32 v200, v140, v136, s68
    v_perm_b32 v201, v148, v144, s68
    v_perm_b32 v202, v156, v152, s68
    v_perm_b32 v203, v164, v160, s68
    s_nop 1
    v_mfma_f32_16x16x32_bf16 v[8:11], a[16:19], v[200:203], v[8:11]
    v_perm_b32 v204, v140, v136, s69
    v_perm_b32 v205, v148, v144, s69
    v_mfma_f32_16x16x32_bf16 v[40:43], a[80:83], v[200:203], v[40:43]
    v_perm_b32 v206, v156, v152, s69
    v_perm_b32 v207, v164, v160, s69
    v_mfma_f32_16x16x32_bf16 v[72:75], a[144:147], v[200:203], v[72:75]
    ds_read_b128 v[168:171], v232 offset:40960
    ds_read_b128 v[172:175], v232 offset:41216
    v_mfma_f32_16x16x32_bf16 v[104:107], a[208:211], v[200:203], v[104:107]
    ds_read_b128 v[176:179], v232 offset:41472
    ds_read_b128 v[180:183], v232 offset:41728
    v_mfma_f32_16x16x32_bf16 v[12:15], a[16:19], v[204:207], v[12:15]
    v_perm_b32 v208, v141, v137, s68
    v_perm_b32 v209, v149, v145, s68
    v_mfma_f32_16x16x32_bf16 v[44:47], a[80:83], v[204:207], v[44:47]
    v_perm_b32 v210, v157, v153, s68
    v_perm_b32 v211, v165, v161, s68
    v_mfma_f32_16x16x32_bf16 v[76:79], a[144:147], v[204:207], v[76:79]
    ds_read_b128 v[184:187], v232 offset:41984
    ds_read_b128 v[188:191], v232 offset:42240
    v_mfma_f32_16x16x32_bf16 v[108:111], a[208:211], v[204:207], v[108:111]
    ds_read_b128 v[192:195], v232 offset:42496
    ds_read_b128 v[196:199], v232 offset:42752
    v_mfma_f32_16x16x32_bf16 v[16:19], a[16:19], v[208:211], v[16:19]
    v_perm_b32 v212, v141, v137, s69
    v_perm_b32 v213, v149, v145, s69
    v_mfma_f32_16x16x32_bf16 v[48:51], a[80:83], v[208:211], v[48:51]
    v_perm_b32 v214, v157, v153, s69
    v_perm_b32 v215, v165, v161, s69
    v_mfma_f32_16x16x32_bf16 v[80:83], a[144:147], v[208:211], v[80:83]
    s_add_u32 m0, s39, 0
    s_add_u32 s38, s37, 0
    v_mfma_f32_16x16x32_bf16 v[112:115], a[208:211], v[208:211], v[112:115]
    buffer_load_dwordx4 v7, s[32:35], s38 offen lds
    s_add_u32 m0, s39, 1024
    v_mfma_f32_16x16x32_bf16 v[20:23], a[16:19], v[212:215], v[20:23]
    v_perm_b32 v216, v142, v138, s68
    v_perm_b32 v217, v150, v146, s68
    v_mfma_f32_16x16x32_bf16 v[52:55], a[80:83], v[212:215], v[52:55]
    v_perm_b32 v218, v158, v154, s68
    v_perm_b32 v219, v166, v162, s68
    v_mfma_f32_16x16x32_bf16 v[84:87], a[144:147], v[212:215], v[84:87]
    s_add_u32 s38, s37, 32768
    buffer_load_dwordx4 v7, s[32:35], s38 offen lds
    v_mfma_f32_16x16x32_bf16 v[116:119], a[208:211], v[212:215], v[116:119]
    s_add_u32 m0, s39, 2048
    s_add_u32 s38, s37, 65536
    v_mfma_f32_16x16x32_bf16 v[24:27], a[16:19], v[216:219], v[24:27]
    v_perm_b32 v220, v142, v138, s69
    v_perm_b32 v221, v150, v146, s69
    v_mfma_f32_16x16x32_bf16 v[56:59], a[80:83], v[216:219], v[56:59]
    v_perm_b32 v222, v158, v154, s69
    v_perm_b32 v223, v166, v162, s69
    v_mfma_f32_16x16x32_bf16 v[88:91], a[144:147], v[216:219], v[88:91]
    buffer_load_dwordx4 v7, s[32:35], s38 offen lds
    s_add_u32 m0, s39, 3072
    v_mfma_f32_16x16x32_bf16 v[120:123], a[208:211], v[216:219], v[120:123]
    s_add_u32 s38, s37, 98304
    buffer_load_dwordx4 v7, s[32:35], s38 offen lds
    v_mfma_f32_16x16x32_bf16 v[28:31], a[16:19], v[220:223], v[28:31]
    v_perm_b32 v224, v143, v139, s68
    v_perm_b32 v225, v151, v147, s68
    v_mfma_f32_16x16x32_bf16 v[60:63], a[80:83], v[220:223], v[60:63]
    v_perm_b32 v226, v159, v155, s68
    v_perm_b32 v227, v167, v163, s68
    v_mfma_f32_16x16x32_bf16 v[92:95], a[144:147], v[220:223], v[92:95]
    s_add_u32 m0, s39, 4096
    s_add_u32 s38, s37, 131072
    v_mfma_f32_16x16x32_bf16 v[124:127], a[208:211], v[220:223], v[124:127]
    buffer_load_dwordx4 v7, s[32:35], s38 offen lds
    s_add_u32 m0, s39, 5120
    v_mfma_f32_16x16x32_bf16 v[32:35], a[16:19], v[224:227], v[32:35]
    v_perm_b32 v228, v143, v139, s69
    v_perm_b32 v229, v151, v147, s69
    v_mfma_f32_16x16x32_bf16 v[64:67], a[80:83], v[224:227], v[64:67]
    v_perm_b32 v230, v159, v155, s69
    v_perm_b32 v231, v167, v163, s69
    v_mfma_f32_16x16x32_bf16 v[96:99], a[144:147], v[224:227], v[96:99]
    s_add_u32 s38, s37, 163840
    buffer_load_dwordx4 v7, s[32:35], s38 offen lds
    v_mfma_f32_16x16x32_bf16 v[128:131], a[208:211], v[224:227], v[128:131]
    s_add_u32 m0, s39, 6144
    s_add_u32 s38, s37, 196608
    v_mfma_f32_16x16x32_bf16 v[36:39], a[16:19], v[228:231], v[36:39]
    buffer_load_dwordx4 v7, s[32:35], s38 offen lds
    s_add_u32 m0, s39, 7168
    v_mfma_f32_16x16x32_bf16 v[68:71], a[80:83], v[228:231], v[68:71]
    s_add_u32 s38, s37, 229376
    buffer_load_dwordx4 v7, s[32:35], s38 offen lds
    v_mfma_f32_16x16x32_bf16 v[100:103], a[144:147], v[228:231], v[100:103]
    v_mfma_f32_16x16x32_bf16 v[132:135], a[208:211], v[228:231], v[132:135]
    s_waitcnt lgkmcnt(0)
    v_perm_b32 v200, v172, v168, s68
    v_perm_b32 v201, v180, v176, s68
    v_perm_b32 v202, v188, v184, s68
    v_perm_b32 v203, v196, v192, s68
    s_nop 1
    v_mfma_f32_16x16x32_bf16 v[8:11], a[20:23], v[200:203], v[8:11]
    v_perm_b32 v204, v172, v168, s69
    v_perm_b32 v205, v180, v176, s69
    v_mfma_f32_16x16x32_bf16 v[40:43], a[84:87], v[200:203], v[40:43]
    v_perm_b32 v206, v188, v184, s69
    v_perm_b32 v207, v196, v192, s69
    v_mfma_f32_16x16x32_bf16 v[72:75], a[148:151], v[200:203], v[72:75]
    ds_read_b128 v[136:139], v232 offset:49152
    ds_read_b128 v[140:143], v232 offset:49408
    v_mfma_f32_16x16x32_bf16 v[104:107], a[212:215], v[200:203], v[104:107]
    ds_read_b128 v[144:147], v232 offset:49664
    ds_read_b128 v[148:151], v232 offset:49920
    v_mfma_f32_16x16x32_bf16 v[12:15], a[20:23], v[204:207], v[12:15]
    v_perm_b32 v208, v173, v169, s68
    v_perm_b32 v209, v181, v177, s68
    v_mfma_f32_16x16x32_bf16 v[44:47], a[84:87], v[204:207], v[44:47]
    v_perm_b32 v210, v189, v185, s68
    v_perm_b32 v211, v197, v193, s68
    v_mfma_f32_16x16x32_bf16 v[76:79], a[148:151], v[204:207], v[76:79]
    ds_read_b128 v[152:155], v232 offset:50176
    ds_read_b128 v[156:159], v232 offset:50432
    v_mfma_f32_16x16x32_bf16 v[108:111], a[212:215], v[204:207], v[108:111]
    ds_read_b128 v[160:163], v232 offset:50688
    ds_read_b128 v[164:167], v232 offset:50944
    v_mfma_f32_16x16x32_bf16 v[16:19], a[20:23], v[208:211], v[16:19]
    v_perm_b32 v212, v173, v169, s69
    v_perm_b32 v213, v181, v177, s69
    v_mfma_f32_16x16x32_bf16 v[48:51], a[84:87], v[208:211], v[48:51]
    v_perm_b32 v214, v189, v185, s69
    v_perm_b32 v215, v197, v193, s69
    v_mfma_f32_16x16x32_bf16 v[80:83], a[148:151], v[208:211], v[80:83]
    v_mfma_f32_16x16x32_bf16 v[112:115], a[212:215], v[208:211], v[112:115]
    v_mfma_f32_16x16x32_bf16 v[20:23], a[20:23], v[212:215], v[20:23]
    v_perm_b32 v216, v174, v170, s68
    v_perm_b32 v217, v182, v178, s68
    v_mfma_f32_16x16x32_bf16 v[52:55], a[84:87], v[212:215], v[52:55]
    v_perm_b32 v218, v190, v186, s68
    v_perm_b32 v219, v198, v194, s68
    v_mfma_f32_16x16x32_bf16 v[84:87], a[148:151], v[212:215], v[84:87]
    v_mfma_f32_16x16x32_bf16 v[116:119], a[212:215], v[212:215], v[116:119]
    v_mfma_f32_16x16x32_bf16 v[24:27], a[20:23], v[216:219], v[24:27]
    v_perm_b32 v220, v174, v170, s69
    v_perm_b32 v221, v182, v178, s69
    v_mfma_f32_16x16x32_bf16 v[56:59], a[84:87], v[216:219], v[56:59]
    v_perm_b32 v222, v190, v186, s69
    v_perm_b32 v223, v198, v194, s69
    v_mfma_f32_16x16x32_bf16 v[88:91], a[148:151], v[216:219], v[88:91]
    v_mfma_f32_16x16x32_bf16 v[120:123], a[212:215], v[216:219], v[120:123]
    v_mfma_f32_16x16x32_bf16 v[28:31], a[20:23], v[220:223], v[28:31]
    v_perm_b32 v224, v175, v171, s68
    v_perm_b32 v225, v183, v179, s68
    v_mfma_f32_16x16x32_bf16 v[60:63], a[84:87], v[220:223], v[60:63]
    v_perm_b32 v226, v191, v187, s68
    v_perm_b32 v227, v199, v195, s68
    v_mfma_f32_16x16x32_bf16 v[92:95], a[148:151], v[220:223], v[92:95]
    v_mfma_f32_16x16x32_bf16 v[124:127], a[212:215], v[220:223], v[124:127]
    v_mfma_f32_16x16x32_bf16 v[32:35], a[20:23], v[224:227], v[32:35]
    v_perm_b32 v228, v175, v171, s69
    v_perm_b32 v229, v183, v179, s69
    v_mfma_f32_16x16x32_bf16 v[64:67], a[84:87], v[224:227], v[64:67]
    v_perm_b32 v230, v191, v187, s69
    v_perm_b32 v231, v199, v195, s69
    v_mfma_f32_16x16x32_bf16 v[96:99], a[148:151], v[224:227], v[96:99]
    v_mfma_f32_16x16x32_bf16 v[128:131], a[212:215], v[224:227], v[128:131]
    v_mfma_f32_16x16x32_bf16 v[36:39], a[20:23], v[228:231], v[36:39]
    v_mfma_f32_16x16x32_bf16 v[68:71], a[84:87], v[228:231], v[68:71]
    v_mfma_f32_16x16x32_bf16 v[100:103], a[148:151], v[228:231], v[100:103]
    v_mfma_f32_16x16x32_bf16 v[132:135], a[212:215], v[228:231], v[132:135]
    s_waitcnt lgkmcnt(0)
    v_perm_b32 v200, v140, v136, s68
    v_perm_b32 v201, v148, v144, s68
    v_perm_b32 v202, v156, v152, s68
    v_perm_b32 v203, v164, v160, s68
    s_nop 1
    v_mfma_f32_16x16x32_bf16 v[8:11], a[24:27], v[200:203], v[8:11]
    v_perm_b32 v204, v140, v136, s69
    v_perm_b32 v205, v148, v144, s69
    v_mfma_f32_16x16x32_bf16 v[40:43], a[88:91], v[200:203], v[40:43]
    v_perm_b32 v206, v156, v152, s69
    v_perm_b32 v207, v164, v160, s69
    v_mfma_f32_16x16x32_bf16 v[72:75], a[152:155], v[200:203], v[72:75]
    ds_read_b128 v[168:171], v232 offset:57344
    ds_read_b128 v[172:175], v232 offset:57600
    v_mfma_f32_16x16x32_bf16 v[104:107], a[216:219], v[200:203], v[104:107]
    ds_read_b128 v[176:179], v232 offset:57856
    ds_read_b128 v[180:183], v232 offset:58112
    v_mfma_f32_16x16x32_bf16 v[12:15], a[24:27], v[204:207], v[12:15]
    v_perm_b32 v208, v141, v137, s68
    v_perm_b32 v209, v149, v145, s68
    v_mfma_f32_16x16x32_bf16 v[44:47], a[88:91], v[204:207], v[44:47]
    v_perm_b32 v210, v157, v153, s68
    v_perm_b32 v211, v165, v161, s68
    v_mfma_f32_16x16x32_bf16 v[76:79], a[152:155], v[204:207], v[76:79]
    ds_read_b128 v[184:187], v232 offset:58368
    ds_read_b128 v[188:191], v232 offset:58624
    v_mfma_f32_16x16x32_bf16 v[108:111], a[216:219], v[204:207], v[108:111]
    ds_read_b128 v[192:195], v232 offset:58880
    ds_read_b128 v[196:199], v232 offset:59136
    v_mfma_f32_16x16x32_bf16 v[16:19], a[24:27], v[208:211], v[16:19]
    v_perm_b32 v212, v141, v137, s69
    v_perm_b32 v213, v149, v145, s69
    v_mfma_f32_16x16x32_bf16 v[48:51], a[88:91], v[208:211], v[48:51]
    v_perm_b32 v214, v157, v153, s69
    v_perm_b32 v215, v165, v161, s69
    v_mfma_f32_16x16x32_bf16 v[80:83], a[152:155], v[208:211], v[80:83]
    v_mfma_f32_16x16x32_bf16 v[112:115], a[216:219], v[208:211], v[112:115]
    v_mfma_f32_16x16x32_bf16 v[20:23], a[24:27], v[212:215], v[20:23]
    v_perm_b32 v216, v142, v138, s68
    v_perm_b32 v217, v150, v146, s68
    v_mfma_f32_16x16x32_bf16 v[52:55], a[88:91], v[212:215], v[52:55]
    v_perm_b32 v218, v158, v154, s68
    v_perm_b32 v219, v166, v162, s68
    v_mfma_f32_16x16x32_bf16 v[84:87], a[152:155], v[212:215], v[84:87]
    v_mfma_f32_16x16x32_bf16 v[116:119], a[216:219], v[212:215], v[116:119]
    v_mfma_f32_16x16x32_bf16 v[24:27], a[24:27], v[216:219], v[24:27]
    v_perm_b32 v220, v142, v138, s69
    v_perm_b32 v221, v150, v146, s69
    v_mfma_f32_16x16x32_bf16 v[56:59], a[88:91], v[216:219], v[56:59]
    v_perm_b32 v222, v158, v154, s69
    v_perm_b32 v223, v166, v162, s69
    v_mfma_f32_16x16x32_bf16 v[88:91], a[152:155], v[216:219], v[88:91]
    v_mfma_f32_16x16x32_bf16 v[120:123], a[216:219], v[216:219], v[120:123]
    v_mfma_f32_16x16x32_bf16 v[28:31], a[24:27], v[220:223], v[28:31]
    v_perm_b32 v224, v143, v139, s68
    v_perm_b32 v225, v151, v147, s68
    v_mfma_f32_16x16x32_bf16 v[60:63], a[88:91], v[220:223], v[60:63]
    v_perm_b32 v226, v159, v155, s68
    v_perm_b32 v227, v167, v163, s68
    v_mfma_f32_16x16x32_bf16 v[92:95], a[152:155], v[220:223], v[92:95]
    v_mfma_f32_16x16x32_bf16 v[124:127], a[216:219], v[220:223], v[124:127]
    v_mfma_f32_16x16x32_bf16 v[32:35], a[24:27], v[224:227], v[32:35]
    v_perm_b32 v228, v143, v139, s69
    v_perm_b32 v229, v151, v147, s69
    v_mfma_f32_16x16x32_bf16 v[64:67], a[88:91], v[224:227], v[64:67]
    v_perm_b32 v230, v159, v155, s69
    v_perm_b32 v231, v167, v163, s69
    v_mfma_f32_16x16x32_bf16 v[96:99], a[152:155], v[224:227], v[96:99]
    v_mfma_f32_16x16x32_bf16 v[128:131], a[216:219], v[224:227], v[128:131]
    v_mfma_f32_16x16x32_bf16 v[36:39], a[24:27], v[228:231], v[36:39]
    v_mfma_f32_16x16x32_bf16 v[68:71], a[88:91], v[228:231], v[68:71]
    v_mfma_f32_16x16x32_bf16 v[100:103], a[152:155], v[228:231], v[100:103]
    v_mfma_f32_16x16x32_bf16 v[132:135], a[216:219], v[228:231], v[132:135]
    s_waitcnt lgkmcnt(0)
    v_perm_b32 v200, v172, v168, s68
    v_perm_b32 v201, v180, v176, s68
    v_perm_b32 v202, v188, v184, s68
    v_perm_b32 v203, v196, v192, s68
    s_nop 1
    v_mfma_f32_16x16x32_bf16 v[8:11], a[28:31], v[200:203], v[8:11]
    v_perm_b32 v204, v172, v168, s69
    v_perm_b32 v205, v180, v176, s69
    v_mfma_f32_16x16x32_bf16 v[40:43], a[92:95], v[200:203], v[40:43]
    v_perm_b32 v206, v188, v184, s69
    v_perm_b32 v207, v196, v192, s69
    v_mfma_f32_16x16x32_bf16 v[72:75], a[156:159], v[200:203], v[72:75]
    v_mfma_f32_16x16x32_bf16 v[104:107], a[220:223], v[200:203], v[104:107]
    v_mfma_f32_16x16x32_bf16 v[12:15], a[28:31], v[204:207], v[12:15]
    v_perm_b32 v208, v173, v169, s68
    v_perm_b32 v209, v181, v177, s68
    v_mfma_f32_16x16x32_bf16 v[44:47], a[92:95], v[204:207], v[44:47]
    v_perm_b32 v210, v189, v185, s68
    v_perm_b32 v211, v197, v193, s68
    v_mfma_f32_16x16x32_bf16 v[76:79], a[156:159], v[204:207], v[76:79]
    v_mfma_f32_16x16x32_bf16 v[108:111], a[220:223], v[204:207], v[108:111]
    v_mfma_f32_16x16x32_bf16 v[16:19], a[28:31], v[208:211], v[16:19]
    v_perm_b32 v212, v173, v169, s69
    v_perm_b32 v213, v181, v177, s69
    v_mfma_f32_16x16x32_bf16 v[48:51], a[92:95], v[208:211], v[48:51]
    v_perm_b32 v214, v189, v185, s69
    v_perm_b32 v215, v197, v193, s69
    v_mfma_f32_16x16x32_bf16 v[80:83], a[156:159], v[208:211], v[80:83]
    v_mfma_f32_16x16x32_bf16 v[112:115], a[220:223], v[208:211], v[112:115]
    v_mfma_f32_16x16x32_bf16 v[20:23], a[28:31], v[212:215], v[20:23]
    v_perm_b32 v216, v174, v170, s68
    v_perm_b32 v217, v182, v178, s68
    v_mfma_f32_16x16x32_bf16 v[52:55], a[92:95], v[212:215], v[52:55]
    v_perm_b32 v218, v190, v186, s68
    v_perm_b32 v219, v198, v194, s68
    v_mfma_f32_16x16x32_bf16 v[84:87], a[156:159], v[212:215], v[84:87]
    v_mfma_f32_16x16x32_bf16 v[116:119], a[220:223], v[212:215], v[116:119]
    v_mfma_f32_16x16x32_bf16 v[24:27], a[28:31], v[216:219], v[24:27]
    v_perm_b32 v220, v174, v170, s69
    v_perm_b32 v221, v182, v178, s69
    v_mfma_f32_16x16x32_bf16 v[56:59], a[92:95], v[216:219], v[56:59]
    v_perm_b32 v222, v190, v186, s69
    v_perm_b32 v223, v198, v194, s69
    v_mfma_f32_16x16x32_bf16 v[88:91], a[156:159], v[216:219], v[88:91]
    v_mfma_f32_16x16x32_bf16 v[120:123], a[220:223], v[216:219], v[120:123]
    v_mfma_f32_16x16x32_bf16 v[28:31], a[28:31], v[220:223], v[28:31]
    v_perm_b32 v224, v175, v171, s68
    v_perm_b32 v225, v183, v179, s68
    v_mfma_f32_16x16x32_bf16 v[60:63], a[92:95], v[220:223], v[60:63]
    v_perm_b32 v226, v191, v187, s68
    v_perm_b32 v227, v199, v195, s68
    v_mfma_f32_16x16x32_bf16 v[92:95], a[156:159], v[220:223], v[92:95]
    v_mfma_f32_16x16x32_bf16 v[124:127], a[220:223], v[220:223], v[124:127]
    v_mfma_f32_16x16x32_bf16 v[32:35], a[28:31], v[224:227], v[32:35]
    v_perm_b32 v228, v175, v171, s69
    v_perm_b32 v229, v183, v179, s69
    v_mfma_f32_16x16x32_bf16 v[64:67], a[92:95], v[224:227], v[64:67]
    v_perm_b32 v230, v191, v187, s69
    v_perm_b32 v231, v199, v195, s69
    v_mfma_f32_16x16x32_bf16 v[96:99], a[156:159], v[224:227], v[96:99]
    v_mfma_f32_16x16x32_bf16 v[128:131], a[220:223], v[224:227], v[128:131]
    v_mfma_f32_16x16x32_bf16 v[36:39], a[28:31], v[228:231], v[36:39]
    v_mfma_f32_16x16x32_bf16 v[68:71], a[92:95], v[228:231], v[68:71]
    v_mfma_f32_16x16x32_bf16 v[100:103], a[156:159], v[228:231], v[100:103]
    v_mfma_f32_16x16x32_bf16 v[132:135], a[220:223], v[228:231], v[132:135]
    s_waitcnt vmcnt(16)
    s_barrier
    ds_read_b128 v[136:139], v233 offset:0
    ds_read_b128 v[140:143], v233 offset:256
    ds_read_b128 v[144:147], v233 offset:512
    ds_read_b128 v[148:151], v233 offset:768
    ds_read_b128 v[152:155], v233 offset:1024
    ds_read_b128 v[156:159], v233 offset:1280
    ds_read_b128 v[160:163], v233 offset:1536
    ds_read_b128 v[164:167], v233 offset:1792
    s_waitcnt lgkmcnt(0)
    v_perm_b32 v200, v140, v136, s68
    v_perm_b32 v201, v148, v144, s68
    v_perm_b32 v202, v156, v152, s68
    v_perm_b32 v203, v164, v160, s68
    s_nop 1
    v_mfma_f32_16x16x32_bf16 v[8:11], a[32:35], v[200:203], v[8:11]
    v_perm_b32 v204, v140, v136, s69
    v_perm_b32 v205, v148, v144, s69
    v_mfma_f32_16x16x32_bf16 v[40:43], a[96:99], v[200:203], v[40:43]
    v_perm_b32 v206, v156, v152, s69
    v_perm_b32 v207, v164, v160, s69
    v_mfma_f32_16x16x32_bf16 v[72:75], a[160:163], v[200:203], v[72:75]
    ds_read_b128 v[168:171], v233 offset:8192
    ds_read_b128 v[172:175], v233 offset:8448
    v_mfma_f32_16x16x32_bf16 v[104:107], a[224:227], v[200:203], v[104:107]
    ds_read_b128 v[176:179], v233 offset:8704
    ds_read_b128 v[180:183], v233 offset:8960
    v_mfma_f32_16x16x32_bf16 v[12:15], a[32:35], v[204:207], v[12:15]
    v_perm_b32 v208, v141, v137, s68
    v_perm_b32 v209, v149, v145, s68
    v_mfma_f32_16x16x32_bf16 v[44:47], a[96:99], v[204:207], v[44:47]
    v_perm_b32 v210, v157, v153, s68
    v_perm_b32 v211, v165, v161, s68
    v_mfma_f32_16x16x32_bf16 v[76:79], a[160:163], v[204:207], v[76:79]
    ds_read_b128 v[184:187], v233 offset:9216
    ds_read_b128 v[188:191], v233 offset:9472
    v_mfma_f32_16x16x32_bf16 v[108:111], a[224:227], v[204:207], v[108:111]
    ds_read_b128 v[192:195], v233 offset:9728
    ds_read_b128 v[196:199], v233 offset:9984
    v_mfma_f32_16x16x32_bf16 v[16:19], a[32:35], v[208:211], v[16:19]
    v_perm_b32 v212, v141, v137, s69
    v_perm_b32 v213, v149, v145, s69
    v_mfma_f32_16x16x32_bf16 v[48:51], a[96:99], v[208:211], v[48:51]
    v_perm_b32 v214, v157, v153, s69
    v_perm_b32 v215, v165, v161, s69
    v_mfma_f32_16x16x32_bf16 v[80:83], a[160:163], v[208:211], v[80:83]
    s_add_u32 m0, s39, 32768
    s_add_u32 s38, s37, 1048576
    v_mfma_f32_16x16x32_bf16 v[112:115], a[224:227], v[208:211], v[112:115]
    buffer_load_dwordx4 v7, s[32:35], s38 offen lds
    s_add_u32 m0, s39, 33792
    v_mfma_f32_16x16x32_bf16 v[20:23], a[32:35], v[212:215], v[20:23]
    v_perm_b32 v216, v142, v138, s68
    v_perm_b32 v217, v150, v146, s68
    v_mfma_f32_16x16x32_bf16 v[52:55], a[96:99], v[212:215], v[52:55]
    v_perm_b32 v218, v158, v154, s68
    v_perm_b32 v219, v166, v162, s68
    v_mfma_f32_16x16x32_bf16 v[84:87], a[160:163], v[212:215], v[84:87]
    s_add_u32 s38, s37, 1081344
    buffer_load_dwordx4 v7, s[32:35], s38 offen lds
    v_mfma_f32_16x16x32_bf16 v[116:119], a[224:227], v[212:215], v[116:119]
    s_add_u32 m0, s39, 34816
    s_add_u32 s38, s37, 1114112
    v_mfma_f32_16x16x32_bf16 v[24:27], a[32:35], v[216:219], v[24:27]
    v_perm_b32 v220, v142, v138, s69
    v_perm_b32 v221, v150, v146, s69
    v_mfma_f32_16x16x32_bf16 v[56:59], a[96:99], v[216:219], v[56:59]
    v_perm_b32 v222, v158, v154, s69
    v_perm_b32 v223, v166, v162, s69
    v_mfma_f32_16x16x32_bf16 v[88:91], a[160:163], v[216:219], v[88:91]
    buffer_load_dwordx4 v7, s[32:35], s38 offen lds
    s_add_u32 m0, s39, 35840
    v_mfma_f32_16x16x32_bf16 v[120:123], a[224:227], v[216:219], v[120:123]
    s_add_u32 s38, s37, 1146880
    buffer_load_dwordx4 v7, s[32:35], s38 offen lds
    v_mfma_f32_16x16x32_bf16 v[28:31], a[32:35], v[220:223], v[28:31]
    v_perm_b32 v224, v143, v139, s68
    v_perm_b32 v225, v151, v147, s68
    v_mfma_f32_16x16x32_bf16 v[60:63], a[96:99], v[220:223], v[60:63]
    v_perm_b32 v226, v159, v155, s68
    v_perm_b32 v227, v167, v163, s68
    v_mfma_f32_16x16x32_bf16 v[92:95], a[160:163], v[220:223], v[92:95]
    s_add_u32 m0, s39, 36864
    s_add_u32 s38, s37, 1179648
    v_mfma_f32_16x16x32_bf16 v[124:127], a[224:227], v[220:223], v[124:127]
    buffer_load_dwordx4 v7, s[32:35], s38 offen lds
    s_add_u32 m0, s39, 37888
    v_mfma_f32_16x16x32_bf16 v[32:35], a[32:35], v[224:227], v[32:35]
    v_perm_b32 v228, v143, v139, s69
    v_perm_b32 v229, v151, v147, s69
    v_mfma_f32_16x16x32_bf16 v[64:67], a[96:99], v[224:227], v[64:67]
    v_perm_b32 v230, v159, v155, s69
    v_perm_b32 v231, v167, v163, s69
    v_mfma_f32_16x16x32_bf16 v[96:99], a[160:163], v[224:227], v[96:99]
    s_add_u32 s38, s37, 1212416
    buffer_load_dwordx4 v7, s[32:35], s38 offen lds
    v_mfma_f32_16x16x32_bf16 v[128:131], a[224:227], v[224:227], v[128:131]
    s_add_u32 m0, s39, 38912
    s_add_u32 s38, s37, 1245184
    v_mfma_f32_16x16x32_bf16 v[36:39], a[32:35], v[228:231], v[36:39]
    buffer_load_dwordx4 v7, s[32:35], s38 offen lds
    s_add_u32 m0, s39, 39936
    v_mfma_f32_16x16x32_bf16 v[68:71], a[96:99], v[228:231], v[68:71]
    s_add_u32 s38, s37, 1277952
    buffer_load_dwordx4 v7, s[32:35], s38 offen lds
    v_mfma_f32_16x16x32_bf16 v[100:103], a[160:163], v[228:231], v[100:103]
    v_mfma_f32_16x16x32_bf16 v[132:135], a[224:227], v[228:231], v[132:135]
    s_waitcnt lgkmcnt(0)
    v_perm_b32 v200, v172, v168, s68
    v_perm_b32 v201, v180, v176, s68
    v_perm_b32 v202, v188, v184, s68
    v_perm_b32 v203, v196, v192, s68
    s_nop 1
    v_mfma_f32_16x16x32_bf16 v[8:11], a[36:39], v[200:203], v[8:11]
    v_perm_b32 v204, v172, v168, s69
    v_perm_b32 v205, v180, v176, s69
    v_mfma_f32_16x16x32_bf16 v[40:43], a[100:103], v[200:203], v[40:43]
    v_perm_b32 v206, v188, v184, s69
    v_perm_b32 v207, v196, v192, s69
    v_mfma_f32_16x16x32_bf16 v[72:75], a[164:167], v[200:203], v[72:75]
    ds_read_b128 v[136:139], v233 offset:16384
    ds_read_b128 v[140:143], v233 offset:16640
    v_mfma_f32_16x16x32_bf16 v[104:107], a[228:231], v[200:203], v[104:107]
    ds_read_b128 v[144:147], v233 offset:16896
    ds_read_b128 v[148:151], v233 offset:17152
    v_mfma_f32_16x16x32_bf16 v[12:15], a[36:39], v[204:207], v[12:15]
    v_perm_b32 v208, v173, v169, s68
    v_perm_b32 v209, v181, v177, s68
    v_mfma_f32_16x16x32_bf16 v[44:47], a[100:103], v[204:207], v[44:47]
    v_perm_b32 v210, v189, v185, s68
    v_perm_b32 v211, v197, v193, s68
    v_mfma_f32_16x16x32_bf16 v[76:79], a[164:167], v[204:207], v[76:79]
    ds_read_b128 v[152:155], v233 offset:17408
    ds_read_b128 v[156:159], v233 offset:17664
    v_mfma_f32_16x16x32_bf16 v[108:111], a[228:231], v[204:207], v[108:111]
    ds_read_b128 v[160:163], v233 offset:17920
    ds_read_b128 v[164:167], v233 offset:18176
    v_mfma_f32_16x16x32_bf16 v[16:19], a[36:39], v[208:211], v[16:19]
    v_perm_b32 v212, v173, v169, s69
    v_perm_b32 v213, v181, v177, s69
    v_mfma_f32_16x16x32_bf16 v[48:51], a[100:103], v[208:211], v[48:51]
    v_perm_b32 v214, v189, v185, s69
    v_perm_b32 v215, v197, v193, s69
    v_mfma_f32_16x16x32_bf16 v[80:83], a[164:167], v[208:211], v[80:83]
    v_mfma_f32_16x16x32_bf16 v[112:115], a[228:231], v[208:211], v[112:115]
    v_mfma_f32_16x16x32_bf16 v[20:23], a[36:39], v[212:215], v[20:23]
    v_perm_b32 v216, v174, v170, s68
    v_perm_b32 v217, v182, v178, s68
    v_mfma_f32_16x16x32_bf16 v[52:55], a[100:103], v[212:215], v[52:55]
    v_perm_b32 v218, v190, v186, s68
    v_perm_b32 v219, v198, v194, s68
    v_mfma_f32_16x16x32_bf16 v[84:87], a[164:167], v[212:215], v[84:87]
    v_mfma_f32_16x16x32_bf16 v[116:119], a[228:231], v[212:215], v[116:119]
    v_mfma_f32_16x16x32_bf16 v[24:27], a[36:39], v[216:219], v[24:27]
    v_perm_b32 v220, v174, v170, s69
    v_perm_b32 v221, v182, v178, s69
    v_mfma_f32_16x16x32_bf16 v[56:59], a[100:103], v[216:219], v[56:59]
    v_perm_b32 v222, v190, v186, s69
    v_perm_b32 v223, v198, v194, s69
    v_mfma_f32_16x16x32_bf16 v[88:91], a[164:167], v[216:219], v[88:91]
    v_mfma_f32_16x16x32_bf16 v[120:123], a[228:231], v[216:219], v[120:123]
    v_mfma_f32_16x16x32_bf16 v[28:31], a[36:39], v[220:223], v[28:31]
    v_perm_b32 v224, v175, v171, s68
    v_perm_b32 v225, v183, v179, s68
    v_mfma_f32_16x16x32_bf16 v[60:63], a[100:103], v[220:223], v[60:63]
    v_perm_b32 v226, v191, v187, s68
    v_perm_b32 v227, v199, v195, s68
    v_mfma_f32_16x16x32_bf16 v[92:95], a[164:167], v[220:223], v[92:95]
    v_mfma_f32_16x16x32_bf16 v[124:127], a[228:231], v[220:223], v[124:127]
    v_mfma_f32_16x16x32_bf16 v[32:35], a[36:39], v[224:227], v[32:35]
    v_perm_b32 v228, v175, v171, s69
    v_perm_b32 v229, v183, v179, s69
    v_mfma_f32_16x16x32_bf16 v[64:67], a[100:103], v[224:227], v[64:67]
    v_perm_b32 v230, v191, v187, s69
    v_perm_b32 v231, v199, v195, s69
    v_mfma_f32_16x16x32_bf16 v[96:99], a[164:167], v[224:227], v[96:99]
    v_mfma_f32_16x16x32_bf16 v[128:131], a[228:231], v[224:227], v[128:131]
    v_mfma_f32_16x16x32_bf16 v[36:39], a[36:39], v[228:231], v[36:39]
    v_mfma_f32_16x16x32_bf16 v[68:71], a[100:103], v[228:231], v[68:71]
    v_mfma_f32_16x16x32_bf16 v[100:103], a[164:167], v[228:231], v[100:103]
    v_mfma_f32_16x16x32_bf16 v[132:135], a[228:231], v[228:231], v[132:135]
    s_waitcnt lgkmcnt(0)
    v_perm_b32 v200, v140, v136, s68
    v_perm_b32 v201, v148, v144, s68
    v_perm_b32 v202, v156, v152, s68
    v_perm_b32 v203, v164, v160, s68
    s_nop 1
    v_mfma_f32_16x16x32_bf16 v[8:11], a[40:43], v[200:203], v[8:11]
    v_perm_b32 v204, v140, v136, s69
    v_perm_b32 v205, v148, v144, s69
    v_mfma_f32_16x16x32_bf16 v[40:43], a[104:107], v[200:203], v[40:43]
    v_perm_b32 v206, v156, v152, s69
    v_perm_b32 v207, v164, v160, s69
    v_mfma_f32_16x16x32_bf16 v[72:75], a[168:171], v[200:203], v[72:75]
    ds_read_b128 v[168:171], v233 offset:24576
    ds_read_b128 v[172:175], v233 offset:24832
    v_mfma_f32_16x16x32_bf16 v[104:107], a[232:235], v[200:203], v[104:107]
    ds_read_b128 v[176:179], v233 offset:25088
    ds_read_b128 v[180:183], v233 offset:25344
    v_mfma_f32_16x16x32_bf16 v[12:15], a[40:43], v[204:207], v[12:15]
    v_perm_b32 v208, v141, v137, s68
    v_perm_b32 v209, v149, v145, s68
    v_mfma_f32_16x16x32_bf16 v[44:47], a[104:107], v[204:207], v[44:47]
    v_perm_b32 v210, v157, v153, s68
    v_perm_b32 v211, v165, v161, s68
    v_mfma_f32_16x16x32_bf16 v[76:79], a[168:171], v[204:207], v[76:79]
    ds_read_b128 v[184:187], v233 offset:25600
    ds_read_b128 v[188:191], v233 offset:25856
    v_mfma_f32_16x16x32_bf16 v[108:111], a[232:235], v[204:207], v[108:111]
    ds_read_b128 v[192:195], v233 offset:26112
    ds_read_b128 v[196:199], v233 offset:26368
    v_mfma_f32_16x16x32_bf16 v[16:19], a[40:43], v[208:211], v[16:19]
    v_perm_b32 v212, v141, v137, s69
    v_perm_b32 v213, v149, v145, s69
    v_mfma_f32_16x16x32_bf16 v[48:51], a[104:107], v[208:211], v[48:51]
    v_perm_b32 v214, v157, v153, s69
    v_perm_b32 v215, v165, v161, s69
    v_mfma_f32_16x16x32_bf16 v[80:83], a[168:171], v[208:211], v[80:83]
    v_mfma_f32_16x16x32_bf16 v[112:115], a[232:235], v[208:211], v[112:115]
    v_mfma_f32_16x16x32_bf16 v[20:23], a[40:43], v[212:215], v[20:23]
    v_perm_b32 v216, v142, v138, s68
    v_perm_b32 v217, v150, v146, s68
    v_mfma_f32_16x16x32_bf16 v[52:55], a[104:107], v[212:215], v[52:55]
    v_perm_b32 v218, v158, v154, s68
    v_perm_b32 v219, v166, v162, s68
    v_mfma_f32_16x16x32_bf16 v[84:87], a[168:171], v[212:215], v[84:87]
    v_mfma_f32_16x16x32_bf16 v[116:119], a[232:235], v[212:215], v[116:119]
    v_mfma_f32_16x16x32_bf16 v[24:27], a[40:43], v[216:219], v[24:27]
    v_perm_b32 v220, v142, v138, s69
    v_perm_b32 v221, v150, v146, s69
    v_mfma_f32_16x16x32_bf16 v[56:59], a[104:107], v[216:219], v[56:59]
    v_perm_b32 v222, v158, v154, s69
    v_perm_b32 v223, v166, v162, s69
    v_mfma_f32_16x16x32_bf16 v[88:91], a[168:171], v[216:219], v[88:91]
    v_mfma_f32_16x16x32_bf16 v[120:123], a[232:235], v[216:219], v[120:123]
    v_mfma_f32_16x16x32_bf16 v[28:31], a[40:43], v[220:223], v[28:31]
    v_perm_b32 v224, v143, v139, s68
    v_perm_b32 v225, v151, v147, s68
    v_mfma_f32_16x16x32_bf16 v[60:63], a[104:107], v[220:223], v[60:63]
    v_perm_b32 v226, v159, v155, s68
    v_perm_b32 v227, v167, v163, s68
    v_mfma_f32_16x16x32_bf16 v[92:95], a[168:171], v[220:223], v[92:95]
    v_mfma_f32_16x16x32_bf16 v[124:127], a[232:235], v[220:223], v[124:127]
    v_mfma_f32_16x16x32_bf16 v[32:35], a[40:43], v[224:227], v[32:35]
    v_perm_b32 v228, v143, v139, s69
    v_perm_b32 v229, v151, v147, s69
    v_mfma_f32_16x16x32_bf16 v[64:67], a[104:107], v[224:227], v[64:67]
    v_perm_b32 v230, v159, v155, s69
    v_perm_b32 v231, v167, v163, s69
    v_mfma_f32_16x16x32_bf16 v[96:99], a[168:171], v[224:227], v[96:99]
    v_mfma_f32_16x16x32_bf16 v[128:131], a[232:235], v[224:227], v[128:131]
    v_mfma_f32_16x16x32_bf16 v[36:39], a[40:43], v[228:231], v[36:39]
    v_mfma_f32_16x16x32_bf16 v[68:71], a[104:107], v[228:231], v[68:71]
    v_mfma_f32_16x16x32_bf16 v[100:103], a[168:171], v[228:231], v[100:103]
    v_mfma_f32_16x16x32_bf16 v[132:135], a[232:235], v[228:231], v[132:135]
    s_waitcnt lgkmcnt(0)
    v_perm_b32 v200, v172, v168, s68
    v_perm_b32 v201, v180, v176, s68
    v_perm_b32 v202, v188, v184, s68
    v_perm_b32 v203, v196, v192, s68
    s_nop 1
    v_mfma_f32_16x16x32_bf16 v[8:11], a[44:47], v[200:203], v[8:11]
    v_perm_b32 v204, v172, v168, s69
    v_perm_b32 v205, v180, v176, s69
    v_mfma_f32_16x16x32_bf16 v[40:43], a[108:111], v[200:203], v[40:43]
    v_perm_b32 v206, v188, v184, s69
    v_perm_b32 v207, v196, v192, s69
    v_mfma_f32_16x16x32_bf16 v[72:75], a[172:175], v[200:203], v[72:75]
    v_mfma_f32_16x16x32_bf16 v[104:107], a[236:239], v[200:203], v[104:107]
    v_mfma_f32_16x16x32_bf16 v[12:15], a[44:47], v[204:207], v[12:15]
    v_perm_b32 v208, v173, v169, s68
    v_perm_b32 v209, v181, v177, s68
    v_mfma_f32_16x16x32_bf16 v[44:47], a[108:111], v[204:207], v[44:47]
    v_perm_b32 v210, v189, v185, s68
    v_perm_b32 v211, v197, v193, s68
    v_mfma_f32_16x16x32_bf16 v[76:79], a[172:175], v[204:207], v[76:79]
    v_mfma_f32_16x16x32_bf16 v[108:111], a[236:239], v[204:207], v[108:111]
    v_mfma_f32_16x16x32_bf16 v[16:19], a[44:47], v[208:211], v[16:19]
    v_perm_b32 v212, v173, v169, s69
    v_perm_b32 v213, v181, v177, s69
    v_mfma_f32_16x16x32_bf16 v[48:51], a[108:111], v[208:211], v[48:51]
    v_perm_b32 v214, v189, v185, s69
    v_perm_b32 v215, v197, v193, s69
    v_mfma_f32_16x16x32_bf16 v[80:83], a[172:175], v[208:211], v[80:83]
    v_mfma_f32_16x16x32_bf16 v[112:115], a[236:239], v[208:211], v[112:115]
    v_mfma_f32_16x16x32_bf16 v[20:23], a[44:47], v[212:215], v[20:23]
    v_perm_b32 v216, v174, v170, s68
    v_perm_b32 v217, v182, v178, s68
    v_mfma_f32_16x16x32_bf16 v[52:55], a[108:111], v[212:215], v[52:55]
    v_perm_b32 v218, v190, v186, s68
    v_perm_b32 v219, v198, v194, s68
    v_mfma_f32_16x16x32_bf16 v[84:87], a[172:175], v[212:215], v[84:87]
    v_mfma_f32_16x16x32_bf16 v[116:119], a[236:239], v[212:215], v[116:119]
    v_mfma_f32_16x16x32_bf16 v[24:27], a[44:47], v[216:219], v[24:27]
    v_perm_b32 v220, v174, v170, s69
    v_perm_b32 v221, v182, v178, s69
    v_mfma_f32_16x16x32_bf16 v[56:59], a[108:111], v[216:219], v[56:59]
    v_perm_b32 v222, v190, v186, s69
    v_perm_b32 v223, v198, v194, s69
    v_mfma_f32_16x16x32_bf16 v[88:91], a[172:175], v[216:219], v[88:91]
    v_mfma_f32_16x16x32_bf16 v[120:123], a[236:239], v[216:219], v[120:123]
    v_mfma_f32_16x16x32_bf16 v[28:31], a[44:47], v[220:223], v[28:31]
    v_perm_b32 v224, v175, v171, s68
    v_perm_b32 v225, v183, v179, s68
    v_mfma_f32_16x16x32_bf16 v[60:63], a[108:111], v[220:223], v[60:63]
    v_perm_b32 v226, v191, v187, s68
    v_perm_b32 v227, v199, v195, s68
    v_mfma_f32_16x16x32_bf16 v[92:95], a[172:175], v[220:223], v[92:95]
    v_mfma_f32_16x16x32_bf16 v[124:127], a[236:239], v[220:223], v[124:127]
    v_mfma_f32_16x16x32_bf16 v[32:35], a[44:47], v[224:227], v[32:35]
    v_perm_b32 v228, v175, v171, s69
    v_perm_b32 v229, v183, v179, s69
    v_mfma_f32_16x16x32_bf16 v[64:67], a[108:111], v[224:227], v[64:67]
    v_perm_b32 v230, v191, v187, s69
    v_perm_b32 v231, v199, v195, s69
    v_mfma_f32_16x16x32_bf16 v[96:99], a[172:175], v[224:227], v[96:99]
    v_mfma_f32_16x16x32_bf16 v[128:131], a[236:239], v[224:227], v[128:131]
    v_mfma_f32_16x16x32_bf16 v[36:39], a[44:47], v[228:231], v[36:39]
    v_mfma_f32_16x16x32_bf16 v[68:71], a[108:111], v[228:231], v[68:71]
    v_mfma_f32_16x16x32_bf16 v[100:103], a[172:175], v[228:231], v[100:103]
    v_mfma_f32_16x16x32_bf16 v[132:135], a[236:239], v[228:231], v[132:135]
    s_waitcnt vmcnt(16)
    s_barrier
    ds_read_b128 v[136:139], v233 offset:32768
    ds_read_b128 v[140:143], v233 offset:33024
    ds_read_b128 v[144:147], v233 offset:33280
    ds_read_b128 v[148:151], v233 offset:33536
    ds_read_b128 v[152:155], v233 offset:33792
    ds_read_b128 v[156:159], v233 offset:34048
    ds_read_b128 v[160:163], v233 offset:34304
    ds_read_b128 v[164:167], v233 offset:34560
    s_waitcnt lgkmcnt(0)
    v_perm_b32 v200, v140, v136, s68
    v_perm_b32 v201, v148, v144, s68
    v_perm_b32 v202, v156, v152, s68
    v_perm_b32 v203, v164, v160, s68
    s_nop 1
    v_mfma_f32_16x16x32_bf16 v[8:11], a[48:51], v[200:203], v[8:11]
    v_perm_b32 v204, v140, v136, s69
    v_perm_b32 v205, v148, v144, s69
    v_mfma_f32_16x16x32_bf16 v[40:43], a[112:115], v[200:203], v[40:43]
    v_perm_b32 v206, v156, v152, s69
    v_perm_b32 v207, v164, v160, s69
    v_mfma_f32_16x16x32_bf16 v[72:75], a[176:179], v[200:203], v[72:75]
    ds_read_b128 v[168:171], v233 offset:40960
    ds_read_b128 v[172:175], v233 offset:41216
    v_mfma_f32_16x16x32_bf16 v[104:107], a[240:243], v[200:203], v[104:107]
    ds_read_b128 v[176:179], v233 offset:41472
    ds_read_b128 v[180:183], v233 offset:41728
    v_mfma_f32_16x16x32_bf16 v[12:15], a[48:51], v[204:207], v[12:15]
    v_perm_b32 v208, v141, v137, s68
    v_perm_b32 v209, v149, v145, s68
    v_mfma_f32_16x16x32_bf16 v[44:47], a[112:115], v[204:207], v[44:47]
    v_perm_b32 v210, v157, v153, s68
    v_perm_b32 v211, v165, v161, s68
    v_mfma_f32_16x16x32_bf16 v[76:79], a[176:179], v[204:207], v[76:79]
    ds_read_b128 v[184:187], v233 offset:41984
    ds_read_b128 v[188:191], v233 offset:42240
    v_mfma_f32_16x16x32_bf16 v[108:111], a[240:243], v[204:207], v[108:111]
    ds_read_b128 v[192:195], v233 offset:42496
    ds_read_b128 v[196:199], v233 offset:42752
    v_mfma_f32_16x16x32_bf16 v[16:19], a[48:51], v[208:211], v[16:19]
    v_perm_b32 v212, v141, v137, s69
    v_perm_b32 v213, v149, v145, s69
    v_mfma_f32_16x16x32_bf16 v[48:51], a[112:115], v[208:211], v[48:51]
    v_perm_b32 v214, v157, v153, s69
    v_perm_b32 v215, v165, v161, s69
    v_mfma_f32_16x16x32_bf16 v[80:83], a[176:179], v[208:211], v[80:83]
    s_add_u32 m0, s39, 65536
    s_add_u32 s38, s37, 2097152
    v_mfma_f32_16x16x32_bf16 v[112:115], a[240:243], v[208:211], v[112:115]
    buffer_load_dwordx4 v7, s[32:35], s38 offen lds
    s_add_u32 m0, s39, 66560
    v_mfma_f32_16x16x32_bf16 v[20:23], a[48:51], v[212:215], v[20:23]
    v_perm_b32 v216, v142, v138, s68
    v_perm_b32 v217, v150, v146, s68
    v_mfma_f32_16x16x32_bf16 v[52:55], a[112:115], v[212:215], v[52:55]
    v_perm_b32 v218, v158, v154, s68
    v_perm_b32 v219, v166, v162, s68
    v_mfma_f32_16x16x32_bf16 v[84:87], a[176:179], v[212:215], v[84:87]
    s_add_u32 s38, s37, 2129920
    buffer_load_dwordx4 v7, s[32:35], s38 offen lds
    v_mfma_f32_16x16x32_bf16 v[116:119], a[240:243], v[212:215], v[116:119]
    s_add_u32 m0, s39, 67584
    s_add_u32 s38, s37, 2162688
    v_mfma_f32_16x16x32_bf16 v[24:27], a[48:51], v[216:219], v[24:27]
    v_perm_b32 v220, v142, v138, s69
    v_perm_b32 v221, v150, v146, s69
    v_mfma_f32_16x16x32_bf16 v[56:59], a[112:115], v[216:219], v[56:59]
    v_perm_b32 v222, v158, v154, s69
    v_perm_b32 v223, v166, v162, s69
    v_mfma_f32_16x16x32_bf16 v[88:91], a[176:179], v[216:219], v[88:91]
    buffer_load_dwordx4 v7, s[32:35], s38 offen lds
    s_add_u32 m0, s39, 68608
    v_mfma_f32_16x16x32_bf16 v[120:123], a[240:243], v[216:219], v[120:123]
    s_add_u32 s38, s37, 2195456
    buffer_load_dwordx4 v7, s[32:35], s38 offen lds
    v_mfma_f32_16x16x32_bf16 v[28:31], a[48:51], v[220:223], v[28:31]
    v_perm_b32 v224, v143, v139, s68
    v_perm_b32 v225, v151, v147, s68
    v_mfma_f32_16x16x32_bf16 v[60:63], a[112:115], v[220:223], v[60:63]
    v_perm_b32 v226, v159, v155, s68
    v_perm_b32 v227, v167, v163, s68
    v_mfma_f32_16x16x32_bf16 v[92:95], a[176:179], v[220:223], v[92:95]
    s_add_u32 m0, s39, 69632
    s_add_u32 s38, s37, 2228224
    v_mfma_f32_16x16x32_bf16 v[124:127], a[240:243], v[220:223], v[124:127]
    buffer_load_dwordx4 v7, s[32:35], s38 offen lds
    s_add_u32 m0, s39, 70656
    v_mfma_f32_16x16x32_bf16 v[32:35], a[48:51], v[224:227], v[32:35]
    v_perm_b32 v228, v143, v139, s69
    v_perm_b32 v229, v151, v147, s69
    v_mfma_f32_16x16x32_bf16 v[64:67], a[112:115], v[224:227], v[64:67]
    v_perm_b32 v230, v159, v155, s69
    v_perm_b32 v231, v167, v163, s69
    v_mfma_f32_16x16x32_bf16 v[96:99], a[176:179], v[224:227], v[96:99]
    s_add_u32 s38, s37, 2260992
    buffer_load_dwordx4 v7, s[32:35], s38 offen lds
    v_mfma_f32_16x16x32_bf16 v[128:131], a[240:243], v[224:227], v[128:131]
    s_add_u32 m0, s39, 71680
    s_add_u32 s38, s37, 2293760
    v_mfma_f32_16x16x32_bf16 v[36:39], a[48:51], v[228:231], v[36:39]
    buffer_load_dwordx4 v7, s[32:35], s38 offen lds
    s_add_u32 m0, s39, 72704
    v_mfma_f32_16x16x32_bf16 v[68:71], a[112:115], v[228:231], v[68:71]
    s_add_u32 s38, s37, 2326528
    buffer_load_dwordx4 v7, s[32:35], s38 offen lds
    v_mfma_f32_16x16x32_bf16 v[100:103], a[176:179], v[228:231], v[100:103]
    v_mfma_f32_16x16x32_bf16 v[132:135], a[240:243], v[228:231], v[132:135]
    s_waitcnt lgkmcnt(0)
    v_perm_b32 v200, v172, v168, s68
    v_perm_b32 v201, v180, v176, s68
    v_perm_b32 v202, v188, v184, s68
    v_perm_b32 v203, v196, v192, s68
    s_nop 1
    v_mfma_f32_16x16x32_bf16 v[8:11], a[52:55], v[200:203], v[8:11]
    v_perm_b32 v204, v172, v168, s69
    v_perm_b32 v205, v180, v176, s69
    v_mfma_f32_16x16x32_bf16 v[40:43], a[116:119], v[200:203], v[40:43]
    v_perm_b32 v206, v188, v184, s69
    v_perm_b32 v207, v196, v192, s69
    v_mfma_f32_16x16x32_bf16 v[72:75], a[180:183], v[200:203], v[72:75]
    ds_read_b128 v[136:139], v233 offset:49152
    ds_read_b128 v[140:143], v233 offset:49408
    v_mfma_f32_16x16x32_bf16 v[104:107], a[244:247], v[200:203], v[104:107]
    ds_read_b128 v[144:147], v233 offset:49664
    ds_read_b128 v[148:151], v233 offset:49920
    v_mfma_f32_16x16x32_bf16 v[12:15], a[52:55], v[204:207], v[12:15]
    v_perm_b32 v208, v173, v169, s68
    v_perm_b32 v209, v181, v177, s68
    v_mfma_f32_16x16x32_bf16 v[44:47], a[116:119], v[204:207], v[44:47]
    v_perm_b32 v210, v189, v185, s68
    v_perm_b32 v211, v197, v193, s68
    v_mfma_f32_16x16x32_bf16 v[76:79], a[180:183], v[204:207], v[76:79]
    ds_read_b128 v[152:155], v233 offset:50176
    ds_read_b128 v[156:159], v233 offset:50432
    v_mfma_f32_16x16x32_bf16 v[108:111], a[244:247], v[204:207], v[108:111]
    ds_read_b128 v[160:163], v233 offset:50688
    ds_read_b128 v[164:167], v233 offset:50944
    v_mfma_f32_16x16x32_bf16 v[16:19], a[52:55], v[208:211], v[16:19]
    v_perm_b32 v212, v173, v169, s69
    v_perm_b32 v213, v181, v177, s69
    v_mfma_f32_16x16x32_bf16 v[48:51], a[116:119], v[208:211], v[48:51]
    v_perm_b32 v214, v189, v185, s69
    v_perm_b32 v215, v197, v193, s69
    v_mfma_f32_16x16x32_bf16 v[80:83], a[180:183], v[208:211], v[80:83]
    v_mfma_f32_16x16x32_bf16 v[112:115], a[244:247], v[208:211], v[112:115]
    v_mfma_f32_16x16x32_bf16 v[20:23], a[52:55], v[212:215], v[20:23]
    v_perm_b32 v216, v174, v170, s68
    v_perm_b32 v217, v182, v178, s68
    v_mfma_f32_16x16x32_bf16 v[52:55], a[116:119], v[212:215], v[52:55]
    v_perm_b32 v218, v190, v186, s68
    v_perm_b32 v219, v198, v194, s68
    v_mfma_f32_16x16x32_bf16 v[84:87], a[180:183], v[212:215], v[84:87]
    v_mfma_f32_16x16x32_bf16 v[116:119], a[244:247], v[212:215], v[116:119]
    v_mfma_f32_16x16x32_bf16 v[24:27], a[52:55], v[216:219], v[24:27]
    v_perm_b32 v220, v174, v170, s69
    v_perm_b32 v221, v182, v178, s69
    v_mfma_f32_16x16x32_bf16 v[56:59], a[116:119], v[216:219], v[56:59]
    v_perm_b32 v222, v190, v186, s69
    v_perm_b32 v223, v198, v194, s69
    v_mfma_f32_16x16x32_bf16 v[88:91], a[180:183], v[216:219], v[88:91]
    v_mfma_f32_16x16x32_bf16 v[120:123], a[244:247], v[216:219], v[120:123]
    v_mfma_f32_16x16x32_bf16 v[28:31], a[52:55], v[220:223], v[28:31]
    v_perm_b32 v224, v175, v171, s68
    v_perm_b32 v225, v183, v179, s68
    v_mfma_f32_16x16x32_bf16 v[60:63], a[116:119], v[220:223], v[60:63]
    v_perm_b32 v226, v191, v187, s68
    v_perm_b32 v227, v199, v195, s68
    v_mfma_f32_16x16x32_bf16 v[92:95], a[180:183], v[220:223], v[92:95]
    v_mfma_f32_16x16x32_bf16 v[124:127], a[244:247], v[220:223], v[124:127]
    v_mfma_f32_16x16x32_bf16 v[32:35], a[52:55], v[224:227], v[32:35]
    v_perm_b32 v228, v175, v171, s69
    v_perm_b32 v229, v183, v179, s69
    v_mfma_f32_16x16x32_bf16 v[64:67], a[116:119], v[224:227], v[64:67]
    v_perm_b32 v230, v191, v187, s69
    v_perm_b32 v231, v199, v195, s69
    v_mfma_f32_16x16x32_bf16 v[96:99], a[180:183], v[224:227], v[96:99]
    v_mfma_f32_16x16x32_bf16 v[128:131], a[244:247], v[224:227], v[128:131]
    v_mfma_f32_16x16x32_bf16 v[36:39], a[52:55], v[228:231], v[36:39]
    v_mfma_f32_16x16x32_bf16 v[68:71], a[116:119], v[228:231], v[68:71]
    v_mfma_f32_16x16x32_bf16 v[100:103], a[180:183], v[228:231], v[100:103]
    v_mfma_f32_16x16x32_bf16 v[132:135], a[244:247], v[228:231], v[132:135]
    s_waitcnt lgkmcnt(0)
    v_perm_b32 v200, v140, v136, s68
    v_perm_b32 v201, v148, v144, s68
    v_perm_b32 v202, v156, v152, s68
    v_perm_b32 v203, v164, v160, s68
    s_nop 1
    v_mfma_f32_16x16x32_bf16 v[8:11], a[56:59], v[200:203], v[8:11]
    v_perm_b32 v204, v140, v136, s69
    v_perm_b32 v205, v148, v144, s69
    v_mfma_f32_16x16x32_bf16 v[40:43], a[120:123], v[200:203], v[40:43]
    v_perm_b32 v206, v156, v152, s69
    v_perm_b32 v207, v164, v160, s69
    v_mfma_f32_16x16x32_bf16 v[72:75], a[184:187], v[200:203], v[72:75]
    ds_read_b128 v[168:171], v233 offset:57344
    ds_read_b128 v[172:175], v233 offset:57600
    v_mfma_f32_16x16x32_bf16 v[104:107], a[248:251], v[200:203], v[104:107]
    ds_read_b128 v[176:179], v233 offset:57856
    ds_read_b128 v[180:183], v233 offset:58112
    v_mfma_f32_16x16x32_bf16 v[12:15], a[56:59], v[204:207], v[12:15]
    v_perm_b32 v208, v141, v137, s68
    v_perm_b32 v209, v149, v145, s68
    v_mfma_f32_16x16x32_bf16 v[44:47], a[120:123], v[204:207], v[44:47]
    v_perm_b32 v210, v157, v153, s68
    v_perm_b32 v211, v165, v161, s68
    v_mfma_f32_16x16x32_bf16 v[76:79], a[184:187], v[204:207], v[76:79]
    ds_read_b128 v[184:187], v233 offset:58368
    ds_read_b128 v[188:191], v233 offset:58624
    v_mfma_f32_16x16x32_bf16 v[108:111], a[248:251], v[204:207], v[108:111]
    ds_read_b128 v[192:195], v233 offset:58880
    ds_read_b128 v[196:199], v233 offset:59136
    v_mfma_f32_16x16x32_bf16 v[16:19], a[56:59], v[208:211], v[16:19]
    v_perm_b32 v212, v141, v137, s69
    v_perm_b32 v213, v149, v145, s69
    v_mfma_f32_16x16x32_bf16 v[48:51], a[120:123], v[208:211], v[48:51]
    v_perm_b32 v214, v157, v153, s69
    v_perm_b32 v215, v165, v161, s69
    v_mfma_f32_16x16x32_bf16 v[80:83], a[184:187], v[208:211], v[80:83]
    v_mfma_f32_16x16x32_bf16 v[112:115], a[248:251], v[208:211], v[112:115]
    v_mfma_f32_16x16x32_bf16 v[20:23], a[56:59], v[212:215], v[20:23]
    v_perm_b32 v216, v142, v138, s68
    v_perm_b32 v217, v150, v146, s68
    v_mfma_f32_16x16x32_bf16 v[52:55], a[120:123], v[212:215], v[52:55]
    v_perm_b32 v218, v158, v154, s68
    v_perm_b32 v219, v166, v162, s68
    v_mfma_f32_16x16x32_bf16 v[84:87], a[184:187], v[212:215], v[84:87]
    v_mfma_f32_16x16x32_bf16 v[116:119], a[248:251], v[212:215], v[116:119]
    v_mfma_f32_16x16x32_bf16 v[24:27], a[56:59], v[216:219], v[24:27]
    v_perm_b32 v220, v142, v138, s69
    v_perm_b32 v221, v150, v146, s69
    v_mfma_f32_16x16x32_bf16 v[56:59], a[120:123], v[216:219], v[56:59]
    v_perm_b32 v222, v158, v154, s69
    v_perm_b32 v223, v166, v162, s69
    v_mfma_f32_16x16x32_bf16 v[88:91], a[184:187], v[216:219], v[88:91]
    v_mfma_f32_16x16x32_bf16 v[120:123], a[248:251], v[216:219], v[120:123]
    v_mfma_f32_16x16x32_bf16 v[28:31], a[56:59], v[220:223], v[28:31]
    v_perm_b32 v224, v143, v139, s68
    v_perm_b32 v225, v151, v147, s68
    v_mfma_f32_16x16x32_bf16 v[60:63], a[120:123], v[220:223], v[60:63]
    v_perm_b32 v226, v159, v155, s68
    v_perm_b32 v227, v167, v163, s68
    v_mfma_f32_16x16x32_bf16 v[92:95], a[184:187], v[220:223], v[92:95]
    v_mfma_f32_16x16x32_bf16 v[124:127], a[248:251], v[220:223], v[124:127]
    v_mfma_f32_16x16x32_bf16 v[32:35], a[56:59], v[224:227], v[32:35]
    v_perm_b32 v228, v143, v139, s69
    v_perm_b32 v229, v151, v147, s69
    v_mfma_f32_16x16x32_bf16 v[64:67], a[120:123], v[224:227], v[64:67]
    v_perm_b32 v230, v159, v155, s69
    v_perm_b32 v231, v167, v163, s69
    v_mfma_f32_16x16x32_bf16 v[96:99], a[184:187], v[224:227], v[96:99]
    v_mfma_f32_16x16x32_bf16 v[128:131], a[248:251], v[224:227], v[128:131]
    v_mfma_f32_16x16x32_bf16 v[36:39], a[56:59], v[228:231], v[36:39]
    v_mfma_f32_16x16x32_bf16 v[68:71], a[120:123], v[228:231], v[68:71]
    v_mfma_f32_16x16x32_bf16 v[100:103], a[184:187], v[228:231], v[100:103]
    v_mfma_f32_16x16x32_bf16 v[132:135], a[248:251], v[228:231], v[132:135]
    s_waitcnt lgkmcnt(0)
    v_perm_b32 v200, v172, v168, s68
    v_perm_b32 v201, v180, v176, s68
    v_perm_b32 v202, v188, v184, s68
    v_perm_b32 v203, v196, v192, s68
    s_nop 1
    v_mfma_f32_16x16x32_bf16 v[8:11], a[60:63], v[200:203], v[8:11]
    v_perm_b32 v204, v172, v168, s69
    v_perm_b32 v205, v180, v176, s69
    v_mfma_f32_16x16x32_bf16 v[40:43], a[124:127], v[200:203], v[40:43]
    v_perm_b32 v206, v188, v184, s69
    v_perm_b32 v207, v196, v192, s69
    v_mfma_f32_16x16x32_bf16 v[72:75], a[188:191], v[200:203], v[72:75]
    v_mfma_f32_16x16x32_bf16 v[104:107], a[252:255], v[200:203], v[104:107]
    v_mfma_f32_16x16x32_bf16 v[12:15], a[60:63], v[204:207], v[12:15]
    v_perm_b32 v208, v173, v169, s68
    v_perm_b32 v209, v181, v177, s68
    v_mfma_f32_16x16x32_bf16 v[44:47], a[124:127], v[204:207], v[44:47]
    v_perm_b32 v210, v189, v185, s68
    v_perm_b32 v211, v197, v193, s68
    v_mfma_f32_16x16x32_bf16 v[76:79], a[188:191], v[204:207], v[76:79]
    v_mfma_f32_16x16x32_bf16 v[108:111], a[252:255], v[204:207], v[108:111]
    v_mfma_f32_16x16x32_bf16 v[16:19], a[60:63], v[208:211], v[16:19]
    v_perm_b32 v212, v173, v169, s69
    v_perm_b32 v213, v181, v177, s69
    v_mfma_f32_16x16x32_bf16 v[48:51], a[124:127], v[208:211], v[48:51]
    v_perm_b32 v214, v189, v185, s69
    v_perm_b32 v215, v197, v193, s69
    v_mfma_f32_16x16x32_bf16 v[80:83], a[188:191], v[208:211], v[80:83]
    v_mfma_f32_16x16x32_bf16 v[112:115], a[252:255], v[208:211], v[112:115]
    v_mfma_f32_16x16x32_bf16 v[20:23], a[60:63], v[212:215], v[20:23]
    v_perm_b32 v216, v174, v170, s68
    v_perm_b32 v217, v182, v178, s68
    v_mfma_f32_16x16x32_bf16 v[52:55], a[124:127], v[212:215], v[52:55]
    v_perm_b32 v218, v190, v186, s68
    v_perm_b32 v219, v198, v194, s68
    v_mfma_f32_16x16x32_bf16 v[84:87], a[188:191], v[212:215], v[84:87]
    v_mfma_f32_16x16x32_bf16 v[116:119], a[252:255], v[212:215], v[116:119]
    v_mfma_f32_16x16x32_bf16 v[24:27], a[60:63], v[216:219], v[24:27]
    v_perm_b32 v220, v174, v170, s69
    v_perm_b32 v221, v182, v178, s69
    v_mfma_f32_16x16x32_bf16 v[56:59], a[124:127], v[216:219], v[56:59]
    v_perm_b32 v222, v190, v186, s69
    v_perm_b32 v223, v198, v194, s69
    v_mfma_f32_16x16x32_bf16 v[88:91], a[188:191], v[216:219], v[88:91]
    v_mfma_f32_16x16x32_bf16 v[120:123], a[252:255], v[216:219], v[120:123]
    v_mfma_f32_16x16x32_bf16 v[28:31], a[60:63], v[220:223], v[28:31]
    v_perm_b32 v224, v175, v171, s68
    v_perm_b32 v225, v183, v179, s68
    v_mfma_f32_16x16x32_bf16 v[60:63], a[124:127], v[220:223], v[60:63]
    v_perm_b32 v226, v191, v187, s68
    v_perm_b32 v227, v199, v195, s68
    v_mfma_f32_16x16x32_bf16 v[92:95], a[188:191], v[220:223], v[92:95]
    v_mfma_f32_16x16x32_bf16 v[124:127], a[252:255], v[220:223], v[124:127]
    v_mfma_f32_16x16x32_bf16 v[32:35], a[60:63], v[224:227], v[32:35]
    v_perm_b32 v228, v175, v171, s69
    v_perm_b32 v229, v183, v179, s69
    v_mfma_f32_16x16x32_bf16 v[64:67], a[124:127], v[224:227], v[64:67]
    v_perm_b32 v230, v191, v187, s69
    v_perm_b32 v231, v199, v195, s69
    v_mfma_f32_16x16x32_bf16 v[96:99], a[188:191], v[224:227], v[96:99]
    v_mfma_f32_16x16x32_bf16 v[128:131], a[252:255], v[224:227], v[128:131]
    v_mfma_f32_16x16x32_bf16 v[36:39], a[60:63], v[228:231], v[36:39]
    v_mfma_f32_16x16x32_bf16 v[68:71], a[124:127], v[228:231], v[68:71]
    v_mfma_f32_16x16x32_bf16 v[100:103], a[188:191], v[228:231], v[100:103]
    v_mfma_f32_16x16x32_bf16 v[132:135], a[252:255], v[228:231], v[132:135]
    s_lshl_b32 s28, s27, 20
    s_lshl_b32 s29, s47, 14
    s_add_u32 s28, s28, s29
    s_add_u32 s28, s28, 20979712
    v_cvt_pk_bf16_f32 v200, v8, v9
    v_cvt_pk_bf16_f32 v201, v10, v11
    v_cvt_pk_bf16_f32 v202, v40, v41
    v_cvt_pk_bf16_f32 v203, v42, v43
    buffer_store_dwordx4 v[200:203], v4, s[8:11], s28 offen offset:0 sc1
    v_cvt_pk_bf16_f32 v204, v12, v13
    v_cvt_pk_bf16_f32 v205, v14, v15
    v_cvt_pk_bf16_f32 v206, v44, v45
    v_cvt_pk_bf16_f32 v207, v46, v47
    buffer_store_dwordx4 v[204:207], v4, s[8:11], s28 offen offset:1024 sc1
    v_cvt_pk_bf16_f32 v208, v16, v17
    v_cvt_pk_bf16_f32 v209, v18, v19
    v_cvt_pk_bf16_f32 v210, v48, v49
    v_cvt_pk_bf16_f32 v211, v50, v51
    buffer_store_dwordx4 v[208:211], v4, s[8:11], s28 offen offset:2048 sc1
    v_cvt_pk_bf16_f32 v212, v20, v21
    v_cvt_pk_bf16_f32 v213, v22, v23
    v_cvt_pk_bf16_f32 v214, v52, v53
    v_cvt_pk_bf16_f32 v215, v54, v55
    buffer_store_dwordx4 v[212:215], v4, s[8:11], s28 offen offset:3072 sc1
    s_add_u32 s28, s28, 4096
    v_cvt_pk_bf16_f32 v216, v24, v25
    v_cvt_pk_bf16_f32 v217, v26, v27
    v_cvt_pk_bf16_f32 v218, v56, v57
    v_cvt_pk_bf16_f32 v219, v58, v59
    buffer_store_dwordx4 v[216:219], v4, s[8:11], s28 offen offset:0 sc1
    v_cvt_pk_bf16_f32 v220, v28, v29
    v_cvt_pk_bf16_f32 v221, v30, v31
    v_cvt_pk_bf16_f32 v222, v60, v61
    v_cvt_pk_bf16_f32 v223, v62, v63
    buffer_store_dwordx4 v[220:223], v4, s[8:11], s28 offen offset:1024 sc1
    v_cvt_pk_bf16_f32 v224, v32, v33
    v_cvt_pk_bf16_f32 v225, v34, v35
    v_cvt_pk_bf16_f32 v226, v64, v65
    v_cvt_pk_bf16_f32 v227, v66, v67
    buffer_store_dwordx4 v[224:227], v4, s[8:11], s28 offen offset:2048 sc1
    v_cvt_pk_bf16_f32 v228, v36, v37
    v_cvt_pk_bf16_f32 v229, v38, v39
    v_cvt_pk_bf16_f32 v230, v68, v69
    v_cvt_pk_bf16_f32 v231, v70, v71
    buffer_store_dwordx4 v[228:231], v4, s[8:11], s28 offen offset:3072 sc1
    s_add_u32 s28, s28, 12288
    v_cvt_pk_bf16_f32 v200, v72, v73
    v_cvt_pk_bf16_f32 v201, v74, v75
    v_cvt_pk_bf16_f32 v202, v104, v105
    v_cvt_pk_bf16_f32 v203, v106, v107
    buffer_store_dwordx4 v[200:203], v4, s[8:11], s28 offen offset:0 sc1
    v_cvt_pk_bf16_f32 v204, v76, v77
    v_cvt_pk_bf16_f32 v205, v78, v79
    v_cvt_pk_bf16_f32 v206, v108, v109
    v_cvt_pk_bf16_f32 v207, v110, v111
    buffer_store_dwordx4 v[204:207], v4, s[8:11], s28 offen offset:1024 sc1
    v_cvt_pk_bf16_f32 v208, v80, v81
    v_cvt_pk_bf16_f32 v209, v82, v83
    v_cvt_pk_bf16_f32 v210, v112, v113
    v_cvt_pk_bf16_f32 v211, v114, v115
    buffer_store_dwordx4 v[208:211], v4, s[8:11], s28 offen offset:2048 sc1
    v_cvt_pk_bf16_f32 v212, v84, v85
    v_cvt_pk_bf16_f32 v213, v86, v87
    v_cvt_pk_bf16_f32 v214, v116, v117
    v_cvt_pk_bf16_f32 v215, v118, v119
    buffer_store_dwordx4 v[212:215], v4, s[8:11], s28 offen offset:3072 sc1
    s_add_u32 s28, s28, 4096
    v_cvt_pk_bf16_f32 v216, v88, v89
    v_cvt_pk_bf16_f32 v217, v90, v91
    v_cvt_pk_bf16_f32 v218, v120, v121
    v_cvt_pk_bf16_f32 v219, v122, v123
    buffer_store_dwordx4 v[216:219], v4, s[8:11], s28 offen offset:0 sc1
    v_cvt_pk_bf16_f32 v220, v92, v93
    v_cvt_pk_bf16_f32 v221, v94, v95
    v_cvt_pk_bf16_f32 v222, v124, v125
    v_cvt_pk_bf16_f32 v223, v126, v127
    buffer_store_dwordx4 v[220:223], v4, s[8:11], s28 offen offset:1024 sc1
    v_cvt_pk_bf16_f32 v224, v96, v97
    v_cvt_pk_bf16_f32 v225, v98, v99
    v_cvt_pk_bf16_f32 v226, v128, v129
    v_cvt_pk_bf16_f32 v227, v130, v131
    buffer_store_dwordx4 v[224:227], v4, s[8:11], s28 offen offset:2048 sc1
    v_cvt_pk_bf16_f32 v228, v100, v101
    v_cvt_pk_bf16_f32 v229, v102, v103
    v_cvt_pk_bf16_f32 v230, v132, v133
    v_cvt_pk_bf16_f32 v231, v134, v135
    buffer_store_dwordx4 v[228:231], v4, s[8:11], s28 offen offset:3072 sc1
    s_nop 1
Ltd_112:
    s_and_b32 s24, s6, 31
    s_lshl_b32 s25, s5, 5
    s_add_u32 s24, s24, s25
    s_lshl_b32 s24, s24, 10
    s_lshr_b32 s25, s6, 5
    s_sub_u32 s26, s25, 1
    s_lshl_b32 s26, s26, 7
    s_cmp_eq_u32 s25, 0
    s_cselect_b32 s25, 512, s26
    s_add_u32 s24, s24, s25
    s_add_u32 s24, s24, 159449088
    s_waitcnt vmcnt(0) lgkmcnt(0)
    s_barrier
    s_cmp_lg_u32 s19, 0
    s_cbranch_scc1 Lsig_115
    v_mov_b64 v[236:237], s[62:63]
    v_mov_b64 v[238:239], s[62:63]
    s_mov_b64 exec, 0xff
    buffer_store_dwordx4 v[236:239], v4, s[8:11], s24 offen sc1
    buffer_store_dwordx4 v[236:239], v4, s[8:11], s24 offen offset:256 sc1
    s_mov_b64 exec, -1
    s_nop 0
Lsig_115:
    s_mov_b32 s6, s46
    s_mov_b32 s12, s32
    s_mov_b32 s13, s33
    s_mov_b32 s36, s37
    s_sub_u32 s48, s48, 1
    s_cmp_gt_u32 s48, 0
    s_cbranch_scc1 Lnt_108
    s_branch Lnext_92
Lh_98:
    s_lshl_b32 s30, s7, 4
    s_lshl_b32 s31, s19, 2
    s_add_u32 s30, s30, s31
    s_cmp_lg_u32 s6, 0
    s_cbranch_scc1 Lpn_117
    s_mov_b32 s31, 0
Lpl_118:
    s_load_dwordx2 s[12:13], s[0:1], 40
    s_mul_hi_u32 s26, s30, 33554433
    s_mul_i32 s27, s26, 128
    s_sub_u32 s27, s30, s27
    v_and_b32 v72, 15, v1
    v_lshrrev_b32 v73, 4, v1
    v_mul_u32_u24 v74, 32768, v73
    v_lshl_add_u32 v74, v72, 4, v74
    s_lshl_b32 s26, s26, 8
    s_lshr_b32 s14, s27, 2
    s_lshl_b32 s14, s14, 7
    s_and_b32 s15, s27, 3
    s_lshl_b32 s15, s15, 1
    s_add_u32 s27, s14, s15
    s_mul_i32 s27, s27, 1024
    s_add_u32 s26, s26, s27
    s_waitcnt lgkmcnt(0)
    s_and_b32 s13, s13, 0xffff
    s_mov_b32 s14, 4194304
    s_mov_b32 s15, 0x00020000
    s_add_u32 s27, s26, 0
    buffer_load_dwordx4 v[8:11], v74, s[12:15], s27 offen
    s_add_u32 s27, s26, 1024
    buffer_load_dwordx4 v[12:15], v74, s[12:15], s27 offen
    s_add_u32 s27, s26, 8192
    buffer_load_dwordx4 v[16:19], v74, s[12:15], s27 offen
    s_add_u32 s27, s26, 9216
    buffer_load_dwordx4 v[20:23], v74, s[12:15], s27 offen
    s_add_u32 s27, s26, 16384
    buffer_load_dwordx4 v[24:27], v74, s[12:15], s27 offen
    s_add_u32 s27, s26, 17408
    buffer_load_dwordx4 v[28:31], v74, s[12:15], s27 offen
    s_add_u32 s27, s26, 24576
    buffer_load_dwordx4 v[32:35], v74, s[12:15], s27 offen
    s_add_u32 s27, s26, 25600
    buffer_load_dwordx4 v[36:39], v74, s[12:15], s27 offen
    v_lshlrev_b32 v74, 4, v1
    v_add_u32 v75, 4096, v74
    s_lshl_b32 s26, s30, 13
    s_add_u32 s26, s26, 113246208
    s_waitcnt vmcnt(0)
    v_perm_b32 v40, v12, v8, s68
    v_perm_b32 v41, v20, v16, s68
    v_perm_b32 v42, v28, v24, s68
    v_perm_b32 v43, v36, v32, s68
    buffer_store_dwordx4 v[40:43], v74, s[8:11], s26 offen offset:0 sc1
    v_perm_b32 v44, v12, v8, s69
    v_perm_b32 v45, v20, v16, s69
    v_perm_b32 v46, v28, v24, s69
    v_perm_b32 v47, v36, v32, s69
    buffer_store_dwordx4 v[44:47], v74, s[8:11], s26 offen offset:1024 sc1
    v_perm_b32 v48, v13, v9, s68
    v_perm_b32 v49, v21, v17, s68
    v_perm_b32 v50, v29, v25, s68
    v_perm_b32 v51, v37, v33, s68
    buffer_store_dwordx4 v[48:51], v74, s[8:11], s26 offen offset:2048 sc1
    v_perm_b32 v52, v13, v9, s69
    v_perm_b32 v53, v21, v17, s69
    v_perm_b32 v54, v29, v25, s69
    v_perm_b32 v55, v37, v33, s69
    buffer_store_dwordx4 v[52:55], v74, s[8:11], s26 offen offset:3072 sc1
    v_perm_b32 v56, v14, v10, s68
    v_perm_b32 v57, v22, v18, s68
    v_perm_b32 v58, v30, v26, s68
    v_perm_b32 v59, v38, v34, s68
    buffer_store_dwordx4 v[56:59], v75, s[8:11], s26 offen offset:0 sc1
    v_perm_b32 v60, v14, v10, s69
    v_perm_b32 v61, v22, v18, s69
    v_perm_b32 v62, v30, v26, s69
    v_perm_b32 v63, v38, v34, s69
    buffer_store_dwordx4 v[60:63], v75, s[8:11], s26 offen offset:1024 sc1
    v_perm_b32 v64, v15, v11, s68
    v_perm_b32 v65, v23, v19, s68
    v_perm_b32 v66, v31, v27, s68
    v_perm_b32 v67, v39, v35, s68
    buffer_store_dwordx4 v[64:67], v75, s[8:11], s26 offen offset:2048 sc1
    v_perm_b32 v68, v15, v11, s69
    v_perm_b32 v69, v23, v19, s69
    v_perm_b32 v70, v31, v27, s69
    v_perm_b32 v71, v39, v35, s69
    buffer_store_dwordx4 v[68:71], v75, s[8:11], s26 offen offset:3072 sc1
    s_add_u32 s30, s30, 1
    s_add_u32 s31, s31, 1
    s_cmp_lt_u32 s31, 4
    s_cbranch_scc1 Lpl_118
    s_branch Lpd_116
Lpn_117:
    s_cmp_lg_u32 s6, 1
    s_cbranch_scc1 Lpn_119
    s_mov_b32 s31, 0
Lpl_120:
    s_load_dwordx2 s[12:13], s[0:1], 64
    s_mul_hi_u32 s26, s30, 268435457
    s_mul_i32 s27, s26, 16
    s_sub_u32 s27, s30, s27
    v_and_b32 v72, 15, v1
    v_lshrrev_b32 v73, 4, v1
    v_mul_u32_u24 v74, 8192, v73
    v_lshl_add_u32 v74, v72, 4, v74
    s_lshl_b32 s26, s26, 8
    s_lshl_b32 s27, s27, 5
    s_mul_i32 s27, s27, 1024
    s_add_u32 s26, s26, s27
    s_waitcnt lgkmcnt(0)
    s_and_b32 s13, s13, 0xffff
    s_mov_b32 s14, 524288
    s_mov_b32 s15, 0x00020000
    s_add_u32 s27, s26, 0
    buffer_load_dwordx4 v[8:11], v74, s[12:15], s27 offen
    s_add_u32 s27, s26, 1024
    buffer_load_dwordx4 v[12:15], v74, s[12:15], s27 offen
    s_add_u32 s27, s26, 2048
    buffer_load_dwordx4 v[16:19], v74, s[12:15], s27 offen
    s_add_u32 s27, s26, 3072
    buffer_load_dwordx4 v[20:23], v74, s[12:15], s27 offen
    s_add_u32 s27, s26, 4096
    buffer_load_dwordx4 v[24:27], v74, s[12:15], s27 offen
    s_add_u32 s27, s26, 5120
    buffer_load_dwordx4 v[28:31], v74, s[12:15], s27 offen
    s_add_u32 s27, s26, 6144
    buffer_load_dwordx4 v[32:35], v74, s[12:15], s27 offen
    s_add_u32 s27, s26, 7168
    buffer_load_dwordx4 v[36:39], v74, s[12:15], s27 offen
    v_lshlrev_b32 v74, 4, v1
    v_add_u32 v75, 4096, v74
    s_lshl_b32 s26, s30, 13
    s_add_u32 s26, s26, 117440512
    s_waitcnt vmcnt(0)
    v_perm_b32 v40, v12, v8, s68
    v_perm_b32 v41, v20, v16, s68
    v_perm_b32 v42, v28, v24, s68
    v_perm_b32 v43, v36, v32, s68
    buffer_store_dwordx4 v[40:43], v74, s[8:11], s26 offen offset:0 sc1
    v_perm_b32 v44, v12, v8, s69
    v_perm_b32 v45, v20, v16, s69
    v_perm_b32 v46, v28, v24, s69
    v_perm_b32 v47, v36, v32, s69
    buffer_store_dwordx4 v[44:47], v74, s[8:11], s26 offen offset:1024 sc1
    v_perm_b32 v48, v13, v9, s68
    v_perm_b32 v49, v21, v17, s68
    v_perm_b32 v50, v29, v25, s68
    v_perm_b32 v51, v37, v33, s68
    buffer_store_dwordx4 v[48:51], v74, s[8:11], s26 offen offset:2048 sc1
    v_perm_b32 v52, v13, v9, s69
    v_perm_b32 v53, v21, v17, s69
    v_perm_b32 v54, v29, v25, s69
    v_perm_b32 v55, v37, v33, s69
    buffer_store_dwordx4 v[52:55], v74, s[8:11], s26 offen offset:3072 sc1
    v_perm_b32 v56, v14, v10, s68
    v_perm_b32 v57, v22, v18, s68
    v_perm_b32 v58, v30, v26, s68
    v_perm_b32 v59, v38, v34, s68
    buffer_store_dwordx4 v[56:59], v75, s[8:11], s26 offen offset:0 sc1
    v_perm_b32 v60, v14, v10, s69
    v_perm_b32 v61, v22, v18, s69
    v_perm_b32 v62, v30, v26, s69
    v_perm_b32 v63, v38, v34, s69
    buffer_store_dwordx4 v[60:63], v75, s[8:11], s26 offen offset:1024 sc1
    v_perm_b32 v64, v15, v11, s68
    v_perm_b32 v65, v23, v19, s68
    v_perm_b32 v66, v31, v27, s68
    v_perm_b32 v67, v39, v35, s68
    buffer_store_dwordx4 v[64:67], v75, s[8:11], s26 offen offset:2048 sc1
    v_perm_b32 v68, v15, v11, s69
    v_perm_b32 v69, v23, v19, s69
    v_perm_b32 v70, v31, v27, s69
    v_perm_b32 v71, v39, v35, s69
    buffer_store_dwordx4 v[68:71], v75, s[8:11], s26 offen offset:3072 sc1
    s_add_u32 s30, s30, 1
    s_add_u32 s31, s31, 1
    s_cmp_lt_u32 s31, 4
    s_cbranch_scc1 Lpl_120
    s_branch Lpd_116
Lpn_119:
    s_cmp_lg_u32 s6, 2
    s_cbranch_scc1 Lpn_121
    s_mov_b32 s31, 0
Lpl_122:
    s_load_dwordx2 s[12:13], s[0:1], 72
    s_mul_hi_u32 s26, s30, 268435457
    s_mul_i32 s27, s26, 16
    s_sub_u32 s27, s30, s27
    v_and_b32 v72, 15, v1
    v_lshrrev_b32 v73, 4, v1
    v_mul_u32_u24 v74, 8192, v73
    v_lshl_add_u32 v74, v72, 4, v74
    s_lshl_b32 s26, s26, 8
    s_lshl_b32 s27, s27, 5
    s_mul_i32 s27, s27, 1024
    s_add_u32 s26, s26, s27
    s_waitcnt lgkmcnt(0)
    s_and_b32 s13, s13, 0xffff
    s_mov_b32 s14, 524288
    s_mov_b32 s15, 0x00020000
    s_add_u32 s27, s26, 0
    buffer_load_dwordx4 v[8:11], v74, s[12:15], s27 offen
    s_add_u32 s27, s26, 1024
    buffer_load_dwordx4 v[12:15], v74, s[12:15], s27 offen
    s_add_u32 s27, s26, 2048
    buffer_load_dwordx4 v[16:19], v74, s[12:15], s27 offen
    s_add_u32 s27, s26, 3072
    buffer_load_dwordx4 v[20:23], v74, s[12:15], s27 offen
    s_add_u32 s27, s26, 4096
    buffer_load_dwordx4 v[24:27], v74, s[12:15], s27 offen
    s_add_u32 s27, s26, 5120
    buffer_load_dwordx4 v[28:31], v74, s[12:15], s27 offen
    s_add_u32 s27, s26, 6144
    buffer_load_dwordx4 v[32:35], v74, s[12:15], s27 offen
    s_add_u32 s27, s26, 7168
    buffer_load_dwordx4 v[36:39], v74, s[12:15], s27 offen
    v_lshlrev_b32 v74, 4, v1
    v_add_u32 v75, 4096, v74
    s_lshl_b32 s26, s30, 13
    s_add_u32 s26, s26, 117964800
    s_waitcnt vmcnt(0)
    v_perm_b32 v40, v12, v8, s68
    v_perm_b32 v41, v20, v16, s68
    v_perm_b32 v42, v28, v24, s68
    v_perm_b32 v43, v36, v32, s68
    buffer_store_dwordx4 v[40:43], v74, s[8:11], s26 offen offset:0 sc1
    v_perm_b32 v44, v12, v8, s69
    v_perm_b32 v45, v20, v16, s69
    v_perm_b32 v46, v28, v24, s69
    v_perm_b32 v47, v36, v32, s69
    buffer_store_dwordx4 v[44:47], v74, s[8:11], s26 offen offset:1024 sc1
    v_perm_b32 v48, v13, v9, s68
    v_perm_b32 v49, v21, v17, s68
    v_perm_b32 v50, v29, v25, s68
    v_perm_b32 v51, v37, v33, s68
    buffer_store_dwordx4 v[48:51], v74, s[8:11], s26 offen offset:2048 sc1
    v_perm_b32 v52, v13, v9, s69
    v_perm_b32 v53, v21, v17, s69
    v_perm_b32 v54, v29, v25, s69
    v_perm_b32 v55, v37, v33, s69
    buffer_store_dwordx4 v[52:55], v74, s[8:11], s26 offen offset:3072 sc1
    v_perm_b32 v56, v14, v10, s68
    v_perm_b32 v57, v22, v18, s68
    v_perm_b32 v58, v30, v26, s68
    v_perm_b32 v59, v38, v34, s68
    buffer_store_dwordx4 v[56:59], v75, s[8:11], s26 offen offset:0 sc1
    v_perm_b32 v60, v14, v10, s69
    v_perm_b32 v61, v22, v18, s69
    v_perm_b32 v62, v30, v26, s69
    v_perm_b32 v63, v38, v34, s69
    buffer_store_dwordx4 v[60:63], v75, s[8:11], s26 offen offset:1024 sc1
    v_perm_b32 v64, v15, v11, s68
    v_perm_b32 v65, v23, v19, s68
    v_perm_b32 v66, v31, v27, s68
    v_perm_b32 v67, v39, v35, s68
    buffer_store_dwordx4 v[64:67], v75, s[8:11], s26 offen offset:2048 sc1
    v_perm_b32 v68, v15, v11, s69
    v_perm_b32 v69, v23, v19, s69
    v_perm_b32 v70, v31, v27, s69
    v_perm_b32 v71, v39, v35, s69
    buffer_store_dwordx4 v[68:71], v75, s[8:11], s26 offen offset:3072 sc1
    s_add_u32 s30, s30, 1
    s_add_u32 s31, s31, 1
    s_cmp_lt_u32 s31, 4
    s_cbranch_scc1 Lpl_122
    s_branch Lpd_116
Lpn_121:
    s_cmp_lg_u32 s6, 3
    s_cbranch_scc1 Lpn_123
    s_mov_b32 s31, 0
Lpl_124:
    s_load_dwordx2 s[12:13], s[0:1], 80
    s_mul_hi_u32 s26, s30, 268435457
    s_mul_i32 s27, s26, 16
    s_sub_u32 s27, s30, s27
    v_and_b32 v72, 15, v1
    v_lshrrev_b32 v73, 4, v1
    v_mul_u32_u24 v74, 28672, v73
    v_lshl_add_u32 v74, v72, 4, v74
    s_lshl_b32 s26, s26, 8
    s_lshl_b32 s27, s27, 5
    s_mul_i32 s27, s27, 3584
    s_add_u32 s26, s26, s27
    s_waitcnt lgkmcnt(0)
    s_and_b32 s13, s13, 0xffff
    s_mov_b32 s14, 1835008
    s_mov_b32 s15, 0x00020000
    s_add_u32 s27, s26, 0
    buffer_load_dwordx4 v[8:11], v74, s[12:15], s27 offen
    s_add_u32 s27, s26, 3584
    buffer_load_dwordx4 v[12:15], v74, s[12:15], s27 offen
    s_add_u32 s27, s26, 7168
    buffer_load_dwordx4 v[16:19], v74, s[12:15], s27 offen
    s_add_u32 s27, s26, 10752
    buffer_load_dwordx4 v[20:23], v74, s[12:15], s27 offen
    s_add_u32 s27, s26, 14336
    buffer_load_dwordx4 v[24:27], v74, s[12:15], s27 offen
    s_add_u32 s27, s26, 17920
    buffer_load_dwordx4 v[28:31], v74, s[12:15], s27 offen
    s_add_u32 s27, s26, 21504
    buffer_load_dwordx4 v[32:35], v74, s[12:15], s27 offen
    s_add_u32 s27, s26, 25088
    buffer_load_dwordx4 v[36:39], v74, s[12:15], s27 offen
    v_lshlrev_b32 v74, 4, v1
    v_add_u32 v75, 4096, v74
    s_lshl_b32 s26, s30, 13
    s_add_u32 s26, s26, 118489088
    s_waitcnt vmcnt(0)
    v_perm_b32 v40, v12, v8, s68
    v_perm_b32 v41, v20, v16, s68
    v_perm_b32 v42, v28, v24, s68
    v_perm_b32 v43, v36, v32, s68
    buffer_store_dwordx4 v[40:43], v74, s[8:11], s26 offen offset:0 sc1
    v_perm_b32 v44, v12, v8, s69
    v_perm_b32 v45, v20, v16, s69
    v_perm_b32 v46, v28, v24, s69
    v_perm_b32 v47, v36, v32, s69
    buffer_store_dwordx4 v[44:47], v74, s[8:11], s26 offen offset:1024 sc1
    v_perm_b32 v48, v13, v9, s68
    v_perm_b32 v49, v21, v17, s68
    v_perm_b32 v50, v29, v25, s68
    v_perm_b32 v51, v37, v33, s68
    buffer_store_dwordx4 v[48:51], v74, s[8:11], s26 offen offset:2048 sc1
    v_perm_b32 v52, v13, v9, s69
    v_perm_b32 v53, v21, v17, s69
    v_perm_b32 v54, v29, v25, s69
    v_perm_b32 v55, v37, v33, s69
    buffer_store_dwordx4 v[52:55], v74, s[8:11], s26 offen offset:3072 sc1
    v_perm_b32 v56, v14, v10, s68
    v_perm_b32 v57, v22, v18, s68
    v_perm_b32 v58, v30, v26, s68
    v_perm_b32 v59, v38, v34, s68
    buffer_store_dwordx4 v[56:59], v75, s[8:11], s26 offen offset:0 sc1
    v_perm_b32 v60, v14, v10, s69
    v_perm_b32 v61, v22, v18, s69
    v_perm_b32 v62, v30, v26, s69
    v_perm_b32 v63, v38, v34, s69
    buffer_store_dwordx4 v[60:63], v75, s[8:11], s26 offen offset:1024 sc1
    v_perm_b32 v64, v15, v11, s68
    v_perm_b32 v65, v23, v19, s68
    v_perm_b32 v66, v31, v27, s68
    v_perm_b32 v67, v39, v35, s68
    buffer_store_dwordx4 v[64:67], v75, s[8:11], s26 offen offset:2048 sc1
    v_perm_b32 v68, v15, v11, s69
    v_perm_b32 v69, v23, v19, s69
    v_perm_b32 v70, v31, v27, s69
    v_perm_b32 v71, v39, v35, s69
    buffer_store_dwordx4 v[68:71], v75, s[8:11], s26 offen offset:3072 sc1
    s_add_u32 s30, s30, 1
    s_add_u32 s31, s31, 1
    s_cmp_lt_u32 s31, 4
    s_cbranch_scc1 Lpl_124
    s_branch Lpd_116
Lpn_123:
    s_mov_b32 s31, 0
Lpl_126:
    s_load_dwordx2 s[12:13], s[0:1], 88
    s_mul_hi_u32 s26, s30, 76695845
    s_mul_i32 s27, s26, 56
    s_sub_u32 s27, s30, s27
    v_and_b32 v72, 15, v1
    v_lshrrev_b32 v73, 4, v1
    v_mul_u32_u24 v74, 8192, v73
    v_lshl_add_u32 v74, v72, 4, v74
    s_lshl_b32 s26, s26, 8
    s_lshl_b32 s27, s27, 5
    s_mul_i32 s27, s27, 1024
    s_add_u32 s26, s26, s27
    s_waitcnt lgkmcnt(0)
    s_and_b32 s13, s13, 0xffff
    s_mov_b32 s14, 1835008
    s_mov_b32 s15, 0x00020000
    s_add_u32 s27, s26, 0
    buffer_load_dwordx4 v[8:11], v74, s[12:15], s27 offen
    s_add_u32 s27, s26, 1024
    buffer_load_dwordx4 v[12:15], v74, s[12:15], s27 offen
    s_add_u32 s27, s26, 2048
    buffer_load_dwordx4 v[16:19], v74, s[12:15], s27 offen
    s_add_u32 s27, s26, 3072
    buffer_load_dwordx4 v[20:23], v74, s[12:15], s27 offen
    s_add_u32 s27, s26, 4096
    buffer_load_dwordx4 v[24:27], v74, s[12:15], s27 offen
    s_add_u32 s27, s26, 5120
    buffer_load_dwordx4 v[28:31], v74, s[12:15], s27 offen
    s_add_u32 s27, s26, 6144
    buffer_load_dwordx4 v[32:35], v74, s[12:15], s27 offen
    s_add_u32 s27, s26, 7168
    buffer_load_dwordx4 v[36:39], v74, s[12:15], s27 offen
    v_lshlrev_b32 v74, 4, v1
    v_add_u32 v75, 4096, v74
    s_lshl_b32 s26, s30, 13
    s_add_u32 s26, s26, 120586240
    s_waitcnt vmcnt(0)
    v_perm_b32 v40, v12, v8, s68
    v_perm_b32 v41, v20, v16, s68
    v_perm_b32 v42, v28, v24, s68
    v_perm_b32 v43, v36, v32, s68
    buffer_store_dwordx4 v[40:43], v74, s[8:11], s26 offen offset:0 sc1
    v_perm_b32 v44, v12, v8, s69
    v_perm_b32 v45, v20, v16, s69
    v_perm_b32 v46, v28, v24, s69
    v_perm_b32 v47, v36, v32, s69
    buffer_store_dwordx4 v[44:47], v74, s[8:11], s26 offen offset:1024 sc1
    v_perm_b32 v48, v13, v9, s68
    v_perm_b32 v49, v21, v17, s68
    v_perm_b32 v50, v29, v25, s68
    v_perm_b32 v51, v37, v33, s68
    buffer_store_dwordx4 v[48:51], v74, s[8:11], s26 offen offset:2048 sc1
    v_perm_b32 v52, v13, v9, s69
    v_perm_b32 v53, v21, v17, s69
    v_perm_b32 v54, v29, v25, s69
    v_perm_b32 v55, v37, v33, s69
    buffer_store_dwordx4 v[52:55], v74, s[8:11], s26 offen offset:3072 sc1
    v_perm_b32 v56, v14, v10, s68
    v_perm_b32 v57, v22, v18, s68
    v_perm_b32 v58, v30, v26, s68
    v_perm_b32 v59, v38, v34, s68
    buffer_store_dwordx4 v[56:59], v75, s[8:11], s26 offen offset:0 sc1
    v_perm_b32 v60, v14, v10, s69
    v_perm_b32 v61, v22, v18, s69
    v_perm_b32 v62, v30, v26, s69
    v_perm_b32 v63, v38, v34, s69
    buffer_store_dwordx4 v[60:63], v75, s[8:11], s26 offen offset:1024 sc1
    v_perm_b32 v64, v15, v11, s68
    v_perm_b32 v65, v23, v19, s68
    v_perm_b32 v66, v31, v27, s68
    v_perm_b32 v67, v39, v35, s68
    buffer_store_dwordx4 v[64:67], v75, s[8:11], s26 offen offset:2048 sc1
    v_perm_b32 v68, v15, v11, s69
    v_perm_b32 v69, v23, v19, s69
    v_perm_b32 v70, v31, v27, s69
    v_perm_b32 v71, v39, v35, s69
    buffer_store_dwordx4 v[68:71], v75, s[8:11], s26 offen offset:3072 sc1
    s_add_u32 s30, s30, 1
    s_add_u32 s31, s31, 1
    s_cmp_lt_u32 s31, 4
    s_cbranch_scc1 Lpl_126
Lpd_116:
    s_lshl_b32 s26, s5, 7
    s_add_u32 s26, s26, 159776768
    s_waitcnt vmcnt(0) lgkmcnt(0)
    s_barrier
    s_cmp_lg_u32 s19, 0
    s_cbranch_scc1 Lsig_127
    v_mov_b64 v[8:9], s[62:63]
    v_mov_b64 v[10:11], s[62:63]
    s_mov_b64 exec, 0xff
    buffer_store_dwordx4 v[8:11], v4, s[8:11], s26 offen sc1
    s_mov_b64 exec, -1
    s_nop 0
Lsig_127:
    s_branch Lnext_92
Lh_99:
    s_lshl_b32 s12, s6, 2
    s_add_u32 s12, s12, s19
Lst_128:
    s_lshl_b32 s24, s5, 5
    s_lshl_b32 s24, s24, 7
    s_add_u32 s24, s24, 147062784
    v_mov_b32 v10, 0
    s_cmp_lg_u32 s19, 0
    s_nop 0
    s_cbranch_scc1 Lco_129
Lw_130:
    buffer_load_dwordx2 v[12:13], v10, s[8:11], s24 offen sc1
    s_waitcnt vmcnt(0)
    v_cmp_ne_u64 vcc, s[62:63], v[12:13]
    s_nop 4
    s_cbranch_vccz Lwd_131
    s_sleep 16
    s_sub_u32 s21, s21, 1
    s_cbranch_scc0 Lw_130
    s_mov_b32 s21, 0
Lwd_131:
Lco_129:
    s_barrier
    s_lshr_b32 s13, s5, 3
    s_lshl_b32 s13, s13, 5
    s_add_u32 s13, s13, s12
    s_lshl_b32 s13, s13, 10
    s_add_u32 s13, s13, 159449088
    s_lshl_b32 s14, s5, 5
    s_add_u32 s14, s14, s12
    s_lshl_b32 s14, s14, 7
    s_add_u32 s14, s14, 147066880
    v_min_u32 v8, 4, v1
    v_mul_u32_u24 v8, 128, v8
    s_nop 1
Lw_132:
    buffer_load_dwordx2 v[10:11], v8, s[8:11], s13 offen sc1
    s_waitcnt vmcnt(0)
    v_cmp_ne_u64 vcc, s[62:63], v[10:11]
    s_nop 4
    s_cbranch_vccz Lwd_133
    s_sleep 2
    s_sub_u32 s21, s21, 1
    s_cbranch_scc0 Lw_132
    s_mov_b32 s21, 0
Lwd_133:
    v_add_u32 v161, 4096, v4
    s_lshl_b32 s24, s5, 18
    s_lshl_b32 s25, s12, 13
    s_add_u32 s24, s24, s25
    s_add_u32 s24, s24, 4194304
    s_lshl_b32 s25, s12, 6
    s_add_u32 s25, s25, s5
    s_lshl_b32 s26, s25, 13
    s_add_u32 s26, s26, 54525952
    s_lshl_b32 s25, s25, 14
    s_add_u32 s25, s25, 20971520
    buffer_load_dwordx4 v[8:11], v4, s[8:11], s24 offen offset:0 sc1
    buffer_load_dwordx4 v[12:15], v4, s[8:11], s24 offen offset:1024 sc1
    buffer_load_dwordx4 v[16:19], v4, s[8:11], s24 offen offset:2048 sc1
    buffer_load_dwordx4 v[20:23], v4, s[8:11], s24 offen offset:3072 sc1
    buffer_load_dwordx4 v[24:27], v161, s[8:11], s24 offen offset:0 sc1
    buffer_load_dwordx4 v[28:31], v161, s[8:11], s24 offen offset:1024 sc1
    buffer_load_dwordx4 v[32:35], v161, s[8:11], s24 offen offset:2048 sc1
    buffer_load_dwordx4 v[36:39], v161, s[8:11], s24 offen offset:3072 sc1
    buffer_load_dwordx4 v[40:43], v4, s[8:11], s25 offen offset:0 sc1
    buffer_load_dwordx4 v[44:47], v4, s[8:11], s25 offen offset:1024 sc1
    buffer_load_dwordx4 v[48:51], v4, s[8:11], s25 offen offset:2048 sc1
    buffer_load_dwordx4 v[52:55], v4, s[8:11], s25 offen offset:3072 sc1
    buffer_load_dwordx4 v[56:59], v161, s[8:11], s25 offen offset:0 sc1
    buffer_load_dwordx4 v[60:63], v161, s[8:11], s25 offen offset:1024 sc1
    buffer_load_dwordx4 v[64:67], v161, s[8:11], s25 offen offset:2048 sc1
    buffer_load_dwordx4 v[68:71], v161, s[8:11], s25 offen offset:3072 sc1
    s_add_u32 s25, s25, 8192
    buffer_load_dwordx4 v[88:91], v4, s[8:11], s25 offen offset:0 sc1
    buffer_load_dwordx4 v[92:95], v4, s[8:11], s25 offen offset:1024 sc1
    buffer_load_dwordx4 v[96:99], v4, s[8:11], s25 offen offset:2048 sc1
    buffer_load_dwordx4 v[100:103], v4, s[8:11], s25 offen offset:3072 sc1
    buffer_load_dwordx4 v[104:107], v161, s[8:11], s25 offen offset:0 sc1
    buffer_load_dwordx4 v[108:111], v161, s[8:11], s25 offen offset:1024 sc1
    buffer_load_dwordx4 v[112:115], v161, s[8:11], s25 offen offset:2048 sc1
    buffer_load_dwordx4 v[116:119], v161, s[8:11], s25 offen offset:3072 sc1
    v_mov_b32 v200, 0
    s_nop 1
Lw_134:
    buffer_load_dwordx2 v[202:203], v200, s[8:11], s14 offen sc1
    s_waitcnt vmcnt(0)
    v_cmp_ne_u64 vcc, s[62:63], v[202:203]
    s_nop 4
    s_cbranch_vccz Lwd_135
    s_sleep 2
    s_sub_u32 s21, s21, 1
    s_cbranch_scc0 Lw_134
    s_mov_b32 s21, 0
Lwd_135:
    buffer_load_dwordx4 v[72:75], v4, s[8:11], s26 offen offset:0 sc1
    buffer_load_dwordx4 v[76:79], v4, s[8:11], s26 offen offset:1024 sc1
    buffer_load_dwordx4 v[80:83], v4, s[8:11], s26 offen offset:2048 sc1
    buffer_load_dwordx4 v[84:87], v4, s[8:11], s26 offen offset:3072 sc1
    v_lshrrev_b32 v128, 1, v4
    s_lshl_b32 s25, s12, 18
    s_lshl_b32 s27, s5, 11
    s_add_u32 s25, s25, s27
    s_add_u32 s25, s25, 150994944
    buffer_load_dwordx2 v[120:121], v128, s[8:11], s25 offen offset:0 sc1
    buffer_load_dwordx2 v[122:123], v128, s[8:11], s25 offen offset:512 sc1
    buffer_load_dwordx2 v[124:125], v128, s[8:11], s25 offen offset:1024 sc1
    buffer_load_dwordx2 v[126:127], v128, s[8:11], s25 offen offset:1536 sc1
    s_mov_b32 s28, 0x3e0293ee
    s_mov_b32 s29, 0x3e0293ee
    v_mov_b32 v148, 0x3f803f80
    v_mov_b32 v149, 0x3f803f80
    v_mov_b32 v150, 0x3f803f80
    v_mov_b32 v151, 0x3f803f80
    v_mov_b32 v152, 0
    v_mov_b32 v153, 0
    v_mov_b32 v160, 0xf149f2ca
    v_lshlrev_b32 v154, 2, v3
    v_add_u32 v155, 0, v154
    v_cmp_le_u32 s[30:31], v155, v2
    v_add_u32 v155, 1, v154
    v_cmp_le_u32 s[32:33], v155, v2
    v_add_u32 v155, 2, v154
    v_cmp_le_u32 s[34:35], v155, v2
    v_add_u32 v155, 3, v154
    v_cmp_le_u32 s[36:37], v155, v2
    s_lshl_b32 s24, s5, 18
    s_lshl_b32 s26, s12, 12
    s_add_u32 s24, s24, s26
    s_add_u32 s24, s24, 75497472
    s_waitcnt vmcnt(4)
    v_mfma_f32_16x16x32_bf16 v[136:139], v[40:43], v[8:11], 0
    v_mfma_f32_16x16x32_bf16 v[144:147], v[72:75], v[8:11], 0
    v_mfma_f32_16x16x32_bf16 v[136:139], v[44:47], v[12:15], v[136:139]
    v_mfma_f32_16x16x32_bf16 v[144:147], v[76:79], v[12:15], v[144:147]
    v_mfma_f32_16x16x32_bf16 v[136:139], v[48:51], v[16:19], v[136:139]
    v_mfma_f32_16x16x32_bf16 v[144:147], v[80:83], v[16:19], v[144:147]
    v_mfma_f32_16x16x32_bf16 v[136:139], v[52:55], v[20:23], v[136:139]
    v_mfma_f32_16x16x32_bf16 v[144:147], v[84:87], v[20:23], v[144:147]
    s_nop 6
    v_cndmask_b32 v136, v160, v136, s[30:31]
    v_cndmask_b32 v137, v160, v137, s[32:33]
    v_cndmask_b32 v138, v160, v138, s[34:35]
    v_cndmask_b32 v139, v160, v139, s[36:37]
    v_max3_f32 v154, v136, v137, v138
    v_max3_f32 v154, v154, v139, v144
    v_max3_f32 v154, v154, v145, v146
    v_max_f32 v154, v154, v147
    v_mov_b32 v155, v154
    s_nop 1
    v_permlane16_swap_b32 v154, v155
    v_max_f32 v154, v154, v155
    v_mov_b32 v155, v154
    s_nop 1
    v_permlane32_swap_b32 v154, v155
    v_max_f32 v154, v154, v155
    v_mul_f32 v154, s28, v154
    v_pk_fma_f32 v[136:137], v[136:137], s[28:29], v[154:155] op_sel_hi:[1,0,0] neg_lo:[0,0,1] neg_hi:[0,0,1]
    v_pk_fma_f32 v[138:139], v[138:139], s[28:29], v[154:155] op_sel_hi:[1,0,0] neg_lo:[0,0,1] neg_hi:[0,0,1]
    v_pk_fma_f32 v[144:145], v[144:145], s[28:29], v[154:155] op_sel_hi:[1,0,0] neg_lo:[0,0,1] neg_hi:[0,0,1]
    v_pk_fma_f32 v[146:147], v[146:147], s[28:29], v[154:155] op_sel_hi:[1,0,0] neg_lo:[0,0,1] neg_hi:[0,0,1]
    v_exp_f32 v136, v136
    v_exp_f32 v137, v137
    v_exp_f32 v138, v138
    v_exp_f32 v139, v139
    v_exp_f32 v144, v144
    v_exp_f32 v145, v145
    v_exp_f32 v146, v146
    v_exp_f32 v147, v147
    v_cvt_pk_bf16_f32 v136, v136, v137
    v_cvt_pk_bf16_f32 v137, v138, v139
    v_cvt_pk_bf16_f32 v144, v144, v145
    v_cvt_pk_bf16_f32 v145, v146, v147
    v_mfma_f32_16x16x16_bf16 v[156:159], v[148:149], v[136:137], 0
    s_waitcnt vmcnt(0)
    v_mfma_f32_16x16x16_bf16 v[164:167], v[88:89], v[136:137], 0
    v_mfma_f32_16x16x16_bf16 v[168:171], v[92:93], v[136:137], 0
    v_mfma_f32_16x16x16_bf16 v[172:175], v[96:97], v[136:137], 0
    v_mfma_f32_16x16x16_bf16 v[176:179], v[100:101], v[136:137], 0
    v_mfma_f32_16x16x16_bf16 v[180:183], v[104:105], v[136:137], 0
    v_mfma_f32_16x16x16_bf16 v[184:187], v[108:109], v[136:137], 0
    v_mfma_f32_16x16x16_bf16 v[188:191], v[112:113], v[136:137], 0
    v_mfma_f32_16x16x16_bf16 v[192:195], v[116:117], v[136:137], 0
    s_mov_b32 exec_hi, 0
    v_mov_b64 v[152:153], v[144:145]
    v_mov_b64 v[144:145], 0
    s_mov_b32 exec_hi, -1
    v_mfma_f32_16x16x16_bf16 v[156:159], v[148:149], v[152:153], v[156:159]
    v_mfma_f32_16x16x16_bf16 v[164:167], v[120:121], v[152:153], v[164:167]
    v_mfma_f32_16x16x16_bf16 v[168:171], v[120:121], v[144:145], v[168:171]
    v_mfma_f32_16x16x16_bf16 v[172:175], v[122:123], v[152:153], v[172:175]
    v_mfma_f32_16x16x16_bf16 v[176:179], v[122:123], v[144:145], v[176:179]
    v_mfma_f32_16x16x16_bf16 v[180:183], v[124:125], v[152:153], v[180:183]
    v_mfma_f32_16x16x16_bf16 v[184:187], v[124:125], v[144:145], v[184:187]
    v_mfma_f32_16x16x16_bf16 v[188:191], v[126:127], v[152:153], v[188:191]
    v_mfma_f32_16x16x16_bf16 v[192:195], v[126:127], v[144:145], v[192:195]
    v_rcp_f32 v154, v156
    s_nop 0
    v_pk_mul_f32 v[164:165], v[164:165], v[154:155] op_sel_hi:[1,0]
    v_pk_mul_f32 v[166:167], v[166:167], v[154:155] op_sel_hi:[1,0]
    v_pk_mul_f32 v[168:169], v[168:169], v[154:155] op_sel_hi:[1,0]
    v_pk_mul_f32 v[170:171], v[170:171], v[154:155] op_sel_hi:[1,0]
    v_cvt_pk_bf16_f32 v164, v164, v168
    v_cvt_pk_bf16_f32 v165, v165, v169
    v_cvt_pk_bf16_f32 v166, v166, v170
    v_cvt_pk_bf16_f32 v167, v167, v171
    buffer_store_dwordx4 v[164:167], v4, s[8:11], s24 offen offset:0 sc1
    v_pk_mul_f32 v[172:173], v[172:173], v[154:155] op_sel_hi:[1,0]
    v_pk_mul_f32 v[174:175], v[174:175], v[154:155] op_sel_hi:[1,0]
    v_pk_mul_f32 v[176:177], v[176:177], v[154:155] op_sel_hi:[1,0]
    v_pk_mul_f32 v[178:179], v[178:179], v[154:155] op_sel_hi:[1,0]
    v_cvt_pk_bf16_f32 v172, v172, v176
    v_cvt_pk_bf16_f32 v173, v173, v177
    v_cvt_pk_bf16_f32 v174, v174, v178
    v_cvt_pk_bf16_f32 v175, v175, v179
    buffer_store_dwordx4 v[172:175], v4, s[8:11], s24 offen offset:1024 sc1
    v_pk_mul_f32 v[180:181], v[180:181], v[154:155] op_sel_hi:[1,0]
    v_pk_mul_f32 v[182:183], v[182:183], v[154:155] op_sel_hi:[1,0]
    v_pk_mul_f32 v[184:185], v[184:185], v[154:155] op_sel_hi:[1,0]
    v_pk_mul_f32 v[186:187], v[186:187], v[154:155] op_sel_hi:[1,0]
    v_cvt_pk_bf16_f32 v180, v180, v184
    v_cvt_pk_bf16_f32 v181, v181, v185
    v_cvt_pk_bf16_f32 v182, v182, v186
    v_cvt_pk_bf16_f32 v183, v183, v187
    buffer_store_dwordx4 v[180:183], v4, s[8:11], s24 offen offset:2048 sc1
    v_pk_mul_f32 v[188:189], v[188:189], v[154:155] op_sel_hi:[1,0]
    v_pk_mul_f32 v[190:191], v[190:191], v[154:155] op_sel_hi:[1,0]
    v_pk_mul_f32 v[192:193], v[192:193], v[154:155] op_sel_hi:[1,0]
    v_pk_mul_f32 v[194:195], v[194:195], v[154:155] op_sel_hi:[1,0]
    v_cvt_pk_bf16_f32 v188, v188, v192
    v_cvt_pk_bf16_f32 v189, v189, v193
    v_cvt_pk_bf16_f32 v190, v190, v194
    v_cvt_pk_bf16_f32 v191, v191, v195
    buffer_store_dwordx4 v[188:191], v4, s[8:11], s24 offen offset:3072 sc1
    s_add_u32 s24, s24, 131072
    v_mfma_f32_16x16x32_bf16 v[136:139], v[40:43], v[24:27], 0
    v_mfma_f32_16x16x32_bf16 v[140:143], v[56:59], v[24:27], 0
    v_mfma_f32_16x16x32_bf16 v[144:147], v[72:75], v[24:27], 0
    v_mfma_f32_16x16x32_bf16 v[136:139], v[44:47], v[28:31], v[136:139]
    v_mfma_f32_16x16x32_bf16 v[140:143], v[60:63], v[28:31], v[140:143]
    v_mfma_f32_16x16x32_bf16 v[144:147], v[76:79], v[28:31], v[144:147]
    v_mfma_f32_16x16x32_bf16 v[136:139], v[48:51], v[32:35], v[136:139]
    v_mfma_f32_16x16x32_bf16 v[140:143], v[64:67], v[32:35], v[140:143]
    v_mfma_f32_16x16x32_bf16 v[144:147], v[80:83], v[32:35], v[144:147]
    v_mfma_f32_16x16x32_bf16 v[136:139], v[52:55], v[36:39], v[136:139]
    v_mfma_f32_16x16x32_bf16 v[140:143], v[68:71], v[36:39], v[140:143]
    v_mfma_f32_16x16x32_bf16 v[144:147], v[84:87], v[36:39], v[144:147]
    s_nop 6
    v_cndmask_b32 v140, v160, v140, s[30:31]
    v_cndmask_b32 v141, v160, v141, s[32:33]
    v_cndmask_b32 v142, v160, v142, s[34:35]
    v_cndmask_b32 v143, v160, v143, s[36:37]
    v_max3_f32 v154, v136, v137, v138
    v_max3_f32 v154, v154, v139, v140
    v_max3_f32 v154, v154, v141, v142
    v_max3_f32 v154, v154, v143, v144
    v_max3_f32 v154, v154, v145, v146
    v_max_f32 v154, v154, v147
    v_mov_b32 v155, v154
    s_nop 1
    v_permlane16_swap_b32 v154, v155
    v_max_f32 v154, v154, v155
    v_mov_b32 v155, v154
    s_nop 1
    v_permlane32_swap_b32 v154, v155
    v_max_f32 v154, v154, v155
    v_mul_f32 v154, s28, v154
    v_pk_fma_f32 v[136:137], v[136:137], s[28:29], v[154:155] op_sel_hi:[1,0,0] neg_lo:[0,0,1] neg_hi:[0,0,1]
    v_pk_fma_f32 v[138:139], v[138:139], s[28:29], v[154:155] op_sel_hi:[1,0,0] neg_lo:[0,0,1] neg_hi:[0,0,1]
    v_pk_fma_f32 v[140:141], v[140:141], s[28:29], v[154:155] op_sel_hi:[1,0,0] neg_lo:[0,0,1] neg_hi:[0,0,1]
    v_pk_fma_f32 v[142:143], v[142:143], s[28:29], v[154:155] op_sel_hi:[1,0,0] neg_lo:[0,0,1] neg_hi:[0,0,1]
    v_pk_fma_f32 v[144:145], v[144:145], s[28:29], v[154:155] op_sel_hi:[1,0,0] neg_lo:[0,0,1] neg_hi:[0,0,1]
    v_pk_fma_f32 v[146:147], v[146:147], s[28:29], v[154:155] op_sel_hi:[1,0,0] neg_lo:[0,0,1] neg_hi:[0,0,1]
    v_exp_f32 v136, v136
    v_exp_f32 v137, v137
    v_exp_f32 v138, v138
    v_exp_f32 v139, v139
    v_exp_f32 v140, v140
    v_exp_f32 v141, v141
    v_exp_f32 v142, v142
    v_exp_f32 v143, v143
    v_exp_f32 v144, v144
    v_exp_f32 v145, v145
    v_exp_f32 v146, v146
    v_exp_f32 v147, v147
    v_cvt_pk_bf16_f32 v136, v136, v137
    v_cvt_pk_bf16_f32 v137, v138, v139
    v_cvt_pk_bf16_f32 v138, v140, v141
    v_cvt_pk_bf16_f32 v139, v142, v143
    v_cvt_pk_bf16_f32 v144, v144, v145
    v_cvt_pk_bf16_f32 v145, v146, v147
    v_mfma_f32_16x16x32_bf16 v[156:159], v[148:151], v[136:139], 0
    v_mfma_f32_16x16x32_bf16 v[164:167], v[88:91], v[136:139], 0
    v_mfma_f32_16x16x32_bf16 v[168:171], v[92:95], v[136:139], 0
    v_mfma_f32_16x16x32_bf16 v[172:175], v[96:99], v[136:139], 0
    v_mfma_f32_16x16x32_bf16 v[176:179], v[100:103], v[136:139], 0
    v_mfma_f32_16x16x32_bf16 v[180:183], v[104:107], v[136:139], 0
    v_mfma_f32_16x16x32_bf16 v[184:187], v[108:111], v[136:139], 0
    v_mfma_f32_16x16x32_bf16 v[188:191], v[112:115], v[136:139], 0
    v_mfma_f32_16x16x32_bf16 v[192:195], v[116:119], v[136:139], 0
    s_mov_b32 exec_hi, 0
    v_mov_b64 v[152:153], v[144:145]
    v_mov_b64 v[144:145], 0
    s_mov_b32 exec_hi, -1
    v_mfma_f32_16x16x16_bf16 v[156:159], v[148:149], v[152:153], v[156:159]
    v_mfma_f32_16x16x16_bf16 v[164:167], v[120:121], v[152:153], v[164:167]
    v_mfma_f32_16x16x16_bf16 v[168:171], v[120:121], v[144:145], v[168:171]
    v_mfma_f32_16x16x16_bf16 v[172:175], v[122:123], v[152:153], v[172:175]
    v_mfma_f32_16x16x16_bf16 v[176:179], v[122:123], v[144:145], v[176:179]
    v_mfma_f32_16x16x16_bf16 v[180:183], v[124:125], v[152:153], v[180:183]
    v_mfma_f32_16x16x16_bf16 v[184:187], v[124:125], v[144:145], v[184:187]
    v_mfma_f32_16x16x16_bf16 v[188:191], v[126:127], v[152:153], v[188:191]
    v_mfma_f32_16x16x16_bf16 v[192:195], v[126:127], v[144:145], v[192:195]
    v_rcp_f32 v154, v156
    s_nop 0
    v_pk_mul_f32 v[164:165], v[164:165], v[154:155] op_sel_hi:[1,0]
    v_pk_mul_f32 v[166:167], v[166:167], v[154:155] op_sel_hi:[1,0]
    v_pk_mul_f32 v[168:169], v[168:169], v[154:155] op_sel_hi:[1,0]
    v_pk_mul_f32 v[170:171], v[170:171], v[154:155] op_sel_hi:[1,0]
    v_cvt_pk_bf16_f32 v164, v164, v168
    v_cvt_pk_bf16_f32 v165, v165, v169
    v_cvt_pk_bf16_f32 v166, v166, v170
    v_cvt_pk_bf16_f32 v167, v167, v171
    buffer_store_dwordx4 v[164:167], v4, s[8:11], s24 offen offset:0 sc1
    v_pk_mul_f32 v[172:173], v[172:173], v[154:155] op_sel_hi:[1,0]
    v_pk_mul_f32 v[174:175], v[174:175], v[154:155] op_sel_hi:[1,0]
    v_pk_mul_f32 v[176:177], v[176:177], v[154:155] op_sel_hi:[1,0]
    v_pk_mul_f32 v[178:179], v[178:179], v[154:155] op_sel_hi:[1,0]
    v_cvt_pk_bf16_f32 v172, v172, v176
    v_cvt_pk_bf16_f32 v173, v173, v177
    v_cvt_pk_bf16_f32 v174, v174, v178
    v_cvt_pk_bf16_f32 v175, v175, v179
    buffer_store_dwordx4 v[172:175], v4, s[8:11], s24 offen offset:1024 sc1
    v_pk_mul_f32 v[180:181], v[180:181], v[154:155] op_sel_hi:[1,0]
    v_pk_mul_f32 v[182:183], v[182:183], v[154:155] op_sel_hi:[1,0]
    v_pk_mul_f32 v[184:185], v[184:185], v[154:155] op_sel_hi:[1,0]
    v_pk_mul_f32 v[186:187], v[186:187], v[154:155] op_sel_hi:[1,0]
    v_cvt_pk_bf16_f32 v180, v180, v184
    v_cvt_pk_bf16_f32 v181, v181, v185
    v_cvt_pk_bf16_f32 v182, v182, v186
    v_cvt_pk_bf16_f32 v183, v183, v187
    buffer_store_dwordx4 v[180:183], v4, s[8:11], s24 offen offset:2048 sc1
    v_pk_mul_f32 v[188:189], v[188:189], v[154:155] op_sel_hi:[1,0]
    v_pk_mul_f32 v[190:191], v[190:191], v[154:155] op_sel_hi:[1,0]
    v_pk_mul_f32 v[192:193], v[192:193], v[154:155] op_sel_hi:[1,0]
    v_pk_mul_f32 v[194:195], v[194:195], v[154:155] op_sel_hi:[1,0]
    v_cvt_pk_bf16_f32 v188, v188, v192
    v_cvt_pk_bf16_f32 v189, v189, v193
    v_cvt_pk_bf16_f32 v190, v190, v194
    v_cvt_pk_bf16_f32 v191, v191, v195
    buffer_store_dwordx4 v[188:191], v4, s[8:11], s24 offen offset:3072 sc1
    s_lshl_b32 s24, s5, 3
    s_add_u32 s24, s24, s6
    s_lshl_b32 s24, s24, 7
    s_add_u32 s24, s24, 159842304
    s_waitcnt vmcnt(0) lgkmcnt(0)
    s_barrier
    s_cmp_lg_u32 s19, 0
    s_cbranch_scc1 Lsig_136
    v_mov_b64 v[8:9], s[62:63]
    v_mov_b64 v[10:11], s[62:63]
    s_mov_b64 exec, 0xff
    buffer_store_dwordx4 v[8:11], v4, s[8:11], s24 offen sc1
    s_mov_b64 exec, -1
    s_nop 0
Lsig_136:
    s_add_u32 s5, s5, 4
    s_cmp_lt_u32 s5, 64
    s_cbranch_scc1 Lst_128
    s_branch Lnext_92
Lh_100:
    s_cmp_lg_u32 s64, 0
    s_cbranch_scc1 Lpk_137
    s_mov_b32 s24, 159776768
    v_min_u32 v8, 63, v1
    v_mul_u32_u24 v8, 128, v8
    s_nop 1
Lw_138:
    buffer_load_dwordx2 v[10:11], v8, s[8:11], s24 offen sc1
    s_waitcnt vmcnt(0)
    v_cmp_ne_u64 vcc, s[62:63], v[10:11]
    s_nop 4
    s_cbranch_vccz Lwd_139
    s_sleep 2
    s_sub_u32 s21, s21, 1
    s_cbranch_scc0 Lw_138
    s_mov_b32 s21, 0
Lwd_139:
    s_mov_b32 s24, 159784960
    v_min_u32 v8, 3, v1
    v_mul_u32_u24 v8, 128, v8
    s_nop 1
Lw_140:
    buffer_load_dwordx2 v[10:11], v8, s[8:11], s24 offen sc1
    s_waitcnt vmcnt(0)
    v_cmp_ne_u64 vcc, s[62:63], v[10:11]
    s_nop 4
    s_cbranch_vccz Lwd_141
    s_sleep 2
    s_sub_u32 s21, s21, 1
    s_cbranch_scc0 Lw_140
    s_mov_b32 s21, 0
Lwd_141:
    s_mov_b32 s64, 1
Lpk_137:
    s_lshl_b32 s12, s7, 2
    s_add_u32 s12, s12, s19
    s_lshl_b32 s13, s6, 20
    s_lshl_b32 s14, s12, 16
    s_add_u32 s13, s13, s14
    s_add_u32 s13, s13, 113246208
    buffer_load_dwordx4 a[0:3], v4, s[8:11], s13 offen offset:0 sc1
    buffer_load_dwordx4 a[4:7], v4, s[8:11], s13 offen offset:1024 sc1
    buffer_load_dwordx4 a[8:11], v4, s[8:11], s13 offen offset:2048 sc1
    buffer_load_dwordx4 a[12:15], v4, s[8:11], s13 offen offset:3072 sc1
    buffer_load_dwordx4 a[16:19], v5, s[8:11], s13 offen offset:0 sc1
    buffer_load_dwordx4 a[20:23], v5, s[8:11], s13 offen offset:1024 sc1
    buffer_load_dwordx4 a[24:27], v5, s[8:11], s13 offen offset:2048 sc1
    buffer_load_dwordx4 a[28:31], v5, s[8:11], s13 offen offset:3072 sc1
    s_add_u32 s13, s13, 8192
    buffer_load_dwordx4 a[32:35], v4, s[8:11], s13 offen offset:0 sc1
    buffer_load_dwordx4 a[36:39], v4, s[8:11], s13 offen offset:1024 sc1
    buffer_load_dwordx4 a[40:43], v4, s[8:11], s13 offen offset:2048 sc1
    buffer_load_dwordx4 a[44:47], v4, s[8:11], s13 offen offset:3072 sc1
    buffer_load_dwordx4 a[48:51], v5, s[8:11], s13 offen offset:0 sc1
    buffer_load_dwordx4 a[52:55], v5, s[8:11], s13 offen offset:1024 sc1
    buffer_load_dwordx4 a[56:59], v5, s[8:11], s13 offen offset:2048 sc1
    buffer_load_dwordx4 a[60:63], v5, s[8:11], s13 offen offset:3072 sc1
    s_add_u32 s13, s13, 8192
    buffer_load_dwordx4 a[64:67], v4, s[8:11], s13 offen offset:0 sc1
    buffer_load_dwordx4 a[68:71], v4, s[8:11], s13 offen offset:1024 sc1
    buffer_load_dwordx4 a[72:75], v4, s[8:11], s13 offen offset:2048 sc1
    buffer_load_dwordx4 a[76:79], v4, s[8:11], s13 offen offset:3072 sc1
    buffer_load_dwordx4 a[80:83], v5, s[8:11], s13 offen offset:0 sc1
    buffer_load_dwordx4 a[84:87], v5, s[8:11], s13 offen offset:1024 sc1
    buffer_load_dwordx4 a[88:91], v5, s[8:11], s13 offen offset:2048 sc1
    buffer_load_dwordx4 a[92:95], v5, s[8:11], s13 offen offset:3072 sc1
    s_add_u32 s13, s13, 8192
    buffer_load_dwordx4 a[96:99], v4, s[8:11], s13 offen offset:0 sc1
    buffer_load_dwordx4 a[100:103], v4, s[8:11], s13 offen offset:1024 sc1
    buffer_load_dwordx4 a[104:107], v4, s[8:11], s13 offen offset:2048 sc1
    buffer_load_dwordx4 a[108:111], v4, s[8:11], s13 offen offset:3072 sc1
    buffer_load_dwordx4 a[112:115], v5, s[8:11], s13 offen offset:0 sc1
    buffer_load_dwordx4 a[116:119], v5, s[8:11], s13 offen offset:1024 sc1
    buffer_load_dwordx4 a[120:123], v5, s[8:11], s13 offen offset:2048 sc1
    buffer_load_dwordx4 a[124:127], v5, s[8:11], s13 offen offset:3072 sc1
    s_add_u32 s13, s13, 8192
    buffer_load_dwordx4 a[128:131], v4, s[8:11], s13 offen offset:0 sc1
    buffer_load_dwordx4 a[132:135], v4, s[8:11], s13 offen offset:1024 sc1
    buffer_load_dwordx4 a[136:139], v4, s[8:11], s13 offen offset:2048 sc1
    buffer_load_dwordx4 a[140:143], v4, s[8:11], s13 offen offset:3072 sc1
    buffer_load_dwordx4 a[144:147], v5, s[8:11], s13 offen offset:0 sc1
    buffer_load_dwordx4 a[148:151], v5, s[8:11], s13 offen offset:1024 sc1
    buffer_load_dwordx4 a[152:155], v5, s[8:11], s13 offen offset:2048 sc1
    buffer_load_dwordx4 a[156:159], v5, s[8:11], s13 offen offset:3072 sc1
    s_add_u32 s13, s13, 8192
    buffer_load_dwordx4 a[160:163], v4, s[8:11], s13 offen offset:0 sc1
    buffer_load_dwordx4 a[164:167], v4, s[8:11], s13 offen offset:1024 sc1
    buffer_load_dwordx4 a[168:171], v4, s[8:11], s13 offen offset:2048 sc1
    buffer_load_dwordx4 a[172:175], v4, s[8:11], s13 offen offset:3072 sc1
    buffer_load_dwordx4 a[176:179], v5, s[8:11], s13 offen offset:0 sc1
    buffer_load_dwordx4 a[180:183], v5, s[8:11], s13 offen offset:1024 sc1
    buffer_load_dwordx4 a[184:187], v5, s[8:11], s13 offen offset:2048 sc1
    buffer_load_dwordx4 a[188:191], v5, s[8:11], s13 offen offset:3072 sc1
    s_add_u32 s13, s13, 8192
    s_waitcnt vmcnt(12)
    buffer_load_dwordx4 a[192:195], v4, s[8:11], s13 offen offset:0 sc1
    buffer_load_dwordx4 a[196:199], v4, s[8:11], s13 offen offset:1024 sc1
    buffer_load_dwordx4 a[200:203], v4, s[8:11], s13 offen offset:2048 sc1
    buffer_load_dwordx4 a[204:207], v4, s[8:11], s13 offen offset:3072 sc1
    buffer_load_dwordx4 a[208:211], v5, s[8:11], s13 offen offset:0 sc1
    buffer_load_dwordx4 a[212:215], v5, s[8:11], s13 offen offset:1024 sc1
    buffer_load_dwordx4 a[216:219], v5, s[8:11], s13 offen offset:2048 sc1
    buffer_load_dwordx4 a[220:223], v5, s[8:11], s13 offen offset:3072 sc1
    s_add_u32 s13, s13, 8192
    buffer_load_dwordx4 a[224:227], v4, s[8:11], s13 offen offset:0 sc1
    buffer_load_dwordx4 a[228:231], v4, s[8:11], s13 offen offset:1024 sc1
    buffer_load_dwordx4 a[232:235], v4, s[8:11], s13 offen offset:2048 sc1
    buffer_load_dwordx4 a[236:239], v4, s[8:11], s13 offen offset:3072 sc1
    buffer_load_dwordx4 a[240:243], v5, s[8:11], s13 offen offset:0 sc1
    buffer_load_dwordx4 a[244:247], v5, s[8:11], s13 offen offset:1024 sc1
    buffer_load_dwordx4 a[248:251], v5, s[8:11], s13 offen offset:2048 sc1
    buffer_load_dwordx4 a[252:255], v5, s[8:11], s13 offen offset:3072 sc1
    s_add_u32 s13, s13, 8192
Lst_142:
    s_lshl_b32 s24, s5, 5
    s_lshl_b32 s24, s24, 7
    s_add_u32 s24, s24, 147066880
    v_mov_b32 v8, 0
    s_cmp_lg_u32 s19, 0
    s_nop 0
    s_cbranch_scc1 Lco_143
Lw_144:
    buffer_load_dwordx2 v[10:11], v8, s[8:11], s24 offen sc1
    s_waitcnt vmcnt(0)
    v_cmp_ne_u64 vcc, s[62:63], v[10:11]
    s_nop 4
    s_cbranch_vccz Lwd_145
    s_sleep 16
    s_sub_u32 s21, s21, 1
    s_cbranch_scc0 Lw_144
    s_mov_b32 s21, 0
Lwd_145:
Lco_143:
    s_barrier
    s_lshl_b32 s14, s5, 18
    s_lshl_b32 s15, s12, 13
    s_add_u32 s14, s14, s15
    s_add_u32 s14, s14, 75497472
    s_add_u32 s15, s14, 131072
    s_lshl_b32 s24, s5, 3
    s_lshr_b32 s25, s12, 1
    s_add_u32 s24, s24, s25
    s_lshl_b32 s24, s24, 7
    s_add_u32 s24, s24, 159842304
    v_mov_b32 v8, 0
    s_nop 1
Lw_146:
    buffer_load_dwordx2 v[10:11], v8, s[8:11], s24 offen sc1
    s_waitcnt vmcnt(0)
    v_cmp_ne_u64 vcc, s[62:63], v[10:11]
    s_nop 4
    s_cbranch_vccz Lwd_147
    s_sleep 2
    s_sub_u32 s21, s21, 1
    s_cbranch_scc0 Lw_146
    s_mov_b32 s21, 0
Lwd_147:
    buffer_load_dwordx4 v[76:79], v4, s[8:11], s14 offen offset:0 sc1
    buffer_load_dwordx4 v[80:83], v4, s[8:11], s15 offen offset:0 sc1
    buffer_load_dwordx4 v[84:87], v4, s[8:11], s14 offen offset:1024 sc1
    buffer_load_dwordx4 v[88:91], v4, s[8:11], s15 offen offset:1024 sc1
    buffer_load_dwordx4 v[92:95], v4, s[8:11], s14 offen offset:2048 sc1
    buffer_load_dwordx4 v[96:99], v4, s[8:11], s15 offen offset:2048 sc1
    buffer_load_dwordx4 v[100:103], v4, s[8:11], s14 offen offset:3072 sc1
    buffer_load_dwordx4 v[104:107], v4, s[8:11], s15 offen offset:3072 sc1
    buffer_load_dwordx4 v[108:111], v5, s[8:11], s14 offen offset:0 sc1
    buffer_load_dwordx4 v[112:115], v5, s[8:11], s15 offen offset:0 sc1
    buffer_load_dwordx4 v[116:119], v5, s[8:11], s14 offen offset:1024 sc1
    buffer_load_dwordx4 v[120:123], v5, s[8:11], s15 offen offset:1024 sc1
    buffer_load_dwordx4 v[124:127], v5, s[8:11], s14 offen offset:2048 sc1
    buffer_load_dwordx4 v[128:131], v5, s[8:11], s15 offen offset:2048 sc1
    buffer_load_dwordx4 v[132:135], v5, s[8:11], s14 offen offset:3072 sc1
    buffer_load_dwordx4 v[136:139], v5, s[8:11], s15 offen offset:3072 sc1
    s_waitcnt vmcnt(14)
    v_mfma_f32_16x16x32_bf16 v[12:15], a[0:3], v[76:79], 0
    v_mfma_f32_16x16x32_bf16 v[44:47], a[0:3], v[80:83], 0
    v_mfma_f32_16x16x32_bf16 v[16:19], a[4:7], v[76:79], 0
    v_mfma_f32_16x16x32_bf16 v[48:51], a[4:7], v[80:83], 0
    v_mfma_f32_16x16x32_bf16 v[20:23], a[8:11], v[76:79], 0
    v_mfma_f32_16x16x32_bf16 v[52:55], a[8:11], v[80:83], 0
    v_mfma_f32_16x16x32_bf16 v[24:27], a[12:15], v[76:79], 0
    v_mfma_f32_16x16x32_bf16 v[56:59], a[12:15], v[80:83], 0
    v_mfma_f32_16x16x32_bf16 v[28:31], a[16:19], v[76:79], 0
    v_mfma_f32_16x16x32_bf16 v[60:63], a[16:19], v[80:83], 0
    v_mfma_f32_16x16x32_bf16 v[32:35], a[20:23], v[76:79], 0
    v_mfma_f32_16x16x32_bf16 v[64:67], a[20:23], v[80:83], 0
    v_mfma_f32_16x16x32_bf16 v[36:39], a[24:27], v[76:79], 0
    v_mfma_f32_16x16x32_bf16 v[68:71], a[24:27], v[80:83], 0
    v_mfma_f32_16x16x32_bf16 v[40:43], a[28:31], v[76:79], 0
    v_mfma_f32_16x16x32_bf16 v[72:75], a[28:31], v[80:83], 0
    s_waitcnt vmcnt(12)
    v_mfma_f32_16x16x32_bf16 v[12:15], a[32:35], v[84:87], v[12:15]
    v_mfma_f32_16x16x32_bf16 v[44:47], a[32:35], v[88:91], v[44:47]
    v_mfma_f32_16x16x32_bf16 v[16:19], a[36:39], v[84:87], v[16:19]
    v_mfma_f32_16x16x32_bf16 v[48:51], a[36:39], v[88:91], v[48:51]
    v_mfma_f32_16x16x32_bf16 v[20:23], a[40:43], v[84:87], v[20:23]
    v_mfma_f32_16x16x32_bf16 v[52:55], a[40:43], v[88:91], v[52:55]
    v_mfma_f32_16x16x32_bf16 v[24:27], a[44:47], v[84:87], v[24:27]
    v_mfma_f32_16x16x32_bf16 v[56:59], a[44:47], v[88:91], v[56:59]
    v_mfma_f32_16x16x32_bf16 v[28:31], a[48:51], v[84:87], v[28:31]
    v_mfma_f32_16x16x32_bf16 v[60:63], a[48:51], v[88:91], v[60:63]
    v_mfma_f32_16x16x32_bf16 v[32:35], a[52:55], v[84:87], v[32:35]
    v_mfma_f32_16x16x32_bf16 v[64:67], a[52:55], v[88:91], v[64:67]
    v_mfma_f32_16x16x32_bf16 v[36:39], a[56:59], v[84:87], v[36:39]
    v_mfma_f32_16x16x32_bf16 v[68:71], a[56:59], v[88:91], v[68:71]
    v_mfma_f32_16x16x32_bf16 v[40:43], a[60:63], v[84:87], v[40:43]
    v_mfma_f32_16x16x32_bf16 v[72:75], a[60:63], v[88:91], v[72:75]
    s_waitcnt vmcnt(10)
    v_mfma_f32_16x16x32_bf16 v[12:15], a[64:67], v[92:95], v[12:15]
    v_mfma_f32_16x16x32_bf16 v[44:47], a[64:67], v[96:99], v[44:47]
    v_mfma_f32_16x16x32_bf16 v[16:19], a[68:71], v[92:95], v[16:19]
    v_mfma_f32_16x16x32_bf16 v[48:51], a[68:71], v[96:99], v[48:51]
    v_mfma_f32_16x16x32_bf16 v[20:23], a[72:75], v[92:95], v[20:23]
    v_mfma_f32_16x16x32_bf16 v[52:55], a[72:75], v[96:99], v[52:55]
    v_mfma_f32_16x16x32_bf16 v[24:27], a[76:79], v[92:95], v[24:27]
    v_mfma_f32_16x16x32_bf16 v[56:59], a[76:79], v[96:99], v[56:59]
    v_mfma_f32_16x16x32_bf16 v[28:31], a[80:83], v[92:95], v[28:31]
    v_mfma_f32_16x16x32_bf16 v[60:63], a[80:83], v[96:99], v[60:63]
    v_mfma_f32_16x16x32_bf16 v[32:35], a[84:87], v[92:95], v[32:35]
    v_mfma_f32_16x16x32_bf16 v[64:67], a[84:87], v[96:99], v[64:67]
    v_mfma_f32_16x16x32_bf16 v[36:39], a[88:91], v[92:95], v[36:39]
    v_mfma_f32_16x16x32_bf16 v[68:71], a[88:91], v[96:99], v[68:71]
    v_mfma_f32_16x16x32_bf16 v[40:43], a[92:95], v[92:95], v[40:43]
    v_mfma_f32_16x16x32_bf16 v[72:75], a[92:95], v[96:99], v[72:75]
    s_waitcnt vmcnt(8)
    v_mfma_f32_16x16x32_bf16 v[12:15], a[96:99], v[100:103], v[12:15]
    v_mfma_f32_16x16x32_bf16 v[44:47], a[96:99], v[104:107], v[44:47]
    v_mfma_f32_16x16x32_bf16 v[16:19], a[100:103], v[100:103], v[16:19]
    v_mfma_f32_16x16x32_bf16 v[48:51], a[100:103], v[104:107], v[48:51]
    v_mfma_f32_16x16x32_bf16 v[20:23], a[104:107], v[100:103], v[20:23]
    v_mfma_f32_16x16x32_bf16 v[52:55], a[104:107], v[104:107], v[52:55]
    v_mfma_f32_16x16x32_bf16 v[24:27], a[108:111], v[100:103], v[24:27]
    v_mfma_f32_16x16x32_bf16 v[56:59], a[108:111], v[104:107], v[56:59]
    v_mfma_f32_16x16x32_bf16 v[28:31], a[112:115], v[100:103], v[28:31]
    v_mfma_f32_16x16x32_bf16 v[60:63], a[112:115], v[104:107], v[60:63]
    v_mfma_f32_16x16x32_bf16 v[32:35], a[116:119], v[100:103], v[32:35]
    v_mfma_f32_16x16x32_bf16 v[64:67], a[116:119], v[104:107], v[64:67]
    v_mfma_f32_16x16x32_bf16 v[36:39], a[120:123], v[100:103], v[36:39]
    v_mfma_f32_16x16x32_bf16 v[68:71], a[120:123], v[104:107], v[68:71]
    v_mfma_f32_16x16x32_bf16 v[40:43], a[124:127], v[100:103], v[40:43]
    v_mfma_f32_16x16x32_bf16 v[72:75], a[124:127], v[104:107], v[72:75]
    s_waitcnt vmcnt(6)
    v_mfma_f32_16x16x32_bf16 v[12:15], a[128:131], v[108:111], v[12:15]
    v_mfma_f32_16x16x32_bf16 v[44:47], a[128:131], v[112:115], v[44:47]
    v_mfma_f32_16x16x32_bf16 v[16:19], a[132:135], v[108:111], v[16:19]
    v_mfma_f32_16x16x32_bf16 v[48:51], a[132:135], v[112:115], v[48:51]
    v_mfma_f32_16x16x32_bf16 v[20:23], a[136:139], v[108:111], v[20:23]
    v_mfma_f32_16x16x32_bf16 v[52:55], a[136:139], v[112:115], v[52:55]
    v_mfma_f32_16x16x32_bf16 v[24:27], a[140:143], v[108:111], v[24:27]
    v_mfma_f32_16x16x32_bf16 v[56:59], a[140:143], v[112:115], v[56:59]
    v_mfma_f32_16x16x32_bf16 v[28:31], a[144:147], v[108:111], v[28:31]
    v_mfma_f32_16x16x32_bf16 v[60:63], a[144:147], v[112:115], v[60:63]
    v_mfma_f32_16x16x32_bf16 v[32:35], a[148:151], v[108:111], v[32:35]
    v_mfma_f32_16x16x32_bf16 v[64:67], a[148:151], v[112:115], v[64:67]
    v_mfma_f32_16x16x32_bf16 v[36:39], a[152:155], v[108:111], v[36:39]
    v_mfma_f32_16x16x32_bf16 v[68:71], a[152:155], v[112:115], v[68:71]
    v_mfma_f32_16x16x32_bf16 v[40:43], a[156:159], v[108:111], v[40:43]
    v_mfma_f32_16x16x32_bf16 v[72:75], a[156:159], v[112:115], v[72:75]
    s_waitcnt vmcnt(4)
    v_mfma_f32_16x16x32_bf16 v[12:15], a[160:163], v[116:119], v[12:15]
    v_mfma_f32_16x16x32_bf16 v[44:47], a[160:163], v[120:123], v[44:47]
    v_mfma_f32_16x16x32_bf16 v[16:19], a[164:167], v[116:119], v[16:19]
    v_mfma_f32_16x16x32_bf16 v[48:51], a[164:167], v[120:123], v[48:51]
    v_mfma_f32_16x16x32_bf16 v[20:23], a[168:171], v[116:119], v[20:23]
    v_mfma_f32_16x16x32_bf16 v[52:55], a[168:171], v[120:123], v[52:55]
    v_mfma_f32_16x16x32_bf16 v[24:27], a[172:175], v[116:119], v[24:27]
    v_mfma_f32_16x16x32_bf16 v[56:59], a[172:175], v[120:123], v[56:59]
    v_mfma_f32_16x16x32_bf16 v[28:31], a[176:179], v[116:119], v[28:31]
    v_mfma_f32_16x16x32_bf16 v[60:63], a[176:179], v[120:123], v[60:63]
    v_mfma_f32_16x16x32_bf16 v[32:35], a[180:183], v[116:119], v[32:35]
    v_mfma_f32_16x16x32_bf16 v[64:67], a[180:183], v[120:123], v[64:67]
    v_mfma_f32_16x16x32_bf16 v[36:39], a[184:187], v[116:119], v[36:39]
    v_mfma_f32_16x16x32_bf16 v[68:71], a[184:187], v[120:123], v[68:71]
    v_mfma_f32_16x16x32_bf16 v[40:43], a[188:191], v[116:119], v[40:43]
    v_mfma_f32_16x16x32_bf16 v[72:75], a[188:191], v[120:123], v[72:75]
    s_waitcnt vmcnt(2)
    v_mfma_f32_16x16x32_bf16 v[12:15], a[192:195], v[124:127], v[12:15]
    v_mfma_f32_16x16x32_bf16 v[44:47], a[192:195], v[128:131], v[44:47]
    v_mfma_f32_16x16x32_bf16 v[16:19], a[196:199], v[124:127], v[16:19]
    v_mfma_f32_16x16x32_bf16 v[48:51], a[196:199], v[128:131], v[48:51]
    v_mfma_f32_16x16x32_bf16 v[20:23], a[200:203], v[124:127], v[20:23]
    v_mfma_f32_16x16x32_bf16 v[52:55], a[200:203], v[128:131], v[52:55]
    v_mfma_f32_16x16x32_bf16 v[24:27], a[204:207], v[124:127], v[24:27]
    v_mfma_f32_16x16x32_bf16 v[56:59], a[204:207], v[128:131], v[56:59]
    v_mfma_f32_16x16x32_bf16 v[28:31], a[208:211], v[124:127], v[28:31]
    v_mfma_f32_16x16x32_bf16 v[60:63], a[208:211], v[128:131], v[60:63]
    v_mfma_f32_16x16x32_bf16 v[32:35], a[212:215], v[124:127], v[32:35]
    v_mfma_f32_16x16x32_bf16 v[64:67], a[212:215], v[128:131], v[64:67]
    v_mfma_f32_16x16x32_bf16 v[36:39], a[216:219], v[124:127], v[36:39]
    v_mfma_f32_16x16x32_bf16 v[68:71], a[216:219], v[128:131], v[68:71]
    v_mfma_f32_16x16x32_bf16 v[40:43], a[220:223], v[124:127], v[40:43]
    v_mfma_f32_16x16x32_bf16 v[72:75], a[220:223], v[128:131], v[72:75]
    s_waitcnt vmcnt(0)
    v_mfma_f32_16x16x32_bf16 v[12:15], a[224:227], v[132:135], v[12:15]
    v_mfma_f32_16x16x32_bf16 v[44:47], a[224:227], v[136:139], v[44:47]
    v_mfma_f32_16x16x32_bf16 v[16:19], a[228:231], v[132:135], v[16:19]
    v_mfma_f32_16x16x32_bf16 v[48:51], a[228:231], v[136:139], v[48:51]
    v_mfma_f32_16x16x32_bf16 v[20:23], a[232:235], v[132:135], v[20:23]
    v_mfma_f32_16x16x32_bf16 v[52:55], a[232:235], v[136:139], v[52:55]
    v_mfma_f32_16x16x32_bf16 v[24:27], a[236:239], v[132:135], v[24:27]
    v_mfma_f32_16x16x32_bf16 v[56:59], a[236:239], v[136:139], v[56:59]
    v_mfma_f32_16x16x32_bf16 v[28:31], a[240:243], v[132:135], v[28:31]
    v_mfma_f32_16x16x32_bf16 v[60:63], a[240:243], v[136:139], v[60:63]
    v_mfma_f32_16x16x32_bf16 v[32:35], a[244:247], v[132:135], v[32:35]
    v_mfma_f32_16x16x32_bf16 v[64:67], a[244:247], v[136:139], v[64:67]
    v_mfma_f32_16x16x32_bf16 v[36:39], a[248:251], v[132:135], v[36:39]
    v_mfma_f32_16x16x32_bf16 v[68:71], a[248:251], v[136:139], v[68:71]
    v_mfma_f32_16x16x32_bf16 v[40:43], a[252:255], v[132:135], v[40:43]
    v_mfma_f32_16x16x32_bf16 v[72:75], a[252:255], v[136:139], v[72:75]
    s_mul_i32 s30, s19, 16384
    v_add_u32 v92, s30, v4
    ds_write_b128 v92, v[12:15] offset:0
    ds_write_b128 v92, v[16:19] offset:1024
    ds_write_b128 v92, v[20:23] offset:2048
    ds_write_b128 v92, v[24:27] offset:3072
    ds_write_b128 v92, v[28:31] offset:4096
    ds_write_b128 v92, v[32:35] offset:5120
    ds_write_b128 v92, v[36:39] offset:6144
    ds_write_b128 v92, v[40:43] offset:7168
    ds_write_b128 v92, v[44:47] offset:8192
    ds_write_b128 v92, v[48:51] offset:9216
    ds_write_b128 v92, v[52:55] offset:10240
    ds_write_b128 v92, v[56:59] offset:11264
    ds_write_b128 v92, v[60:63] offset:12288
    ds_write_b128 v92, v[64:67] offset:13312
    ds_write_b128 v92, v[68:71] offset:14336
    ds_write_b128 v92, v[72:75] offset:15360
    s_mul_i32 s30, s19, 4096
    v_add_u32 v92, s30, v4
    s_waitcnt lgkmcnt(0)
    s_barrier
    ds_read_b128 v[12:15], v92 offset:0
    ds_read_b128 v[16:19], v92 offset:1024
    ds_read_b128 v[20:23], v92 offset:2048
    ds_read_b128 v[24:27], v92 offset:3072
    ds_read_b128 v[28:31], v92 offset:16384
    ds_read_b128 v[32:35], v92 offset:17408
    ds_read_b128 v[36:39], v92 offset:18432
    ds_read_b128 v[40:43], v92 offset:19456
    ds_read_b128 v[44:47], v92 offset:32768
    ds_read_b128 v[48:51], v92 offset:33792
    ds_read_b128 v[52:55], v92 offset:34816
    ds_read_b128 v[56:59], v92 offset:35840
    s_waitcnt lgkmcnt(4)
    ds_read_b128 v[60:63], v92 offset:49152
    ds_read_b128 v[64:67], v92 offset:50176
    ds_read_b128 v[68:71], v92 offset:51200
    ds_read_b128 v[72:75], v92 offset:52224
    s_waitcnt lgkmcnt(0)
    v_pk_add_f32 v[76:77], v[12:13], v[28:29]
    v_pk_add_f32 v[12:13], v[44:45], v[60:61]
    v_pk_add_f32 v[76:77], v[76:77], v[12:13]
    v_pk_add_f32 v[78:79], v[14:15], v[30:31]
    v_pk_add_f32 v[14:15], v[46:47], v[62:63]
    v_pk_add_f32 v[78:79], v[78:79], v[14:15]
    v_pk_add_f32 v[80:81], v[16:17], v[32:33]
    v_pk_add_f32 v[16:17], v[48:49], v[64:65]
    v_pk_add_f32 v[80:81], v[80:81], v[16:17]
    v_pk_add_f32 v[82:83], v[18:19], v[34:35]
    v_pk_add_f32 v[18:19], v[50:51], v[66:67]
    v_pk_add_f32 v[82:83], v[82:83], v[18:19]
    v_pk_add_f32 v[84:85], v[20:21], v[36:37]
    v_pk_add_f32 v[20:21], v[52:53], v[68:69]
    v_pk_add_f32 v[84:85], v[84:85], v[20:21]
    v_pk_add_f32 v[86:87], v[22:23], v[38:39]
    v_pk_add_f32 v[22:23], v[54:55], v[70:71]
    v_pk_add_f32 v[86:87], v[86:87], v[22:23]
    v_pk_add_f32 v[88:89], v[24:25], v[40:41]
    v_pk_add_f32 v[24:25], v[56:57], v[72:73]
    v_pk_add_f32 v[88:89], v[88:89], v[24:25]
    v_pk_add_f32 v[90:91], v[26:27], v[42:43]
    v_pk_add_f32 v[26:27], v[58:59], v[74:75]
    v_pk_add_f32 v[90:91], v[90:91], v[26:27]
    s_lshl_b32 s24, s7, 7
    s_lshl_b32 s25, s5, 1
    s_add_u32 s24, s24, s25
    s_lshr_b32 s25, s19, 1
    s_add_u32 s24, s24, s25
    s_lshl_b32 s24, s24, 2
    s_add_u32 s24, s24, s6
    s_lshl_b32 s24, s24, 13
    s_and_b32 s25, s19, 1
    s_lshl_b32 s25, s25, 12
    s_add_u32 s24, s24, s25
    s_add_u32 s24, s24, 125829120
    buffer_store_dwordx4 v[76:79], v4, s[8:11], s24 offen offset:0 sc1
    buffer_store_dwordx4 v[80:83], v4, s[8:11], s24 offen offset:1024 sc1
    buffer_store_dwordx4 v[84:87], v4, s[8:11], s24 offen offset:2048 sc1
    buffer_store_dwordx4 v[88:91], v4, s[8:11], s24 offen offset:3072 sc1
    s_lshl_b32 s24, s5, 4
    s_lshl_b32 s25, s7, 2
    s_add_u32 s24, s24, s25
    s_add_u32 s24, s24, s6
    s_lshl_b32 s24, s24, 7
    s_add_u32 s24, s24, 159907840
    s_waitcnt vmcnt(0) lgkmcnt(0)
    s_barrier
    s_cmp_lg_u32 s19, 0
    s_cbranch_scc1 Lsig_148
    v_mov_b64 v[8:9], s[62:63]
    v_mov_b64 v[10:11], s[62:63]
    s_mov_b64 exec, 0xff
    buffer_store_dwordx4 v[8:11], v4, s[8:11], s24 offen sc1
    s_mov_b64 exec, -1
    s_nop 0
Lsig_148:
    s_add_u32 s5, s5, 4
    s_cmp_lt_u32 s5, 64
    s_cbranch_scc1 Lst_142
    s_branch Lnext_92
Lh_101:
    s_cmp_lg_u32 s64, 0
    s_cbranch_scc1 Lpk_149
    s_mov_b32 s24, 159776768
    v_min_u32 v8, 63, v1
    v_mul_u32_u24 v8, 128, v8
    s_nop 1
Lw_150:
    buffer_load_dwordx2 v[10:11], v8, s[8:11], s24 offen sc1
    s_waitcnt vmcnt(0)
    v_cmp_ne_u64 vcc, s[62:63], v[10:11]
    s_nop 4
    s_cbranch_vccz Lwd_151
    s_sleep 2
    s_sub_u32 s21, s21, 1
    s_cbranch_scc0 Lw_150
    s_mov_b32 s21, 0
Lwd_151:
    s_mov_b32 s24, 159784960
    v_min_u32 v8, 3, v1
    v_mul_u32_u24 v8, 128, v8
    s_nop 1
Lw_152:
    buffer_load_dwordx2 v[10:11], v8, s[8:11], s24 offen sc1
    s_waitcnt vmcnt(0)
    v_cmp_ne_u64 vcc, s[62:63], v[10:11]
    s_nop 4
    s_cbranch_vccz Lwd_153
    s_sleep 2
    s_sub_u32 s21, s21, 1
    s_cbranch_scc0 Lw_152
    s_mov_b32 s21, 0
Lwd_153:
    s_mov_b32 s64, 1
Lpk_149:
    s_load_dwordx2 s[24:25], s[0:1], 0
    s_waitcnt lgkmcnt(0)
    s_mov_b32 s12, s24
    s_and_b32 s13, s25, 0xffff
    s_mov_b32 s14, 2097152
    s_mov_b32 s15, 0x00020000
    v_lshlrev_b32 v7, 10, v2
    v_lshl_add_u32 v7, v3, 6, v7
    v_lshlrev_b32 v9, 4, v2
    v_add_u32 v9, 16384, v9
    s_lshl_b32 s30, s19, 2
    v_add_u32 v8, s30, v9
    s_lshl_b32 s26, s19, 17
    s_add_u32 s26, s26, 117440512
    s_mov_b32 s33, s26
    buffer_load_dwordx4 v[192:195], v4, s[8:11], s26 offen offset:0 sc1
    buffer_load_dwordx4 v[196:199], v4, s[8:11], s26 offen offset:1024 sc1
    buffer_load_dwordx4 v[200:203], v4, s[8:11], s26 offen offset:2048 sc1
    buffer_load_dwordx4 v[204:207], v4, s[8:11], s26 offen offset:3072 sc1
    buffer_load_dwordx4 v[208:211], v5, s[8:11], s26 offen offset:0 sc1
    buffer_load_dwordx4 v[212:215], v5, s[8:11], s26 offen offset:1024 sc1
    buffer_load_dwordx4 v[216:219], v5, s[8:11], s26 offen offset:2048 sc1
    buffer_load_dwordx4 v[220:223], v5, s[8:11], s26 offen offset:3072 sc1
    s_add_u32 s26, s26, 8192
    buffer_load_dwordx4 v[224:227], v4, s[8:11], s26 offen offset:0 sc1
    buffer_load_dwordx4 v[228:231], v4, s[8:11], s26 offen offset:1024 sc1
    buffer_load_dwordx4 v[232:235], v4, s[8:11], s26 offen offset:2048 sc1
    buffer_load_dwordx4 v[236:239], v4, s[8:11], s26 offen offset:3072 sc1
    buffer_load_dwordx4 v[240:243], v5, s[8:11], s26 offen offset:0 sc1
    buffer_load_dwordx4 v[244:247], v5, s[8:11], s26 offen offset:1024 sc1
    buffer_load_dwordx4 v[248:251], v5, s[8:11], s26 offen offset:2048 sc1
    buffer_load_dwordx4 v[252:255], v5, s[8:11], s26 offen offset:3072 sc1
    s_add_u32 s26, s26, 8192
    buffer_load_dwordx4 a[0:3], v4, s[8:11], s26 offen offset:0 sc1
    buffer_load_dwordx4 a[4:7], v4, s[8:11], s26 offen offset:1024 sc1
    buffer_load_dwordx4 a[8:11], v4, s[8:11], s26 offen offset:2048 sc1
    buffer_load_dwordx4 a[12:15], v4, s[8:11], s26 offen offset:3072 sc1
    buffer_load_dwordx4 a[16:19], v5, s[8:11], s26 offen offset:0 sc1
    buffer_load_dwordx4 a[20:23], v5, s[8:11], s26 offen offset:1024 sc1
    buffer_load_dwordx4 a[24:27], v5, s[8:11], s26 offen offset:2048 sc1
    buffer_load_dwordx4 a[28:31], v5, s[8:11], s26 offen offset:3072 sc1
    s_add_u32 s26, s26, 8192
    buffer_load_dwordx4 a[32:35], v4, s[8:11], s26 offen offset:0 sc1
    buffer_load_dwordx4 a[36:39], v4, s[8:11], s26 offen offset:1024 sc1
    buffer_load_dwordx4 a[40:43], v4, s[8:11], s26 offen offset:2048 sc1
    buffer_load_dwordx4 a[44:47], v4, s[8:11], s26 offen offset:3072 sc1
    buffer_load_dwordx4 a[48:51], v5, s[8:11], s26 offen offset:0 sc1
    buffer_load_dwordx4 a[52:55], v5, s[8:11], s26 offen offset:1024 sc1
    buffer_load_dwordx4 a[56:59], v5, s[8:11], s26 offen offset:2048 sc1
    buffer_load_dwordx4 a[60:63], v5, s[8:11], s26 offen offset:3072 sc1
    s_add_u32 s26, s26, 8192
    buffer_load_dwordx4 a[64:67], v4, s[8:11], s26 offen offset:0 sc1
    buffer_load_dwordx4 a[68:71], v4, s[8:11], s26 offen offset:1024 sc1
    buffer_load_dwordx4 a[72:75], v4, s[8:11], s26 offen offset:2048 sc1
    buffer_load_dwordx4 a[76:79], v4, s[8:11], s26 offen offset:3072 sc1
    buffer_load_dwordx4 a[80:83], v5, s[8:11], s26 offen offset:0 sc1
    buffer_load_dwordx4 a[84:87], v5, s[8:11], s26 offen offset:1024 sc1
    buffer_load_dwordx4 a[88:91], v5, s[8:11], s26 offen offset:2048 sc1
    buffer_load_dwordx4 a[92:95], v5, s[8:11], s26 offen offset:3072 sc1
    s_add_u32 s26, s26, 8192
    buffer_load_dwordx4 a[96:99], v4, s[8:11], s26 offen offset:0 sc1
    buffer_load_dwordx4 a[100:103], v4, s[8:11], s26 offen offset:1024 sc1
    buffer_load_dwordx4 a[104:107], v4, s[8:11], s26 offen offset:2048 sc1
    buffer_load_dwordx4 a[108:111], v4, s[8:11], s26 offen offset:3072 sc1
    buffer_load_dwordx4 a[112:115], v5, s[8:11], s26 offen offset:0 sc1
    buffer_load_dwordx4 a[116:119], v5, s[8:11], s26 offen offset:1024 sc1
    buffer_load_dwordx4 a[120:123], v5, s[8:11], s26 offen offset:2048 sc1
    buffer_load_dwordx4 a[124:127], v5, s[8:11], s26 offen offset:3072 sc1
    s_waitcnt vmcnt(12)
    s_add_u32 s26, s26, 8192
    buffer_load_dwordx4 a[128:131], v4, s[8:11], s26 offen offset:0 sc1
    buffer_load_dwordx4 a[132:135], v4, s[8:11], s26 offen offset:1024 sc1
    buffer_load_dwordx4 a[136:139], v4, s[8:11], s26 offen offset:2048 sc1
    buffer_load_dwordx4 a[140:143], v4, s[8:11], s26 offen offset:3072 sc1
    buffer_load_dwordx4 a[144:147], v5, s[8:11], s26 offen offset:0 sc1
    buffer_load_dwordx4 a[148:151], v5, s[8:11], s26 offen offset:1024 sc1
    buffer_load_dwordx4 a[152:155], v5, s[8:11], s26 offen offset:2048 sc1
    buffer_load_dwordx4 a[156:159], v5, s[8:11], s26 offen offset:3072 sc1
    s_add_u32 s26, s26, 8192
    buffer_load_dwordx4 a[160:163], v4, s[8:11], s26 offen offset:0 sc1
    buffer_load_dwordx4 a[164:167], v4, s[8:11], s26 offen offset:1024 sc1
    buffer_load_dwordx4 a[168:171], v4, s[8:11], s26 offen offset:2048 sc1
    buffer_load_dwordx4 a[172:175], v4, s[8:11], s26 offen offset:3072 sc1
    buffer_load_dwordx4 a[176:179], v5, s[8:11], s26 offen offset:0 sc1
    buffer_load_dwordx4 a[180:183], v5, s[8:11], s26 offen offset:1024 sc1
    buffer_load_dwordx4 a[184:187], v5, s[8:11], s26 offen offset:2048 sc1
    buffer_load_dwordx4 a[188:191], v5, s[8:11], s26 offen offset:3072 sc1
    s_add_u32 s26, s26, 8192
    buffer_load_dwordx4 a[192:195], v4, s[8:11], s26 offen offset:0 sc1
    buffer_load_dwordx4 a[196:199], v4, s[8:11], s26 offen offset:1024 sc1
    buffer_load_dwordx4 a[200:203], v4, s[8:11], s26 offen offset:2048 sc1
    buffer_load_dwordx4 a[204:207], v4, s[8:11], s26 offen offset:3072 sc1
    buffer_load_dwordx4 a[208:211], v5, s[8:11], s26 offen offset:0 sc1
    buffer_load_dwordx4 a[212:215], v5, s[8:11], s26 offen offset:1024 sc1
    buffer_load_dwordx4 a[216:219], v5, s[8:11], s26 offen offset:2048 sc1
    buffer_load_dwordx4 a[220:223], v5, s[8:11], s26 offen offset:3072 sc1
    s_add_u32 s26, s26, 8192
    buffer_load_dwordx4 a[224:227], v4, s[8:11], s26 offen offset:0 sc1
    buffer_load_dwordx4 a[228:231], v4, s[8:11], s26 offen offset:1024 sc1
    buffer_load_dwordx4 a[232:235], v4, s[8:11], s26 offen offset:2048 sc1
    buffer_load_dwordx4 a[236:239], v4, s[8:11], s26 offen offset:3072 sc1
    buffer_load_dwordx4 a[240:243], v5, s[8:11], s26 offen offset:0 sc1
    buffer_load_dwordx4 a[244:247], v5, s[8:11], s26 offen offset:1024 sc1
    buffer_load_dwordx4 a[248:251], v5, s[8:11], s26 offen offset:2048 sc1
    buffer_load_dwordx4 a[252:255], v5, s[8:11], s26 offen offset:3072 sc1
    s_add_u32 s26, s26, 8192
    s_add_u32 s26, s26, 8192
    s_add_u32 s26, s26, 8192
    s_mul_i32 s31, s19, 32768
    s_add_u32 s31, s31, 32768
    s_add_u32 m0, s31, 0
    s_nop 0
    buffer_load_dwordx4 v4, s[8:11], s26 offen offset:0 sc1 lds
    buffer_load_dwordx4 v4, s[8:11], s26 offen offset:1024 sc1 lds
    buffer_load_dwordx4 v4, s[8:11], s26 offen offset:2048 sc1 lds
    buffer_load_dwordx4 v4, s[8:11], s26 offen offset:3072 sc1 lds
    s_add_u32 s26, s26, 4096
    s_add_u32 m0, s31, 4096
    s_nop 0
    buffer_load_dwordx4 v4, s[8:11], s26 offen offset:0 sc1 lds
    buffer_load_dwordx4 v4, s[8:11], s26 offen offset:1024 sc1 lds
    buffer_load_dwordx4 v4, s[8:11], s26 offen offset:2048 sc1 lds
    buffer_load_dwordx4 v4, s[8:11], s26 offen offset:3072 sc1 lds
    s_add_u32 s26, s26, 4096
    s_add_u32 m0, s31, 8192
    s_nop 0
    buffer_load_dwordx4 v4, s[8:11], s26 offen offset:0 sc1 lds
    buffer_load_dwordx4 v4, s[8:11], s26 offen offset:1024 sc1 lds
    buffer_load_dwordx4 v4, s[8:11], s26 offen offset:2048 sc1 lds
    buffer_load_dwordx4 v4, s[8:11], s26 offen offset:3072 sc1 lds
    s_add_u32 s26, s26, 4096
    s_add_u32 m0, s31, 12288
    s_nop 0
    buffer_load_dwordx4 v4, s[8:11], s26 offen offset:0 sc1 lds
    buffer_load_dwordx4 v4, s[8:11], s26 offen offset:1024 sc1 lds
    buffer_load_dwordx4 v4, s[8:11], s26 offen offset:2048 sc1 lds
    buffer_load_dwordx4 v4, s[8:11], s26 offen offset:3072 sc1 lds
    s_add_u32 s26, s26, 4096
    s_waitcnt vmcnt(12)
    s_add_u32 m0, s31, 16384
    s_nop 0
    buffer_load_dwordx4 v4, s[8:11], s26 offen offset:0 sc1 lds
    buffer_load_dwordx4 v4, s[8:11], s26 offen offset:1024 sc1 lds
    buffer_load_dwordx4 v4, s[8:11], s26 offen offset:2048 sc1 lds
    buffer_load_dwordx4 v4, s[8:11], s26 offen offset:3072 sc1 lds
    s_add_u32 s26, s26, 4096
    s_add_u32 m0, s31, 20480
    s_nop 0
    buffer_load_dwordx4 v4, s[8:11], s26 offen offset:0 sc1 lds
    buffer_load_dwordx4 v4, s[8:11], s26 offen offset:1024 sc1 lds
    buffer_load_dwordx4 v4, s[8:11], s26 offen offset:2048 sc1 lds
    buffer_load_dwordx4 v4, s[8:11], s26 offen offset:3072 sc1 lds
    s_add_u32 s26, s26, 4096
    s_add_u32 m0, s31, 24576
    s_nop 0
    buffer_load_dwordx4 v4, s[8:11], s26 offen offset:0 sc1 lds
    buffer_load_dwordx4 v4, s[8:11], s26 offen offset:1024 sc1 lds
    buffer_load_dwordx4 v4, s[8:11], s26 offen offset:2048 sc1 lds
    buffer_load_dwordx4 v4, s[8:11], s26 offen offset:3072 sc1 lds
    s_add_u32 s26, s26, 4096
    s_add_u32 m0, s31, 28672
    s_nop 0
    buffer_load_dwordx4 v4, s[8:11], s26 offen offset:0 sc1 lds
    buffer_load_dwordx4 v4, s[8:11], s26 offen offset:1024 sc1 lds
    buffer_load_dwordx4 v4, s[8:11], s26 offen offset:2048 sc1 lds
    buffer_load_dwordx4 v4, s[8:11], s26 offen offset:3072 sc1 lds
    s_add_u32 s26, s26, 4096
Lst_154:
    s_lshr_b32 s25, s5, 1
    s_lshl_b32 s25, s25, 10
    s_add_u32 s25, s25, 159842304
    v_mov_b32 v10, 0
    s_cmp_lg_u32 s19, 0
    s_nop 0
    s_cbranch_scc1 Lco_155
Lw_156:
    buffer_load_dwordx2 v[12:13], v10, s[8:11], s25 offen sc1
    s_waitcnt vmcnt(0)
    v_cmp_ne_u64 vcc, s[62:63], v[12:13]
    s_nop 4
    s_cbranch_vccz Lwd_157
    s_sleep 16
    s_sub_u32 s21, s21, 1
    s_cbranch_scc0 Lw_156
    s_mov_b32 s21, 0
Lwd_157:
Lco_155:
    s_barrier
    s_lshl_b32 s24, s5, 14
    s_lshl_b32 s25, s19, 8
    s_add_u32 s24, s24, s25
    buffer_load_dwordx4 v[84:87], v7, s[12:15], s24 offen offset:0
    buffer_load_dwordx4 v[88:91], v7, s[12:15], s24 offen offset:16
    buffer_load_dwordx4 v[92:95], v7, s[12:15], s24 offen offset:32
    buffer_load_dwordx4 v[96:99], v7, s[12:15], s24 offen offset:48
    s_lshr_b32 s24, s5, 1
    s_lshl_b32 s24, s24, 11
    s_add_u32 s24, s24, 159907840
    v_min_u32 v14, 15, v1
    v_mul_u32_u24 v14, 128, v14
    s_nop 1
Lw_158:
    buffer_load_dwordx2 v[18:19], v14, s[8:11], s24 offen sc1
    s_waitcnt vmcnt(0)
    v_cmp_ne_u64 vcc, s[62:63], v[18:19]
    s_nop 4
    s_cbranch_vccz Lwd_159
    s_sleep 2
    s_sub_u32 s21, s21, 1
    s_cbranch_scc0 Lw_158
    s_mov_b32 s21, 0
Lwd_159:
    s_lshl_b32 s27, s5, 2
    s_add_u32 s27, s27, s19
    s_lshl_b32 s24, s27, 13
    s_add_u32 s24, s24, 125829120
    buffer_load_dwordx4 v[52:55], v4, s[8:11], s24 offen offset:0 sc1
    buffer_load_dwordx4 v[56:59], v4, s[8:11], s24 offen offset:1024 sc1
    buffer_load_dwordx4 v[60:63], v4, s[8:11], s24 offen offset:2048 sc1
    buffer_load_dwordx4 v[64:67], v4, s[8:11], s24 offen offset:3072 sc1
    buffer_load_dwordx4 v[68:71], v5, s[8:11], s24 offen offset:0 sc1
    buffer_load_dwordx4 v[72:75], v5, s[8:11], s24 offen offset:1024 sc1
    buffer_load_dwordx4 v[76:79], v5, s[8:11], s24 offen offset:2048 sc1
    buffer_load_dwordx4 v[80:83], v5, s[8:11], s24 offen offset:3072 sc1
    s_add_u32 s24, s24, 4194304
    buffer_load_dwordx4 v[128:131], v4, s[8:11], s24 offen offset:0 sc1
    buffer_load_dwordx4 v[132:135], v4, s[8:11], s24 offen offset:1024 sc1
    buffer_load_dwordx4 v[136:139], v4, s[8:11], s24 offen offset:2048 sc1
    buffer_load_dwordx4 v[140:143], v4, s[8:11], s24 offen offset:3072 sc1
    buffer_load_dwordx4 v[144:147], v5, s[8:11], s24 offen offset:0 sc1
    buffer_load_dwordx4 v[148:151], v5, s[8:11], s24 offen offset:1024 sc1
    buffer_load_dwordx4 v[152:155], v5, s[8:11], s24 offen offset:2048 sc1
    buffer_load_dwordx4 v[156:159], v5, s[8:11], s24 offen offset:3072 sc1
    s_add_u32 s24, s24, 4194304
    buffer_load_dwordx4 v[160:163], v4, s[8:11], s24 offen offset:0 sc1
    buffer_load_dwordx4 v[164:167], v4, s[8:11], s24 offen offset:1024 sc1
    buffer_load_dwordx4 v[168:171], v4, s[8:11], s24 offen offset:2048 sc1
    buffer_load_dwordx4 v[172:175], v4, s[8:11], s24 offen offset:3072 sc1
    buffer_load_dwordx4 v[176:179], v5, s[8:11], s24 offen offset:0 sc1
    buffer_load_dwordx4 v[180:183], v5, s[8:11], s24 offen offset:1024 sc1
    buffer_load_dwordx4 v[184:187], v5, s[8:11], s24 offen offset:2048 sc1
    buffer_load_dwordx4 v[188:191], v5, s[8:11], s24 offen offset:3072 sc1
    s_add_u32 s24, s24, 4194304
    buffer_load_dwordx4 v[20:23], v4, s[8:11], s24 offen offset:0 sc1
    buffer_load_dwordx4 v[24:27], v4, s[8:11], s24 offen offset:1024 sc1
    buffer_load_dwordx4 v[28:31], v4, s[8:11], s24 offen offset:2048 sc1
    buffer_load_dwordx4 v[32:35], v4, s[8:11], s24 offen offset:3072 sc1
    buffer_load_dwordx4 v[36:39], v5, s[8:11], s24 offen offset:0 sc1
    buffer_load_dwordx4 v[40:43], v5, s[8:11], s24 offen offset:1024 sc1
    buffer_load_dwordx4 v[44:47], v5, s[8:11], s24 offen offset:2048 sc1
    buffer_load_dwordx4 v[48:51], v5, s[8:11], s24 offen offset:3072 sc1
    s_add_u32 s24, s24, 4194304
    s_waitcnt vmcnt(16)
    v_pk_add_f32 v[128:129], v[128:129], v[52:53]
    v_pk_add_f32 v[130:131], v[130:131], v[54:55]
    v_pk_add_f32 v[132:133], v[132:133], v[56:57]
    v_pk_add_f32 v[134:135], v[134:135], v[58:59]
    v_pk_add_f32 v[136:137], v[136:137], v[60:61]
    v_pk_add_f32 v[138:139], v[138:139], v[62:63]
    v_pk_add_f32 v[140:141], v[140:141], v[64:65]
    v_pk_add_f32 v[142:143], v[142:143], v[66:67]
    v_pk_add_f32 v[144:145], v[144:145], v[68:69]
    v_pk_add_f32 v[146:147], v[146:147], v[70:71]
    v_pk_add_f32 v[148:149], v[148:149], v[72:73]
    v_pk_add_f32 v[150:151], v[150:151], v[74:75]
    v_pk_add_f32 v[152:153], v[152:153], v[76:77]
    v_pk_add_f32 v[154:155], v[154:155], v[78:79]
    v_pk_add_f32 v[156:157], v[156:157], v[80:81]
    v_pk_add_f32 v[158:159], v[158:159], v[82:83]
    s_waitcnt vmcnt(0)
    v_pk_add_f32 v[20:21], v[20:21], v[160:161]
    v_pk_add_f32 v[20:21], v[128:129], v[20:21]
    v_pk_add_f32 v[22:23], v[22:23], v[162:163]
    v_pk_add_f32 v[22:23], v[130:131], v[22:23]
    v_pk_add_f32 v[24:25], v[24:25], v[164:165]
    v_pk_add_f32 v[24:25], v[132:133], v[24:25]
    v_pk_add_f32 v[26:27], v[26:27], v[166:167]
    v_pk_add_f32 v[26:27], v[134:135], v[26:27]
    v_pk_add_f32 v[28:29], v[28:29], v[168:169]
    v_pk_add_f32 v[28:29], v[136:137], v[28:29]
    v_pk_add_f32 v[30:31], v[30:31], v[170:171]
    v_pk_add_f32 v[30:31], v[138:139], v[30:31]
    v_pk_add_f32 v[32:33], v[32:33], v[172:173]
    v_pk_add_f32 v[32:33], v[140:141], v[32:33]
    v_pk_add_f32 v[34:35], v[34:35], v[174:175]
    v_pk_add_f32 v[34:35], v[142:143], v[34:35]
    v_pk_add_f32 v[36:37], v[36:37], v[176:177]
    v_pk_add_f32 v[36:37], v[144:145], v[36:37]
    v_pk_add_f32 v[38:39], v[38:39], v[178:179]
    v_pk_add_f32 v[38:39], v[146:147], v[38:39]
    v_pk_add_f32 v[40:41], v[40:41], v[180:181]
    v_pk_add_f32 v[40:41], v[148:149], v[40:41]
    v_pk_add_f32 v[42:43], v[42:43], v[182:183]
    v_pk_add_f32 v[42:43], v[150:151], v[42:43]
    v_pk_add_f32 v[44:45], v[44:45], v[184:185]
    v_pk_add_f32 v[44:45], v[152:153], v[44:45]
    v_pk_add_f32 v[46:47], v[46:47], v[186:187]
    v_pk_add_f32 v[46:47], v[154:155], v[46:47]
    v_pk_add_f32 v[48:49], v[48:49], v[188:189]
    v_pk_add_f32 v[48:49], v[156:157], v[48:49]
    v_pk_add_f32 v[50:51], v[50:51], v[190:191]
    v_pk_add_f32 v[50:51], v[158:159], v[50:51]
    s_add_u32 s26, s33, 81920
    buffer_load_dwordx4 v[128:131], v4, s[8:11], s26 offen offset:0 sc1
    buffer_load_dwordx4 v[132:135], v4, s[8:11], s26 offen offset:1024 sc1
    buffer_load_dwordx4 v[136:139], v4, s[8:11], s26 offen offset:2048 sc1
    buffer_load_dwordx4 v[140:143], v4, s[8:11], s26 offen offset:3072 sc1
    buffer_load_dwordx4 v[144:147], v5, s[8:11], s26 offen offset:0 sc1
    buffer_load_dwordx4 v[148:151], v5, s[8:11], s26 offen offset:1024 sc1
    buffer_load_dwordx4 v[152:155], v5, s[8:11], s26 offen offset:2048 sc1
    buffer_load_dwordx4 v[156:159], v5, s[8:11], s26 offen offset:3072 sc1
    s_add_u32 s26, s33, 90112
    buffer_load_dwordx4 v[160:163], v4, s[8:11], s26 offen offset:0 sc1
    buffer_load_dwordx4 v[164:167], v4, s[8:11], s26 offen offset:1024 sc1
    buffer_load_dwordx4 v[168:171], v4, s[8:11], s26 offen offset:2048 sc1
    buffer_load_dwordx4 v[172:175], v4, s[8:11], s26 offen offset:3072 sc1
    buffer_load_dwordx4 v[176:179], v5, s[8:11], s26 offen offset:0 sc1
    buffer_load_dwordx4 v[180:183], v5, s[8:11], s26 offen offset:1024 sc1
    buffer_load_dwordx4 v[184:187], v5, s[8:11], s26 offen offset:2048 sc1
    buffer_load_dwordx4 v[188:191], v5, s[8:11], s26 offen offset:3072 sc1
    v_cvt_pk_bf16_f32 v16, v20, v21
    v_lshlrev_b32 v20, 16, v16
    v_and_b32 v21, 0xffff0000, v16
    v_cvt_pk_bf16_f32 v16, v22, v23
    v_lshlrev_b32 v22, 16, v16
    v_and_b32 v23, 0xffff0000, v16
    v_cvt_pk_bf16_f32 v16, v24, v25
    v_lshlrev_b32 v24, 16, v16
    v_and_b32 v25, 0xffff0000, v16
    v_cvt_pk_bf16_f32 v16, v26, v27
    v_lshlrev_b32 v26, 16, v16
    v_and_b32 v27, 0xffff0000, v16
    v_cvt_pk_bf16_f32 v16, v28, v29
    v_lshlrev_b32 v28, 16, v16
    v_and_b32 v29, 0xffff0000, v16
    v_cvt_pk_bf16_f32 v16, v30, v31
    v_lshlrev_b32 v30, 16, v16
    v_and_b32 v31, 0xffff0000, v16
    v_cvt_pk_bf16_f32 v16, v32, v33
    v_lshlrev_b32 v32, 16, v16
    v_and_b32 v33, 0xffff0000, v16
    v_cvt_pk_bf16_f32 v16, v34, v35
    v_lshlrev_b32 v34, 16, v16
    v_and_b32 v35, 0xffff0000, v16
    v_cvt_pk_bf16_f32 v16, v36, v37
    v_lshlrev_b32 v36, 16, v16
    v_and_b32 v37, 0xffff0000, v16
    v_cvt_pk_bf16_f32 v16, v38, v39
    v_lshlrev_b32 v38, 16, v16
    v_and_b32 v39, 0xffff0000, v16
    v_cvt_pk_bf16_f32 v16, v40, v41
    v_lshlrev_b32 v40, 16, v16
    v_and_b32 v41, 0xffff0000, v16
    v_cvt_pk_bf16_f32 v16, v42, v43
    v_lshlrev_b32 v42, 16, v16
    v_and_b32 v43, 0xffff0000, v16
    v_cvt_pk_bf16_f32 v16, v44, v45
    v_lshlrev_b32 v44, 16, v16
    v_and_b32 v45, 0xffff0000, v16
    v_cvt_pk_bf16_f32 v16, v46, v47
    v_lshlrev_b32 v46, 16, v16
    v_and_b32 v47, 0xffff0000, v16
    v_cvt_pk_bf16_f32 v16, v48, v49
    v_lshlrev_b32 v48, 16, v16
    v_and_b32 v49, 0xffff0000, v16
    v_cvt_pk_bf16_f32 v16, v50, v51
    v_lshlrev_b32 v50, 16, v16
    v_and_b32 v51, 0xffff0000, v16
    v_lshlrev_b32 v52, 16, v84
    v_and_b32 v56, 0xffff0000, v84
    v_lshlrev_b32 v60, 16, v85
    v_and_b32 v64, 0xffff0000, v85
    v_lshlrev_b32 v68, 16, v86
    v_and_b32 v72, 0xffff0000, v86
    v_lshlrev_b32 v76, 16, v87
    v_and_b32 v80, 0xffff0000, v87
    v_lshlrev_b32 v53, 16, v88
    v_and_b32 v57, 0xffff0000, v88
    v_lshlrev_b32 v61, 16, v89
    v_and_b32 v65, 0xffff0000, v89
    v_lshlrev_b32 v69, 16, v90
    v_and_b32 v73, 0xffff0000, v90
    v_lshlrev_b32 v77, 16, v91
    v_and_b32 v81, 0xffff0000, v91
    v_lshlrev_b32 v54, 16, v92
    v_and_b32 v58, 0xffff0000, v92
    v_lshlrev_b32 v62, 16, v93
    v_and_b32 v66, 0xffff0000, v93
    v_lshlrev_b32 v70, 16, v94
    v_and_b32 v74, 0xffff0000, v94
    v_lshlrev_b32 v78, 16, v95
    v_and_b32 v82, 0xffff0000, v95
    v_lshlrev_b32 v55, 16, v96
    v_and_b32 v59, 0xffff0000, v96
    v_lshlrev_b32 v63, 16, v97
    v_and_b32 v67, 0xffff0000, v97
    v_lshlrev_b32 v71, 16, v98
    v_and_b32 v75, 0xffff0000, v98
    v_lshlrev_b32 v79, 16, v99
    v_and_b32 v83, 0xffff0000, v99
    v_pk_add_f32 v[52:53], v[52:53], v[20:21]
    v_pk_add_f32 v[54:55], v[54:55], v[22:23]
    v_pk_add_f32 v[56:57], v[56:57], v[24:25]
    v_pk_add_f32 v[58:59], v[58:59], v[26:27]
    v_pk_add_f32 v[60:61], v[60:61], v[28:29]
    v_pk_add_f32 v[62:63], v[62:63], v[30:31]
    v_pk_add_f32 v[64:65], v[64:65], v[32:33]
    v_pk_add_f32 v[66:67], v[66:67], v[34:35]
    v_pk_add_f32 v[68:69], v[68:69], v[36:37]
    v_pk_add_f32 v[70:71], v[70:71], v[38:39]
    v_pk_add_f32 v[72:73], v[72:73], v[40:41]
    v_pk_add_f32 v[74:75], v[74:75], v[42:43]
    v_pk_add_f32 v[76:77], v[76:77], v[44:45]
    v_pk_add_f32 v[78:79], v[78:79], v[46:47]
    v_pk_add_f32 v[80:81], v[80:81], v[48:49]
    v_pk_add_f32 v[82:83], v[82:83], v[50:51]
    s_lshl_b32 s27, s27, 12
    s_add_u32 s24, s27, 92274688
    s_add_u32 s25, s27, 94371840
    v_cvt_pk_bf16_f32 v84, v52, v56
    v_cvt_pk_bf16_f32 v85, v60, v64
    v_cvt_pk_bf16_f32 v86, v68, v72
    v_cvt_pk_bf16_f32 v87, v76, v80
    buffer_store_dwordx4 v[84:87], v6, s[8:11], s24 offen offset:0 sc1
    v_lshlrev_b32 v52, 16, v84
    v_and_b32 v56, 0xffff0000, v84
    v_lshlrev_b32 v60, 16, v85
    v_and_b32 v64, 0xffff0000, v85
    v_lshlrev_b32 v68, 16, v86
    v_and_b32 v72, 0xffff0000, v86
    v_lshlrev_b32 v76, 16, v87
    v_and_b32 v80, 0xffff0000, v87
    v_cvt_pk_bf16_f32 v88, v53, v57
    v_cvt_pk_bf16_f32 v89, v61, v65
    v_cvt_pk_bf16_f32 v90, v69, v73
    v_cvt_pk_bf16_f32 v91, v77, v81
    buffer_store_dwordx4 v[88:91], v6, s[8:11], s24 offen offset:256 sc1
    v_lshlrev_b32 v53, 16, v88
    v_and_b32 v57, 0xffff0000, v88
    v_lshlrev_b32 v61, 16, v89
    v_and_b32 v65, 0xffff0000, v89
    v_lshlrev_b32 v69, 16, v90
    v_and_b32 v73, 0xffff0000, v90
    v_lshlrev_b32 v77, 16, v91
    v_and_b32 v81, 0xffff0000, v91
    v_cvt_pk_bf16_f32 v92, v54, v58
    v_cvt_pk_bf16_f32 v93, v62, v66
    v_cvt_pk_bf16_f32 v94, v70, v74
    v_cvt_pk_bf16_f32 v95, v78, v82
    buffer_store_dwordx4 v[92:95], v6, s[8:11], s24 offen offset:512 sc1
    v_lshlrev_b32 v54, 16, v92
    v_and_b32 v58, 0xffff0000, v92
    v_lshlrev_b32 v62, 16, v93
    v_and_b32 v66, 0xffff0000, v93
    v_lshlrev_b32 v70, 16, v94
    v_and_b32 v74, 0xffff0000, v94
    v_lshlrev_b32 v78, 16, v95
    v_and_b32 v82, 0xffff0000, v95
    v_cvt_pk_bf16_f32 v96, v55, v59
    v_cvt_pk_bf16_f32 v97, v63, v67
    v_cvt_pk_bf16_f32 v98, v71, v75
    v_cvt_pk_bf16_f32 v99, v79, v83
    buffer_store_dwordx4 v[96:99], v6, s[8:11], s24 offen offset:768 sc1
    v_lshlrev_b32 v55, 16, v96
    v_and_b32 v59, 0xffff0000, v96
    v_lshlrev_b32 v63, 16, v97
    v_and_b32 v67, 0xffff0000, v97
    v_lshlrev_b32 v71, 16, v98
    v_and_b32 v75, 0xffff0000, v98
    v_lshlrev_b32 v79, 16, v99
    v_and_b32 v83, 0xffff0000, v99
    v_pk_add_f32 v[14:15], v[52:53], v[54:55]
    v_pk_add_f32 v[16:17], v[56:57], v[58:59]
    v_pk_add_f32 v[14:15], v[14:15], v[60:61]
    v_pk_add_f32 v[16:17], v[16:17], v[62:63]
    v_pk_add_f32 v[14:15], v[14:15], v[64:65]
    v_pk_add_f32 v[16:17], v[16:17], v[66:67]
    v_pk_add_f32 v[14:15], v[14:15], v[68:69]
    v_pk_add_f32 v[16:17], v[16:17], v[70:71]
    v_pk_add_f32 v[14:15], v[14:15], v[72:73]
    v_pk_add_f32 v[16:17], v[16:17], v[74:75]
    v_pk_add_f32 v[14:15], v[14:15], v[76:77]
    v_pk_add_f32 v[16:17], v[16:17], v[78:79]
    v_pk_add_f32 v[14:15], v[14:15], v[80:81]
    v_pk_add_f32 v[16:17], v[16:17], v[82:83]
    v_pk_add_f32 v[14:15], v[14:15], v[16:17]
    v_add_f32 v14, v14, v15
    v_mov_b32 v16, v14
    s_nop 1
    v_permlane16_swap_b32 v14, v16
    v_add_f32 v14, v14, v16
    v_mov_b32 v16, v14
    s_nop 1
    v_permlane32_swap_b32 v14, v16
    v_add_f32 v14, v14, v16
    ds_write_b32 v8, v14 offset:0
    s_waitcnt lgkmcnt(0)
    s_barrier
    ds_read_b128 v[10:13], v9 offset:0
    s_waitcnt lgkmcnt(0)
    v_add_f32 v14, v10, v11
    v_add_f32 v16, v12, v13
    v_add_f32 v14, v14, v16
    v_mul_f32 v18, 0x3b000000, v14
    v_pk_add_f32 v[16:17], v[52:53], v[18:19] op_sel_hi:[1,0] neg_lo:[0,1] neg_hi:[0,1]
    s_nop 0
    v_pk_mul_f32 v[14:15], v[16:17], v[16:17]
    v_pk_add_f32 v[16:17], v[54:55], v[18:19] op_sel_hi:[1,0] neg_lo:[0,1] neg_hi:[0,1]
    s_nop 0
    v_pk_fma_f32 v[14:15], v[16:17], v[16:17], v[14:15]
    v_pk_add_f32 v[16:17], v[56:57], v[18:19] op_sel_hi:[1,0] neg_lo:[0,1] neg_hi:[0,1]
    s_nop 0
    v_pk_fma_f32 v[14:15], v[16:17], v[16:17], v[14:15]
    v_pk_add_f32 v[16:17], v[58:59], v[18:19] op_sel_hi:[1,0] neg_lo:[0,1] neg_hi:[0,1]
    s_nop 0
    v_pk_fma_f32 v[14:15], v[16:17], v[16:17], v[14:15]
    v_pk_add_f32 v[16:17], v[60:61], v[18:19] op_sel_hi:[1,0] neg_lo:[0,1] neg_hi:[0,1]
    s_nop 0
    v_pk_fma_f32 v[14:15], v[16:17], v[16:17], v[14:15]
    v_pk_add_f32 v[16:17], v[62:63], v[18:19] op_sel_hi:[1,0] neg_lo:[0,1] neg_hi:[0,1]
    s_nop 0
    v_pk_fma_f32 v[14:15], v[16:17], v[16:17], v[14:15]
    v_pk_add_f32 v[16:17], v[64:65], v[18:19] op_sel_hi:[1,0] neg_lo:[0,1] neg_hi:[0,1]
    s_nop 0
    v_pk_fma_f32 v[14:15], v[16:17], v[16:17], v[14:15]
    v_pk_add_f32 v[16:17], v[66:67], v[18:19] op_sel_hi:[1,0] neg_lo:[0,1] neg_hi:[0,1]
    s_nop 0
    v_pk_fma_f32 v[14:15], v[16:17], v[16:17], v[14:15]
    v_pk_add_f32 v[16:17], v[68:69], v[18:19] op_sel_hi:[1,0] neg_lo:[0,1] neg_hi:[0,1]
    s_nop 0
    v_pk_fma_f32 v[14:15], v[16:17], v[16:17], v[14:15]
    v_pk_add_f32 v[16:17], v[70:71], v[18:19] op_sel_hi:[1,0] neg_lo:[0,1] neg_hi:[0,1]
    s_nop 0
    v_pk_fma_f32 v[14:15], v[16:17], v[16:17], v[14:15]
    v_pk_add_f32 v[16:17], v[72:73], v[18:19] op_sel_hi:[1,0] neg_lo:[0,1] neg_hi:[0,1]
    s_nop 0
    v_pk_fma_f32 v[14:15], v[16:17], v[16:17], v[14:15]
    v_pk_add_f32 v[16:17], v[74:75], v[18:19] op_sel_hi:[1,0] neg_lo:[0,1] neg_hi:[0,1]
    s_nop 0
    v_pk_fma_f32 v[14:15], v[16:17], v[16:17], v[14:15]
    v_pk_add_f32 v[16:17], v[76:77], v[18:19] op_sel_hi:[1,0] neg_lo:[0,1] neg_hi:[0,1]
    s_nop 0
    v_pk_fma_f32 v[14:15], v[16:17], v[16:17], v[14:15]
    v_pk_add_f32 v[16:17], v[78:79], v[18:19] op_sel_hi:[1,0] neg_lo:[0,1] neg_hi:[0,1]
    s_nop 0
    v_pk_fma_f32 v[14:15], v[16:17], v[16:17], v[14:15]
    v_pk_add_f32 v[16:17], v[80:81], v[18:19] op_sel_hi:[1,0] neg_lo:[0,1] neg_hi:[0,1]
    s_nop 0
    v_pk_fma_f32 v[14:15], v[16:17], v[16:17], v[14:15]
    v_pk_add_f32 v[16:17], v[82:83], v[18:19] op_sel_hi:[1,0] neg_lo:[0,1] neg_hi:[0,1]
    s_nop 0
    v_pk_fma_f32 v[14:15], v[16:17], v[16:17], v[14:15]
    v_add_f32 v14, v14, v15
    v_mov_b32 v16, v14
    s_nop 1
    v_permlane16_swap_b32 v14, v16
    v_add_f32 v14, v14, v16
    v_mov_b32 v16, v14
    s_nop 1
    v_permlane32_swap_b32 v14, v16
    v_add_f32 v14, v14, v16
    ds_write_b32 v8, v14 offset:256
    s_waitcnt lgkmcnt(0)
    s_barrier
    ds_read_b128 v[10:13], v9 offset:256
    s_waitcnt lgkmcnt(0)
    v_add_f32 v14, v10, v11
    v_add_f32 v16, v12, v13
    v_add_f32 v14, v14, v16
    v_mul_f32 v0, 0x3b000000, v14
    v_cvt_pk_bf16_f32 v0, v0, v0
    v_and_b32 v0, 0xffff0000, v0
    v_add_f32 v0, 0x3727c5ac, v0
    v_cvt_pk_bf16_f32 v0, v0, v0
    v_and_b32 v0, 0xffff0000, v0
    v_sqrt_f32 v0, v0
    s_nop 0
    v_cvt_pk_bf16_f32 v0, v0, v0
    v_and_b32 v0, 0xffff0000, v0
    v_rcp_f32 v0, v0
    v_cvt_pk_bf16_f32 v18, v18, v18
    v_and_b32 v18, 0xffff0000, v18
    v_mov_b32 v14, v0
    v_pk_add_f32 v[52:53], v[52:53], v[18:19] op_sel_hi:[1,0] neg_lo:[0,1] neg_hi:[0,1]
    s_nop 0
    v_cvt_pk_bf16_f32 v16, v52, v53
    v_lshlrev_b32 v52, 16, v16
    v_and_b32 v53, 0xffff0000, v16
    v_pk_mul_f32 v[52:53], v[52:53], v[14:15] op_sel_hi:[1,0]
    v_pk_add_f32 v[54:55], v[54:55], v[18:19] op_sel_hi:[1,0] neg_lo:[0,1] neg_hi:[0,1]
    s_nop 0
    v_cvt_pk_bf16_f32 v17, v54, v55
    v_lshlrev_b32 v54, 16, v17
    v_and_b32 v55, 0xffff0000, v17
    v_pk_mul_f32 v[54:55], v[54:55], v[14:15] op_sel_hi:[1,0]
    v_pk_add_f32 v[56:57], v[56:57], v[18:19] op_sel_hi:[1,0] neg_lo:[0,1] neg_hi:[0,1]
    s_nop 0
    v_cvt_pk_bf16_f32 v16, v56, v57
    v_lshlrev_b32 v56, 16, v16
    v_and_b32 v57, 0xffff0000, v16
    v_pk_mul_f32 v[56:57], v[56:57], v[14:15] op_sel_hi:[1,0]
    v_pk_add_f32 v[58:59], v[58:59], v[18:19] op_sel_hi:[1,0] neg_lo:[0,1] neg_hi:[0,1]
    s_nop 0
    v_cvt_pk_bf16_f32 v17, v58, v59
    v_lshlrev_b32 v58, 16, v17
    v_and_b32 v59, 0xffff0000, v17
    v_pk_mul_f32 v[58:59], v[58:59], v[14:15] op_sel_hi:[1,0]
    v_pk_add_f32 v[60:61], v[60:61], v[18:19] op_sel_hi:[1,0] neg_lo:[0,1] neg_hi:[0,1]
    s_nop 0
    v_cvt_pk_bf16_f32 v16, v60, v61
    v_lshlrev_b32 v60, 16, v16
    v_and_b32 v61, 0xffff0000, v16
    v_pk_mul_f32 v[60:61], v[60:61], v[14:15] op_sel_hi:[1,0]
    v_pk_add_f32 v[62:63], v[62:63], v[18:19] op_sel_hi:[1,0] neg_lo:[0,1] neg_hi:[0,1]
    s_nop 0
    v_cvt_pk_bf16_f32 v17, v62, v63
    v_lshlrev_b32 v62, 16, v17
    v_and_b32 v63, 0xffff0000, v17
    v_pk_mul_f32 v[62:63], v[62:63], v[14:15] op_sel_hi:[1,0]
    v_pk_add_f32 v[64:65], v[64:65], v[18:19] op_sel_hi:[1,0] neg_lo:[0,1] neg_hi:[0,1]
    s_nop 0
    v_cvt_pk_bf16_f32 v16, v64, v65
    v_lshlrev_b32 v64, 16, v16
    v_and_b32 v65, 0xffff0000, v16
    v_pk_mul_f32 v[64:65], v[64:65], v[14:15] op_sel_hi:[1,0]
    v_pk_add_f32 v[66:67], v[66:67], v[18:19] op_sel_hi:[1,0] neg_lo:[0,1] neg_hi:[0,1]
    s_nop 0
    v_cvt_pk_bf16_f32 v17, v66, v67
    v_lshlrev_b32 v66, 16, v17
    v_and_b32 v67, 0xffff0000, v17
    v_pk_mul_f32 v[66:67], v[66:67], v[14:15] op_sel_hi:[1,0]
    v_pk_add_f32 v[68:69], v[68:69], v[18:19] op_sel_hi:[1,0] neg_lo:[0,1] neg_hi:[0,1]
    s_nop 0
    v_cvt_pk_bf16_f32 v16, v68, v69
    v_lshlrev_b32 v68, 16, v16
    v_and_b32 v69, 0xffff0000, v16
    v_pk_mul_f32 v[68:69], v[68:69], v[14:15] op_sel_hi:[1,0]
    v_pk_add_f32 v[70:71], v[70:71], v[18:19] op_sel_hi:[1,0] neg_lo:[0,1] neg_hi:[0,1]
    s_nop 0
    v_cvt_pk_bf16_f32 v17, v70, v71
    v_lshlrev_b32 v70, 16, v17
    v_and_b32 v71, 0xffff0000, v17
    v_pk_mul_f32 v[70:71], v[70:71], v[14:15] op_sel_hi:[1,0]
    v_pk_add_f32 v[72:73], v[72:73], v[18:19] op_sel_hi:[1,0] neg_lo:[0,1] neg_hi:[0,1]
    s_nop 0
    v_cvt_pk_bf16_f32 v16, v72, v73
    v_lshlrev_b32 v72, 16, v16
    v_and_b32 v73, 0xffff0000, v16
    v_pk_mul_f32 v[72:73], v[72:73], v[14:15] op_sel_hi:[1,0]
    v_pk_add_f32 v[74:75], v[74:75], v[18:19] op_sel_hi:[1,0] neg_lo:[0,1] neg_hi:[0,1]
    s_nop 0
    v_cvt_pk_bf16_f32 v17, v74, v75
    v_lshlrev_b32 v74, 16, v17
    v_and_b32 v75, 0xffff0000, v17
    v_pk_mul_f32 v[74:75], v[74:75], v[14:15] op_sel_hi:[1,0]
    v_pk_add_f32 v[76:77], v[76:77], v[18:19] op_sel_hi:[1,0] neg_lo:[0,1] neg_hi:[0,1]
    s_nop 0
    v_cvt_pk_bf16_f32 v16, v76, v77
    v_lshlrev_b32 v76, 16, v16
    v_and_b32 v77, 0xffff0000, v16
    v_pk_mul_f32 v[76:77], v[76:77], v[14:15] op_sel_hi:[1,0]
    v_pk_add_f32 v[78:79], v[78:79], v[18:19] op_sel_hi:[1,0] neg_lo:[0,1] neg_hi:[0,1]
    s_nop 0
    v_cvt_pk_bf16_f32 v17, v78, v79
    v_lshlrev_b32 v78, 16, v17
    v_and_b32 v79, 0xffff0000, v17
    v_pk_mul_f32 v[78:79], v[78:79], v[14:15] op_sel_hi:[1,0]
    v_pk_add_f32 v[80:81], v[80:81], v[18:19] op_sel_hi:[1,0] neg_lo:[0,1] neg_hi:[0,1]
    s_nop 0
    v_cvt_pk_bf16_f32 v16, v80, v81
    v_lshlrev_b32 v80, 16, v16
    v_and_b32 v81, 0xffff0000, v16
    v_pk_mul_f32 v[80:81], v[80:81], v[14:15] op_sel_hi:[1,0]
    v_pk_add_f32 v[82:83], v[82:83], v[18:19] op_sel_hi:[1,0] neg_lo:[0,1] neg_hi:[0,1]
    s_nop 0
    v_cvt_pk_bf16_f32 v17, v82, v83
    v_lshlrev_b32 v82, 16, v17
    v_and_b32 v83, 0xffff0000, v17
    v_pk_mul_f32 v[82:83], v[82:83], v[14:15] op_sel_hi:[1,0]
    v_cvt_pk_bf16_f32 v20, v52, v56
    v_cvt_pk_bf16_f32 v21, v60, v64
    v_cvt_pk_bf16_f32 v22, v68, v72
    v_cvt_pk_bf16_f32 v23, v76, v80
    buffer_store_dwordx4 v[20:23], v6, s[8:11], s25 offen offset:0 sc1
    v_lshlrev_b32 v52, 16, v20
    v_and_b32 v56, 0xffff0000, v20
    v_lshlrev_b32 v60, 16, v21
    v_and_b32 v64, 0xffff0000, v21
    v_lshlrev_b32 v68, 16, v22
    v_and_b32 v72, 0xffff0000, v22
    v_lshlrev_b32 v76, 16, v23
    v_and_b32 v80, 0xffff0000, v23
    v_cvt_pk_bf16_f32 v24, v53, v57
    v_cvt_pk_bf16_f32 v25, v61, v65
    v_cvt_pk_bf16_f32 v26, v69, v73
    v_cvt_pk_bf16_f32 v27, v77, v81
    buffer_store_dwordx4 v[24:27], v6, s[8:11], s25 offen offset:256 sc1
    v_lshlrev_b32 v53, 16, v24
    v_and_b32 v57, 0xffff0000, v24
    v_lshlrev_b32 v61, 16, v25
    v_and_b32 v65, 0xffff0000, v25
    v_lshlrev_b32 v69, 16, v26
    v_and_b32 v73, 0xffff0000, v26
    v_lshlrev_b32 v77, 16, v27
    v_and_b32 v81, 0xffff0000, v27
    v_cvt_pk_bf16_f32 v28, v54, v58
    v_cvt_pk_bf16_f32 v29, v62, v66
    v_cvt_pk_bf16_f32 v30, v70, v74
    v_cvt_pk_bf16_f32 v31, v78, v82
    buffer_store_dwordx4 v[28:31], v6, s[8:11], s25 offen offset:512 sc1
    v_lshlrev_b32 v54, 16, v28
    v_and_b32 v58, 0xffff0000, v28
    v_lshlrev_b32 v62, 16, v29
    v_and_b32 v66, 0xffff0000, v29
    v_lshlrev_b32 v70, 16, v30
    v_and_b32 v74, 0xffff0000, v30
    v_lshlrev_b32 v78, 16, v31
    v_and_b32 v82, 0xffff0000, v31
    v_cvt_pk_bf16_f32 v32, v55, v59
    v_cvt_pk_bf16_f32 v33, v63, v67
    v_cvt_pk_bf16_f32 v34, v71, v75
    v_cvt_pk_bf16_f32 v35, v79, v83
    buffer_store_dwordx4 v[32:35], v6, s[8:11], s25 offen offset:768 sc1
    v_lshlrev_b32 v55, 16, v32
    v_and_b32 v59, 0xffff0000, v32
    v_lshlrev_b32 v63, 16, v33
    v_and_b32 v67, 0xffff0000, v33
    v_lshlrev_b32 v71, 16, v34
    v_and_b32 v75, 0xffff0000, v34
    v_lshlrev_b32 v79, 16, v35
    v_and_b32 v83, 0xffff0000, v35
    v_pk_add_f32 v[14:15], v[52:53], v[54:55]
    v_pk_add_f32 v[16:17], v[56:57], v[58:59]
    v_pk_add_f32 v[14:15], v[14:15], v[60:61]
    v_pk_add_f32 v[16:17], v[16:17], v[62:63]
    v_pk_add_f32 v[14:15], v[14:15], v[64:65]
    v_pk_add_f32 v[16:17], v[16:17], v[66:67]
    v_pk_add_f32 v[14:15], v[14:15], v[68:69]
    v_pk_add_f32 v[16:17], v[16:17], v[70:71]
    v_pk_add_f32 v[14:15], v[14:15], v[72:73]
    v_pk_add_f32 v[16:17], v[16:17], v[74:75]
    v_pk_add_f32 v[14:15], v[14:15], v[76:77]
    v_pk_add_f32 v[16:17], v[16:17], v[78:79]
    v_pk_add_f32 v[14:15], v[14:15], v[80:81]
    v_pk_add_f32 v[16:17], v[16:17], v[82:83]
    v_pk_add_f32 v[14:15], v[14:15], v[16:17]
    v_add_f32 v14, v14, v15
    v_mov_b32 v16, v14
    s_nop 1
    v_permlane16_swap_b32 v14, v16
    v_add_f32 v14, v14, v16
    v_mov_b32 v16, v14
    s_nop 1
    v_permlane32_swap_b32 v14, v16
    v_add_f32 v14, v14, v16
    ds_write_b32 v8, v14 offset:512
    s_waitcnt lgkmcnt(0)
    s_barrier
    ds_read_b128 v[10:13], v9 offset:512
    s_waitcnt lgkmcnt(0)
    v_add_f32 v14, v10, v11
    v_add_f32 v16, v12, v13
    v_add_f32 v14, v14, v16
    v_mul_f32 v18, 0x3b000000, v14
    v_pk_add_f32 v[16:17], v[52:53], v[18:19] op_sel_hi:[1,0] neg_lo:[0,1] neg_hi:[0,1]
    s_nop 0
    v_pk_mul_f32 v[14:15], v[16:17], v[16:17]
    v_pk_add_f32 v[16:17], v[54:55], v[18:19] op_sel_hi:[1,0] neg_lo:[0,1] neg_hi:[0,1]
    s_nop 0
    v_pk_fma_f32 v[14:15], v[16:17], v[16:17], v[14:15]
    v_pk_add_f32 v[16:17], v[56:57], v[18:19] op_sel_hi:[1,0] neg_lo:[0,1] neg_hi:[0,1]
    s_nop 0
    v_pk_fma_f32 v[14:15], v[16:17], v[16:17], v[14:15]
    v_pk_add_f32 v[16:17], v[58:59], v[18:19] op_sel_hi:[1,0] neg_lo:[0,1] neg_hi:[0,1]
    s_nop 0
    v_pk_fma_f32 v[14:15], v[16:17], v[16:17], v[14:15]
    v_pk_add_f32 v[16:17], v[60:61], v[18:19] op_sel_hi:[1,0] neg_lo:[0,1] neg_hi:[0,1]
    s_nop 0
    v_pk_fma_f32 v[14:15], v[16:17], v[16:17], v[14:15]
    v_pk_add_f32 v[16:17], v[62:63], v[18:19] op_sel_hi:[1,0] neg_lo:[0,1] neg_hi:[0,1]
    s_nop 0
    v_pk_fma_f32 v[14:15], v[16:17], v[16:17], v[14:15]
    v_pk_add_f32 v[16:17], v[64:65], v[18:19] op_sel_hi:[1,0] neg_lo:[0,1] neg_hi:[0,1]
    s_nop 0
    v_pk_fma_f32 v[14:15], v[16:17], v[16:17], v[14:15]
    v_pk_add_f32 v[16:17], v[66:67], v[18:19] op_sel_hi:[1,0] neg_lo:[0,1] neg_hi:[0,1]
    s_nop 0
    v_pk_fma_f32 v[14:15], v[16:17], v[16:17], v[14:15]
    v_pk_add_f32 v[16:17], v[68:69], v[18:19] op_sel_hi:[1,0] neg_lo:[0,1] neg_hi:[0,1]
    s_nop 0
    v_pk_fma_f32 v[14:15], v[16:17], v[16:17], v[14:15]
    v_pk_add_f32 v[16:17], v[70:71], v[18:19] op_sel_hi:[1,0] neg_lo:[0,1] neg_hi:[0,1]
    s_nop 0
    v_pk_fma_f32 v[14:15], v[16:17], v[16:17], v[14:15]
    v_pk_add_f32 v[16:17], v[72:73], v[18:19] op_sel_hi:[1,0] neg_lo:[0,1] neg_hi:[0,1]
    s_nop 0
    v_pk_fma_f32 v[14:15], v[16:17], v[16:17], v[14:15]
    v_pk_add_f32 v[16:17], v[74:75], v[18:19] op_sel_hi:[1,0] neg_lo:[0,1] neg_hi:[0,1]
    s_nop 0
    v_pk_fma_f32 v[14:15], v[16:17], v[16:17], v[14:15]
    v_pk_add_f32 v[16:17], v[76:77], v[18:19] op_sel_hi:[1,0] neg_lo:[0,1] neg_hi:[0,1]
    s_nop 0
    v_pk_fma_f32 v[14:15], v[16:17], v[16:17], v[14:15]
    v_pk_add_f32 v[16:17], v[78:79], v[18:19] op_sel_hi:[1,0] neg_lo:[0,1] neg_hi:[0,1]
    s_nop 0
    v_pk_fma_f32 v[14:15], v[16:17], v[16:17], v[14:15]
    v_pk_add_f32 v[16:17], v[80:81], v[18:19] op_sel_hi:[1,0] neg_lo:[0,1] neg_hi:[0,1]
    s_nop 0
    v_pk_fma_f32 v[14:15], v[16:17], v[16:17], v[14:15]
    v_pk_add_f32 v[16:17], v[82:83], v[18:19] op_sel_hi:[1,0] neg_lo:[0,1] neg_hi:[0,1]
    s_nop 0
    v_pk_fma_f32 v[14:15], v[16:17], v[16:17], v[14:15]
    v_add_f32 v14, v14, v15
    v_mov_b32 v16, v14
    s_nop 1
    v_permlane16_swap_b32 v14, v16
    v_add_f32 v14, v14, v16
    v_mov_b32 v16, v14
    s_nop 1
    v_permlane32_swap_b32 v14, v16
    v_add_f32 v14, v14, v16
    ds_write_b32 v8, v14 offset:768
    s_waitcnt lgkmcnt(0)
    s_barrier
    ds_read_b128 v[10:13], v9 offset:768
    s_waitcnt lgkmcnt(0)
    v_add_f32 v14, v10, v11
    v_add_f32 v16, v12, v13
    v_add_f32 v14, v14, v16
    v_mul_f32 v0, 0x3b000000, v14
    v_cvt_pk_bf16_f32 v0, v0, v0
    v_and_b32 v0, 0xffff0000, v0
    v_add_f32 v0, 0x3727c5ac, v0
    v_cvt_pk_bf16_f32 v0, v0, v0
    v_and_b32 v0, 0xffff0000, v0
    v_sqrt_f32 v0, v0
    s_nop 0
    v_cvt_pk_bf16_f32 v0, v0, v0
    v_and_b32 v0, 0xffff0000, v0
    v_rcp_f32 v0, v0
    v_cvt_pk_bf16_f32 v18, v18, v18
    v_and_b32 v18, 0xffff0000, v18
    v_mov_b32 v14, v0
    v_pk_add_f32 v[52:53], v[52:53], v[18:19] op_sel_hi:[1,0] neg_lo:[0,1] neg_hi:[0,1]
    s_nop 0
    v_cvt_pk_bf16_f32 v16, v52, v53
    v_lshlrev_b32 v52, 16, v16
    v_and_b32 v53, 0xffff0000, v16
    v_pk_mul_f32 v[52:53], v[52:53], v[14:15] op_sel_hi:[1,0]
    v_pk_add_f32 v[54:55], v[54:55], v[18:19] op_sel_hi:[1,0] neg_lo:[0,1] neg_hi:[0,1]
    s_nop 0
    v_cvt_pk_bf16_f32 v17, v54, v55
    v_lshlrev_b32 v54, 16, v17
    v_and_b32 v55, 0xffff0000, v17
    v_pk_mul_f32 v[54:55], v[54:55], v[14:15] op_sel_hi:[1,0]
    v_pk_add_f32 v[56:57], v[56:57], v[18:19] op_sel_hi:[1,0] neg_lo:[0,1] neg_hi:[0,1]
    s_nop 0
    v_cvt_pk_bf16_f32 v16, v56, v57
    v_lshlrev_b32 v56, 16, v16
    v_and_b32 v57, 0xffff0000, v16
    v_pk_mul_f32 v[56:57], v[56:57], v[14:15] op_sel_hi:[1,0]
    v_pk_add_f32 v[58:59], v[58:59], v[18:19] op_sel_hi:[1,0] neg_lo:[0,1] neg_hi:[0,1]
    s_nop 0
    v_cvt_pk_bf16_f32 v17, v58, v59
    v_lshlrev_b32 v58, 16, v17
    v_and_b32 v59, 0xffff0000, v17
    v_pk_mul_f32 v[58:59], v[58:59], v[14:15] op_sel_hi:[1,0]
    v_pk_add_f32 v[60:61], v[60:61], v[18:19] op_sel_hi:[1,0] neg_lo:[0,1] neg_hi:[0,1]
    s_nop 0
    v_cvt_pk_bf16_f32 v16, v60, v61
    v_lshlrev_b32 v60, 16, v16
    v_and_b32 v61, 0xffff0000, v16
    v_pk_mul_f32 v[60:61], v[60:61], v[14:15] op_sel_hi:[1,0]
    v_pk_add_f32 v[62:63], v[62:63], v[18:19] op_sel_hi:[1,0] neg_lo:[0,1] neg_hi:[0,1]
    s_nop 0
    v_cvt_pk_bf16_f32 v17, v62, v63
    v_lshlrev_b32 v62, 16, v17
    v_and_b32 v63, 0xffff0000, v17
    v_pk_mul_f32 v[62:63], v[62:63], v[14:15] op_sel_hi:[1,0]
    v_pk_add_f32 v[64:65], v[64:65], v[18:19] op_sel_hi:[1,0] neg_lo:[0,1] neg_hi:[0,1]
    s_nop 0
    v_cvt_pk_bf16_f32 v16, v64, v65
    v_lshlrev_b32 v64, 16, v16
    v_and_b32 v65, 0xffff0000, v16
    v_pk_mul_f32 v[64:65], v[64:65], v[14:15] op_sel_hi:[1,0]
    v_pk_add_f32 v[66:67], v[66:67], v[18:19] op_sel_hi:[1,0] neg_lo:[0,1] neg_hi:[0,1]
    s_nop 0
    v_cvt_pk_bf16_f32 v17, v66, v67
    v_lshlrev_b32 v66, 16, v17
    v_and_b32 v67, 0xffff0000, v17
    v_pk_mul_f32 v[66:67], v[66:67], v[14:15] op_sel_hi:[1,0]
    v_pk_add_f32 v[68:69], v[68:69], v[18:19] op_sel_hi:[1,0] neg_lo:[0,1] neg_hi:[0,1]
    s_nop 0
    v_cvt_pk_bf16_f32 v16, v68, v69
    v_lshlrev_b32 v68, 16, v16
    v_and_b32 v69, 0xffff0000, v16
    v_pk_mul_f32 v[68:69], v[68:69], v[14:15] op_sel_hi:[1,0]
    v_pk_add_f32 v[70:71], v[70:71], v[18:19] op_sel_hi:[1,0] neg_lo:[0,1] neg_hi:[0,1]
    s_nop 0
    v_cvt_pk_bf16_f32 v17, v70, v71
    v_lshlrev_b32 v70, 16, v17
    v_and_b32 v71, 0xffff0000, v17
    v_pk_mul_f32 v[70:71], v[70:71], v[14:15] op_sel_hi:[1,0]
    v_pk_add_f32 v[72:73], v[72:73], v[18:19] op_sel_hi:[1,0] neg_lo:[0,1] neg_hi:[0,1]
    s_nop 0
    v_cvt_pk_bf16_f32 v16, v72, v73
    v_lshlrev_b32 v72, 16, v16
    v_and_b32 v73, 0xffff0000, v16
    v_pk_mul_f32 v[72:73], v[72:73], v[14:15] op_sel_hi:[1,0]
    v_pk_add_f32 v[74:75], v[74:75], v[18:19] op_sel_hi:[1,0] neg_lo:[0,1] neg_hi:[0,1]
    s_nop 0
    v_cvt_pk_bf16_f32 v17, v74, v75
    v_lshlrev_b32 v74, 16, v17
    v_and_b32 v75, 0xffff0000, v17
    v_pk_mul_f32 v[74:75], v[74:75], v[14:15] op_sel_hi:[1,0]
    v_pk_add_f32 v[76:77], v[76:77], v[18:19] op_sel_hi:[1,0] neg_lo:[0,1] neg_hi:[0,1]
    s_nop 0
    v_cvt_pk_bf16_f32 v16, v76, v77
    v_lshlrev_b32 v76, 16, v16
    v_and_b32 v77, 0xffff0000, v16
    v_pk_mul_f32 v[76:77], v[76:77], v[14:15] op_sel_hi:[1,0]
    v_pk_add_f32 v[78:79], v[78:79], v[18:19] op_sel_hi:[1,0] neg_lo:[0,1] neg_hi:[0,1]
    s_nop 0
    v_cvt_pk_bf16_f32 v17, v78, v79
    v_lshlrev_b32 v78, 16, v17
    v_and_b32 v79, 0xffff0000, v17
    v_pk_mul_f32 v[78:79], v[78:79], v[14:15] op_sel_hi:[1,0]
    v_pk_add_f32 v[80:81], v[80:81], v[18:19] op_sel_hi:[1,0] neg_lo:[0,1] neg_hi:[0,1]
    s_nop 0
    v_cvt_pk_bf16_f32 v16, v80, v81
    v_lshlrev_b32 v80, 16, v16
    v_and_b32 v81, 0xffff0000, v16
    v_pk_mul_f32 v[80:81], v[80:81], v[14:15] op_sel_hi:[1,0]
    v_pk_add_f32 v[82:83], v[82:83], v[18:19] op_sel_hi:[1,0] neg_lo:[0,1] neg_hi:[0,1]
    s_nop 0
    v_cvt_pk_bf16_f32 v17, v82, v83
    v_lshlrev_b32 v82, 16, v17
    v_and_b32 v83, 0xffff0000, v17
    v_pk_mul_f32 v[82:83], v[82:83], v[14:15] op_sel_hi:[1,0]
    s_lshl_b32 s30, s19, 12
    v_add_u32 v14, s30, v6
    v_cvt_pk_bf16_f32 v36, v52, v56
    v_cvt_pk_bf16_f32 v37, v60, v64
    v_cvt_pk_bf16_f32 v38, v68, v72
    v_cvt_pk_bf16_f32 v39, v76, v80
    ds_write_b128 v14, v[36:39] offset:0
    v_cvt_pk_bf16_f32 v40, v53, v57
    v_cvt_pk_bf16_f32 v41, v61, v65
    v_cvt_pk_bf16_f32 v42, v69, v73
    v_cvt_pk_bf16_f32 v43, v77, v81
    ds_write_b128 v14, v[40:43] offset:256
    v_cvt_pk_bf16_f32 v44, v54, v58
    v_cvt_pk_bf16_f32 v45, v62, v66
    v_cvt_pk_bf16_f32 v46, v70, v74
    v_cvt_pk_bf16_f32 v47, v78, v82
    ds_write_b128 v14, v[44:47] offset:512
    v_cvt_pk_bf16_f32 v48, v55, v59
    v_cvt_pk_bf16_f32 v49, v63, v67
    v_cvt_pk_bf16_f32 v50, v71, v75
    v_cvt_pk_bf16_f32 v51, v79, v83
    ds_write_b128 v14, v[48:51] offset:768
    s_waitcnt lgkmcnt(0)
    s_barrier
    ds_read_b128 v[52:55], v4 offset:0
    ds_read_b128 v[56:59], v4 offset:1024
    ds_read_b128 v[60:63], v4 offset:2048
    ds_read_b128 v[64:67], v4 offset:3072
    ds_read_b128 v[68:71], v4 offset:4096
    ds_read_b128 v[72:75], v4 offset:5120
    ds_read_b128 v[76:79], v4 offset:6144
    ds_read_b128 v[80:83], v4 offset:7168
    ds_read_b128 v[84:87], v4 offset:8192
    ds_read_b128 v[88:91], v4 offset:9216
    ds_read_b128 v[92:95], v4 offset:10240
    ds_read_b128 v[96:99], v4 offset:11264
    s_waitcnt lgkmcnt(4)
    ds_read_b128 v[100:103], v4 offset:12288
    ds_read_b128 v[104:107], v4 offset:13312
    ds_read_b128 v[108:111], v4 offset:14336
    ds_read_b128 v[112:115], v4 offset:15360
    s_waitcnt vmcnt(0) lgkmcnt(0)
    v_add_u32 v14, s31, v4
    v_mfma_f32_16x16x32_bf16 v[20:23], v[192:195], v[52:55], 0
    v_mfma_f32_16x16x32_bf16 v[24:27], v[196:199], v[52:55], 0
    v_mfma_f32_16x16x32_bf16 v[28:31], v[200:203], v[52:55], 0
    v_mfma_f32_16x16x32_bf16 v[32:35], v[204:207], v[52:55], 0
    v_mfma_f32_16x16x32_bf16 v[36:39], v[208:211], v[52:55], 0
    v_mfma_f32_16x16x32_bf16 v[40:43], v[212:215], v[52:55], 0
    v_mfma_f32_16x16x32_bf16 v[44:47], v[216:219], v[52:55], 0
    v_mfma_f32_16x16x32_bf16 v[48:51], v[220:223], v[52:55], 0
    v_mfma_f32_16x16x32_bf16 v[20:23], v[224:227], v[56:59], v[20:23]
    v_mfma_f32_16x16x32_bf16 v[24:27], v[228:231], v[56:59], v[24:27]
    v_mfma_f32_16x16x32_bf16 v[28:31], v[232:235], v[56:59], v[28:31]
    v_mfma_f32_16x16x32_bf16 v[32:35], v[236:239], v[56:59], v[32:35]
    v_mfma_f32_16x16x32_bf16 v[36:39], v[240:243], v[56:59], v[36:39]
    v_mfma_f32_16x16x32_bf16 v[40:43], v[244:247], v[56:59], v[40:43]
    v_mfma_f32_16x16x32_bf16 v[44:47], v[248:251], v[56:59], v[44:47]
    v_mfma_f32_16x16x32_bf16 v[48:51], v[252:255], v[56:59], v[48:51]
    v_mfma_f32_16x16x32_bf16 v[20:23], a[0:3], v[60:63], v[20:23]
    v_mfma_f32_16x16x32_bf16 v[24:27], a[4:7], v[60:63], v[24:27]
    v_mfma_f32_16x16x32_bf16 v[28:31], a[8:11], v[60:63], v[28:31]
    v_mfma_f32_16x16x32_bf16 v[32:35], a[12:15], v[60:63], v[32:35]
    v_mfma_f32_16x16x32_bf16 v[36:39], a[16:19], v[60:63], v[36:39]
    v_mfma_f32_16x16x32_bf16 v[40:43], a[20:23], v[60:63], v[40:43]
    v_mfma_f32_16x16x32_bf16 v[44:47], a[24:27], v[60:63], v[44:47]
    v_mfma_f32_16x16x32_bf16 v[48:51], a[28:31], v[60:63], v[48:51]
    v_mfma_f32_16x16x32_bf16 v[20:23], a[32:35], v[64:67], v[20:23]
    v_mfma_f32_16x16x32_bf16 v[24:27], a[36:39], v[64:67], v[24:27]
    v_mfma_f32_16x16x32_bf16 v[28:31], a[40:43], v[64:67], v[28:31]
    v_mfma_f32_16x16x32_bf16 v[32:35], a[44:47], v[64:67], v[32:35]
    v_mfma_f32_16x16x32_bf16 v[36:39], a[48:51], v[64:67], v[36:39]
    v_mfma_f32_16x16x32_bf16 v[40:43], a[52:55], v[64:67], v[40:43]
    v_mfma_f32_16x16x32_bf16 v[44:47], a[56:59], v[64:67], v[44:47]
    v_mfma_f32_16x16x32_bf16 v[48:51], a[60:63], v[64:67], v[48:51]
    v_mfma_f32_16x16x32_bf16 v[20:23], a[64:67], v[68:71], v[20:23]
    v_mfma_f32_16x16x32_bf16 v[24:27], a[68:71], v[68:71], v[24:27]
    v_mfma_f32_16x16x32_bf16 v[28:31], a[72:75], v[68:71], v[28:31]
    v_mfma_f32_16x16x32_bf16 v[32:35], a[76:79], v[68:71], v[32:35]
    v_mfma_f32_16x16x32_bf16 v[36:39], a[80:83], v[68:71], v[36:39]
    v_mfma_f32_16x16x32_bf16 v[40:43], a[84:87], v[68:71], v[40:43]
    v_mfma_f32_16x16x32_bf16 v[44:47], a[88:91], v[68:71], v[44:47]
    v_mfma_f32_16x16x32_bf16 v[48:51], a[92:95], v[68:71], v[48:51]
    v_mfma_f32_16x16x32_bf16 v[20:23], a[96:99], v[72:75], v[20:23]
    v_mfma_f32_16x16x32_bf16 v[24:27], a[100:103], v[72:75], v[24:27]
    v_mfma_f32_16x16x32_bf16 v[28:31], a[104:107], v[72:75], v[28:31]
    v_mfma_f32_16x16x32_bf16 v[32:35], a[108:111], v[72:75], v[32:35]
    v_mfma_f32_16x16x32_bf16 v[36:39], a[112:115], v[72:75], v[36:39]
    v_mfma_f32_16x16x32_bf16 v[40:43], a[116:119], v[72:75], v[40:43]
    v_mfma_f32_16x16x32_bf16 v[44:47], a[120:123], v[72:75], v[44:47]
    v_mfma_f32_16x16x32_bf16 v[48:51], a[124:127], v[72:75], v[48:51]
    v_mfma_f32_16x16x32_bf16 v[20:23], a[128:131], v[76:79], v[20:23]
    v_mfma_f32_16x16x32_bf16 v[24:27], a[132:135], v[76:79], v[24:27]
    v_mfma_f32_16x16x32_bf16 v[28:31], a[136:139], v[76:79], v[28:31]
    v_mfma_f32_16x16x32_bf16 v[32:35], a[140:143], v[76:79], v[32:35]
    v_mfma_f32_16x16x32_bf16 v[36:39], a[144:147], v[76:79], v[36:39]
    v_mfma_f32_16x16x32_bf16 v[40:43], a[148:151], v[76:79], v[40:43]
    v_mfma_f32_16x16x32_bf16 v[44:47], a[152:155], v[76:79], v[44:47]
    v_mfma_f32_16x16x32_bf16 v[48:51], a[156:159], v[76:79], v[48:51]
    v_mfma_f32_16x16x32_bf16 v[20:23], a[160:163], v[80:83], v[20:23]
    v_mfma_f32_16x16x32_bf16 v[24:27], a[164:167], v[80:83], v[24:27]
    v_mfma_f32_16x16x32_bf16 v[28:31], a[168:171], v[80:83], v[28:31]
    v_mfma_f32_16x16x32_bf16 v[32:35], a[172:175], v[80:83], v[32:35]
    v_mfma_f32_16x16x32_bf16 v[36:39], a[176:179], v[80:83], v[36:39]
    v_mfma_f32_16x16x32_bf16 v[40:43], a[180:183], v[80:83], v[40:43]
    v_mfma_f32_16x16x32_bf16 v[44:47], a[184:187], v[80:83], v[44:47]
    v_mfma_f32_16x16x32_bf16 v[48:51], a[188:191], v[80:83], v[48:51]
    v_mfma_f32_16x16x32_bf16 v[20:23], a[192:195], v[84:87], v[20:23]
    ds_read_b128 v[52:55], v14 offset:0
    v_mfma_f32_16x16x32_bf16 v[24:27], a[196:199], v[84:87], v[24:27]
    ds_read_b128 v[56:59], v14 offset:1024
    v_mfma_f32_16x16x32_bf16 v[28:31], a[200:203], v[84:87], v[28:31]
    ds_read_b128 v[60:63], v14 offset:2048
    v_mfma_f32_16x16x32_bf16 v[32:35], a[204:207], v[84:87], v[32:35]
    ds_read_b128 v[64:67], v14 offset:3072
    v_mfma_f32_16x16x32_bf16 v[36:39], a[208:211], v[84:87], v[36:39]
    ds_read_b128 v[68:71], v14 offset:4096
    v_mfma_f32_16x16x32_bf16 v[40:43], a[212:215], v[84:87], v[40:43]
    ds_read_b128 v[72:75], v14 offset:5120
    v_mfma_f32_16x16x32_bf16 v[44:47], a[216:219], v[84:87], v[44:47]
    ds_read_b128 v[76:79], v14 offset:6144
    v_mfma_f32_16x16x32_bf16 v[48:51], a[220:223], v[84:87], v[48:51]
    ds_read_b128 v[80:83], v14 offset:7168
    v_mfma_f32_16x16x32_bf16 v[20:23], a[224:227], v[88:91], v[20:23]
    v_mfma_f32_16x16x32_bf16 v[24:27], a[228:231], v[88:91], v[24:27]
    v_mfma_f32_16x16x32_bf16 v[28:31], a[232:235], v[88:91], v[28:31]
    v_mfma_f32_16x16x32_bf16 v[32:35], a[236:239], v[88:91], v[32:35]
    v_mfma_f32_16x16x32_bf16 v[36:39], a[240:243], v[88:91], v[36:39]
    v_mfma_f32_16x16x32_bf16 v[40:43], a[244:247], v[88:91], v[40:43]
    v_mfma_f32_16x16x32_bf16 v[44:47], a[248:251], v[88:91], v[44:47]
    v_mfma_f32_16x16x32_bf16 v[48:51], a[252:255], v[88:91], v[48:51]
    s_waitcnt lgkmcnt(7)
    v_mfma_f32_16x16x32_bf16 v[20:23], v[52:55], v[100:103], v[20:23]
    ds_read_b128 v[52:55], v14 offset:8192
    s_waitcnt lgkmcnt(7)
    v_mfma_f32_16x16x32_bf16 v[24:27], v[56:59], v[100:103], v[24:27]
    ds_read_b128 v[56:59], v14 offset:9216
    s_waitcnt lgkmcnt(7)
    v_mfma_f32_16x16x32_bf16 v[28:31], v[60:63], v[100:103], v[28:31]
    ds_read_b128 v[60:63], v14 offset:10240
    s_waitcnt lgkmcnt(7)
    v_mfma_f32_16x16x32_bf16 v[32:35], v[64:67], v[100:103], v[32:35]
    ds_read_b128 v[64:67], v14 offset:11264
    s_waitcnt lgkmcnt(7)
    v_mfma_f32_16x16x32_bf16 v[36:39], v[68:71], v[100:103], v[36:39]
    ds_read_b128 v[68:71], v14 offset:12288
    s_waitcnt lgkmcnt(7)
    v_mfma_f32_16x16x32_bf16 v[40:43], v[72:75], v[100:103], v[40:43]
    ds_read_b128 v[72:75], v14 offset:13312
    s_waitcnt lgkmcnt(7)
    v_mfma_f32_16x16x32_bf16 v[44:47], v[76:79], v[100:103], v[44:47]
    ds_read_b128 v[76:79], v14 offset:14336
    s_waitcnt lgkmcnt(7)
    v_mfma_f32_16x16x32_bf16 v[48:51], v[80:83], v[100:103], v[48:51]
    ds_read_b128 v[80:83], v14 offset:15360
    v_mfma_f32_16x16x32_bf16 v[20:23], v[128:131], v[92:95], v[20:23]
    v_mfma_f32_16x16x32_bf16 v[24:27], v[132:135], v[92:95], v[24:27]
    v_mfma_f32_16x16x32_bf16 v[28:31], v[136:139], v[92:95], v[28:31]
    v_mfma_f32_16x16x32_bf16 v[32:35], v[140:143], v[92:95], v[32:35]
    v_mfma_f32_16x16x32_bf16 v[36:39], v[144:147], v[92:95], v[36:39]
    v_mfma_f32_16x16x32_bf16 v[40:43], v[148:151], v[92:95], v[40:43]
    v_mfma_f32_16x16x32_bf16 v[44:47], v[152:155], v[92:95], v[44:47]
    v_mfma_f32_16x16x32_bf16 v[48:51], v[156:159], v[92:95], v[48:51]
    s_waitcnt lgkmcnt(7)
    v_mfma_f32_16x16x32_bf16 v[20:23], v[52:55], v[104:107], v[20:23]
    ds_read_b128 v[52:55], v14 offset:16384
    s_waitcnt lgkmcnt(7)
    v_mfma_f32_16x16x32_bf16 v[24:27], v[56:59], v[104:107], v[24:27]
    ds_read_b128 v[56:59], v14 offset:17408
    s_waitcnt lgkmcnt(7)
    v_mfma_f32_16x16x32_bf16 v[28:31], v[60:63], v[104:107], v[28:31]
    ds_read_b128 v[60:63], v14 offset:18432
    s_waitcnt lgkmcnt(7)
    v_mfma_f32_16x16x32_bf16 v[32:35], v[64:67], v[104:107], v[32:35]
    ds_read_b128 v[64:67], v14 offset:19456
    s_waitcnt lgkmcnt(7)
    v_mfma_f32_16x16x32_bf16 v[36:39], v[68:71], v[104:107], v[36:39]
    ds_read_b128 v[68:71], v14 offset:20480
    s_waitcnt lgkmcnt(7)
    v_mfma_f32_16x16x32_bf16 v[40:43], v[72:75], v[104:107], v[40:43]
    ds_read_b128 v[72:75], v14 offset:21504
    s_waitcnt lgkmcnt(7)
    v_mfma_f32_16x16x32_bf16 v[44:47], v[76:79], v[104:107], v[44:47]
    ds_read_b128 v[76:79], v14 offset:22528
    s_waitcnt lgkmcnt(7)
    v_mfma_f32_16x16x32_bf16 v[48:51], v[80:83], v[104:107], v[48:51]
    ds_read_b128 v[80:83], v14 offset:23552
    v_mfma_f32_16x16x32_bf16 v[20:23], v[160:163], v[96:99], v[20:23]
    v_mfma_f32_16x16x32_bf16 v[24:27], v[164:167], v[96:99], v[24:27]
    v_mfma_f32_16x16x32_bf16 v[28:31], v[168:171], v[96:99], v[28:31]
    v_mfma_f32_16x16x32_bf16 v[32:35], v[172:175], v[96:99], v[32:35]
    v_mfma_f32_16x16x32_bf16 v[36:39], v[176:179], v[96:99], v[36:39]
    v_mfma_f32_16x16x32_bf16 v[40:43], v[180:183], v[96:99], v[40:43]
    v_mfma_f32_16x16x32_bf16 v[44:47], v[184:187], v[96:99], v[44:47]
    v_mfma_f32_16x16x32_bf16 v[48:51], v[188:191], v[96:99], v[48:51]
    s_waitcnt lgkmcnt(7)
    v_mfma_f32_16x16x32_bf16 v[20:23], v[52:55], v[108:111], v[20:23]
    ds_read_b128 v[52:55], v14 offset:24576
    s_waitcnt lgkmcnt(7)
    v_mfma_f32_16x16x32_bf16 v[24:27], v[56:59], v[108:111], v[24:27]
    ds_read_b128 v[56:59], v14 offset:25600
    s_waitcnt lgkmcnt(7)
    v_mfma_f32_16x16x32_bf16 v[28:31], v[60:63], v[108:111], v[28:31]
    ds_read_b128 v[60:63], v14 offset:26624
    s_waitcnt lgkmcnt(7)
    v_mfma_f32_16x16x32_bf16 v[32:35], v[64:67], v[108:111], v[32:35]
    ds_read_b128 v[64:67], v14 offset:27648
    s_waitcnt lgkmcnt(7)
    v_mfma_f32_16x16x32_bf16 v[36:39], v[68:71], v[108:111], v[36:39]
    ds_read_b128 v[68:71], v14 offset:28672
    s_waitcnt lgkmcnt(7)
    v_mfma_f32_16x16x32_bf16 v[40:43], v[72:75], v[108:111], v[40:43]
    ds_read_b128 v[72:75], v14 offset:29696
    s_waitcnt lgkmcnt(7)
    v_mfma_f32_16x16x32_bf16 v[44:47], v[76:79], v[108:111], v[44:47]
    ds_read_b128 v[76:79], v14 offset:30720
    s_waitcnt lgkmcnt(7)
    v_mfma_f32_16x16x32_bf16 v[48:51], v[80:83], v[108:111], v[48:51]
    ds_read_b128 v[80:83], v14 offset:31744
    s_waitcnt lgkmcnt(7)
    v_mfma_f32_16x16x32_bf16 v[20:23], v[52:55], v[112:115], v[20:23]
    s_waitcnt lgkmcnt(6)
    v_mfma_f32_16x16x32_bf16 v[24:27], v[56:59], v[112:115], v[24:27]
    s_waitcnt lgkmcnt(5)
    v_mfma_f32_16x16x32_bf16 v[28:31], v[60:63], v[112:115], v[28:31]
    s_waitcnt lgkmcnt(4)
    v_mfma_f32_16x16x32_bf16 v[32:35], v[64:67], v[112:115], v[32:35]
    s_waitcnt lgkmcnt(3)
    v_mfma_f32_16x16x32_bf16 v[36:39], v[68:71], v[112:115], v[36:39]
    s_waitcnt lgkmcnt(2)
    v_mfma_f32_16x16x32_bf16 v[40:43], v[72:75], v[112:115], v[40:43]
    s_waitcnt lgkmcnt(1)
    v_mfma_f32_16x16x32_bf16 v[44:47], v[76:79], v[112:115], v[44:47]
    s_waitcnt lgkmcnt(0)
    v_mfma_f32_16x16x32_bf16 v[48:51], v[80:83], v[112:115], v[48:51]
    s_mov_b32 s28, 0xbdd2d3e8
    s_mov_b32 s29, 0xc0135761
    s_add_u32 s25, s27, 98566144
    v_cvt_pk_bf16_f32 v16, v20, v21
    v_lshlrev_b32 v20, 16, v16
    v_and_b32 v21, 0xffff0000, v16
    v_cvt_pk_bf16_f32 v16, v22, v23
    v_lshlrev_b32 v22, 16, v16
    v_and_b32 v23, 0xffff0000, v16
    v_cvt_pk_bf16_f32 v16, v24, v25
    v_lshlrev_b32 v24, 16, v16
    v_and_b32 v25, 0xffff0000, v16
    v_cvt_pk_bf16_f32 v16, v26, v27
    v_lshlrev_b32 v26, 16, v16
    v_and_b32 v27, 0xffff0000, v16
    v_cvt_pk_bf16_f32 v16, v28, v29
    v_lshlrev_b32 v28, 16, v16
    v_and_b32 v29, 0xffff0000, v16
    v_cvt_pk_bf16_f32 v16, v30, v31
    v_lshlrev_b32 v30, 16, v16
    v_and_b32 v31, 0xffff0000, v16
    v_cvt_pk_bf16_f32 v16, v32, v33
    v_lshlrev_b32 v32, 16, v16
    v_and_b32 v33, 0xffff0000, v16
    v_cvt_pk_bf16_f32 v16, v34, v35
    v_lshlrev_b32 v34, 16, v16
    v_and_b32 v35, 0xffff0000, v16
    v_cvt_pk_bf16_f32 v16, v36, v37
    v_lshlrev_b32 v36, 16, v16
    v_and_b32 v37, 0xffff0000, v16
    v_cvt_pk_bf16_f32 v16, v38, v39
    v_lshlrev_b32 v38, 16, v16
    v_and_b32 v39, 0xffff0000, v16
    v_cvt_pk_bf16_f32 v16, v40, v41
    v_lshlrev_b32 v40, 16, v16
    v_and_b32 v41, 0xffff0000, v16
    v_cvt_pk_bf16_f32 v16, v42, v43
    v_lshlrev_b32 v42, 16, v16
    v_and_b32 v43, 0xffff0000, v16
    v_cvt_pk_bf16_f32 v16, v44, v45
    v_lshlrev_b32 v44, 16, v16
    v_and_b32 v45, 0xffff0000, v16
    v_cvt_pk_bf16_f32 v16, v46, v47
    v_lshlrev_b32 v46, 16, v16
    v_and_b32 v47, 0xffff0000, v16
    v_cvt_pk_bf16_f32 v16, v48, v49
    v_lshlrev_b32 v48, 16, v16
    v_and_b32 v49, 0xffff0000, v16
    v_cvt_pk_bf16_f32 v16, v50, v51
    v_lshlrev_b32 v50, 16, v16
    v_and_b32 v51, 0xffff0000, v16
    v_pk_mul_f32 v[16:17], v[20:21], v[20:21]
    v_pk_fma_f32 v[16:17], v[16:17], s[28:29], s[28:29] op_sel:[0,0,1] op_sel_hi:[1,0,1]
    s_nop 0
    v_pk_mul_f32 v[16:17], v[16:17], v[20:21]
    v_exp_f32 v16, v16
    v_exp_f32 v17, v17
    s_nop 0
    v_pk_add_f32 v[16:17], v[16:17], 1.0 op_sel_hi:[1,0]
    s_nop 0
    v_rcp_f32 v16, v16
    v_rcp_f32 v17, v17
    s_nop 0
    v_pk_mul_f32 v[20:21], v[20:21], v[16:17]
    v_pk_mul_f32 v[18:19], v[22:23], v[22:23]
    v_pk_fma_f32 v[18:19], v[18:19], s[28:29], s[28:29] op_sel:[0,0,1] op_sel_hi:[1,0,1]
    s_nop 0
    v_pk_mul_f32 v[18:19], v[18:19], v[22:23]
    v_exp_f32 v18, v18
    v_exp_f32 v19, v19
    s_nop 0
    v_pk_add_f32 v[18:19], v[18:19], 1.0 op_sel_hi:[1,0]
    s_nop 0
    v_rcp_f32 v18, v18
    v_rcp_f32 v19, v19
    s_nop 0
    v_pk_mul_f32 v[22:23], v[22:23], v[18:19]
    v_pk_mul_f32 v[16:17], v[24:25], v[24:25]
    v_pk_fma_f32 v[16:17], v[16:17], s[28:29], s[28:29] op_sel:[0,0,1] op_sel_hi:[1,0,1]
    s_nop 0
    v_pk_mul_f32 v[16:17], v[16:17], v[24:25]
    v_exp_f32 v16, v16
    v_exp_f32 v17, v17
    s_nop 0
    v_pk_add_f32 v[16:17], v[16:17], 1.0 op_sel_hi:[1,0]
    s_nop 0
    v_rcp_f32 v16, v16
    v_rcp_f32 v17, v17
    s_nop 0
    v_pk_mul_f32 v[24:25], v[24:25], v[16:17]
    v_pk_mul_f32 v[18:19], v[26:27], v[26:27]
    v_pk_fma_f32 v[18:19], v[18:19], s[28:29], s[28:29] op_sel:[0,0,1] op_sel_hi:[1,0,1]
    s_nop 0
    v_pk_mul_f32 v[18:19], v[18:19], v[26:27]
    v_exp_f32 v18, v18
    v_exp_f32 v19, v19
    s_nop 0
    v_pk_add_f32 v[18:19], v[18:19], 1.0 op_sel_hi:[1,0]
    s_nop 0
    v_rcp_f32 v18, v18
    v_rcp_f32 v19, v19
    s_nop 0
    v_pk_mul_f32 v[26:27], v[26:27], v[18:19]
    v_pk_mul_f32 v[16:17], v[28:29], v[28:29]
    v_pk_fma_f32 v[16:17], v[16:17], s[28:29], s[28:29] op_sel:[0,0,1] op_sel_hi:[1,0,1]
    s_nop 0
    v_pk_mul_f32 v[16:17], v[16:17], v[28:29]
    v_exp_f32 v16, v16
    v_exp_f32 v17, v17
    s_nop 0
    v_pk_add_f32 v[16:17], v[16:17], 1.0 op_sel_hi:[1,0]
    s_nop 0
    v_rcp_f32 v16, v16
    v_rcp_f32 v17, v17
    s_nop 0
    v_pk_mul_f32 v[28:29], v[28:29], v[16:17]
    v_pk_mul_f32 v[18:19], v[30:31], v[30:31]
    v_pk_fma_f32 v[18:19], v[18:19], s[28:29], s[28:29] op_sel:[0,0,1] op_sel_hi:[1,0,1]
    s_nop 0
    v_pk_mul_f32 v[18:19], v[18:19], v[30:31]
    v_exp_f32 v18, v18
    v_exp_f32 v19, v19
    s_nop 0
    v_pk_add_f32 v[18:19], v[18:19], 1.0 op_sel_hi:[1,0]
    s_nop 0
    v_rcp_f32 v18, v18
    v_rcp_f32 v19, v19
    s_nop 0
    v_pk_mul_f32 v[30:31], v[30:31], v[18:19]
    v_pk_mul_f32 v[16:17], v[32:33], v[32:33]
    v_pk_fma_f32 v[16:17], v[16:17], s[28:29], s[28:29] op_sel:[0,0,1] op_sel_hi:[1,0,1]
    s_nop 0
    v_pk_mul_f32 v[16:17], v[16:17], v[32:33]
    v_exp_f32 v16, v16
    v_exp_f32 v17, v17
    s_nop 0
    v_pk_add_f32 v[16:17], v[16:17], 1.0 op_sel_hi:[1,0]
    s_nop 0
    v_rcp_f32 v16, v16
    v_rcp_f32 v17, v17
    s_nop 0
    v_pk_mul_f32 v[32:33], v[32:33], v[16:17]
    v_pk_mul_f32 v[18:19], v[34:35], v[34:35]
    v_pk_fma_f32 v[18:19], v[18:19], s[28:29], s[28:29] op_sel:[0,0,1] op_sel_hi:[1,0,1]
    s_nop 0
    v_pk_mul_f32 v[18:19], v[18:19], v[34:35]
    v_exp_f32 v18, v18
    v_exp_f32 v19, v19
    s_nop 0
    v_pk_add_f32 v[18:19], v[18:19], 1.0 op_sel_hi:[1,0]
    s_nop 0
    v_rcp_f32 v18, v18
    v_rcp_f32 v19, v19
    s_nop 0
    v_pk_mul_f32 v[34:35], v[34:35], v[18:19]
    v_pk_mul_f32 v[16:17], v[36:37], v[36:37]
    v_pk_fma_f32 v[16:17], v[16:17], s[28:29], s[28:29] op_sel:[0,0,1] op_sel_hi:[1,0,1]
    s_nop 0
    v_pk_mul_f32 v[16:17], v[16:17], v[36:37]
    v_exp_f32 v16, v16
    v_exp_f32 v17, v17
    s_nop 0
    v_pk_add_f32 v[16:17], v[16:17], 1.0 op_sel_hi:[1,0]
    s_nop 0
    v_rcp_f32 v16, v16
    v_rcp_f32 v17, v17
    s_nop 0
    v_pk_mul_f32 v[36:37], v[36:37], v[16:17]
    v_pk_mul_f32 v[18:19], v[38:39], v[38:39]
    v_pk_fma_f32 v[18:19], v[18:19], s[28:29], s[28:29] op_sel:[0,0,1] op_sel_hi:[1,0,1]
    s_nop 0
    v_pk_mul_f32 v[18:19], v[18:19], v[38:39]
    v_exp_f32 v18, v18
    v_exp_f32 v19, v19
    s_nop 0
    v_pk_add_f32 v[18:19], v[18:19], 1.0 op_sel_hi:[1,0]
    s_nop 0
    v_rcp_f32 v18, v18
    v_rcp_f32 v19, v19
    s_nop 0
    v_pk_mul_f32 v[38:39], v[38:39], v[18:19]
    v_pk_mul_f32 v[16:17], v[40:41], v[40:41]
    v_pk_fma_f32 v[16:17], v[16:17], s[28:29], s[28:29] op_sel:[0,0,1] op_sel_hi:[1,0,1]
    s_nop 0
    v_pk_mul_f32 v[16:17], v[16:17], v[40:41]
    v_exp_f32 v16, v16
    v_exp_f32 v17, v17
    s_nop 0
    v_pk_add_f32 v[16:17], v[16:17], 1.0 op_sel_hi:[1,0]
    s_nop 0
    v_rcp_f32 v16, v16
    v_rcp_f32 v17, v17
    s_nop 0
    v_pk_mul_f32 v[40:41], v[40:41], v[16:17]
    v_pk_mul_f32 v[18:19], v[42:43], v[42:43]
    v_pk_fma_f32 v[18:19], v[18:19], s[28:29], s[28:29] op_sel:[0,0,1] op_sel_hi:[1,0,1]
    s_nop 0
    v_pk_mul_f32 v[18:19], v[18:19], v[42:43]
    v_exp_f32 v18, v18
    v_exp_f32 v19, v19
    s_nop 0
    v_pk_add_f32 v[18:19], v[18:19], 1.0 op_sel_hi:[1,0]
    s_nop 0
    v_rcp_f32 v18, v18
    v_rcp_f32 v19, v19
    s_nop 0
    v_pk_mul_f32 v[42:43], v[42:43], v[18:19]
    v_pk_mul_f32 v[16:17], v[44:45], v[44:45]
    v_pk_fma_f32 v[16:17], v[16:17], s[28:29], s[28:29] op_sel:[0,0,1] op_sel_hi:[1,0,1]
    s_nop 0
    v_pk_mul_f32 v[16:17], v[16:17], v[44:45]
    v_exp_f32 v16, v16
    v_exp_f32 v17, v17
    s_nop 0
    v_pk_add_f32 v[16:17], v[16:17], 1.0 op_sel_hi:[1,0]
    s_nop 0
    v_rcp_f32 v16, v16
    v_rcp_f32 v17, v17
    s_nop 0
    v_pk_mul_f32 v[44:45], v[44:45], v[16:17]
    v_pk_mul_f32 v[18:19], v[46:47], v[46:47]
    v_pk_fma_f32 v[18:19], v[18:19], s[28:29], s[28:29] op_sel:[0,0,1] op_sel_hi:[1,0,1]
    s_nop 0
    v_pk_mul_f32 v[18:19], v[18:19], v[46:47]
    v_exp_f32 v18, v18
    v_exp_f32 v19, v19
    s_nop 0
    v_pk_add_f32 v[18:19], v[18:19], 1.0 op_sel_hi:[1,0]
    s_nop 0
    v_rcp_f32 v18, v18
    v_rcp_f32 v19, v19
    s_nop 0
    v_pk_mul_f32 v[46:47], v[46:47], v[18:19]
    v_pk_mul_f32 v[16:17], v[48:49], v[48:49]
    v_pk_fma_f32 v[16:17], v[16:17], s[28:29], s[28:29] op_sel:[0,0,1] op_sel_hi:[1,0,1]
    s_nop 0
    v_pk_mul_f32 v[16:17], v[16:17], v[48:49]
    v_exp_f32 v16, v16
    v_exp_f32 v17, v17
    s_nop 0
    v_pk_add_f32 v[16:17], v[16:17], 1.0 op_sel_hi:[1,0]
    s_nop 0
    v_rcp_f32 v16, v16
    v_rcp_f32 v17, v17
    s_nop 0
    v_pk_mul_f32 v[48:49], v[48:49], v[16:17]
    v_pk_mul_f32 v[18:19], v[50:51], v[50:51]
    v_pk_fma_f32 v[18:19], v[18:19], s[28:29], s[28:29] op_sel:[0,0,1] op_sel_hi:[1,0,1]
    s_nop 0
    v_pk_mul_f32 v[18:19], v[18:19], v[50:51]
    v_exp_f32 v18, v18
    v_exp_f32 v19, v19
    s_nop 0
    v_pk_add_f32 v[18:19], v[18:19], 1.0 op_sel_hi:[1,0]
    s_nop 0
    v_rcp_f32 v18, v18
    v_rcp_f32 v19, v19
    s_nop 0
    v_pk_mul_f32 v[50:51], v[50:51], v[18:19]
    v_cvt_pk_bf16_f32 v52, v20, v24
    v_cvt_pk_bf16_f32 v53, v28, v32
    v_cvt_pk_bf16_f32 v54, v36, v40
    v_cvt_pk_bf16_f32 v55, v44, v48
    buffer_store_dwordx4 v[52:55], v6, s[8:11], s25 offen offset:0 sc1
    v_cvt_pk_bf16_f32 v56, v21, v25
    v_cvt_pk_bf16_f32 v57, v29, v33
    v_cvt_pk_bf16_f32 v58, v37, v41
    v_cvt_pk_bf16_f32 v59, v45, v49
    buffer_store_dwordx4 v[56:59], v6, s[8:11], s25 offen offset:256 sc1
    v_cvt_pk_bf16_f32 v60, v22, v26
    v_cvt_pk_bf16_f32 v61, v30, v34
    v_cvt_pk_bf16_f32 v62, v38, v42
    v_cvt_pk_bf16_f32 v63, v46, v50
    buffer_store_dwordx4 v[60:63], v6, s[8:11], s25 offen offset:512 sc1
    v_cvt_pk_bf16_f32 v64, v23, v27
    v_cvt_pk_bf16_f32 v65, v31, v35
    v_cvt_pk_bf16_f32 v66, v39, v43
    v_cvt_pk_bf16_f32 v67, v47, v51
    buffer_store_dwordx4 v[64:67], v6, s[8:11], s25 offen offset:768 sc1
    s_lshl_b32 s24, s5, 7
    s_add_u32 s24, s24, 160038912
    s_waitcnt vmcnt(0) lgkmcnt(0)
    s_barrier
    s_cmp_lg_u32 s19, 0
    s_cbranch_scc1 Lsig_160
    v_mov_b64 v[10:11], s[62:63]
    v_mov_b64 v[12:13], s[62:63]
    s_mov_b64 exec, 0xff
    buffer_store_dwordx4 v[10:13], v4, s[8:11], s24 offen sc1
    s_mov_b64 exec, -1
    s_nop 0
Lsig_160:
    s_add_u32 s5, s5, 12
    s_cmp_lt_u32 s5, 128
    s_cbranch_scc1 Lst_154
    s_branch Lnext_92
Lh_102:
    s_cmp_lg_u32 s64, 0
    s_cbranch_scc1 Lpk_161
    s_mov_b32 s24, 159776768
    v_min_u32 v8, 63, v1
    v_mul_u32_u24 v8, 128, v8
    s_nop 1
Lw_162:
    buffer_load_dwordx2 v[10:11], v8, s[8:11], s24 offen sc1
    s_waitcnt vmcnt(0)
    v_cmp_ne_u64 vcc, s[62:63], v[10:11]
    s_nop 4
    s_cbranch_vccz Lwd_163
    s_sleep 2
    s_sub_u32 s21, s21, 1
    s_cbranch_scc0 Lw_162
    s_mov_b32 s21, 0
Lwd_163:
    s_mov_b32 s24, 159784960
    v_min_u32 v8, 3, v1
    v_mul_u32_u24 v8, 128, v8
    s_nop 1
Lw_164:
    buffer_load_dwordx2 v[10:11], v8, s[8:11], s24 offen sc1
    s_waitcnt vmcnt(0)
    v_cmp_ne_u64 vcc, s[62:63], v[10:11]
    s_nop 4
    s_cbranch_vccz Lwd_165
    s_sleep 2
    s_sub_u32 s21, s21, 1
    s_cbranch_scc0 Lw_164
    s_mov_b32 s21, 0
Lwd_165:
    s_mov_b32 s64, 1
Lpk_161:
    v_lshlrev_b32 v9, 4, v2
    v_add_u32 v9, 0, v9
    s_lshl_b32 s30, s19, 2
    v_add_u32 v8, s30, v9
    s_lshl_b32 s26, s19, 17
    s_add_u32 s26, s26, 117964800
    s_mov_b32 s33, s26
    buffer_load_dwordx4 v[128:131], v4, s[8:11], s26 offen offset:0 sc1
    buffer_load_dwordx4 v[132:135], v4, s[8:11], s26 offen offset:1024 sc1
    buffer_load_dwordx4 v[136:139], v4, s[8:11], s26 offen offset:2048 sc1
    buffer_load_dwordx4 v[140:143], v4, s[8:11], s26 offen offset:3072 sc1
    buffer_load_dwordx4 v[144:147], v5, s[8:11], s26 offen offset:0 sc1
    buffer_load_dwordx4 v[148:151], v5, s[8:11], s26 offen offset:1024 sc1
    buffer_load_dwordx4 v[152:155], v5, s[8:11], s26 offen offset:2048 sc1
    buffer_load_dwordx4 v[156:159], v5, s[8:11], s26 offen offset:3072 sc1
    s_add_u32 s26, s26, 8192
    buffer_load_dwordx4 v[160:163], v4, s[8:11], s26 offen offset:0 sc1
    buffer_load_dwordx4 v[164:167], v4, s[8:11], s26 offen offset:1024 sc1
    buffer_load_dwordx4 v[168:171], v4, s[8:11], s26 offen offset:2048 sc1
    buffer_load_dwordx4 v[172:175], v4, s[8:11], s26 offen offset:3072 sc1
    buffer_load_dwordx4 v[176:179], v5, s[8:11], s26 offen offset:0 sc1
    buffer_load_dwordx4 v[180:183], v5, s[8:11], s26 offen offset:1024 sc1
    buffer_load_dwordx4 v[184:187], v5, s[8:11], s26 offen offset:2048 sc1
    buffer_load_dwordx4 v[188:191], v5, s[8:11], s26 offen offset:3072 sc1
    s_add_u32 s26, s26, 8192
    buffer_load_dwordx4 v[192:195], v4, s[8:11], s26 offen offset:0 sc1
    buffer_load_dwordx4 v[196:199], v4, s[8:11], s26 offen offset:1024 sc1
    buffer_load_dwordx4 v[200:203], v4, s[8:11], s26 offen offset:2048 sc1
    buffer_load_dwordx4 v[204:207], v4, s[8:11], s26 offen offset:3072 sc1
    buffer_load_dwordx4 v[208:211], v5, s[8:11], s26 offen offset:0 sc1
    buffer_load_dwordx4 v[212:215], v5, s[8:11], s26 offen offset:1024 sc1
    buffer_load_dwordx4 v[216:219], v5, s[8:11], s26 offen offset:2048 sc1
    buffer_load_dwordx4 v[220:223], v5, s[8:11], s26 offen offset:3072 sc1
    s_add_u32 s26, s26, 8192
    buffer_load_dwordx4 v[224:227], v4, s[8:11], s26 offen offset:0 sc1
    buffer_load_dwordx4 v[228:231], v4, s[8:11], s26 offen offset:1024 sc1
    buffer_load_dwordx4 v[232:235], v4, s[8:11], s26 offen offset:2048 sc1
    buffer_load_dwordx4 v[236:239], v4, s[8:11], s26 offen offset:3072 sc1
    buffer_load_dwordx4 v[240:243], v5, s[8:11], s26 offen offset:0 sc1
    buffer_load_dwordx4 v[244:247], v5, s[8:11], s26 offen offset:1024 sc1
    buffer_load_dwordx4 v[248:251], v5, s[8:11], s26 offen offset:2048 sc1
    buffer_load_dwordx4 v[252:255], v5, s[8:11], s26 offen offset:3072 sc1
    s_add_u32 s26, s26, 8192
    buffer_load_dwordx4 a[0:3], v4, s[8:11], s26 offen offset:0 sc1
    buffer_load_dwordx4 a[4:7], v4, s[8:11], s26 offen offset:1024 sc1
    buffer_load_dwordx4 a[8:11], v4, s[8:11], s26 offen offset:2048 sc1
    buffer_load_dwordx4 a[12:15], v4, s[8:11], s26 offen offset:3072 sc1
    buffer_load_dwordx4 a[16:19], v5, s[8:11], s26 offen offset:0 sc1
    buffer_load_dwordx4 a[20:23], v5, s[8:11], s26 offen offset:1024 sc1
    buffer_load_dwordx4 a[24:27], v5, s[8:11], s26 offen offset:2048 sc1
    buffer_load_dwordx4 a[28:31], v5, s[8:11], s26 offen offset:3072 sc1
    s_add_u32 s26, s26, 8192
    buffer_load_dwordx4 a[32:35], v4, s[8:11], s26 offen offset:0 sc1
    buffer_load_dwordx4 a[36:39], v4, s[8:11], s26 offen offset:1024 sc1
    buffer_load_dwordx4 a[40:43], v4, s[8:11], s26 offen offset:2048 sc1
    buffer_load_dwordx4 a[44:47], v4, s[8:11], s26 offen offset:3072 sc1
    buffer_load_dwordx4 a[48:51], v5, s[8:11], s26 offen offset:0 sc1
    buffer_load_dwordx4 a[52:55], v5, s[8:11], s26 offen offset:1024 sc1
    buffer_load_dwordx4 a[56:59], v5, s[8:11], s26 offen offset:2048 sc1
    buffer_load_dwordx4 a[60:63], v5, s[8:11], s26 offen offset:3072 sc1
    s_waitcnt vmcnt(12)
    s_add_u32 s26, s26, 8192
    buffer_load_dwordx4 a[64:67], v4, s[8:11], s26 offen offset:0 sc1
    buffer_load_dwordx4 a[68:71], v4, s[8:11], s26 offen offset:1024 sc1
    buffer_load_dwordx4 a[72:75], v4, s[8:11], s26 offen offset:2048 sc1
    buffer_load_dwordx4 a[76:79], v4, s[8:11], s26 offen offset:3072 sc1
    buffer_load_dwordx4 a[80:83], v5, s[8:11], s26 offen offset:0 sc1
    buffer_load_dwordx4 a[84:87], v5, s[8:11], s26 offen offset:1024 sc1
    buffer_load_dwordx4 a[88:91], v5, s[8:11], s26 offen offset:2048 sc1
    buffer_load_dwordx4 a[92:95], v5, s[8:11], s26 offen offset:3072 sc1
    s_add_u32 s26, s26, 8192
    buffer_load_dwordx4 a[96:99], v4, s[8:11], s26 offen offset:0 sc1
    buffer_load_dwordx4 a[100:103], v4, s[8:11], s26 offen offset:1024 sc1
    buffer_load_dwordx4 a[104:107], v4, s[8:11], s26 offen offset:2048 sc1
    buffer_load_dwordx4 a[108:111], v4, s[8:11], s26 offen offset:3072 sc1
    buffer_load_dwordx4 a[112:115], v5, s[8:11], s26 offen offset:0 sc1
    buffer_load_dwordx4 a[116:119], v5, s[8:11], s26 offen offset:1024 sc1
    buffer_load_dwordx4 a[120:123], v5, s[8:11], s26 offen offset:2048 sc1
    buffer_load_dwordx4 a[124:127], v5, s[8:11], s26 offen offset:3072 sc1
    s_add_u32 s26, s26, 8192
    buffer_load_dwordx4 a[128:131], v4, s[8:11], s26 offen offset:0 sc1
    buffer_load_dwordx4 a[132:135], v4, s[8:11], s26 offen offset:1024 sc1
    buffer_load_dwordx4 a[136:139], v4, s[8:11], s26 offen offset:2048 sc1
    buffer_load_dwordx4 a[140:143], v4, s[8:11], s26 offen offset:3072 sc1
    buffer_load_dwordx4 a[144:147], v5, s[8:11], s26 offen offset:0 sc1
    buffer_load_dwordx4 a[148:151], v5, s[8:11], s26 offen offset:1024 sc1
    buffer_load_dwordx4 a[152:155], v5, s[8:11], s26 offen offset:2048 sc1
    buffer_load_dwordx4 a[156:159], v5, s[8:11], s26 offen offset:3072 sc1
    s_add_u32 s26, s26, 8192
    buffer_load_dwordx4 a[160:163], v4, s[8:11], s26 offen offset:0 sc1
    buffer_load_dwordx4 a[164:167], v4, s[8:11], s26 offen offset:1024 sc1
    buffer_load_dwordx4 a[168:171], v4, s[8:11], s26 offen offset:2048 sc1
    buffer_load_dwordx4 a[172:175], v4, s[8:11], s26 offen offset:3072 sc1
    buffer_load_dwordx4 a[176:179], v5, s[8:11], s26 offen offset:0 sc1
    buffer_load_dwordx4 a[180:183], v5, s[8:11], s26 offen offset:1024 sc1
    buffer_load_dwordx4 a[184:187], v5, s[8:11], s26 offen offset:2048 sc1
    buffer_load_dwordx4 a[188:191], v5, s[8:11], s26 offen offset:3072 sc1
    s_add_u32 s26, s26, 8192
    buffer_load_dwordx4 a[192:195], v4, s[8:11], s26 offen offset:0 sc1
    buffer_load_dwordx4 a[196:199], v4, s[8:11], s26 offen offset:1024 sc1
    buffer_load_dwordx4 a[200:203], v4, s[8:11], s26 offen offset:2048 sc1
    buffer_load_dwordx4 a[204:207], v4, s[8:11], s26 offen offset:3072 sc1
    buffer_load_dwordx4 a[208:211], v5, s[8:11], s26 offen offset:0 sc1
    buffer_load_dwordx4 a[212:215], v5, s[8:11], s26 offen offset:1024 sc1
    buffer_load_dwordx4 a[216:219], v5, s[8:11], s26 offen offset:2048 sc1
    buffer_load_dwordx4 a[220:223], v5, s[8:11], s26 offen offset:3072 sc1
    s_add_u32 s26, s26, 8192
    buffer_load_dwordx4 a[224:227], v4, s[8:11], s26 offen offset:0 sc1
    buffer_load_dwordx4 a[228:231], v4, s[8:11], s26 offen offset:1024 sc1
    buffer_load_dwordx4 a[232:235], v4, s[8:11], s26 offen offset:2048 sc1
    buffer_load_dwordx4 a[236:239], v4, s[8:11], s26 offen offset:3072 sc1
    buffer_load_dwordx4 a[240:243], v5, s[8:11], s26 offen offset:0 sc1
    buffer_load_dwordx4 a[244:247], v5, s[8:11], s26 offen offset:1024 sc1
    buffer_load_dwordx4 a[248:251], v5, s[8:11], s26 offen offset:2048 sc1
    buffer_load_dwordx4 a[252:255], v5, s[8:11], s26 offen offset:3072 sc1
    s_waitcnt vmcnt(12)
    s_add_u32 s26, s26, 8192
    s_mul_i32 s31, s19, 32768
    s_add_u32 s31, s31, 32768
    s_add_u32 m0, s31, 0
    s_nop 0
    buffer_load_dwordx4 v4, s[8:11], s26 offen offset:0 sc1 lds
    buffer_load_dwordx4 v4, s[8:11], s26 offen offset:1024 sc1 lds
    buffer_load_dwordx4 v4, s[8:11], s26 offen offset:2048 sc1 lds
    buffer_load_dwordx4 v4, s[8:11], s26 offen offset:3072 sc1 lds
    s_add_u32 s26, s26, 4096
    s_add_u32 m0, s31, 4096
    s_nop 0
    buffer_load_dwordx4 v4, s[8:11], s26 offen offset:0 sc1 lds
    buffer_load_dwordx4 v4, s[8:11], s26 offen offset:1024 sc1 lds
    buffer_load_dwordx4 v4, s[8:11], s26 offen offset:2048 sc1 lds
    buffer_load_dwordx4 v4, s[8:11], s26 offen offset:3072 sc1 lds
    s_add_u32 s26, s26, 4096
    s_add_u32 m0, s31, 8192
    s_nop 0
    buffer_load_dwordx4 v4, s[8:11], s26 offen offset:0 sc1 lds
    buffer_load_dwordx4 v4, s[8:11], s26 offen offset:1024 sc1 lds
    buffer_load_dwordx4 v4, s[8:11], s26 offen offset:2048 sc1 lds
    buffer_load_dwordx4 v4, s[8:11], s26 offen offset:3072 sc1 lds
    s_add_u32 s26, s26, 4096
    s_add_u32 m0, s31, 12288
    s_nop 0
    buffer_load_dwordx4 v4, s[8:11], s26 offen offset:0 sc1 lds
    buffer_load_dwordx4 v4, s[8:11], s26 offen offset:1024 sc1 lds
    buffer_load_dwordx4 v4, s[8:11], s26 offen offset:2048 sc1 lds
    buffer_load_dwordx4 v4, s[8:11], s26 offen offset:3072 sc1 lds
    s_add_u32 s26, s26, 4096
    s_add_u32 m0, s31, 16384
    s_nop 0
    buffer_load_dwordx4 v4, s[8:11], s26 offen offset:0 sc1 lds
    buffer_load_dwordx4 v4, s[8:11], s26 offen offset:1024 sc1 lds
    buffer_load_dwordx4 v4, s[8:11], s26 offen offset:2048 sc1 lds
    buffer_load_dwordx4 v4, s[8:11], s26 offen offset:3072 sc1 lds
    s_add_u32 s26, s26, 4096
    s_add_u32 m0, s31, 20480
    s_nop 0
    buffer_load_dwordx4 v4, s[8:11], s26 offen offset:0 sc1 lds
    buffer_load_dwordx4 v4, s[8:11], s26 offen offset:1024 sc1 lds
    buffer_load_dwordx4 v4, s[8:11], s26 offen offset:2048 sc1 lds
    buffer_load_dwordx4 v4, s[8:11], s26 offen offset:3072 sc1 lds
    s_add_u32 s26, s26, 4096
    s_add_u32 m0, s31, 24576
    s_nop 0
    buffer_load_dwordx4 v4, s[8:11], s26 offen offset:0 sc1 lds
    buffer_load_dwordx4 v4, s[8:11], s26 offen offset:1024 sc1 lds
    buffer_load_dwordx4 v4, s[8:11], s26 offen offset:2048 sc1 lds
    buffer_load_dwordx4 v4, s[8:11], s26 offen offset:3072 sc1 lds
    s_add_u32 s26, s26, 4096
    s_add_u32 m0, s31, 28672
    s_nop 0
    buffer_load_dwordx4 v4, s[8:11], s26 offen offset:0 sc1 lds
    buffer_load_dwordx4 v4, s[8:11], s26 offen offset:1024 sc1 lds
    buffer_load_dwordx4 v4, s[8:11], s26 offen offset:2048 sc1 lds
    buffer_load_dwordx4 v4, s[8:11], s26 offen offset:3072 sc1 lds
    s_add_u32 s26, s26, 4096
Lst_166:
    s_lshr_b32 s25, s5, 1
    s_lshl_b32 s25, s25, 11
    s_add_u32 s25, s25, 159907840
    v_mov_b32 v10, 0
    s_cmp_lg_u32 s19, 0
    s_nop 0
    s_cbranch_scc1 Lco_167
Lw_168:
    buffer_load_dwordx2 v[12:13], v10, s[8:11], s25 offen sc1
    s_waitcnt vmcnt(0)
    v_cmp_ne_u64 vcc, s[62:63], v[12:13]
    s_nop 4
    s_cbranch_vccz Lwd_169
    s_sleep 16
    s_sub_u32 s21, s21, 1
    s_cbranch_scc0 Lw_168
    s_mov_b32 s21, 0
Lwd_169:
Lco_167:
    s_barrier
    s_lshl_b32 s27, s5, 2
    s_add_u32 s27, s27, s19
    s_lshl_b32 s27, s27, 12
    s_add_u32 s25, s27, 94371840
    v_min_u32 v14, 2, v1
    s_sub_u32 s24, s5, 1
    v_add_u32 v14, s24, v14
    v_max_i32 v14, 0, v14
    v_min_i32 v14, 0x7f, v14
    v_lshlrev_b32 v14, 7, v14
    s_mov_b32 s24, 160038912
    s_nop 0
Lw_170:
    buffer_load_dwordx2 v[116:117], v14, s[8:11], s24 offen sc1
    s_waitcnt vmcnt(0)
    v_cmp_ne_u64 vcc, s[62:63], v[116:117]
    s_nop 4
    s_cbranch_vccz Lwd_171
    s_sleep 2
    s_sub_u32 s21, s21, 1
    s_cbranch_scc0 Lw_170
    s_mov_b32 s21, 0
Lwd_171:
    s_lshl_b32 s24, s5, 4
    v_add_u32 v18, s24, v2
    v_mov_b32 v19, 0x40000000
    s_mov_b32 s24, 98566144
    v_subrev_u32 v14, 1, v18
    v_cmp_gt_u32 vcc, 0x800, v14
    v_lshrrev_b32 v16, 4, v14
    v_and_b32 v14, 15, v14
    v_lshlrev_b32 v16, 14, v16
    v_lshl_add_u32 v14, v14, 4, v16
    v_lshl_add_u32 v14, v3, 8, v14
    v_cndmask_b32 v14, v19, v14, vcc
    buffer_load_dwordx4 v[52:55], v14, s[8:11], s24 offen offset:0 sc1
    buffer_load_dwordx4 v[56:59], v14, s[8:11], s24 offen offset:1024 sc1
    buffer_load_dwordx4 v[60:63], v14, s[8:11], s24 offen offset:2048 sc1
    buffer_load_dwordx4 v[64:67], v14, s[8:11], s24 offen offset:3072 sc1
    s_add_u32 s24, s24, 4096
    v_subrev_u32 v14, -1, v18
    v_cmp_gt_u32 vcc, 0x800, v14
    v_lshrrev_b32 v16, 4, v14
    v_and_b32 v14, 15, v14
    v_lshlrev_b32 v16, 14, v16
    v_lshl_add_u32 v14, v14, 4, v16
    v_lshl_add_u32 v14, v3, 8, v14
    v_cndmask_b32 v14, v19, v14, vcc
    buffer_load_dwordx4 v[68:71], v14, s[8:11], s24 offen offset:0 sc1
    buffer_load_dwordx4 v[72:75], v14, s[8:11], s24 offen offset:1024 sc1
    buffer_load_dwordx4 v[76:79], v14, s[8:11], s24 offen offset:2048 sc1
    buffer_load_dwordx4 v[80:83], v14, s[8:11], s24 offen offset:3072 sc1
    s_add_u32 s24, s24, 4096
    v_subrev_u32 v14, 2, v18
    v_cmp_gt_u32 vcc, 0x800, v14
    v_lshrrev_b32 v16, 4, v14
    v_and_b32 v14, 15, v14
    v_lshlrev_b32 v16, 14, v16
    v_lshl_add_u32 v14, v14, 4, v16
    v_lshl_add_u32 v14, v3, 8, v14
    v_cndmask_b32 v14, v19, v14, vcc
    buffer_load_dwordx4 v[84:87], v14, s[8:11], s24 offen offset:0 sc1
    buffer_load_dwordx4 v[88:91], v14, s[8:11], s24 offen offset:1024 sc1
    buffer_load_dwordx4 v[92:95], v14, s[8:11], s24 offen offset:2048 sc1
    buffer_load_dwordx4 v[96:99], v14, s[8:11], s24 offen offset:3072 sc1
    s_add_u32 s24, s24, 4096
    v_subrev_u32 v14, -2, v18
    v_cmp_gt_u32 vcc, 0x800, v14
    v_lshrrev_b32 v16, 4, v14
    v_and_b32 v14, 15, v14
    v_lshlrev_b32 v16, 14, v16
    v_lshl_add_u32 v14, v14, 4, v16
    v_lshl_add_u32 v14, v3, 8, v14
    v_cndmask_b32 v14, v19, v14, vcc
    buffer_load_dwordx4 v[100:103], v14, s[8:11], s24 offen offset:0 sc1
    buffer_load_dwordx4 v[104:107], v14, s[8:11], s24 offen offset:1024 sc1
    buffer_load_dwordx4 v[108:111], v14, s[8:11], s24 offen offset:2048 sc1
    buffer_load_dwordx4 v[112:115], v14, s[8:11], s24 offen offset:3072 sc1
    s_add_u32 s24, s24, 4096
    buffer_load_dwordx4 v[116:119], v6, s[8:11], s25 offen offset:0 sc1
    buffer_load_dwordx4 v[120:123], v6, s[8:11], s25 offen offset:256 sc1
    buffer_load_dwordx4 v[124:127], v6, s[8:11], s25 offen offset:512 sc1
    buffer_load_dwordx4 v[10:13], v6, s[8:11], s25 offen offset:768 sc1
    s_waitcnt vmcnt(0)
    v_add_u32 v7, s31, v4
    v_mfma_f32_16x16x32_bf16 v[20:23], v[128:131], v[52:55], 0
    v_mfma_f32_16x16x32_bf16 v[24:27], v[132:135], v[52:55], 0
    v_mfma_f32_16x16x32_bf16 v[28:31], v[136:139], v[52:55], 0
    v_mfma_f32_16x16x32_bf16 v[32:35], v[140:143], v[52:55], 0
    v_mfma_f32_16x16x32_bf16 v[36:39], v[144:147], v[52:55], 0
    v_mfma_f32_16x16x32_bf16 v[40:43], v[148:151], v[52:55], 0
    v_mfma_f32_16x16x32_bf16 v[44:47], v[152:155], v[52:55], 0
    v_mfma_f32_16x16x32_bf16 v[48:51], v[156:159], v[52:55], 0
    v_mfma_f32_16x16x32_bf16 v[20:23], v[160:163], v[56:59], v[20:23]
    v_mfma_f32_16x16x32_bf16 v[24:27], v[164:167], v[56:59], v[24:27]
    v_mfma_f32_16x16x32_bf16 v[28:31], v[168:171], v[56:59], v[28:31]
    v_mfma_f32_16x16x32_bf16 v[32:35], v[172:175], v[56:59], v[32:35]
    v_mfma_f32_16x16x32_bf16 v[36:39], v[176:179], v[56:59], v[36:39]
    v_mfma_f32_16x16x32_bf16 v[40:43], v[180:183], v[56:59], v[40:43]
    v_mfma_f32_16x16x32_bf16 v[44:47], v[184:187], v[56:59], v[44:47]
    v_mfma_f32_16x16x32_bf16 v[48:51], v[188:191], v[56:59], v[48:51]
    v_mfma_f32_16x16x32_bf16 v[20:23], v[192:195], v[60:63], v[20:23]
    v_mfma_f32_16x16x32_bf16 v[24:27], v[196:199], v[60:63], v[24:27]
    v_mfma_f32_16x16x32_bf16 v[28:31], v[200:203], v[60:63], v[28:31]
    v_mfma_f32_16x16x32_bf16 v[32:35], v[204:207], v[60:63], v[32:35]
    v_mfma_f32_16x16x32_bf16 v[36:39], v[208:211], v[60:63], v[36:39]
    v_mfma_f32_16x16x32_bf16 v[40:43], v[212:215], v[60:63], v[40:43]
    v_mfma_f32_16x16x32_bf16 v[44:47], v[216:219], v[60:63], v[44:47]
    v_mfma_f32_16x16x32_bf16 v[48:51], v[220:223], v[60:63], v[48:51]
    v_mfma_f32_16x16x32_bf16 v[20:23], v[224:227], v[64:67], v[20:23]
    v_mfma_f32_16x16x32_bf16 v[24:27], v[228:231], v[64:67], v[24:27]
    v_mfma_f32_16x16x32_bf16 v[28:31], v[232:235], v[64:67], v[28:31]
    v_mfma_f32_16x16x32_bf16 v[32:35], v[236:239], v[64:67], v[32:35]
    v_mfma_f32_16x16x32_bf16 v[36:39], v[240:243], v[64:67], v[36:39]
    v_mfma_f32_16x16x32_bf16 v[40:43], v[244:247], v[64:67], v[40:43]
    v_mfma_f32_16x16x32_bf16 v[44:47], v[248:251], v[64:67], v[44:47]
    v_mfma_f32_16x16x32_bf16 v[48:51], v[252:255], v[64:67], v[48:51]
    v_mfma_f32_16x16x32_bf16 v[20:23], a[0:3], v[68:71], v[20:23]
    v_mfma_f32_16x16x32_bf16 v[24:27], a[4:7], v[68:71], v[24:27]
    v_mfma_f32_16x16x32_bf16 v[28:31], a[8:11], v[68:71], v[28:31]
    v_mfma_f32_16x16x32_bf16 v[32:35], a[12:15], v[68:71], v[32:35]
    v_mfma_f32_16x16x32_bf16 v[36:39], a[16:19], v[68:71], v[36:39]
    v_mfma_f32_16x16x32_bf16 v[40:43], a[20:23], v[68:71], v[40:43]
    v_mfma_f32_16x16x32_bf16 v[44:47], a[24:27], v[68:71], v[44:47]
    v_mfma_f32_16x16x32_bf16 v[48:51], a[28:31], v[68:71], v[48:51]
    v_mfma_f32_16x16x32_bf16 v[20:23], a[32:35], v[72:75], v[20:23]
    v_mfma_f32_16x16x32_bf16 v[24:27], a[36:39], v[72:75], v[24:27]
    v_mfma_f32_16x16x32_bf16 v[28:31], a[40:43], v[72:75], v[28:31]
    v_mfma_f32_16x16x32_bf16 v[32:35], a[44:47], v[72:75], v[32:35]
    v_mfma_f32_16x16x32_bf16 v[36:39], a[48:51], v[72:75], v[36:39]
    v_mfma_f32_16x16x32_bf16 v[40:43], a[52:55], v[72:75], v[40:43]
    v_mfma_f32_16x16x32_bf16 v[44:47], a[56:59], v[72:75], v[44:47]
    v_mfma_f32_16x16x32_bf16 v[48:51], a[60:63], v[72:75], v[48:51]
    v_mfma_f32_16x16x32_bf16 v[20:23], a[64:67], v[76:79], v[20:23]
    v_mfma_f32_16x16x32_bf16 v[24:27], a[68:71], v[76:79], v[24:27]
    v_mfma_f32_16x16x32_bf16 v[28:31], a[72:75], v[76:79], v[28:31]
    v_mfma_f32_16x16x32_bf16 v[32:35], a[76:79], v[76:79], v[32:35]
    v_mfma_f32_16x16x32_bf16 v[36:39], a[80:83], v[76:79], v[36:39]
    v_mfma_f32_16x16x32_bf16 v[40:43], a[84:87], v[76:79], v[40:43]
    v_mfma_f32_16x16x32_bf16 v[44:47], a[88:91], v[76:79], v[44:47]
    v_mfma_f32_16x16x32_bf16 v[48:51], a[92:95], v[76:79], v[48:51]
    v_mfma_f32_16x16x32_bf16 v[20:23], a[96:99], v[80:83], v[20:23]
    v_mfma_f32_16x16x32_bf16 v[24:27], a[100:103], v[80:83], v[24:27]
    v_mfma_f32_16x16x32_bf16 v[28:31], a[104:107], v[80:83], v[28:31]
    v_mfma_f32_16x16x32_bf16 v[32:35], a[108:111], v[80:83], v[32:35]
    v_mfma_f32_16x16x32_bf16 v[36:39], a[112:115], v[80:83], v[36:39]
    v_mfma_f32_16x16x32_bf16 v[40:43], a[116:119], v[80:83], v[40:43]
    v_mfma_f32_16x16x32_bf16 v[44:47], a[120:123], v[80:83], v[44:47]
    v_mfma_f32_16x16x32_bf16 v[48:51], a[124:127], v[80:83], v[48:51]
    v_mfma_f32_16x16x32_bf16 v[20:23], a[128:131], v[84:87], v[20:23]
    ds_read_b128 v[52:55], v7 offset:0
    v_mfma_f32_16x16x32_bf16 v[24:27], a[132:135], v[84:87], v[24:27]
    ds_read_b128 v[56:59], v7 offset:1024
    v_mfma_f32_16x16x32_bf16 v[28:31], a[136:139], v[84:87], v[28:31]
    ds_read_b128 v[60:63], v7 offset:2048
    v_mfma_f32_16x16x32_bf16 v[32:35], a[140:143], v[84:87], v[32:35]
    ds_read_b128 v[64:67], v7 offset:3072
    v_mfma_f32_16x16x32_bf16 v[36:39], a[144:147], v[84:87], v[36:39]
    ds_read_b128 v[68:71], v7 offset:4096
    v_mfma_f32_16x16x32_bf16 v[40:43], a[148:151], v[84:87], v[40:43]
    ds_read_b128 v[72:75], v7 offset:5120
    v_mfma_f32_16x16x32_bf16 v[44:47], a[152:155], v[84:87], v[44:47]
    ds_read_b128 v[76:79], v7 offset:6144
    v_mfma_f32_16x16x32_bf16 v[48:51], a[156:159], v[84:87], v[48:51]
    ds_read_b128 v[80:83], v7 offset:7168
    v_mfma_f32_16x16x32_bf16 v[20:23], a[160:163], v[88:91], v[20:23]
    v_mfma_f32_16x16x32_bf16 v[24:27], a[164:167], v[88:91], v[24:27]
    v_mfma_f32_16x16x32_bf16 v[28:31], a[168:171], v[88:91], v[28:31]
    v_mfma_f32_16x16x32_bf16 v[32:35], a[172:175], v[88:91], v[32:35]
    v_mfma_f32_16x16x32_bf16 v[36:39], a[176:179], v[88:91], v[36:39]
    v_mfma_f32_16x16x32_bf16 v[40:43], a[180:183], v[88:91], v[40:43]
    v_mfma_f32_16x16x32_bf16 v[44:47], a[184:187], v[88:91], v[44:47]
    v_mfma_f32_16x16x32_bf16 v[48:51], a[188:191], v[88:91], v[48:51]
    s_waitcnt lgkmcnt(7)
    v_mfma_f32_16x16x32_bf16 v[20:23], v[52:55], v[100:103], v[20:23]
    ds_read_b128 v[52:55], v7 offset:8192
    s_waitcnt lgkmcnt(7)
    v_mfma_f32_16x16x32_bf16 v[24:27], v[56:59], v[100:103], v[24:27]
    ds_read_b128 v[56:59], v7 offset:9216
    s_waitcnt lgkmcnt(7)
    v_mfma_f32_16x16x32_bf16 v[28:31], v[60:63], v[100:103], v[28:31]
    ds_read_b128 v[60:63], v7 offset:10240
    s_waitcnt lgkmcnt(7)
    v_mfma_f32_16x16x32_bf16 v[32:35], v[64:67], v[100:103], v[32:35]
    ds_read_b128 v[64:67], v7 offset:11264
    s_waitcnt lgkmcnt(7)
    v_mfma_f32_16x16x32_bf16 v[36:39], v[68:71], v[100:103], v[36:39]
    ds_read_b128 v[68:71], v7 offset:12288
    s_waitcnt lgkmcnt(7)
    v_mfma_f32_16x16x32_bf16 v[40:43], v[72:75], v[100:103], v[40:43]
    ds_read_b128 v[72:75], v7 offset:13312
    s_waitcnt lgkmcnt(7)
    v_mfma_f32_16x16x32_bf16 v[44:47], v[76:79], v[100:103], v[44:47]
    ds_read_b128 v[76:79], v7 offset:14336
    s_waitcnt lgkmcnt(7)
    v_mfma_f32_16x16x32_bf16 v[48:51], v[80:83], v[100:103], v[48:51]
    ds_read_b128 v[80:83], v7 offset:15360
    v_mfma_f32_16x16x32_bf16 v[20:23], a[192:195], v[92:95], v[20:23]
    v_mfma_f32_16x16x32_bf16 v[24:27], a[196:199], v[92:95], v[24:27]
    v_mfma_f32_16x16x32_bf16 v[28:31], a[200:203], v[92:95], v[28:31]
    v_mfma_f32_16x16x32_bf16 v[32:35], a[204:207], v[92:95], v[32:35]
    v_mfma_f32_16x16x32_bf16 v[36:39], a[208:211], v[92:95], v[36:39]
    v_mfma_f32_16x16x32_bf16 v[40:43], a[212:215], v[92:95], v[40:43]
    v_mfma_f32_16x16x32_bf16 v[44:47], a[216:219], v[92:95], v[44:47]
    v_mfma_f32_16x16x32_bf16 v[48:51], a[220:223], v[92:95], v[48:51]
    s_waitcnt lgkmcnt(7)
    v_mfma_f32_16x16x32_bf16 v[20:23], v[52:55], v[104:107], v[20:23]
    ds_read_b128 v[52:55], v7 offset:16384
    s_waitcnt lgkmcnt(7)
    v_mfma_f32_16x16x32_bf16 v[24:27], v[56:59], v[104:107], v[24:27]
    ds_read_b128 v[56:59], v7 offset:17408
    s_waitcnt lgkmcnt(7)
    v_mfma_f32_16x16x32_bf16 v[28:31], v[60:63], v[104:107], v[28:31]
    ds_read_b128 v[60:63], v7 offset:18432
    s_waitcnt lgkmcnt(7)
    v_mfma_f32_16x16x32_bf16 v[32:35], v[64:67], v[104:107], v[32:35]
    ds_read_b128 v[64:67], v7 offset:19456
    s_waitcnt lgkmcnt(7)
    v_mfma_f32_16x16x32_bf16 v[36:39], v[68:71], v[104:107], v[36:39]
    ds_read_b128 v[68:71], v7 offset:20480
    s_waitcnt lgkmcnt(7)
    v_mfma_f32_16x16x32_bf16 v[40:43], v[72:75], v[104:107], v[40:43]
    ds_read_b128 v[72:75], v7 offset:21504
    s_waitcnt lgkmcnt(7)
    v_mfma_f32_16x16x32_bf16 v[44:47], v[76:79], v[104:107], v[44:47]
    ds_read_b128 v[76:79], v7 offset:22528
    s_waitcnt lgkmcnt(7)
    v_mfma_f32_16x16x32_bf16 v[48:51], v[80:83], v[104:107], v[48:51]
    ds_read_b128 v[80:83], v7 offset:23552
    v_mfma_f32_16x16x32_bf16 v[20:23], a[224:227], v[96:99], v[20:23]
    v_mfma_f32_16x16x32_bf16 v[24:27], a[228:231], v[96:99], v[24:27]
    v_mfma_f32_16x16x32_bf16 v[28:31], a[232:235], v[96:99], v[28:31]
    v_mfma_f32_16x16x32_bf16 v[32:35], a[236:239], v[96:99], v[32:35]
    v_mfma_f32_16x16x32_bf16 v[36:39], a[240:243], v[96:99], v[36:39]
    v_mfma_f32_16x16x32_bf16 v[40:43], a[244:247], v[96:99], v[40:43]
    v_mfma_f32_16x16x32_bf16 v[44:47], a[248:251], v[96:99], v[44:47]
    v_mfma_f32_16x16x32_bf16 v[48:51], a[252:255], v[96:99], v[48:51]
    s_waitcnt lgkmcnt(7)
    v_mfma_f32_16x16x32_bf16 v[20:23], v[52:55], v[108:111], v[20:23]
    ds_read_b128 v[52:55], v7 offset:24576
    s_waitcnt lgkmcnt(7)
    v_mfma_f32_16x16x32_bf16 v[24:27], v[56:59], v[108:111], v[24:27]
    ds_read_b128 v[56:59], v7 offset:25600
    s_waitcnt lgkmcnt(7)
    v_mfma_f32_16x16x32_bf16 v[28:31], v[60:63], v[108:111], v[28:31]
    ds_read_b128 v[60:63], v7 offset:26624
    s_waitcnt lgkmcnt(7)
    v_mfma_f32_16x16x32_bf16 v[32:35], v[64:67], v[108:111], v[32:35]
    ds_read_b128 v[64:67], v7 offset:27648
    s_waitcnt lgkmcnt(7)
    v_mfma_f32_16x16x32_bf16 v[36:39], v[68:71], v[108:111], v[36:39]
    ds_read_b128 v[68:71], v7 offset:28672
    s_waitcnt lgkmcnt(7)
    v_mfma_f32_16x16x32_bf16 v[40:43], v[72:75], v[108:111], v[40:43]
    ds_read_b128 v[72:75], v7 offset:29696
    s_waitcnt lgkmcnt(7)
    v_mfma_f32_16x16x32_bf16 v[44:47], v[76:79], v[108:111], v[44:47]
    ds_read_b128 v[76:79], v7 offset:30720
    s_waitcnt lgkmcnt(7)
    v_mfma_f32_16x16x32_bf16 v[48:51], v[80:83], v[108:111], v[48:51]
    ds_read_b128 v[80:83], v7 offset:31744
    s_waitcnt lgkmcnt(7)
    v_mfma_f32_16x16x32_bf16 v[20:23], v[52:55], v[112:115], v[20:23]
    s_waitcnt lgkmcnt(6)
    v_mfma_f32_16x16x32_bf16 v[24:27], v[56:59], v[112:115], v[24:27]
    s_waitcnt lgkmcnt(5)
    v_mfma_f32_16x16x32_bf16 v[28:31], v[60:63], v[112:115], v[28:31]
    s_waitcnt lgkmcnt(4)
    v_mfma_f32_16x16x32_bf16 v[32:35], v[64:67], v[112:115], v[32:35]
    s_waitcnt lgkmcnt(3)
    v_mfma_f32_16x16x32_bf16 v[36:39], v[68:71], v[112:115], v[36:39]
    s_waitcnt lgkmcnt(2)
    v_mfma_f32_16x16x32_bf16 v[40:43], v[72:75], v[112:115], v[40:43]
    s_waitcnt lgkmcnt(1)
    v_mfma_f32_16x16x32_bf16 v[44:47], v[76:79], v[112:115], v[44:47]
    s_waitcnt lgkmcnt(0)
    v_mfma_f32_16x16x32_bf16 v[48:51], v[80:83], v[112:115], v[48:51]
    s_waitcnt vmcnt(0)
    v_lshlrev_b32 v68, 16, v116
    v_and_b32 v72, 0xffff0000, v116
    v_lshlrev_b32 v76, 16, v117
    v_and_b32 v80, 0xffff0000, v117
    v_lshlrev_b32 v84, 16, v118
    v_and_b32 v88, 0xffff0000, v118
    v_lshlrev_b32 v92, 16, v119
    v_and_b32 v96, 0xffff0000, v119
    v_lshlrev_b32 v69, 16, v120
    v_and_b32 v73, 0xffff0000, v120
    v_lshlrev_b32 v77, 16, v121
    v_and_b32 v81, 0xffff0000, v121
    v_lshlrev_b32 v85, 16, v122
    v_and_b32 v89, 0xffff0000, v122
    v_lshlrev_b32 v93, 16, v123
    v_and_b32 v97, 0xffff0000, v123
    v_lshlrev_b32 v70, 16, v124
    v_and_b32 v74, 0xffff0000, v124
    v_lshlrev_b32 v78, 16, v125
    v_and_b32 v82, 0xffff0000, v125
    v_lshlrev_b32 v86, 16, v126
    v_and_b32 v90, 0xffff0000, v126
    v_lshlrev_b32 v94, 16, v127
    v_and_b32 v98, 0xffff0000, v127
    v_lshlrev_b32 v71, 16, v10
    v_and_b32 v75, 0xffff0000, v10
    v_lshlrev_b32 v79, 16, v11
    v_and_b32 v83, 0xffff0000, v11
    v_lshlrev_b32 v87, 16, v12
    v_and_b32 v91, 0xffff0000, v12
    v_lshlrev_b32 v95, 16, v13
    v_and_b32 v99, 0xffff0000, v13
    v_cvt_pk_bf16_f32 v16, v20, v21
    v_lshlrev_b32 v20, 16, v16
    v_and_b32 v21, 0xffff0000, v16
    v_cvt_pk_bf16_f32 v16, v22, v23
    v_lshlrev_b32 v22, 16, v16
    v_and_b32 v23, 0xffff0000, v16
    v_cvt_pk_bf16_f32 v16, v24, v25
    v_lshlrev_b32 v24, 16, v16
    v_and_b32 v25, 0xffff0000, v16
    v_cvt_pk_bf16_f32 v16, v26, v27
    v_lshlrev_b32 v26, 16, v16
    v_and_b32 v27, 0xffff0000, v16
    v_cvt_pk_bf16_f32 v16, v28, v29
    v_lshlrev_b32 v28, 16, v16
    v_and_b32 v29, 0xffff0000, v16
    v_cvt_pk_bf16_f32 v16, v30, v31
    v_lshlrev_b32 v30, 16, v16
    v_and_b32 v31, 0xffff0000, v16
    v_cvt_pk_bf16_f32 v16, v32, v33
    v_lshlrev_b32 v32, 16, v16
    v_and_b32 v33, 0xffff0000, v16
    v_cvt_pk_bf16_f32 v16, v34, v35
    v_lshlrev_b32 v34, 16, v16
    v_and_b32 v35, 0xffff0000, v16
    v_cvt_pk_bf16_f32 v16, v36, v37
    v_lshlrev_b32 v36, 16, v16
    v_and_b32 v37, 0xffff0000, v16
    v_cvt_pk_bf16_f32 v16, v38, v39
    v_lshlrev_b32 v38, 16, v16
    v_and_b32 v39, 0xffff0000, v16
    v_cvt_pk_bf16_f32 v16, v40, v41
    v_lshlrev_b32 v40, 16, v16
    v_and_b32 v41, 0xffff0000, v16
    v_cvt_pk_bf16_f32 v16, v42, v43
    v_lshlrev_b32 v42, 16, v16
    v_and_b32 v43, 0xffff0000, v16
    v_cvt_pk_bf16_f32 v16, v44, v45
    v_lshlrev_b32 v44, 16, v16
    v_and_b32 v45, 0xffff0000, v16
    v_cvt_pk_bf16_f32 v16, v46, v47
    v_lshlrev_b32 v46, 16, v16
    v_and_b32 v47, 0xffff0000, v16
    v_cvt_pk_bf16_f32 v16, v48, v49
    v_lshlrev_b32 v48, 16, v16
    v_and_b32 v49, 0xffff0000, v16
    v_cvt_pk_bf16_f32 v16, v50, v51
    v_lshlrev_b32 v50, 16, v16
    v_and_b32 v51, 0xffff0000, v16
    v_pk_add_f32 v[68:69], v[68:69], v[20:21]
    v_pk_add_f32 v[70:71], v[70:71], v[22:23]
    v_pk_add_f32 v[72:73], v[72:73], v[24:25]
    v_pk_add_f32 v[74:75], v[74:75], v[26:27]
    v_pk_add_f32 v[76:77], v[76:77], v[28:29]
    v_pk_add_f32 v[78:79], v[78:79], v[30:31]
    v_pk_add_f32 v[80:81], v[80:81], v[32:33]
    v_pk_add_f32 v[82:83], v[82:83], v[34:35]
    v_pk_add_f32 v[84:85], v[84:85], v[36:37]
    v_pk_add_f32 v[86:87], v[86:87], v[38:39]
    v_pk_add_f32 v[88:89], v[88:89], v[40:41]
    v_pk_add_f32 v[90:91], v[90:91], v[42:43]
    v_pk_add_f32 v[92:93], v[92:93], v[44:45]
    v_pk_add_f32 v[94:95], v[94:95], v[46:47]
    v_pk_add_f32 v[96:97], v[96:97], v[48:49]
    v_pk_add_f32 v[98:99], v[98:99], v[50:51]
    s_add_u32 s24, s27, 100663296
    s_add_u32 s25, s27, 102760448
    v_cvt_pk_bf16_f32 v52, v68, v72
    v_cvt_pk_bf16_f32 v53, v76, v80
    v_cvt_pk_bf16_f32 v54, v84, v88
    v_cvt_pk_bf16_f32 v55, v92, v96
    buffer_store_dwordx4 v[52:55], v6, s[8:11], s24 offen offset:0 sc1
    v_lshlrev_b32 v68, 16, v52
    v_and_b32 v72, 0xffff0000, v52
    v_lshlrev_b32 v76, 16, v53
    v_and_b32 v80, 0xffff0000, v53
    v_lshlrev_b32 v84, 16, v54
    v_and_b32 v88, 0xffff0000, v54
    v_lshlrev_b32 v92, 16, v55
    v_and_b32 v96, 0xffff0000, v55
    v_cvt_pk_bf16_f32 v56, v69, v73
    v_cvt_pk_bf16_f32 v57, v77, v81
    v_cvt_pk_bf16_f32 v58, v85, v89
    v_cvt_pk_bf16_f32 v59, v93, v97
    buffer_store_dwordx4 v[56:59], v6, s[8:11], s24 offen offset:256 sc1
    v_lshlrev_b32 v69, 16, v56
    v_and_b32 v73, 0xffff0000, v56
    v_lshlrev_b32 v77, 16, v57
    v_and_b32 v81, 0xffff0000, v57
    v_lshlrev_b32 v85, 16, v58
    v_and_b32 v89, 0xffff0000, v58
    v_lshlrev_b32 v93, 16, v59
    v_and_b32 v97, 0xffff0000, v59
    v_cvt_pk_bf16_f32 v60, v70, v74
    v_cvt_pk_bf16_f32 v61, v78, v82
    v_cvt_pk_bf16_f32 v62, v86, v90
    v_cvt_pk_bf16_f32 v63, v94, v98
    buffer_store_dwordx4 v[60:63], v6, s[8:11], s24 offen offset:512 sc1
    v_lshlrev_b32 v70, 16, v60
    v_and_b32 v74, 0xffff0000, v60
    v_lshlrev_b32 v78, 16, v61
    v_and_b32 v82, 0xffff0000, v61
    v_lshlrev_b32 v86, 16, v62
    v_and_b32 v90, 0xffff0000, v62
    v_lshlrev_b32 v94, 16, v63
    v_and_b32 v98, 0xffff0000, v63
    v_cvt_pk_bf16_f32 v64, v71, v75
    v_cvt_pk_bf16_f32 v65, v79, v83
    v_cvt_pk_bf16_f32 v66, v87, v91
    v_cvt_pk_bf16_f32 v67, v95, v99
    buffer_store_dwordx4 v[64:67], v6, s[8:11], s24 offen offset:768 sc1
    v_lshlrev_b32 v71, 16, v64
    v_and_b32 v75, 0xffff0000, v64
    v_lshlrev_b32 v79, 16, v65
    v_and_b32 v83, 0xffff0000, v65
    v_lshlrev_b32 v87, 16, v66
    v_and_b32 v91, 0xffff0000, v66
    v_lshlrev_b32 v95, 16, v67
    v_and_b32 v99, 0xffff0000, v67
    v_pk_add_f32 v[14:15], v[68:69], v[70:71]
    v_pk_add_f32 v[16:17], v[72:73], v[74:75]
    v_pk_add_f32 v[14:15], v[14:15], v[76:77]
    v_pk_add_f32 v[16:17], v[16:17], v[78:79]
    v_pk_add_f32 v[14:15], v[14:15], v[80:81]
    v_pk_add_f32 v[16:17], v[16:17], v[82:83]
    v_pk_add_f32 v[14:15], v[14:15], v[84:85]
    v_pk_add_f32 v[16:17], v[16:17], v[86:87]
    v_pk_add_f32 v[14:15], v[14:15], v[88:89]
    v_pk_add_f32 v[16:17], v[16:17], v[90:91]
    v_pk_add_f32 v[14:15], v[14:15], v[92:93]
    v_pk_add_f32 v[16:17], v[16:17], v[94:95]
    v_pk_add_f32 v[14:15], v[14:15], v[96:97]
    v_pk_add_f32 v[16:17], v[16:17], v[98:99]
    v_pk_add_f32 v[14:15], v[14:15], v[16:17]
    v_add_f32 v14, v14, v15
    v_mov_b32 v16, v14
    s_nop 1
    v_permlane16_swap_b32 v14, v16
    v_add_f32 v14, v14, v16
    v_mov_b32 v16, v14
    s_nop 1
    v_permlane32_swap_b32 v14, v16
    v_add_f32 v14, v14, v16
    ds_write_b32 v8, v14 offset:0
    s_waitcnt lgkmcnt(0)
    s_barrier
    ds_read_b128 v[10:13], v9 offset:0
    s_waitcnt lgkmcnt(0)
    v_add_f32 v14, v10, v11
    v_add_f32 v16, v12, v13
    v_add_f32 v14, v14, v16
    v_mul_f32 v18, 0x3b000000, v14
    v_pk_add_f32 v[16:17], v[68:69], v[18:19] op_sel_hi:[1,0] neg_lo:[0,1] neg_hi:[0,1]
    s_nop 0
    v_pk_mul_f32 v[14:15], v[16:17], v[16:17]
    v_pk_add_f32 v[16:17], v[70:71], v[18:19] op_sel_hi:[1,0] neg_lo:[0,1] neg_hi:[0,1]
    s_nop 0
    v_pk_fma_f32 v[14:15], v[16:17], v[16:17], v[14:15]
    v_pk_add_f32 v[16:17], v[72:73], v[18:19] op_sel_hi:[1,0] neg_lo:[0,1] neg_hi:[0,1]
    s_nop 0
    v_pk_fma_f32 v[14:15], v[16:17], v[16:17], v[14:15]
    v_pk_add_f32 v[16:17], v[74:75], v[18:19] op_sel_hi:[1,0] neg_lo:[0,1] neg_hi:[0,1]
    s_nop 0
    v_pk_fma_f32 v[14:15], v[16:17], v[16:17], v[14:15]
    v_pk_add_f32 v[16:17], v[76:77], v[18:19] op_sel_hi:[1,0] neg_lo:[0,1] neg_hi:[0,1]
    s_nop 0
    v_pk_fma_f32 v[14:15], v[16:17], v[16:17], v[14:15]
    v_pk_add_f32 v[16:17], v[78:79], v[18:19] op_sel_hi:[1,0] neg_lo:[0,1] neg_hi:[0,1]
    s_nop 0
    v_pk_fma_f32 v[14:15], v[16:17], v[16:17], v[14:15]
    v_pk_add_f32 v[16:17], v[80:81], v[18:19] op_sel_hi:[1,0] neg_lo:[0,1] neg_hi:[0,1]
    s_nop 0
    v_pk_fma_f32 v[14:15], v[16:17], v[16:17], v[14:15]
    v_pk_add_f32 v[16:17], v[82:83], v[18:19] op_sel_hi:[1,0] neg_lo:[0,1] neg_hi:[0,1]
    s_nop 0
    v_pk_fma_f32 v[14:15], v[16:17], v[16:17], v[14:15]
    v_pk_add_f32 v[16:17], v[84:85], v[18:19] op_sel_hi:[1,0] neg_lo:[0,1] neg_hi:[0,1]
    s_nop 0
    v_pk_fma_f32 v[14:15], v[16:17], v[16:17], v[14:15]
    v_pk_add_f32 v[16:17], v[86:87], v[18:19] op_sel_hi:[1,0] neg_lo:[0,1] neg_hi:[0,1]
    s_nop 0
    v_pk_fma_f32 v[14:15], v[16:17], v[16:17], v[14:15]
    v_pk_add_f32 v[16:17], v[88:89], v[18:19] op_sel_hi:[1,0] neg_lo:[0,1] neg_hi:[0,1]
    s_nop 0
    v_pk_fma_f32 v[14:15], v[16:17], v[16:17], v[14:15]
    v_pk_add_f32 v[16:17], v[90:91], v[18:19] op_sel_hi:[1,0] neg_lo:[0,1] neg_hi:[0,1]
    s_nop 0
    v_pk_fma_f32 v[14:15], v[16:17], v[16:17], v[14:15]
    v_pk_add_f32 v[16:17], v[92:93], v[18:19] op_sel_hi:[1,0] neg_lo:[0,1] neg_hi:[0,1]
    s_nop 0
    v_pk_fma_f32 v[14:15], v[16:17], v[16:17], v[14:15]
    v_pk_add_f32 v[16:17], v[94:95], v[18:19] op_sel_hi:[1,0] neg_lo:[0,1] neg_hi:[0,1]
    s_nop 0
    v_pk_fma_f32 v[14:15], v[16:17], v[16:17], v[14:15]
    v_pk_add_f32 v[16:17], v[96:97], v[18:19] op_sel_hi:[1,0] neg_lo:[0,1] neg_hi:[0,1]
    s_nop 0
    v_pk_fma_f32 v[14:15], v[16:17], v[16:17], v[14:15]
    v_pk_add_f32 v[16:17], v[98:99], v[18:19] op_sel_hi:[1,0] neg_lo:[0,1] neg_hi:[0,1]
    s_nop 0
    v_pk_fma_f32 v[14:15], v[16:17], v[16:17], v[14:15]
    v_add_f32 v14, v14, v15
    v_mov_b32 v16, v14
    s_nop 1
    v_permlane16_swap_b32 v14, v16
    v_add_f32 v14, v14, v16
    v_mov_b32 v16, v14
    s_nop 1
    v_permlane32_swap_b32 v14, v16
    v_add_f32 v14, v14, v16
    ds_write_b32 v8, v14 offset:256
    s_waitcnt lgkmcnt(0)
    s_barrier
    ds_read_b128 v[10:13], v9 offset:256
    s_waitcnt lgkmcnt(0)
    v_add_f32 v14, v10, v11
    v_add_f32 v16, v12, v13
    v_add_f32 v14, v14, v16
    v_mul_f32 v0, 0x3b000000, v14
    v_cvt_pk_bf16_f32 v0, v0, v0
    v_and_b32 v0, 0xffff0000, v0
    v_add_f32 v0, 0x3727c5ac, v0
    v_cvt_pk_bf16_f32 v0, v0, v0
    v_and_b32 v0, 0xffff0000, v0
    v_sqrt_f32 v0, v0
    s_nop 0
    v_cvt_pk_bf16_f32 v0, v0, v0
    v_and_b32 v0, 0xffff0000, v0
    v_rcp_f32 v0, v0
    v_cvt_pk_bf16_f32 v18, v18, v18
    v_and_b32 v18, 0xffff0000, v18
    v_mov_b32 v14, v0
    v_pk_add_f32 v[68:69], v[68:69], v[18:19] op_sel_hi:[1,0] neg_lo:[0,1] neg_hi:[0,1]
    s_nop 0
    v_cvt_pk_bf16_f32 v16, v68, v69
    v_lshlrev_b32 v68, 16, v16
    v_and_b32 v69, 0xffff0000, v16
    v_pk_mul_f32 v[68:69], v[68:69], v[14:15] op_sel_hi:[1,0]
    v_pk_add_f32 v[70:71], v[70:71], v[18:19] op_sel_hi:[1,0] neg_lo:[0,1] neg_hi:[0,1]
    s_nop 0
    v_cvt_pk_bf16_f32 v17, v70, v71
    v_lshlrev_b32 v70, 16, v17
    v_and_b32 v71, 0xffff0000, v17
    v_pk_mul_f32 v[70:71], v[70:71], v[14:15] op_sel_hi:[1,0]
    v_pk_add_f32 v[72:73], v[72:73], v[18:19] op_sel_hi:[1,0] neg_lo:[0,1] neg_hi:[0,1]
    s_nop 0
    v_cvt_pk_bf16_f32 v16, v72, v73
    v_lshlrev_b32 v72, 16, v16
    v_and_b32 v73, 0xffff0000, v16
    v_pk_mul_f32 v[72:73], v[72:73], v[14:15] op_sel_hi:[1,0]
    v_pk_add_f32 v[74:75], v[74:75], v[18:19] op_sel_hi:[1,0] neg_lo:[0,1] neg_hi:[0,1]
    s_nop 0
    v_cvt_pk_bf16_f32 v17, v74, v75
    v_lshlrev_b32 v74, 16, v17
    v_and_b32 v75, 0xffff0000, v17
    v_pk_mul_f32 v[74:75], v[74:75], v[14:15] op_sel_hi:[1,0]
    v_pk_add_f32 v[76:77], v[76:77], v[18:19] op_sel_hi:[1,0] neg_lo:[0,1] neg_hi:[0,1]
    s_nop 0
    v_cvt_pk_bf16_f32 v16, v76, v77
    v_lshlrev_b32 v76, 16, v16
    v_and_b32 v77, 0xffff0000, v16
    v_pk_mul_f32 v[76:77], v[76:77], v[14:15] op_sel_hi:[1,0]
    v_pk_add_f32 v[78:79], v[78:79], v[18:19] op_sel_hi:[1,0] neg_lo:[0,1] neg_hi:[0,1]
    s_nop 0
    v_cvt_pk_bf16_f32 v17, v78, v79
    v_lshlrev_b32 v78, 16, v17
    v_and_b32 v79, 0xffff0000, v17
    v_pk_mul_f32 v[78:79], v[78:79], v[14:15] op_sel_hi:[1,0]
    v_pk_add_f32 v[80:81], v[80:81], v[18:19] op_sel_hi:[1,0] neg_lo:[0,1] neg_hi:[0,1]
    s_nop 0
    v_cvt_pk_bf16_f32 v16, v80, v81
    v_lshlrev_b32 v80, 16, v16
    v_and_b32 v81, 0xffff0000, v16
    v_pk_mul_f32 v[80:81], v[80:81], v[14:15] op_sel_hi:[1,0]
    v_pk_add_f32 v[82:83], v[82:83], v[18:19] op_sel_hi:[1,0] neg_lo:[0,1] neg_hi:[0,1]
    s_nop 0
    v_cvt_pk_bf16_f32 v17, v82, v83
    v_lshlrev_b32 v82, 16, v17
    v_and_b32 v83, 0xffff0000, v17
    v_pk_mul_f32 v[82:83], v[82:83], v[14:15] op_sel_hi:[1,0]
    v_pk_add_f32 v[84:85], v[84:85], v[18:19] op_sel_hi:[1,0] neg_lo:[0,1] neg_hi:[0,1]
    s_nop 0
    v_cvt_pk_bf16_f32 v16, v84, v85
    v_lshlrev_b32 v84, 16, v16
    v_and_b32 v85, 0xffff0000, v16
    v_pk_mul_f32 v[84:85], v[84:85], v[14:15] op_sel_hi:[1,0]
    v_pk_add_f32 v[86:87], v[86:87], v[18:19] op_sel_hi:[1,0] neg_lo:[0,1] neg_hi:[0,1]
    s_nop 0
    v_cvt_pk_bf16_f32 v17, v86, v87
    v_lshlrev_b32 v86, 16, v17
    v_and_b32 v87, 0xffff0000, v17
    v_pk_mul_f32 v[86:87], v[86:87], v[14:15] op_sel_hi:[1,0]
    v_pk_add_f32 v[88:89], v[88:89], v[18:19] op_sel_hi:[1,0] neg_lo:[0,1] neg_hi:[0,1]
    s_nop 0
    v_cvt_pk_bf16_f32 v16, v88, v89
    v_lshlrev_b32 v88, 16, v16
    v_and_b32 v89, 0xffff0000, v16
    v_pk_mul_f32 v[88:89], v[88:89], v[14:15] op_sel_hi:[1,0]
    v_pk_add_f32 v[90:91], v[90:91], v[18:19] op_sel_hi:[1,0] neg_lo:[0,1] neg_hi:[0,1]
    s_nop 0
    v_cvt_pk_bf16_f32 v17, v90, v91
    v_lshlrev_b32 v90, 16, v17
    v_and_b32 v91, 0xffff0000, v17
    v_pk_mul_f32 v[90:91], v[90:91], v[14:15] op_sel_hi:[1,0]
    v_pk_add_f32 v[92:93], v[92:93], v[18:19] op_sel_hi:[1,0] neg_lo:[0,1] neg_hi:[0,1]
    s_nop 0
    v_cvt_pk_bf16_f32 v16, v92, v93
    v_lshlrev_b32 v92, 16, v16
    v_and_b32 v93, 0xffff0000, v16
    v_pk_mul_f32 v[92:93], v[92:93], v[14:15] op_sel_hi:[1,0]
    v_pk_add_f32 v[94:95], v[94:95], v[18:19] op_sel_hi:[1,0] neg_lo:[0,1] neg_hi:[0,1]
    s_nop 0
    v_cvt_pk_bf16_f32 v17, v94, v95
    v_lshlrev_b32 v94, 16, v17
    v_and_b32 v95, 0xffff0000, v17
    v_pk_mul_f32 v[94:95], v[94:95], v[14:15] op_sel_hi:[1,0]
    v_pk_add_f32 v[96:97], v[96:97], v[18:19] op_sel_hi:[1,0] neg_lo:[0,1] neg_hi:[0,1]
    s_nop 0
    v_cvt_pk_bf16_f32 v16, v96, v97
    v_lshlrev_b32 v96, 16, v16
    v_and_b32 v97, 0xffff0000, v16
    v_pk_mul_f32 v[96:97], v[96:97], v[14:15] op_sel_hi:[1,0]
    v_pk_add_f32 v[98:99], v[98:99], v[18:19] op_sel_hi:[1,0] neg_lo:[0,1] neg_hi:[0,1]
    s_nop 0
    v_cvt_pk_bf16_f32 v17, v98, v99
    v_lshlrev_b32 v98, 16, v17
    v_and_b32 v99, 0xffff0000, v17
    v_pk_mul_f32 v[98:99], v[98:99], v[14:15] op_sel_hi:[1,0]
    v_cvt_pk_bf16_f32 v20, v68, v72
    v_cvt_pk_bf16_f32 v21, v76, v80
    v_cvt_pk_bf16_f32 v22, v84, v88
    v_cvt_pk_bf16_f32 v23, v92, v96
    buffer_store_dwordx4 v[20:23], v6, s[8:11], s25 offen offset:0 sc1
    v_cvt_pk_bf16_f32 v24, v69, v73
    v_cvt_pk_bf16_f32 v25, v77, v81
    v_cvt_pk_bf16_f32 v26, v85, v89
    v_cvt_pk_bf16_f32 v27, v93, v97
    buffer_store_dwordx4 v[24:27], v6, s[8:11], s25 offen offset:256 sc1
    v_cvt_pk_bf16_f32 v28, v70, v74
    v_cvt_pk_bf16_f32 v29, v78, v82
    v_cvt_pk_bf16_f32 v30, v86, v90
    v_cvt_pk_bf16_f32 v31, v94, v98
    buffer_store_dwordx4 v[28:31], v6, s[8:11], s25 offen offset:512 sc1
    v_cvt_pk_bf16_f32 v32, v71, v75
    v_cvt_pk_bf16_f32 v33, v79, v83
    v_cvt_pk_bf16_f32 v34, v87, v91
    v_cvt_pk_bf16_f32 v35, v95, v99
    buffer_store_dwordx4 v[32:35], v6, s[8:11], s25 offen offset:768 sc1
    s_lshl_b32 s24, s5, 7
    s_add_u32 s24, s24, 160071680
    s_waitcnt vmcnt(0) lgkmcnt(0)
    s_barrier
    s_cmp_lg_u32 s19, 0
    s_cbranch_scc1 Lsig_172
    v_mov_b64 v[10:11], s[62:63]
    v_mov_b64 v[12:13], s[62:63]
    s_mov_b64 exec, 0xff
    buffer_store_dwordx4 v[10:13], v4, s[8:11], s24 offen sc1
    s_mov_b64 exec, -1
    s_nop 0
Lsig_172:
    s_add_u32 s5, s5, 8
    s_cmp_lt_u32 s5, 128
    s_cbranch_scc1 Lst_166
    s_branch Lnext_92
Lh_103:
    s_cmp_lg_u32 s64, 0
    s_cbranch_scc1 Lpk_173
    s_mov_b32 s24, 159776768
    v_min_u32 v8, 63, v1
    v_mul_u32_u24 v8, 128, v8
    s_nop 1
Lw_174:
    buffer_load_dwordx2 v[10:11], v8, s[8:11], s24 offen sc1
    s_waitcnt vmcnt(0)
    v_cmp_ne_u64 vcc, s[62:63], v[10:11]
    s_nop 4
    s_cbranch_vccz Lwd_175
    s_sleep 2
    s_sub_u32 s21, s21, 1
    s_cbranch_scc0 Lw_174
    s_mov_b32 s21, 0
Lwd_175:
    s_mov_b32 s24, 159784960
    v_min_u32 v8, 3, v1
    v_mul_u32_u24 v8, 128, v8
    s_nop 1
Lw_176:
    buffer_load_dwordx2 v[10:11], v8, s[8:11], s24 offen sc1
    s_waitcnt vmcnt(0)
    v_cmp_ne_u64 vcc, s[62:63], v[10:11]
    s_nop 4
    s_cbranch_vccz Lwd_177
    s_sleep 2
    s_sub_u32 s21, s21, 1
    s_cbranch_scc0 Lw_176
    s_mov_b32 s21, 0
Lwd_177:
    s_mov_b32 s64, 1
Lpk_173:
    s_lshl_b32 s12, s6, 2
    s_add_u32 s12, s12, s19
    s_cmp_ge_u32 s12, 14
    s_cbranch_scc1 Lf1z_179
    s_lshl_b32 s26, s12, 17
    s_add_u32 s26, s26, 118489088
    s_mov_b32 s33, s26
    buffer_load_dwordx4 v[128:131], v4, s[8:11], s26 offen offset:0 sc1
    buffer_load_dwordx4 v[132:135], v4, s[8:11], s26 offen offset:1024 sc1
    buffer_load_dwordx4 v[136:139], v4, s[8:11], s26 offen offset:2048 sc1
    buffer_load_dwordx4 v[140:143], v4, s[8:11], s26 offen offset:3072 sc1
    buffer_load_dwordx4 v[144:147], v5, s[8:11], s26 offen offset:0 sc1
    buffer_load_dwordx4 v[148:151], v5, s[8:11], s26 offen offset:1024 sc1
    buffer_load_dwordx4 v[152:155], v5, s[8:11], s26 offen offset:2048 sc1
    buffer_load_dwordx4 v[156:159], v5, s[8:11], s26 offen offset:3072 sc1
    s_add_u32 s26, s26, 8192
    buffer_load_dwordx4 v[160:163], v4, s[8:11], s26 offen offset:0 sc1
    buffer_load_dwordx4 v[164:167], v4, s[8:11], s26 offen offset:1024 sc1
    buffer_load_dwordx4 v[168:171], v4, s[8:11], s26 offen offset:2048 sc1
    buffer_load_dwordx4 v[172:175], v4, s[8:11], s26 offen offset:3072 sc1
    buffer_load_dwordx4 v[176:179], v5, s[8:11], s26 offen offset:0 sc1
    buffer_load_dwordx4 v[180:183], v5, s[8:11], s26 offen offset:1024 sc1
    buffer_load_dwordx4 v[184:187], v5, s[8:11], s26 offen offset:2048 sc1
    buffer_load_dwordx4 v[188:191], v5, s[8:11], s26 offen offset:3072 sc1
    s_add_u32 s26, s26, 8192
    buffer_load_dwordx4 v[192:195], v4, s[8:11], s26 offen offset:0 sc1
    buffer_load_dwordx4 v[196:199], v4, s[8:11], s26 offen offset:1024 sc1
    buffer_load_dwordx4 v[200:203], v4, s[8:11], s26 offen offset:2048 sc1
    buffer_load_dwordx4 v[204:207], v4, s[8:11], s26 offen offset:3072 sc1
    buffer_load_dwordx4 v[208:211], v5, s[8:11], s26 offen offset:0 sc1
    buffer_load_dwordx4 v[212:215], v5, s[8:11], s26 offen offset:1024 sc1
    buffer_load_dwordx4 v[216:219], v5, s[8:11], s26 offen offset:2048 sc1
    buffer_load_dwordx4 v[220:223], v5, s[8:11], s26 offen offset:3072 sc1
    s_add_u32 s26, s26, 8192
    buffer_load_dwordx4 v[224:227], v4, s[8:11], s26 offen offset:0 sc1
    buffer_load_dwordx4 v[228:231], v4, s[8:11], s26 offen offset:1024 sc1
    buffer_load_dwordx4 v[232:235], v4, s[8:11], s26 offen offset:2048 sc1
    buffer_load_dwordx4 v[236:239], v4, s[8:11], s26 offen offset:3072 sc1
    buffer_load_dwordx4 v[240:243], v5, s[8:11], s26 offen offset:0 sc1
    buffer_load_dwordx4 v[244:247], v5, s[8:11], s26 offen offset:1024 sc1
    buffer_load_dwordx4 v[248:251], v5, s[8:11], s26 offen offset:2048 sc1
    buffer_load_dwordx4 v[252:255], v5, s[8:11], s26 offen offset:3072 sc1
    s_add_u32 s26, s26, 8192
    buffer_load_dwordx4 a[0:3], v4, s[8:11], s26 offen offset:0 sc1
    buffer_load_dwordx4 a[4:7], v4, s[8:11], s26 offen offset:1024 sc1
    buffer_load_dwordx4 a[8:11], v4, s[8:11], s26 offen offset:2048 sc1
    buffer_load_dwordx4 a[12:15], v4, s[8:11], s26 offen offset:3072 sc1
    buffer_load_dwordx4 a[16:19], v5, s[8:11], s26 offen offset:0 sc1
    buffer_load_dwordx4 a[20:23], v5, s[8:11], s26 offen offset:1024 sc1
    buffer_load_dwordx4 a[24:27], v5, s[8:11], s26 offen offset:2048 sc1
    buffer_load_dwordx4 a[28:31], v5, s[8:11], s26 offen offset:3072 sc1
    s_add_u32 s26, s26, 8192
    buffer_load_dwordx4 a[32:35], v4, s[8:11], s26 offen offset:0 sc1
    buffer_load_dwordx4 a[36:39], v4, s[8:11], s26 offen offset:1024 sc1
    buffer_load_dwordx4 a[40:43], v4, s[8:11], s26 offen offset:2048 sc1
    buffer_load_dwordx4 a[44:47], v4, s[8:11], s26 offen offset:3072 sc1
    buffer_load_dwordx4 a[48:51], v5, s[8:11], s26 offen offset:0 sc1
    buffer_load_dwordx4 a[52:55], v5, s[8:11], s26 offen offset:1024 sc1
    buffer_load_dwordx4 a[56:59], v5, s[8:11], s26 offen offset:2048 sc1
    buffer_load_dwordx4 a[60:63], v5, s[8:11], s26 offen offset:3072 sc1
    s_waitcnt vmcnt(12)
    s_add_u32 s26, s26, 8192
    buffer_load_dwordx4 a[64:67], v4, s[8:11], s26 offen offset:0 sc1
    buffer_load_dwordx4 a[68:71], v4, s[8:11], s26 offen offset:1024 sc1
    buffer_load_dwordx4 a[72:75], v4, s[8:11], s26 offen offset:2048 sc1
    buffer_load_dwordx4 a[76:79], v4, s[8:11], s26 offen offset:3072 sc1
    buffer_load_dwordx4 a[80:83], v5, s[8:11], s26 offen offset:0 sc1
    buffer_load_dwordx4 a[84:87], v5, s[8:11], s26 offen offset:1024 sc1
    buffer_load_dwordx4 a[88:91], v5, s[8:11], s26 offen offset:2048 sc1
    buffer_load_dwordx4 a[92:95], v5, s[8:11], s26 offen offset:3072 sc1
    s_add_u32 s26, s26, 8192
    buffer_load_dwordx4 a[96:99], v4, s[8:11], s26 offen offset:0 sc1
    buffer_load_dwordx4 a[100:103], v4, s[8:11], s26 offen offset:1024 sc1
    buffer_load_dwordx4 a[104:107], v4, s[8:11], s26 offen offset:2048 sc1
    buffer_load_dwordx4 a[108:111], v4, s[8:11], s26 offen offset:3072 sc1
    buffer_load_dwordx4 a[112:115], v5, s[8:11], s26 offen offset:0 sc1
    buffer_load_dwordx4 a[116:119], v5, s[8:11], s26 offen offset:1024 sc1
    buffer_load_dwordx4 a[120:123], v5, s[8:11], s26 offen offset:2048 sc1
    buffer_load_dwordx4 a[124:127], v5, s[8:11], s26 offen offset:3072 sc1
    s_add_u32 s26, s26, 8192
    buffer_load_dwordx4 a[128:131], v4, s[8:11], s26 offen offset:0 sc1
    buffer_load_dwordx4 a[132:135], v4, s[8:11], s26 offen offset:1024 sc1
    buffer_load_dwordx4 a[136:139], v4, s[8:11], s26 offen offset:2048 sc1
    buffer_load_dwordx4 a[140:143], v4, s[8:11], s26 offen offset:3072 sc1
    buffer_load_dwordx4 a[144:147], v5, s[8:11], s26 offen offset:0 sc1
    buffer_load_dwordx4 a[148:151], v5, s[8:11], s26 offen offset:1024 sc1
    buffer_load_dwordx4 a[152:155], v5, s[8:11], s26 offen offset:2048 sc1
    buffer_load_dwordx4 a[156:159], v5, s[8:11], s26 offen offset:3072 sc1
    s_add_u32 s26, s26, 8192
    buffer_load_dwordx4 a[160:163], v4, s[8:11], s26 offen offset:0 sc1
    buffer_load_dwordx4 a[164:167], v4, s[8:11], s26 offen offset:1024 sc1
    buffer_load_dwordx4 a[168:171], v4, s[8:11], s26 offen offset:2048 sc1
    buffer_load_dwordx4 a[172:175], v4, s[8:11], s26 offen offset:3072 sc1
    buffer_load_dwordx4 a[176:179], v5, s[8:11], s26 offen offset:0 sc1
    buffer_load_dwordx4 a[180:183], v5, s[8:11], s26 offen offset:1024 sc1
    buffer_load_dwordx4 a[184:187], v5, s[8:11], s26 offen offset:2048 sc1
    buffer_load_dwordx4 a[188:191], v5, s[8:11], s26 offen offset:3072 sc1
    s_add_u32 s26, s26, 8192
    buffer_load_dwordx4 a[192:195], v4, s[8:11], s26 offen offset:0 sc1
    buffer_load_dwordx4 a[196:199], v4, s[8:11], s26 offen offset:1024 sc1
    buffer_load_dwordx4 a[200:203], v4, s[8:11], s26 offen offset:2048 sc1
    buffer_load_dwordx4 a[204:207], v4, s[8:11], s26 offen offset:3072 sc1
    buffer_load_dwordx4 a[208:211], v5, s[8:11], s26 offen offset:0 sc1
    buffer_load_dwordx4 a[212:215], v5, s[8:11], s26 offen offset:1024 sc1
    buffer_load_dwordx4 a[216:219], v5, s[8:11], s26 offen offset:2048 sc1
    buffer_load_dwordx4 a[220:223], v5, s[8:11], s26 offen offset:3072 sc1
    s_add_u32 s26, s26, 8192
    buffer_load_dwordx4 a[224:227], v4, s[8:11], s26 offen offset:0 sc1
    buffer_load_dwordx4 a[228:231], v4, s[8:11], s26 offen offset:1024 sc1
    buffer_load_dwordx4 a[232:235], v4, s[8:11], s26 offen offset:2048 sc1
    buffer_load_dwordx4 a[236:239], v4, s[8:11], s26 offen offset:3072 sc1
    buffer_load_dwordx4 a[240:243], v5, s[8:11], s26 offen offset:0 sc1
    buffer_load_dwordx4 a[244:247], v5, s[8:11], s26 offen offset:1024 sc1
    buffer_load_dwordx4 a[248:251], v5, s[8:11], s26 offen offset:2048 sc1
    buffer_load_dwordx4 a[252:255], v5, s[8:11], s26 offen offset:3072 sc1
    s_waitcnt vmcnt(12)
    s_add_u32 s26, s26, 8192
    s_mul_i32 s31, s19, 32768
    s_add_u32 s31, s31, 32768
    s_add_u32 m0, s31, 0
    s_nop 0
    buffer_load_dwordx4 v4, s[8:11], s26 offen offset:0 sc1 lds
    buffer_load_dwordx4 v4, s[8:11], s26 offen offset:1024 sc1 lds
    buffer_load_dwordx4 v4, s[8:11], s26 offen offset:2048 sc1 lds
    buffer_load_dwordx4 v4, s[8:11], s26 offen offset:3072 sc1 lds
    s_add_u32 s26, s26, 4096
    s_add_u32 m0, s31, 4096
    s_nop 0
    buffer_load_dwordx4 v4, s[8:11], s26 offen offset:0 sc1 lds
    buffer_load_dwordx4 v4, s[8:11], s26 offen offset:1024 sc1 lds
    buffer_load_dwordx4 v4, s[8:11], s26 offen offset:2048 sc1 lds
    buffer_load_dwordx4 v4, s[8:11], s26 offen offset:3072 sc1 lds
    s_add_u32 s26, s26, 4096
    s_add_u32 m0, s31, 8192
    s_nop 0
    buffer_load_dwordx4 v4, s[8:11], s26 offen offset:0 sc1 lds
    buffer_load_dwordx4 v4, s[8:11], s26 offen offset:1024 sc1 lds
    buffer_load_dwordx4 v4, s[8:11], s26 offen offset:2048 sc1 lds
    buffer_load_dwordx4 v4, s[8:11], s26 offen offset:3072 sc1 lds
    s_add_u32 s26, s26, 4096
    s_add_u32 m0, s31, 12288
    s_nop 0
    buffer_load_dwordx4 v4, s[8:11], s26 offen offset:0 sc1 lds
    buffer_load_dwordx4 v4, s[8:11], s26 offen offset:1024 sc1 lds
    buffer_load_dwordx4 v4, s[8:11], s26 offen offset:2048 sc1 lds
    buffer_load_dwordx4 v4, s[8:11], s26 offen offset:3072 sc1 lds
    s_add_u32 s26, s26, 4096
    s_add_u32 m0, s31, 16384
    s_nop 0
    buffer_load_dwordx4 v4, s[8:11], s26 offen offset:0 sc1 lds
    buffer_load_dwordx4 v4, s[8:11], s26 offen offset:1024 sc1 lds
    buffer_load_dwordx4 v4, s[8:11], s26 offen offset:2048 sc1 lds
    buffer_load_dwordx4 v4, s[8:11], s26 offen offset:3072 sc1 lds
    s_add_u32 s26, s26, 4096
    s_add_u32 m0, s31, 20480
    s_nop 0
    buffer_load_dwordx4 v4, s[8:11], s26 offen offset:0 sc1 lds
    buffer_load_dwordx4 v4, s[8:11], s26 offen offset:1024 sc1 lds
    buffer_load_dwordx4 v4, s[8:11], s26 offen offset:2048 sc1 lds
    buffer_load_dwordx4 v4, s[8:11], s26 offen offset:3072 sc1 lds
    s_add_u32 s26, s26, 4096
    s_add_u32 m0, s31, 24576
    s_nop 0
    buffer_load_dwordx4 v4, s[8:11], s26 offen offset:0 sc1 lds
    buffer_load_dwordx4 v4, s[8:11], s26 offen offset:1024 sc1 lds
    buffer_load_dwordx4 v4, s[8:11], s26 offen offset:2048 sc1 lds
    buffer_load_dwordx4 v4, s[8:11], s26 offen offset:3072 sc1 lds
    s_add_u32 s26, s26, 4096
    s_add_u32 m0, s31, 28672
    s_nop 0
    buffer_load_dwordx4 v4, s[8:11], s26 offen offset:0 sc1 lds
    buffer_load_dwordx4 v4, s[8:11], s26 offen offset:1024 sc1 lds
    buffer_load_dwordx4 v4, s[8:11], s26 offen offset:2048 sc1 lds
    buffer_load_dwordx4 v4, s[8:11], s26 offen offset:3072 sc1 lds
    s_add_u32 s26, s26, 4096
Lf1z_179:
Lst_180:
    s_lshl_b32 s24, s5, 0
    s_lshl_b32 s24, s24, 7
    s_add_u32 s24, s24, 160038912
    v_mov_b32 v10, 0
    s_cmp_lg_u32 s19, 0
    s_nop 0
    s_cbranch_scc1 Lco_181
Lw_182:
    buffer_load_dwordx2 v[12:13], v10, s[8:11], s24 offen sc1
    s_waitcnt vmcnt(0)
    v_cmp_ne_u64 vcc, s[62:63], v[12:13]
    s_nop 4
    s_cbranch_vccz Lwd_183
    s_sleep 16
    s_sub_u32 s21, s21, 1
    s_cbranch_scc0 Lw_182
    s_mov_b32 s21, 0
Lwd_183:
Lco_181:
    s_barrier
    s_cmp_ge_u32 s12, 14
    s_cbranch_scc1 Lf1s_178
    s_lshl_b32 s24, s5, 7
    s_add_u32 s24, s24, 160071680
    v_mov_b32 v8, 0
    s_nop 1
Lw_184:
    buffer_load_dwordx2 v[10:11], v8, s[8:11], s24 offen sc1
    s_waitcnt vmcnt(0)
    v_cmp_ne_u64 vcc, s[62:63], v[10:11]
    s_nop 4
    s_cbranch_vccz Lwd_185
    s_sleep 2
    s_sub_u32 s21, s21, 1
    s_cbranch_scc0 Lw_184
    s_mov_b32 s21, 0
Lwd_185:
    s_lshl_b32 s24, s5, 14
    s_add_u32 s24, s24, 102760448
    buffer_load_dwordx4 v[52:55], v4, s[8:11], s24 offen offset:0 sc1
    buffer_load_dwordx4 v[56:59], v4, s[8:11], s24 offen offset:1024 sc1
    buffer_load_dwordx4 v[60:63], v4, s[8:11], s24 offen offset:2048 sc1
    buffer_load_dwordx4 v[64:67], v4, s[8:11], s24 offen offset:3072 sc1
    s_add_u32 s24, s24, 4096
    buffer_load_dwordx4 v[68:71], v4, s[8:11], s24 offen offset:0 sc1
    buffer_load_dwordx4 v[72:75], v4, s[8:11], s24 offen offset:1024 sc1
    buffer_load_dwordx4 v[76:79], v4, s[8:11], s24 offen offset:2048 sc1
    buffer_load_dwordx4 v[80:83], v4, s[8:11], s24 offen offset:3072 sc1
    s_add_u32 s24, s24, 4096
    buffer_load_dwordx4 v[84:87], v4, s[8:11], s24 offen offset:0 sc1
    buffer_load_dwordx4 v[88:91], v4, s[8:11], s24 offen offset:1024 sc1
    buffer_load_dwordx4 v[92:95], v4, s[8:11], s24 offen offset:2048 sc1
    buffer_load_dwordx4 v[96:99], v4, s[8:11], s24 offen offset:3072 sc1
    s_add_u32 s24, s24, 4096
    buffer_load_dwordx4 v[100:103], v4, s[8:11], s24 offen offset:0 sc1
    buffer_load_dwordx4 v[104:107], v4, s[8:11], s24 offen offset:1024 sc1
    buffer_load_dwordx4 v[108:111], v4, s[8:11], s24 offen offset:2048 sc1
    buffer_load_dwordx4 v[112:115], v4, s[8:11], s24 offen offset:3072 sc1
    s_add_u32 s24, s24, 4096
    s_waitcnt vmcnt(0)
    v_add_u32 v7, s31, v4
    v_mfma_f32_16x16x32_bf16 v[20:23], v[128:131], v[52:55], 0
    v_mfma_f32_16x16x32_bf16 v[24:27], v[132:135], v[52:55], 0
    v_mfma_f32_16x16x32_bf16 v[28:31], v[136:139], v[52:55], 0
    v_mfma_f32_16x16x32_bf16 v[32:35], v[140:143], v[52:55], 0
    v_mfma_f32_16x16x32_bf16 v[36:39], v[144:147], v[52:55], 0
    v_mfma_f32_16x16x32_bf16 v[40:43], v[148:151], v[52:55], 0
    v_mfma_f32_16x16x32_bf16 v[44:47], v[152:155], v[52:55], 0
    v_mfma_f32_16x16x32_bf16 v[48:51], v[156:159], v[52:55], 0
    v_mfma_f32_16x16x32_bf16 v[20:23], v[160:163], v[56:59], v[20:23]
    v_mfma_f32_16x16x32_bf16 v[24:27], v[164:167], v[56:59], v[24:27]
    v_mfma_f32_16x16x32_bf16 v[28:31], v[168:171], v[56:59], v[28:31]
    v_mfma_f32_16x16x32_bf16 v[32:35], v[172:175], v[56:59], v[32:35]
    v_mfma_f32_16x16x32_bf16 v[36:39], v[176:179], v[56:59], v[36:39]
    v_mfma_f32_16x16x32_bf16 v[40:43], v[180:183], v[56:59], v[40:43]
    v_mfma_f32_16x16x32_bf16 v[44:47], v[184:187], v[56:59], v[44:47]
    v_mfma_f32_16x16x32_bf16 v[48:51], v[188:191], v[56:59], v[48:51]
    v_mfma_f32_16x16x32_bf16 v[20:23], v[192:195], v[60:63], v[20:23]
    v_mfma_f32_16x16x32_bf16 v[24:27], v[196:199], v[60:63], v[24:27]
    v_mfma_f32_16x16x32_bf16 v[28:31], v[200:203], v[60:63], v[28:31]
    v_mfma_f32_16x16x32_bf16 v[32:35], v[204:207], v[60:63], v[32:35]
    v_mfma_f32_16x16x32_bf16 v[36:39], v[208:211], v[60:63], v[36:39]
    v_mfma_f32_16x16x32_bf16 v[40:43], v[212:215], v[60:63], v[40:43]
    v_mfma_f32_16x16x32_bf16 v[44:47], v[216:219], v[60:63], v[44:47]
    v_mfma_f32_16x16x32_bf16 v[48:51], v[220:223], v[60:63], v[48:51]
    v_mfma_f32_16x16x32_bf16 v[20:23], v[224:227], v[64:67], v[20:23]
    v_mfma_f32_16x16x32_bf16 v[24:27], v[228:231], v[64:67], v[24:27]
    v_mfma_f32_16x16x32_bf16 v[28:31], v[232:235], v[64:67], v[28:31]
    v_mfma_f32_16x16x32_bf16 v[32:35], v[236:239], v[64:67], v[32:35]
    v_mfma_f32_16x16x32_bf16 v[36:39], v[240:243], v[64:67], v[36:39]
    v_mfma_f32_16x16x32_bf16 v[40:43], v[244:247], v[64:67], v[40:43]
    v_mfma_f32_16x16x32_bf16 v[44:47], v[248:251], v[64:67], v[44:47]
    v_mfma_f32_16x16x32_bf16 v[48:51], v[252:255], v[64:67], v[48:51]
    v_mfma_f32_16x16x32_bf16 v[20:23], a[0:3], v[68:71], v[20:23]
    v_mfma_f32_16x16x32_bf16 v[24:27], a[4:7], v[68:71], v[24:27]
    v_mfma_f32_16x16x32_bf16 v[28:31], a[8:11], v[68:71], v[28:31]
    v_mfma_f32_16x16x32_bf16 v[32:35], a[12:15], v[68:71], v[32:35]
    v_mfma_f32_16x16x32_bf16 v[36:39], a[16:19], v[68:71], v[36:39]
    v_mfma_f32_16x16x32_bf16 v[40:43], a[20:23], v[68:71], v[40:43]
    v_mfma_f32_16x16x32_bf16 v[44:47], a[24:27], v[68:71], v[44:47]
    v_mfma_f32_16x16x32_bf16 v[48:51], a[28:31], v[68:71], v[48:51]
    v_mfma_f32_16x16x32_bf16 v[20:23], a[32:35], v[72:75], v[20:23]
    v_mfma_f32_16x16x32_bf16 v[24:27], a[36:39], v[72:75], v[24:27]
    v_mfma_f32_16x16x32_bf16 v[28:31], a[40:43], v[72:75], v[28:31]
    v_mfma_f32_16x16x32_bf16 v[32:35], a[44:47], v[72:75], v[32:35]
    v_mfma_f32_16x16x32_bf16 v[36:39], a[48:51], v[72:75], v[36:39]
    v_mfma_f32_16x16x32_bf16 v[40:43], a[52:55], v[72:75], v[40:43]
    v_mfma_f32_16x16x32_bf16 v[44:47], a[56:59], v[72:75], v[44:47]
    v_mfma_f32_16x16x32_bf16 v[48:51], a[60:63], v[72:75], v[48:51]
    v_mfma_f32_16x16x32_bf16 v[20:23], a[64:67], v[76:79], v[20:23]
    v_mfma_f32_16x16x32_bf16 v[24:27], a[68:71], v[76:79], v[24:27]
    v_mfma_f32_16x16x32_bf16 v[28:31], a[72:75], v[76:79], v[28:31]
    v_mfma_f32_16x16x32_bf16 v[32:35], a[76:79], v[76:79], v[32:35]
    v_mfma_f32_16x16x32_bf16 v[36:39], a[80:83], v[76:79], v[36:39]
    v_mfma_f32_16x16x32_bf16 v[40:43], a[84:87], v[76:79], v[40:43]
    v_mfma_f32_16x16x32_bf16 v[44:47], a[88:91], v[76:79], v[44:47]
    v_mfma_f32_16x16x32_bf16 v[48:51], a[92:95], v[76:79], v[48:51]
    v_mfma_f32_16x16x32_bf16 v[20:23], a[96:99], v[80:83], v[20:23]
    v_mfma_f32_16x16x32_bf16 v[24:27], a[100:103], v[80:83], v[24:27]
    v_mfma_f32_16x16x32_bf16 v[28:31], a[104:107], v[80:83], v[28:31]
    v_mfma_f32_16x16x32_bf16 v[32:35], a[108:111], v[80:83], v[32:35]
    v_mfma_f32_16x16x32_bf16 v[36:39], a[112:115], v[80:83], v[36:39]
    v_mfma_f32_16x16x32_bf16 v[40:43], a[116:119], v[80:83], v[40:43]
    v_mfma_f32_16x16x32_bf16 v[44:47], a[120:123], v[80:83], v[44:47]
    v_mfma_f32_16x16x32_bf16 v[48:51], a[124:127], v[80:83], v[48:51]
    v_mfma_f32_16x16x32_bf16 v[20:23], a[128:131], v[84:87], v[20:23]
    ds_read_b128 v[52:55], v7 offset:0
    v_mfma_f32_16x16x32_bf16 v[24:27], a[132:135], v[84:87], v[24:27]
    ds_read_b128 v[56:59], v7 offset:1024
    v_mfma_f32_16x16x32_bf16 v[28:31], a[136:139], v[84:87], v[28:31]
    ds_read_b128 v[60:63], v7 offset:2048
    v_mfma_f32_16x16x32_bf16 v[32:35], a[140:143], v[84:87], v[32:35]
    ds_read_b128 v[64:67], v7 offset:3072
    v_mfma_f32_16x16x32_bf16 v[36:39], a[144:147], v[84:87], v[36:39]
    ds_read_b128 v[68:71], v7 offset:4096
    v_mfma_f32_16x16x32_bf16 v[40:43], a[148:151], v[84:87], v[40:43]
    ds_read_b128 v[72:75], v7 offset:5120
    v_mfma_f32_16x16x32_bf16 v[44:47], a[152:155], v[84:87], v[44:47]
    ds_read_b128 v[76:79], v7 offset:6144
    v_mfma_f32_16x16x32_bf16 v[48:51], a[156:159], v[84:87], v[48:51]
    ds_read_b128 v[80:83], v7 offset:7168
    v_mfma_f32_16x16x32_bf16 v[20:23], a[160:163], v[88:91], v[20:23]
    v_mfma_f32_16x16x32_bf16 v[24:27], a[164:167], v[88:91], v[24:27]
    v_mfma_f32_16x16x32_bf16 v[28:31], a[168:171], v[88:91], v[28:31]
    v_mfma_f32_16x16x32_bf16 v[32:35], a[172:175], v[88:91], v[32:35]
    v_mfma_f32_16x16x32_bf16 v[36:39], a[176:179], v[88:91], v[36:39]
    v_mfma_f32_16x16x32_bf16 v[40:43], a[180:183], v[88:91], v[40:43]
    v_mfma_f32_16x16x32_bf16 v[44:47], a[184:187], v[88:91], v[44:47]
    v_mfma_f32_16x16x32_bf16 v[48:51], a[188:191], v[88:91], v[48:51]
    s_waitcnt lgkmcnt(7)
    v_mfma_f32_16x16x32_bf16 v[20:23], v[52:55], v[100:103], v[20:23]
    ds_read_b128 v[52:55], v7 offset:8192
    s_waitcnt lgkmcnt(7)
    v_mfma_f32_16x16x32_bf16 v[24:27], v[56:59], v[100:103], v[24:27]
    ds_read_b128 v[56:59], v7 offset:9216
    s_waitcnt lgkmcnt(7)
    v_mfma_f32_16x16x32_bf16 v[28:31], v[60:63], v[100:103], v[28:31]
    ds_read_b128 v[60:63], v7 offset:10240
    s_waitcnt lgkmcnt(7)
    v_mfma_f32_16x16x32_bf16 v[32:35], v[64:67], v[100:103], v[32:35]
    ds_read_b128 v[64:67], v7 offset:11264
    s_waitcnt lgkmcnt(7)
    v_mfma_f32_16x16x32_bf16 v[36:39], v[68:71], v[100:103], v[36:39]
    ds_read_b128 v[68:71], v7 offset:12288
    s_waitcnt lgkmcnt(7)
    v_mfma_f32_16x16x32_bf16 v[40:43], v[72:75], v[100:103], v[40:43]
    ds_read_b128 v[72:75], v7 offset:13312
    s_waitcnt lgkmcnt(7)
    v_mfma_f32_16x16x32_bf16 v[44:47], v[76:79], v[100:103], v[44:47]
    ds_read_b128 v[76:79], v7 offset:14336
    s_waitcnt lgkmcnt(7)
    v_mfma_f32_16x16x32_bf16 v[48:51], v[80:83], v[100:103], v[48:51]
    ds_read_b128 v[80:83], v7 offset:15360
    v_mfma_f32_16x16x32_bf16 v[20:23], a[192:195], v[92:95], v[20:23]
    v_mfma_f32_16x16x32_bf16 v[24:27], a[196:199], v[92:95], v[24:27]
    v_mfma_f32_16x16x32_bf16 v[28:31], a[200:203], v[92:95], v[28:31]
    v_mfma_f32_16x16x32_bf16 v[32:35], a[204:207], v[92:95], v[32:35]
    v_mfma_f32_16x16x32_bf16 v[36:39], a[208:211], v[92:95], v[36:39]
    v_mfma_f32_16x16x32_bf16 v[40:43], a[212:215], v[92:95], v[40:43]
    v_mfma_f32_16x16x32_bf16 v[44:47], a[216:219], v[92:95], v[44:47]
    v_mfma_f32_16x16x32_bf16 v[48:51], a[220:223], v[92:95], v[48:51]
    s_waitcnt lgkmcnt(7)
    v_mfma_f32_16x16x32_bf16 v[20:23], v[52:55], v[104:107], v[20:23]
    ds_read_b128 v[52:55], v7 offset:16384
    s_waitcnt lgkmcnt(7)
    v_mfma_f32_16x16x32_bf16 v[24:27], v[56:59], v[104:107], v[24:27]
    ds_read_b128 v[56:59], v7 offset:17408
    s_waitcnt lgkmcnt(7)
    v_mfma_f32_16x16x32_bf16 v[28:31], v[60:63], v[104:107], v[28:31]
    ds_read_b128 v[60:63], v7 offset:18432
    s_waitcnt lgkmcnt(7)
    v_mfma_f32_16x16x32_bf16 v[32:35], v[64:67], v[104:107], v[32:35]
    ds_read_b128 v[64:67], v7 offset:19456
    s_waitcnt lgkmcnt(7)
    v_mfma_f32_16x16x32_bf16 v[36:39], v[68:71], v[104:107], v[36:39]
    ds_read_b128 v[68:71], v7 offset:20480
    s_waitcnt lgkmcnt(7)
    v_mfma_f32_16x16x32_bf16 v[40:43], v[72:75], v[104:107], v[40:43]
    ds_read_b128 v[72:75], v7 offset:21504
    s_waitcnt lgkmcnt(7)
    v_mfma_f32_16x16x32_bf16 v[44:47], v[76:79], v[104:107], v[44:47]
    ds_read_b128 v[76:79], v7 offset:22528
    s_waitcnt lgkmcnt(7)
    v_mfma_f32_16x16x32_bf16 v[48:51], v[80:83], v[104:107], v[48:51]
    ds_read_b128 v[80:83], v7 offset:23552
    v_mfma_f32_16x16x32_bf16 v[20:23], a[224:227], v[96:99], v[20:23]
    v_mfma_f32_16x16x32_bf16 v[24:27], a[228:231], v[96:99], v[24:27]
    v_mfma_f32_16x16x32_bf16 v[28:31], a[232:235], v[96:99], v[28:31]
    v_mfma_f32_16x16x32_bf16 v[32:35], a[236:239], v[96:99], v[32:35]
    v_mfma_f32_16x16x32_bf16 v[36:39], a[240:243], v[96:99], v[36:39]
    v_mfma_f32_16x16x32_bf16 v[40:43], a[244:247], v[96:99], v[40:43]
    v_mfma_f32_16x16x32_bf16 v[44:47], a[248:251], v[96:99], v[44:47]
    v_mfma_f32_16x16x32_bf16 v[48:51], a[252:255], v[96:99], v[48:51]
    s_waitcnt lgkmcnt(7)
    v_mfma_f32_16x16x32_bf16 v[20:23], v[52:55], v[108:111], v[20:23]
    ds_read_b128 v[52:55], v7 offset:24576
    s_waitcnt lgkmcnt(7)
    v_mfma_f32_16x16x32_bf16 v[24:27], v[56:59], v[108:111], v[24:27]
    ds_read_b128 v[56:59], v7 offset:25600
    s_waitcnt lgkmcnt(7)
    v_mfma_f32_16x16x32_bf16 v[28:31], v[60:63], v[108:111], v[28:31]
    ds_read_b128 v[60:63], v7 offset:26624
    s_waitcnt lgkmcnt(7)
    v_mfma_f32_16x16x32_bf16 v[32:35], v[64:67], v[108:111], v[32:35]
    ds_read_b128 v[64:67], v7 offset:27648
    s_waitcnt lgkmcnt(7)
    v_mfma_f32_16x16x32_bf16 v[36:39], v[68:71], v[108:111], v[36:39]
    ds_read_b128 v[68:71], v7 offset:28672
    s_waitcnt lgkmcnt(7)
    v_mfma_f32_16x16x32_bf16 v[40:43], v[72:75], v[108:111], v[40:43]
    ds_read_b128 v[72:75], v7 offset:29696
    s_waitcnt lgkmcnt(7)
    v_mfma_f32_16x16x32_bf16 v[44:47], v[76:79], v[108:111], v[44:47]
    ds_read_b128 v[76:79], v7 offset:30720
    s_waitcnt lgkmcnt(7)
    v_mfma_f32_16x16x32_bf16 v[48:51], v[80:83], v[108:111], v[48:51]
    ds_read_b128 v[80:83], v7 offset:31744
    s_waitcnt lgkmcnt(7)
    v_mfma_f32_16x16x32_bf16 v[20:23], v[52:55], v[112:115], v[20:23]
    s_waitcnt lgkmcnt(6)
    v_mfma_f32_16x16x32_bf16 v[24:27], v[56:59], v[112:115], v[24:27]
    s_waitcnt lgkmcnt(5)
    v_mfma_f32_16x16x32_bf16 v[28:31], v[60:63], v[112:115], v[28:31]
    s_waitcnt lgkmcnt(4)
    v_mfma_f32_16x16x32_bf16 v[32:35], v[64:67], v[112:115], v[32:35]
    s_waitcnt lgkmcnt(3)
    v_mfma_f32_16x16x32_bf16 v[36:39], v[68:71], v[112:115], v[36:39]
    s_waitcnt lgkmcnt(2)
    v_mfma_f32_16x16x32_bf16 v[40:43], v[72:75], v[112:115], v[40:43]
    s_waitcnt lgkmcnt(1)
    v_mfma_f32_16x16x32_bf16 v[44:47], v[76:79], v[112:115], v[44:47]
    s_waitcnt lgkmcnt(0)
    v_mfma_f32_16x16x32_bf16 v[48:51], v[80:83], v[112:115], v[48:51]
    s_mov_b32 s28, 0xbdd2d3e8
    s_mov_b32 s29, 0xc0135761
    s_mul_i32 s24, s5, 57344
    s_lshl_b32 s25, s12, 12
    s_add_u32 s24, s24, s25
    s_add_u32 s24, s24, 104857600
    v_cvt_pk_bf16_f32 v8, v20, v21
    v_lshlrev_b32 v20, 16, v8
    v_and_b32 v21, 0xffff0000, v8
    v_cvt_pk_bf16_f32 v8, v22, v23
    v_lshlrev_b32 v22, 16, v8
    v_and_b32 v23, 0xffff0000, v8
    v_cvt_pk_bf16_f32 v8, v24, v25
    v_lshlrev_b32 v24, 16, v8
    v_and_b32 v25, 0xffff0000, v8
    v_cvt_pk_bf16_f32 v8, v26, v27
    v_lshlrev_b32 v26, 16, v8
    v_and_b32 v27, 0xffff0000, v8
    v_cvt_pk_bf16_f32 v8, v28, v29
    v_lshlrev_b32 v28, 16, v8
    v_and_b32 v29, 0xffff0000, v8
    v_cvt_pk_bf16_f32 v8, v30, v31
    v_lshlrev_b32 v30, 16, v8
    v_and_b32 v31, 0xffff0000, v8
    v_cvt_pk_bf16_f32 v8, v32, v33
    v_lshlrev_b32 v32, 16, v8
    v_and_b32 v33, 0xffff0000, v8
    v_cvt_pk_bf16_f32 v8, v34, v35
    v_lshlrev_b32 v34, 16, v8
    v_and_b32 v35, 0xffff0000, v8
    v_cvt_pk_bf16_f32 v8, v36, v37
    v_lshlrev_b32 v36, 16, v8
    v_and_b32 v37, 0xffff0000, v8
    v_cvt_pk_bf16_f32 v8, v38, v39
    v_lshlrev_b32 v38, 16, v8
    v_and_b32 v39, 0xffff0000, v8
    v_cvt_pk_bf16_f32 v8, v40, v41
    v_lshlrev_b32 v40, 16, v8
    v_and_b32 v41, 0xffff0000, v8
    v_cvt_pk_bf16_f32 v8, v42, v43
    v_lshlrev_b32 v42, 16, v8
    v_and_b32 v43, 0xffff0000, v8
    v_cvt_pk_bf16_f32 v8, v44, v45
    v_lshlrev_b32 v44, 16, v8
    v_and_b32 v45, 0xffff0000, v8
    v_cvt_pk_bf16_f32 v8, v46, v47
    v_lshlrev_b32 v46, 16, v8
    v_and_b32 v47, 0xffff0000, v8
    v_cvt_pk_bf16_f32 v8, v48, v49
    v_lshlrev_b32 v48, 16, v8
    v_and_b32 v49, 0xffff0000, v8
    v_cvt_pk_bf16_f32 v8, v50, v51
    v_lshlrev_b32 v50, 16, v8
    v_and_b32 v51, 0xffff0000, v8
    v_pk_mul_f32 v[8:9], v[20:21], v[20:21]
    v_pk_fma_f32 v[8:9], v[8:9], s[28:29], s[28:29] op_sel:[0,0,1] op_sel_hi:[1,0,1]
    s_nop 0
    v_pk_mul_f32 v[8:9], v[8:9], v[20:21]
    v_exp_f32 v8, v8
    v_exp_f32 v9, v9
    s_nop 0
    v_pk_add_f32 v[8:9], v[8:9], 1.0 op_sel_hi:[1,0]
    s_nop 0
    v_rcp_f32 v8, v8
    v_rcp_f32 v9, v9
    s_nop 0
    v_pk_mul_f32 v[20:21], v[20:21], v[8:9]
    v_pk_mul_f32 v[10:11], v[22:23], v[22:23]
    v_pk_fma_f32 v[10:11], v[10:11], s[28:29], s[28:29] op_sel:[0,0,1] op_sel_hi:[1,0,1]
    s_nop 0
    v_pk_mul_f32 v[10:11], v[10:11], v[22:23]
    v_exp_f32 v10, v10
    v_exp_f32 v11, v11
    s_nop 0
    v_pk_add_f32 v[10:11], v[10:11], 1.0 op_sel_hi:[1,0]
    s_nop 0
    v_rcp_f32 v10, v10
    v_rcp_f32 v11, v11
    s_nop 0
    v_pk_mul_f32 v[22:23], v[22:23], v[10:11]
    v_pk_mul_f32 v[8:9], v[24:25], v[24:25]
    v_pk_fma_f32 v[8:9], v[8:9], s[28:29], s[28:29] op_sel:[0,0,1] op_sel_hi:[1,0,1]
    s_nop 0
    v_pk_mul_f32 v[8:9], v[8:9], v[24:25]
    v_exp_f32 v8, v8
    v_exp_f32 v9, v9
    s_nop 0
    v_pk_add_f32 v[8:9], v[8:9], 1.0 op_sel_hi:[1,0]
    s_nop 0
    v_rcp_f32 v8, v8
    v_rcp_f32 v9, v9
    s_nop 0
    v_pk_mul_f32 v[24:25], v[24:25], v[8:9]
    v_pk_mul_f32 v[10:11], v[26:27], v[26:27]
    v_pk_fma_f32 v[10:11], v[10:11], s[28:29], s[28:29] op_sel:[0,0,1] op_sel_hi:[1,0,1]
    s_nop 0
    v_pk_mul_f32 v[10:11], v[10:11], v[26:27]
    v_exp_f32 v10, v10
    v_exp_f32 v11, v11
    s_nop 0
    v_pk_add_f32 v[10:11], v[10:11], 1.0 op_sel_hi:[1,0]
    s_nop 0
    v_rcp_f32 v10, v10
    v_rcp_f32 v11, v11
    s_nop 0
    v_pk_mul_f32 v[26:27], v[26:27], v[10:11]
    v_pk_mul_f32 v[8:9], v[28:29], v[28:29]
    v_pk_fma_f32 v[8:9], v[8:9], s[28:29], s[28:29] op_sel:[0,0,1] op_sel_hi:[1,0,1]
    s_nop 0
    v_pk_mul_f32 v[8:9], v[8:9], v[28:29]
    v_exp_f32 v8, v8
    v_exp_f32 v9, v9
    s_nop 0
    v_pk_add_f32 v[8:9], v[8:9], 1.0 op_sel_hi:[1,0]
    s_nop 0
    v_rcp_f32 v8, v8
    v_rcp_f32 v9, v9
    s_nop 0
    v_pk_mul_f32 v[28:29], v[28:29], v[8:9]
    v_pk_mul_f32 v[10:11], v[30:31], v[30:31]
    v_pk_fma_f32 v[10:11], v[10:11], s[28:29], s[28:29] op_sel:[0,0,1] op_sel_hi:[1,0,1]
    s_nop 0
    v_pk_mul_f32 v[10:11], v[10:11], v[30:31]
    v_exp_f32 v10, v10
    v_exp_f32 v11, v11
    s_nop 0
    v_pk_add_f32 v[10:11], v[10:11], 1.0 op_sel_hi:[1,0]
    s_nop 0
    v_rcp_f32 v10, v10
    v_rcp_f32 v11, v11
    s_nop 0
    v_pk_mul_f32 v[30:31], v[30:31], v[10:11]
    v_pk_mul_f32 v[8:9], v[32:33], v[32:33]
    v_pk_fma_f32 v[8:9], v[8:9], s[28:29], s[28:29] op_sel:[0,0,1] op_sel_hi:[1,0,1]
    s_nop 0
    v_pk_mul_f32 v[8:9], v[8:9], v[32:33]
    v_exp_f32 v8, v8
    v_exp_f32 v9, v9
    s_nop 0
    v_pk_add_f32 v[8:9], v[8:9], 1.0 op_sel_hi:[1,0]
    s_nop 0
    v_rcp_f32 v8, v8
    v_rcp_f32 v9, v9
    s_nop 0
    v_pk_mul_f32 v[32:33], v[32:33], v[8:9]
    v_pk_mul_f32 v[10:11], v[34:35], v[34:35]
    v_pk_fma_f32 v[10:11], v[10:11], s[28:29], s[28:29] op_sel:[0,0,1] op_sel_hi:[1,0,1]
    s_nop 0
    v_pk_mul_f32 v[10:11], v[10:11], v[34:35]
    v_exp_f32 v10, v10
    v_exp_f32 v11, v11
    s_nop 0
    v_pk_add_f32 v[10:11], v[10:11], 1.0 op_sel_hi:[1,0]
    s_nop 0
    v_rcp_f32 v10, v10
    v_rcp_f32 v11, v11
    s_nop 0
    v_pk_mul_f32 v[34:35], v[34:35], v[10:11]
    v_pk_mul_f32 v[8:9], v[36:37], v[36:37]
    v_pk_fma_f32 v[8:9], v[8:9], s[28:29], s[28:29] op_sel:[0,0,1] op_sel_hi:[1,0,1]
    s_nop 0
    v_pk_mul_f32 v[8:9], v[8:9], v[36:37]
    v_exp_f32 v8, v8
    v_exp_f32 v9, v9
    s_nop 0
    v_pk_add_f32 v[8:9], v[8:9], 1.0 op_sel_hi:[1,0]
    s_nop 0
    v_rcp_f32 v8, v8
    v_rcp_f32 v9, v9
    s_nop 0
    v_pk_mul_f32 v[36:37], v[36:37], v[8:9]
    v_pk_mul_f32 v[10:11], v[38:39], v[38:39]
    v_pk_fma_f32 v[10:11], v[10:11], s[28:29], s[28:29] op_sel:[0,0,1] op_sel_hi:[1,0,1]
    s_nop 0
    v_pk_mul_f32 v[10:11], v[10:11], v[38:39]
    v_exp_f32 v10, v10
    v_exp_f32 v11, v11
    s_nop 0
    v_pk_add_f32 v[10:11], v[10:11], 1.0 op_sel_hi:[1,0]
    s_nop 0
    v_rcp_f32 v10, v10
    v_rcp_f32 v11, v11
    s_nop 0
    v_pk_mul_f32 v[38:39], v[38:39], v[10:11]
    v_pk_mul_f32 v[8:9], v[40:41], v[40:41]
    v_pk_fma_f32 v[8:9], v[8:9], s[28:29], s[28:29] op_sel:[0,0,1] op_sel_hi:[1,0,1]
    s_nop 0
    v_pk_mul_f32 v[8:9], v[8:9], v[40:41]
    v_exp_f32 v8, v8
    v_exp_f32 v9, v9
    s_nop 0
    v_pk_add_f32 v[8:9], v[8:9], 1.0 op_sel_hi:[1,0]
    s_nop 0
    v_rcp_f32 v8, v8
    v_rcp_f32 v9, v9
    s_nop 0
    v_pk_mul_f32 v[40:41], v[40:41], v[8:9]
    v_pk_mul_f32 v[10:11], v[42:43], v[42:43]
    v_pk_fma_f32 v[10:11], v[10:11], s[28:29], s[28:29] op_sel:[0,0,1] op_sel_hi:[1,0,1]
    s_nop 0
    v_pk_mul_f32 v[10:11], v[10:11], v[42:43]
    v_exp_f32 v10, v10
    v_exp_f32 v11, v11
    s_nop 0
    v_pk_add_f32 v[10:11], v[10:11], 1.0 op_sel_hi:[1,0]
    s_nop 0
    v_rcp_f32 v10, v10
    v_rcp_f32 v11, v11
    s_nop 0
    v_pk_mul_f32 v[42:43], v[42:43], v[10:11]
    v_pk_mul_f32 v[8:9], v[44:45], v[44:45]
    v_pk_fma_f32 v[8:9], v[8:9], s[28:29], s[28:29] op_sel:[0,0,1] op_sel_hi:[1,0,1]
    s_nop 0
    v_pk_mul_f32 v[8:9], v[8:9], v[44:45]
    v_exp_f32 v8, v8
    v_exp_f32 v9, v9
    s_nop 0
    v_pk_add_f32 v[8:9], v[8:9], 1.0 op_sel_hi:[1,0]
    s_nop 0
    v_rcp_f32 v8, v8
    v_rcp_f32 v9, v9
    s_nop 0
    v_pk_mul_f32 v[44:45], v[44:45], v[8:9]
    v_pk_mul_f32 v[10:11], v[46:47], v[46:47]
    v_pk_fma_f32 v[10:11], v[10:11], s[28:29], s[28:29] op_sel:[0,0,1] op_sel_hi:[1,0,1]
    s_nop 0
    v_pk_mul_f32 v[10:11], v[10:11], v[46:47]
    v_exp_f32 v10, v10
    v_exp_f32 v11, v11
    s_nop 0
    v_pk_add_f32 v[10:11], v[10:11], 1.0 op_sel_hi:[1,0]
    s_nop 0
    v_rcp_f32 v10, v10
    v_rcp_f32 v11, v11
    s_nop 0
    v_pk_mul_f32 v[46:47], v[46:47], v[10:11]
    v_pk_mul_f32 v[8:9], v[48:49], v[48:49]
    v_pk_fma_f32 v[8:9], v[8:9], s[28:29], s[28:29] op_sel:[0,0,1] op_sel_hi:[1,0,1]
    s_nop 0
    v_pk_mul_f32 v[8:9], v[8:9], v[48:49]
    v_exp_f32 v8, v8
    v_exp_f32 v9, v9
    s_nop 0
    v_pk_add_f32 v[8:9], v[8:9], 1.0 op_sel_hi:[1,0]
    s_nop 0
    v_rcp_f32 v8, v8
    v_rcp_f32 v9, v9
    s_nop 0
    v_pk_mul_f32 v[48:49], v[48:49], v[8:9]
    v_pk_mul_f32 v[10:11], v[50:51], v[50:51]
    v_pk_fma_f32 v[10:11], v[10:11], s[28:29], s[28:29] op_sel:[0,0,1] op_sel_hi:[1,0,1]
    s_nop 0
    v_pk_mul_f32 v[10:11], v[10:11], v[50:51]
    v_exp_f32 v10, v10
    v_exp_f32 v11, v11
    s_nop 0
    v_pk_add_f32 v[10:11], v[10:11], 1.0 op_sel_hi:[1,0]
    s_nop 0
    v_rcp_f32 v10, v10
    v_rcp_f32 v11, v11
    s_nop 0
    v_pk_mul_f32 v[50:51], v[50:51], v[10:11]
    v_cvt_pk_bf16_f32 v52, v20, v24
    v_cvt_pk_bf16_f32 v53, v28, v32
    v_cvt_pk_bf16_f32 v54, v36, v40
    v_cvt_pk_bf16_f32 v55, v44, v48
    buffer_store_dwordx4 v[52:55], v6, s[8:11], s24 offen offset:0 sc1
    v_cvt_pk_bf16_f32 v56, v21, v25
    v_cvt_pk_bf16_f32 v57, v29, v33
    v_cvt_pk_bf16_f32 v58, v37, v41
    v_cvt_pk_bf16_f32 v59, v45, v49
    buffer_store_dwordx4 v[56:59], v6, s[8:11], s24 offen offset:256 sc1
    v_cvt_pk_bf16_f32 v60, v22, v26
    v_cvt_pk_bf16_f32 v61, v30, v34
    v_cvt_pk_bf16_f32 v62, v38, v42
    v_cvt_pk_bf16_f32 v63, v46, v50
    buffer_store_dwordx4 v[60:63], v6, s[8:11], s24 offen offset:512 sc1
    v_cvt_pk_bf16_f32 v64, v23, v27
    v_cvt_pk_bf16_f32 v65, v31, v35
    v_cvt_pk_bf16_f32 v66, v39, v43
    v_cvt_pk_bf16_f32 v67, v47, v51
    buffer_store_dwordx4 v[64:67], v6, s[8:11], s24 offen offset:768 sc1
    s_nop 1
Lf1s_178:
    s_lshl_b32 s24, s5, 2
    s_add_u32 s24, s24, s6
    s_lshl_b32 s24, s24, 7
    s_add_u32 s24, s24, 160104448
    s_waitcnt vmcnt(0) lgkmcnt(0)
    s_barrier
    s_cmp_lg_u32 s19, 0
    s_cbranch_scc1 Lsig_186
    v_mov_b64 v[8:9], s[62:63]
    v_mov_b64 v[10:11], s[62:63]
    s_mov_b64 exec, 0xff
    buffer_store_dwordx4 v[8:11], v4, s[8:11], s24 offen sc1
    s_mov_b64 exec, -1
    s_nop 0
Lsig_186:
    s_add_u32 s5, s5, 6
    s_cmp_lt_u32 s5, 128
    s_cbranch_scc1 Lst_180
    s_branch Lnext_92
Lh_104:
    s_cmp_lg_u32 s64, 0
    s_cbranch_scc1 Lpk_187
    s_mov_b32 s24, 159776768
    v_min_u32 v8, 63, v1
    v_mul_u32_u24 v8, 128, v8
    s_nop 1
Lw_188:
    buffer_load_dwordx2 v[10:11], v8, s[8:11], s24 offen sc1
    s_waitcnt vmcnt(0)
    v_cmp_ne_u64 vcc, s[62:63], v[10:11]
    s_nop 4
    s_cbranch_vccz Lwd_189
    s_sleep 2
    s_sub_u32 s21, s21, 1
    s_cbranch_scc0 Lw_188
    s_mov_b32 s21, 0
Lwd_189:
    s_mov_b32 s24, 159784960
    v_min_u32 v8, 3, v1
    v_mul_u32_u24 v8, 128, v8
    s_nop 1
Lw_190:
    buffer_load_dwordx2 v[10:11], v8, s[8:11], s24 offen sc1
    s_waitcnt vmcnt(0)
    v_cmp_ne_u64 vcc, s[62:63], v[10:11]
    s_nop 4
    s_cbranch_vccz Lwd_191
    s_sleep 2
    s_sub_u32 s21, s21, 1
    s_cbranch_scc0 Lw_190
    s_mov_b32 s21, 0
Lwd_191:
    s_mov_b32 s64, 1
Lpk_187:
    s_load_dwordx2 s[24:25], s[0:1], 96
    s_waitcnt lgkmcnt(0)
    s_mov_b32 s12, s24
    s_and_b32 s13, s25, 0xffff
    s_mov_b32 s14, 2097152
    s_mov_b32 s15, 0x00020000
    s_mul_i32 s26, s6, 458752
    s_mul_i32 s27, s19, 114688
    s_add_u32 s26, s26, s27
    s_add_u32 s26, s26, 120586240
    s_mov_b32 s33, s26
    buffer_load_dwordx4 v[128:131], v4, s[8:11], s26 offen offset:0 sc1
    buffer_load_dwordx4 v[132:135], v4, s[8:11], s26 offen offset:1024 sc1
    buffer_load_dwordx4 v[136:139], v4, s[8:11], s26 offen offset:2048 sc1
    buffer_load_dwordx4 v[140:143], v4, s[8:11], s26 offen offset:3072 sc1
    buffer_load_dwordx4 v[144:147], v5, s[8:11], s26 offen offset:0 sc1
    buffer_load_dwordx4 v[148:151], v5, s[8:11], s26 offen offset:1024 sc1
    buffer_load_dwordx4 v[152:155], v5, s[8:11], s26 offen offset:2048 sc1
    buffer_load_dwordx4 v[156:159], v5, s[8:11], s26 offen offset:3072 sc1
    s_add_u32 s26, s26, 8192
    buffer_load_dwordx4 v[160:163], v4, s[8:11], s26 offen offset:0 sc1
    buffer_load_dwordx4 v[164:167], v4, s[8:11], s26 offen offset:1024 sc1
    buffer_load_dwordx4 v[168:171], v4, s[8:11], s26 offen offset:2048 sc1
    buffer_load_dwordx4 v[172:175], v4, s[8:11], s26 offen offset:3072 sc1
    buffer_load_dwordx4 v[176:179], v5, s[8:11], s26 offen offset:0 sc1
    buffer_load_dwordx4 v[180:183], v5, s[8:11], s26 offen offset:1024 sc1
    buffer_load_dwordx4 v[184:187], v5, s[8:11], s26 offen offset:2048 sc1
    buffer_load_dwordx4 v[188:191], v5, s[8:11], s26 offen offset:3072 sc1
    s_add_u32 s26, s26, 8192
    buffer_load_dwordx4 v[192:195], v4, s[8:11], s26 offen offset:0 sc1
    buffer_load_dwordx4 v[196:199], v4, s[8:11], s26 offen offset:1024 sc1
    buffer_load_dwordx4 v[200:203], v4, s[8:11], s26 offen offset:2048 sc1
    buffer_load_dwordx4 v[204:207], v4, s[8:11], s26 offen offset:3072 sc1
    buffer_load_dwordx4 v[208:211], v5, s[8:11], s26 offen offset:0 sc1
    buffer_load_dwordx4 v[212:215], v5, s[8:11], s26 offen offset:1024 sc1
    buffer_load_dwordx4 v[216:219], v5, s[8:11], s26 offen offset:2048 sc1
    buffer_load_dwordx4 v[220:223], v5, s[8:11], s26 offen offset:3072 sc1
    s_add_u32 s26, s26, 8192
    buffer_load_dwordx4 v[224:227], v4, s[8:11], s26 offen offset:0 sc1
    buffer_load_dwordx4 v[228:231], v4, s[8:11], s26 offen offset:1024 sc1
    buffer_load_dwordx4 v[232:235], v4, s[8:11], s26 offen offset:2048 sc1
    buffer_load_dwordx4 v[236:239], v4, s[8:11], s26 offen offset:3072 sc1
    buffer_load_dwordx4 v[240:243], v5, s[8:11], s26 offen offset:0 sc1
    buffer_load_dwordx4 v[244:247], v5, s[8:11], s26 offen offset:1024 sc1
    buffer_load_dwordx4 v[248:251], v5, s[8:11], s26 offen offset:2048 sc1
    buffer_load_dwordx4 v[252:255], v5, s[8:11], s26 offen offset:3072 sc1
    s_add_u32 s26, s26, 8192
    buffer_load_dwordx4 a[0:3], v4, s[8:11], s26 offen offset:0 sc1
    buffer_load_dwordx4 a[4:7], v4, s[8:11], s26 offen offset:1024 sc1
    buffer_load_dwordx4 a[8:11], v4, s[8:11], s26 offen offset:2048 sc1
    buffer_load_dwordx4 a[12:15], v4, s[8:11], s26 offen offset:3072 sc1
    buffer_load_dwordx4 a[16:19], v5, s[8:11], s26 offen offset:0 sc1
    buffer_load_dwordx4 a[20:23], v5, s[8:11], s26 offen offset:1024 sc1
    buffer_load_dwordx4 a[24:27], v5, s[8:11], s26 offen offset:2048 sc1
    buffer_load_dwordx4 a[28:31], v5, s[8:11], s26 offen offset:3072 sc1
    s_add_u32 s26, s26, 8192
    buffer_load_dwordx4 a[32:35], v4, s[8:11], s26 offen offset:0 sc1
    buffer_load_dwordx4 a[36:39], v4, s[8:11], s26 offen offset:1024 sc1
    buffer_load_dwordx4 a[40:43], v4, s[8:11], s26 offen offset:2048 sc1
    buffer_load_dwordx4 a[44:47], v4, s[8:11], s26 offen offset:3072 sc1
    buffer_load_dwordx4 a[48:51], v5, s[8:11], s26 offen offset:0 sc1
    buffer_load_dwordx4 a[52:55], v5, s[8:11], s26 offen offset:1024 sc1
    buffer_load_dwordx4 a[56:59], v5, s[8:11], s26 offen offset:2048 sc1
    buffer_load_dwordx4 a[60:63], v5, s[8:11], s26 offen offset:3072 sc1
    s_waitcnt vmcnt(12)
    s_add_u32 s26, s26, 8192
    buffer_load_dwordx4 a[64:67], v4, s[8:11], s26 offen offset:0 sc1
    buffer_load_dwordx4 a[68:71], v4, s[8:11], s26 offen offset:1024 sc1
    buffer_load_dwordx4 a[72:75], v4, s[8:11], s26 offen offset:2048 sc1
    buffer_load_dwordx4 a[76:79], v4, s[8:11], s26 offen offset:3072 sc1
    buffer_load_dwordx4 a[80:83], v5, s[8:11], s26 offen offset:0 sc1
    buffer_load_dwordx4 a[84:87], v5, s[8:11], s26 offen offset:1024 sc1
    buffer_load_dwordx4 a[88:91], v5, s[8:11], s26 offen offset:2048 sc1
    buffer_load_dwordx4 a[92:95], v5, s[8:11], s26 offen offset:3072 sc1
    s_add_u32 s26, s26, 8192
    buffer_load_dwordx4 a[96:99], v4, s[8:11], s26 offen offset:0 sc1
    buffer_load_dwordx4 a[100:103], v4, s[8:11], s26 offen offset:1024 sc1
    buffer_load_dwordx4 a[104:107], v4, s[8:11], s26 offen offset:2048 sc1
    buffer_load_dwordx4 a[108:111], v4, s[8:11], s26 offen offset:3072 sc1
    buffer_load_dwordx4 a[112:115], v5, s[8:11], s26 offen offset:0 sc1
    buffer_load_dwordx4 a[116:119], v5, s[8:11], s26 offen offset:1024 sc1
    buffer_load_dwordx4 a[120:123], v5, s[8:11], s26 offen offset:2048 sc1
    buffer_load_dwordx4 a[124:127], v5, s[8:11], s26 offen offset:3072 sc1
    s_add_u32 s26, s26, 8192
    buffer_load_dwordx4 a[128:131], v4, s[8:11], s26 offen offset:0 sc1
    buffer_load_dwordx4 a[132:135], v4, s[8:11], s26 offen offset:1024 sc1
    buffer_load_dwordx4 a[136:139], v4, s[8:11], s26 offen offset:2048 sc1
    buffer_load_dwordx4 a[140:143], v4, s[8:11], s26 offen offset:3072 sc1
    buffer_load_dwordx4 a[144:147], v5, s[8:11], s26 offen offset:0 sc1
    buffer_load_dwordx4 a[148:151], v5, s[8:11], s26 offen offset:1024 sc1
    buffer_load_dwordx4 a[152:155], v5, s[8:11], s26 offen offset:2048 sc1
    buffer_load_dwordx4 a[156:159], v5, s[8:11], s26 offen offset:3072 sc1
    s_add_u32 s26, s26, 8192
    buffer_load_dwordx4 a[160:163], v4, s[8:11], s26 offen offset:0 sc1
    buffer_load_dwordx4 a[164:167], v4, s[8:11], s26 offen offset:1024 sc1
    buffer_load_dwordx4 a[168:171], v4, s[8:11], s26 offen offset:2048 sc1
    buffer_load_dwordx4 a[172:175], v4, s[8:11], s26 offen offset:3072 sc1
    buffer_load_dwordx4 a[176:179], v5, s[8:11], s26 offen offset:0 sc1
    buffer_load_dwordx4 a[180:183], v5, s[8:11], s26 offen offset:1024 sc1
    buffer_load_dwordx4 a[184:187], v5, s[8:11], s26 offen offset:2048 sc1
    buffer_load_dwordx4 a[188:191], v5, s[8:11], s26 offen offset:3072 sc1
    s_add_u32 s26, s26, 8192
    buffer_load_dwordx4 a[192:195], v4, s[8:11], s26 offen offset:0 sc1
    buffer_load_dwordx4 a[196:199], v4, s[8:11], s26 offen offset:1024 sc1
    buffer_load_dwordx4 a[200:203], v4, s[8:11], s26 offen offset:2048 sc1
    buffer_load_dwordx4 a[204:207], v4, s[8:11], s26 offen offset:3072 sc1
    buffer_load_dwordx4 a[208:211], v5, s[8:11], s26 offen offset:0 sc1
    buffer_load_dwordx4 a[212:215], v5, s[8:11], s26 offen offset:1024 sc1
    buffer_load_dwordx4 a[216:219], v5, s[8:11], s26 offen offset:2048 sc1
    buffer_load_dwordx4 a[220:223], v5, s[8:11], s26 offen offset:3072 sc1
    s_add_u32 s26, s26, 8192
    buffer_load_dwordx4 a[224:227], v4, s[8:11], s26 offen offset:0 sc1
    buffer_load_dwordx4 a[228:231], v4, s[8:11], s26 offen offset:1024 sc1
    buffer_load_dwordx4 a[232:235], v4, s[8:11], s26 offen offset:2048 sc1
    buffer_load_dwordx4 a[236:239], v4, s[8:11], s26 offen offset:3072 sc1
    buffer_load_dwordx4 a[240:243], v5, s[8:11], s26 offen offset:0 sc1
    buffer_load_dwordx4 a[244:247], v5, s[8:11], s26 offen offset:1024 sc1
    buffer_load_dwordx4 a[248:251], v5, s[8:11], s26 offen offset:2048 sc1
    buffer_load_dwordx4 a[252:255], v5, s[8:11], s26 offen offset:3072 sc1
    s_waitcnt vmcnt(12)
    s_add_u32 s26, s26, 8192
    s_mul_i32 s31, s19, 16384
    s_add_u32 s31, s31, 32768
    s_add_u32 m0, s31, 0
    s_nop 0
    buffer_load_dwordx4 v4, s[8:11], s26 offen offset:0 sc1 lds
    buffer_load_dwordx4 v4, s[8:11], s26 offen offset:1024 sc1 lds
    buffer_load_dwordx4 v4, s[8:11], s26 offen offset:2048 sc1 lds
    buffer_load_dwordx4 v4, s[8:11], s26 offen offset:3072 sc1 lds
    s_add_u32 s26, s26, 4096
    s_add_u32 m0, s31, 4096
    s_nop 0
    buffer_load_dwordx4 v4, s[8:11], s26 offen offset:0 sc1 lds
    buffer_load_dwordx4 v4, s[8:11], s26 offen offset:1024 sc1 lds
    buffer_load_dwordx4 v4, s[8:11], s26 offen offset:2048 sc1 lds
    buffer_load_dwordx4 v4, s[8:11], s26 offen offset:3072 sc1 lds
    s_add_u32 s26, s26, 4096
    s_add_u32 m0, s31, 8192
    s_nop 0
    buffer_load_dwordx4 v4, s[8:11], s26 offen offset:0 sc1 lds
    buffer_load_dwordx4 v4, s[8:11], s26 offen offset:1024 sc1 lds
    buffer_load_dwordx4 v4, s[8:11], s26 offen offset:2048 sc1 lds
    buffer_load_dwordx4 v4, s[8:11], s26 offen offset:3072 sc1 lds
    s_add_u32 s26, s26, 4096
    s_add_u32 m0, s31, 12288
    s_nop 0
    buffer_load_dwordx4 v4, s[8:11], s26 offen offset:0 sc1 lds
    buffer_load_dwordx4 v4, s[8:11], s26 offen offset:1024 sc1 lds
    buffer_load_dwordx4 v4, s[8:11], s26 offen offset:2048 sc1 lds
    buffer_load_dwordx4 v4, s[8:11], s26 offen offset:3072 sc1 lds
    s_add_u32 s26, s26, 4096
Lst_192:
    s_lshl_b32 s24, s5, 0
    s_lshl_b32 s24, s24, 7
    s_add_u32 s24, s24, 160071680
    v_mov_b32 v10, 0
    s_cmp_lg_u32 s19, 0
    s_nop 0
    s_cbranch_scc1 Lco_193
Lw_194:
    buffer_load_dwordx2 v[12:13], v10, s[8:11], s24 offen sc1
    s_waitcnt vmcnt(0)
    v_cmp_ne_u64 vcc, s[62:63], v[12:13]
    s_nop 4
    s_cbranch_vccz Lwd_195
    s_sleep 16
    s_sub_u32 s21, s21, 1
    s_cbranch_scc0 Lw_194
    s_mov_b32 s21, 0
Lwd_195:
Lco_193:
    s_barrier
    s_lshl_b32 s24, s5, 9
    s_add_u32 s24, s24, 160104448
    v_min_u32 v8, 3, v1
    v_mul_u32_u24 v8, 128, v8
    s_nop 1
Lw_196:
    buffer_load_dwordx2 v[10:11], v8, s[8:11], s24 offen sc1
    s_waitcnt vmcnt(0)
    v_cmp_ne_u64 vcc, s[62:63], v[10:11]
    s_nop 4
    s_cbranch_vccz Lwd_197
    s_sleep 2
    s_sub_u32 s21, s21, 1
    s_cbranch_scc0 Lw_196
    s_mov_b32 s21, 0
Lwd_197:
    s_mul_i32 s24, s5, 57344
    s_mul_i32 s25, s19, 14336
    s_add_u32 s24, s24, s25
    s_add_u32 s24, s24, 104857600
    buffer_load_dwordx4 v[52:55], v4, s[8:11], s24 offen offset:0 sc1
    buffer_load_dwordx4 v[56:59], v4, s[8:11], s24 offen offset:1024 sc1
    buffer_load_dwordx4 v[60:63], v4, s[8:11], s24 offen offset:2048 sc1
    buffer_load_dwordx4 v[64:67], v4, s[8:11], s24 offen offset:3072 sc1
    s_add_u32 s24, s24, 4096
    buffer_load_dwordx4 v[68:71], v4, s[8:11], s24 offen offset:0 sc1
    buffer_load_dwordx4 v[72:75], v4, s[8:11], s24 offen offset:1024 sc1
    buffer_load_dwordx4 v[76:79], v4, s[8:11], s24 offen offset:2048 sc1
    buffer_load_dwordx4 v[80:83], v4, s[8:11], s24 offen offset:3072 sc1
    s_add_u32 s24, s24, 4096
    buffer_load_dwordx4 v[84:87], v4, s[8:11], s24 offen offset:0 sc1
    buffer_load_dwordx4 v[88:91], v4, s[8:11], s24 offen offset:1024 sc1
    buffer_load_dwordx4 v[92:95], v4, s[8:11], s24 offen offset:2048 sc1
    buffer_load_dwordx4 v[96:99], v4, s[8:11], s24 offen offset:3072 sc1
    s_add_u32 s24, s24, 4096
    buffer_load_dwordx4 v[100:103], v4, s[8:11], s24 offen offset:0 sc1
    buffer_load_dwordx4 v[104:107], v4, s[8:11], s24 offen offset:1024 sc1
    s_lshl_b32 s27, s5, 14
    s_lshl_b32 s25, s6, 12
    s_add_u32 s25, s25, s27
    s_lshl_b32 s28, s19, 2
    s_add_u32 s25, s25, s28
    s_add_u32 s24, s25, 100663296
    s_add_u32 s25, s25, 92274688
    buffer_load_dword v116, v6, s[8:11], s24 offen offset:0 sc1
    buffer_load_dword v120, v6, s[8:11], s25 offen offset:0 sc1
    buffer_load_dword v117, v6, s[8:11], s24 offen offset:256 sc1
    buffer_load_dword v121, v6, s[8:11], s25 offen offset:256 sc1
    buffer_load_dword v118, v6, s[8:11], s24 offen offset:512 sc1
    buffer_load_dword v122, v6, s[8:11], s25 offen offset:512 sc1
    buffer_load_dword v119, v6, s[8:11], s24 offen offset:768 sc1
    buffer_load_dword v123, v6, s[8:11], s25 offen offset:768 sc1
    s_waitcnt vmcnt(8)
    v_add_u32 v7, s31, v4
    v_mfma_f32_16x16x32_bf16 v[20:23], v[128:131], v[52:55], 0
    v_mfma_f32_16x16x32_bf16 v[24:27], v[132:135], v[52:55], 0
    v_mfma_f32_16x16x32_bf16 v[28:31], v[136:139], v[52:55], 0
    v_mfma_f32_16x16x32_bf16 v[32:35], v[140:143], v[52:55], 0
    v_mfma_f32_16x16x32_bf16 v[36:39], v[144:147], v[52:55], 0
    v_mfma_f32_16x16x32_bf16 v[40:43], v[148:151], v[52:55], 0
    v_mfma_f32_16x16x32_bf16 v[44:47], v[152:155], v[52:55], 0
    v_mfma_f32_16x16x32_bf16 v[48:51], v[156:159], v[52:55], 0
    v_mfma_f32_16x16x32_bf16 v[20:23], v[160:163], v[56:59], v[20:23]
    v_mfma_f32_16x16x32_bf16 v[24:27], v[164:167], v[56:59], v[24:27]
    v_mfma_f32_16x16x32_bf16 v[28:31], v[168:171], v[56:59], v[28:31]
    v_mfma_f32_16x16x32_bf16 v[32:35], v[172:175], v[56:59], v[32:35]
    v_mfma_f32_16x16x32_bf16 v[36:39], v[176:179], v[56:59], v[36:39]
    v_mfma_f32_16x16x32_bf16 v[40:43], v[180:183], v[56:59], v[40:43]
    v_mfma_f32_16x16x32_bf16 v[44:47], v[184:187], v[56:59], v[44:47]
    v_mfma_f32_16x16x32_bf16 v[48:51], v[188:191], v[56:59], v[48:51]
    v_mfma_f32_16x16x32_bf16 v[20:23], v[192:195], v[60:63], v[20:23]
    v_mfma_f32_16x16x32_bf16 v[24:27], v[196:199], v[60:63], v[24:27]
    v_mfma_f32_16x16x32_bf16 v[28:31], v[200:203], v[60:63], v[28:31]
    v_mfma_f32_16x16x32_bf16 v[32:35], v[204:207], v[60:63], v[32:35]
    v_mfma_f32_16x16x32_bf16 v[36:39], v[208:211], v[60:63], v[36:39]
    v_mfma_f32_16x16x32_bf16 v[40:43], v[212:215], v[60:63], v[40:43]
    v_mfma_f32_16x16x32_bf16 v[44:47], v[216:219], v[60:63], v[44:47]
    v_mfma_f32_16x16x32_bf16 v[48:51], v[220:223], v[60:63], v[48:51]
    v_mfma_f32_16x16x32_bf16 v[20:23], v[224:227], v[64:67], v[20:23]
    v_mfma_f32_16x16x32_bf16 v[24:27], v[228:231], v[64:67], v[24:27]
    v_mfma_f32_16x16x32_bf16 v[28:31], v[232:235], v[64:67], v[28:31]
    v_mfma_f32_16x16x32_bf16 v[32:35], v[236:239], v[64:67], v[32:35]
    v_mfma_f32_16x16x32_bf16 v[36:39], v[240:243], v[64:67], v[36:39]
    v_mfma_f32_16x16x32_bf16 v[40:43], v[244:247], v[64:67], v[40:43]
    v_mfma_f32_16x16x32_bf16 v[44:47], v[248:251], v[64:67], v[44:47]
    v_mfma_f32_16x16x32_bf16 v[48:51], v[252:255], v[64:67], v[48:51]
    v_mfma_f32_16x16x32_bf16 v[20:23], a[0:3], v[68:71], v[20:23]
    v_mfma_f32_16x16x32_bf16 v[24:27], a[4:7], v[68:71], v[24:27]
    v_mfma_f32_16x16x32_bf16 v[28:31], a[8:11], v[68:71], v[28:31]
    v_mfma_f32_16x16x32_bf16 v[32:35], a[12:15], v[68:71], v[32:35]
    v_mfma_f32_16x16x32_bf16 v[36:39], a[16:19], v[68:71], v[36:39]
    v_mfma_f32_16x16x32_bf16 v[40:43], a[20:23], v[68:71], v[40:43]
    v_mfma_f32_16x16x32_bf16 v[44:47], a[24:27], v[68:71], v[44:47]
    v_mfma_f32_16x16x32_bf16 v[48:51], a[28:31], v[68:71], v[48:51]
    v_mfma_f32_16x16x32_bf16 v[20:23], a[32:35], v[72:75], v[20:23]
    v_mfma_f32_16x16x32_bf16 v[24:27], a[36:39], v[72:75], v[24:27]
    v_mfma_f32_16x16x32_bf16 v[28:31], a[40:43], v[72:75], v[28:31]
    v_mfma_f32_16x16x32_bf16 v[32:35], a[44:47], v[72:75], v[32:35]
    v_mfma_f32_16x16x32_bf16 v[36:39], a[48:51], v[72:75], v[36:39]
    v_mfma_f32_16x16x32_bf16 v[40:43], a[52:55], v[72:75], v[40:43]
    v_mfma_f32_16x16x32_bf16 v[44:47], a[56:59], v[72:75], v[44:47]
    v_mfma_f32_16x16x32_bf16 v[48:51], a[60:63], v[72:75], v[48:51]
    v_mfma_f32_16x16x32_bf16 v[20:23], a[64:67], v[76:79], v[20:23]
    v_mfma_f32_16x16x32_bf16 v[24:27], a[68:71], v[76:79], v[24:27]
    v_mfma_f32_16x16x32_bf16 v[28:31], a[72:75], v[76:79], v[28:31]
    v_mfma_f32_16x16x32_bf16 v[32:35], a[76:79], v[76:79], v[32:35]
    v_mfma_f32_16x16x32_bf16 v[36:39], a[80:83], v[76:79], v[36:39]
    v_mfma_f32_16x16x32_bf16 v[40:43], a[84:87], v[76:79], v[40:43]
    v_mfma_f32_16x16x32_bf16 v[44:47], a[88:91], v[76:79], v[44:47]
    v_mfma_f32_16x16x32_bf16 v[48:51], a[92:95], v[76:79], v[48:51]
    v_mfma_f32_16x16x32_bf16 v[20:23], a[96:99], v[80:83], v[20:23]
    v_mfma_f32_16x16x32_bf16 v[24:27], a[100:103], v[80:83], v[24:27]
    v_mfma_f32_16x16x32_bf16 v[28:31], a[104:107], v[80:83], v[28:31]
    v_mfma_f32_16x16x32_bf16 v[32:35], a[108:111], v[80:83], v[32:35]
    v_mfma_f32_16x16x32_bf16 v[36:39], a[112:115], v[80:83], v[36:39]
    v_mfma_f32_16x16x32_bf16 v[40:43], a[116:119], v[80:83], v[40:43]
    v_mfma_f32_16x16x32_bf16 v[44:47], a[120:123], v[80:83], v[44:47]
    v_mfma_f32_16x16x32_bf16 v[48:51], a[124:127], v[80:83], v[48:51]
    v_mfma_f32_16x16x32_bf16 v[20:23], a[128:131], v[84:87], v[20:23]
    ds_read_b128 v[52:55], v7 offset:0
    v_mfma_f32_16x16x32_bf16 v[24:27], a[132:135], v[84:87], v[24:27]
    ds_read_b128 v[56:59], v7 offset:1024
    v_mfma_f32_16x16x32_bf16 v[28:31], a[136:139], v[84:87], v[28:31]
    ds_read_b128 v[60:63], v7 offset:2048
    v_mfma_f32_16x16x32_bf16 v[32:35], a[140:143], v[84:87], v[32:35]
    ds_read_b128 v[64:67], v7 offset:3072
    v_mfma_f32_16x16x32_bf16 v[36:39], a[144:147], v[84:87], v[36:39]
    ds_read_b128 v[68:71], v7 offset:4096
    v_mfma_f32_16x16x32_bf16 v[40:43], a[148:151], v[84:87], v[40:43]
    ds_read_b128 v[72:75], v7 offset:5120
    v_mfma_f32_16x16x32_bf16 v[44:47], a[152:155], v[84:87], v[44:47]
    ds_read_b128 v[76:79], v7 offset:6144
    v_mfma_f32_16x16x32_bf16 v[48:51], a[156:159], v[84:87], v[48:51]
    ds_read_b128 v[80:83], v7 offset:7168
    v_mfma_f32_16x16x32_bf16 v[20:23], a[160:163], v[88:91], v[20:23]
    v_mfma_f32_16x16x32_bf16 v[24:27], a[164:167], v[88:91], v[24:27]
    v_mfma_f32_16x16x32_bf16 v[28:31], a[168:171], v[88:91], v[28:31]
    v_mfma_f32_16x16x32_bf16 v[32:35], a[172:175], v[88:91], v[32:35]
    v_mfma_f32_16x16x32_bf16 v[36:39], a[176:179], v[88:91], v[36:39]
    v_mfma_f32_16x16x32_bf16 v[40:43], a[180:183], v[88:91], v[40:43]
    v_mfma_f32_16x16x32_bf16 v[44:47], a[184:187], v[88:91], v[44:47]
    v_mfma_f32_16x16x32_bf16 v[48:51], a[188:191], v[88:91], v[48:51]
    s_waitcnt lgkmcnt(7)
    v_mfma_f32_16x16x32_bf16 v[20:23], v[52:55], v[100:103], v[20:23]
    ds_read_b128 v[52:55], v7 offset:8192
    s_waitcnt lgkmcnt(7)
    v_mfma_f32_16x16x32_bf16 v[24:27], v[56:59], v[100:103], v[24:27]
    ds_read_b128 v[56:59], v7 offset:9216
    s_waitcnt lgkmcnt(7)
    v_mfma_f32_16x16x32_bf16 v[28:31], v[60:63], v[100:103], v[28:31]
    ds_read_b128 v[60:63], v7 offset:10240
    s_waitcnt lgkmcnt(7)
    v_mfma_f32_16x16x32_bf16 v[32:35], v[64:67], v[100:103], v[32:35]
    ds_read_b128 v[64:67], v7 offset:11264
    s_waitcnt lgkmcnt(7)
    v_mfma_f32_16x16x32_bf16 v[36:39], v[68:71], v[100:103], v[36:39]
    ds_read_b128 v[68:71], v7 offset:12288
    s_waitcnt lgkmcnt(7)
    v_mfma_f32_16x16x32_bf16 v[40:43], v[72:75], v[100:103], v[40:43]
    ds_read_b128 v[72:75], v7 offset:13312
    s_waitcnt lgkmcnt(7)
    v_mfma_f32_16x16x32_bf16 v[44:47], v[76:79], v[100:103], v[44:47]
    ds_read_b128 v[76:79], v7 offset:14336
    s_waitcnt lgkmcnt(7)
    v_mfma_f32_16x16x32_bf16 v[48:51], v[80:83], v[100:103], v[48:51]
    ds_read_b128 v[80:83], v7 offset:15360
    v_mfma_f32_16x16x32_bf16 v[20:23], a[192:195], v[92:95], v[20:23]
    v_mfma_f32_16x16x32_bf16 v[24:27], a[196:199], v[92:95], v[24:27]
    v_mfma_f32_16x16x32_bf16 v[28:31], a[200:203], v[92:95], v[28:31]
    v_mfma_f32_16x16x32_bf16 v[32:35], a[204:207], v[92:95], v[32:35]
    v_mfma_f32_16x16x32_bf16 v[36:39], a[208:211], v[92:95], v[36:39]
    v_mfma_f32_16x16x32_bf16 v[40:43], a[212:215], v[92:95], v[40:43]
    v_mfma_f32_16x16x32_bf16 v[44:47], a[216:219], v[92:95], v[44:47]
    v_mfma_f32_16x16x32_bf16 v[48:51], a[220:223], v[92:95], v[48:51]
    s_waitcnt lgkmcnt(7)
    v_mfma_f32_16x16x32_bf16 v[20:23], v[52:55], v[104:107], v[20:23]
    s_waitcnt lgkmcnt(6)
    v_mfma_f32_16x16x32_bf16 v[24:27], v[56:59], v[104:107], v[24:27]
    s_waitcnt lgkmcnt(5)
    v_mfma_f32_16x16x32_bf16 v[28:31], v[60:63], v[104:107], v[28:31]
    s_waitcnt lgkmcnt(4)
    v_mfma_f32_16x16x32_bf16 v[32:35], v[64:67], v[104:107], v[32:35]
    s_waitcnt lgkmcnt(3)
    v_mfma_f32_16x16x32_bf16 v[36:39], v[68:71], v[104:107], v[36:39]
    s_waitcnt lgkmcnt(2)
    v_mfma_f32_16x16x32_bf16 v[40:43], v[72:75], v[104:107], v[40:43]
    s_waitcnt lgkmcnt(1)
    v_mfma_f32_16x16x32_bf16 v[44:47], v[76:79], v[104:107], v[44:47]
    s_waitcnt lgkmcnt(0)
    v_mfma_f32_16x16x32_bf16 v[48:51], v[80:83], v[104:107], v[48:51]
    v_mfma_f32_16x16x32_bf16 v[20:23], a[224:227], v[96:99], v[20:23]
    v_mfma_f32_16x16x32_bf16 v[24:27], a[228:231], v[96:99], v[24:27]
    v_mfma_f32_16x16x32_bf16 v[28:31], a[232:235], v[96:99], v[28:31]
    v_mfma_f32_16x16x32_bf16 v[32:35], a[236:239], v[96:99], v[32:35]
    v_mfma_f32_16x16x32_bf16 v[36:39], a[240:243], v[96:99], v[36:39]
    v_mfma_f32_16x16x32_bf16 v[40:43], a[244:247], v[96:99], v[40:43]
    v_mfma_f32_16x16x32_bf16 v[44:47], a[248:251], v[96:99], v[44:47]
    v_mfma_f32_16x16x32_bf16 v[48:51], a[252:255], v[96:99], v[48:51]
    s_mul_i32 s30, s19, 8192
    v_add_u32 v60, s30, v4
    ds_write_b128 v60, v[20:23] offset:0
    ds_write_b128 v60, v[24:27] offset:1024
    ds_write_b128 v60, v[28:31] offset:2048
    ds_write_b128 v60, v[32:35] offset:3072
    ds_write_b128 v60, v[36:39] offset:4096
    ds_write_b128 v60, v[40:43] offset:5120
    ds_write_b128 v60, v[44:47] offset:6144
    ds_write_b128 v60, v[48:51] offset:7168
    s_mul_i32 s30, s19, 2048
    v_add_u32 v60, s30, v4
    s_waitcnt lgkmcnt(0)
    s_barrier
    ds_read_b128 v[20:23], v60 offset:0
    ds_read_b128 v[24:27], v60 offset:1024
    ds_read_b128 v[28:31], v60 offset:8192
    ds_read_b128 v[32:35], v60 offset:9216
    ds_read_b128 v[36:39], v60 offset:16384
    ds_read_b128 v[40:43], v60 offset:17408
    ds_read_b128 v[44:47], v60 offset:24576
    ds_read_b128 v[48:51], v60 offset:25600
    s_waitcnt lgkmcnt(0)
    v_pk_add_f32 v[52:53], v[20:21], v[28:29]
    v_pk_add_f32 v[20:21], v[36:37], v[44:45]
    v_pk_add_f32 v[52:53], v[52:53], v[20:21]
    v_pk_add_f32 v[54:55], v[22:23], v[30:31]
    v_pk_add_f32 v[22:23], v[38:39], v[46:47]
    v_pk_add_f32 v[54:55], v[54:55], v[22:23]
    v_pk_add_f32 v[56:57], v[24:25], v[32:33]
    v_pk_add_f32 v[24:25], v[40:41], v[48:49]
    v_pk_add_f32 v[56:57], v[56:57], v[24:25]
    v_pk_add_f32 v[58:59], v[26:27], v[34:35]
    v_pk_add_f32 v[26:27], v[42:43], v[50:51]
    v_pk_add_f32 v[58:59], v[58:59], v[26:27]
    v_lshlrev_b32 v64, 10, v2
    v_lshl_add_u32 v64, v3, 6, v64
    s_lshl_b32 s25, s6, 8
    s_add_u32 s27, s27, s25
    s_add_u32 s27, s27, s28
    v_cvt_pk_bf16_f32 v65, v52, v53
    v_lshlrev_b32 v52, 16, v65
    v_and_b32 v53, 0xffff0000, v65
    v_cvt_pk_bf16_f32 v65, v54, v55
    v_lshlrev_b32 v54, 16, v65
    v_and_b32 v55, 0xffff0000, v65
    v_cvt_pk_bf16_f32 v65, v56, v57
    v_lshlrev_b32 v56, 16, v65
    v_and_b32 v57, 0xffff0000, v65
    v_cvt_pk_bf16_f32 v65, v58, v59
    v_lshlrev_b32 v58, 16, v65
    v_and_b32 v59, 0xffff0000, v65
    s_waitcnt vmcnt(0)
    v_lshlrev_b32 v66, 16, v116
    v_and_b32 v67, 0xffff0000, v116
    v_add_f32 v52, v52, v66
    v_add_f32 v56, v56, v67
    v_cvt_pk_bf16_f32 v68, v52, v56
    v_lshlrev_b32 v52, 16, v68
    v_and_b32 v56, 0xffff0000, v68
    v_lshlrev_b32 v66, 16, v120
    v_and_b32 v67, 0xffff0000, v120
    v_add_f32 v52, v52, v66
    v_add_f32 v56, v56, v67
    v_cvt_pk_bf16_f32 v68, v52, v56
    v_lshlrev_b32 v66, 16, v117
    v_and_b32 v67, 0xffff0000, v117
    v_add_f32 v53, v53, v66
    v_add_f32 v57, v57, v67
    v_cvt_pk_bf16_f32 v69, v53, v57
    v_lshlrev_b32 v53, 16, v69
    v_and_b32 v57, 0xffff0000, v69
    v_lshlrev_b32 v66, 16, v121
    v_and_b32 v67, 0xffff0000, v121
    v_add_f32 v53, v53, v66
    v_add_f32 v57, v57, v67
    v_cvt_pk_bf16_f32 v69, v53, v57
    v_lshlrev_b32 v66, 16, v118
    v_and_b32 v67, 0xffff0000, v118
    v_add_f32 v54, v54, v66
    v_add_f32 v58, v58, v67
    v_cvt_pk_bf16_f32 v70, v54, v58
    v_lshlrev_b32 v54, 16, v70
    v_and_b32 v58, 0xffff0000, v70
    v_lshlrev_b32 v66, 16, v122
    v_and_b32 v67, 0xffff0000, v122
    v_add_f32 v54, v54, v66
    v_add_f32 v58, v58, v67
    v_cvt_pk_bf16_f32 v70, v54, v58
    v_lshlrev_b32 v66, 16, v119
    v_and_b32 v67, 0xffff0000, v119
    v_add_f32 v55, v55, v66
    v_add_f32 v59, v59, v67
    v_cvt_pk_bf16_f32 v71, v55, v59
    v_lshlrev_b32 v55, 16, v71
    v_and_b32 v59, 0xffff0000, v71
    v_lshlrev_b32 v66, 16, v123
    v_and_b32 v67, 0xffff0000, v123
    v_add_f32 v55, v55, v66
    v_add_f32 v59, v59, v67
    v_cvt_pk_bf16_f32 v71, v55, v59
    v_mul_u32_u24 v64, 272, v2
    v_lshl_add_u32 v64, v3, 6, v64
    v_add_u32 v64, s28, v64
    s_barrier
    ds_write_b32 v64, v68 offset:0
    ds_write_b32 v64, v69 offset:16
    ds_write_b32 v64, v70 offset:32
    ds_write_b32 v64, v71 offset:48
    s_lshl_b32 s24, s19, 2
    v_add_u32 v65, s24, v3
    v_mul_u32_u24 v64, 272, v65
    v_lshl_add_u32 v64, v2, 4, v64
    v_lshlrev_b32 v65, 10, v65
    v_lshl_add_u32 v65, v2, 4, v65
    s_sub_u32 s27, s27, s28
    s_waitcnt lgkmcnt(0)
    s_barrier
    ds_read_b128 v[52:55], v64 offset:0
    s_waitcnt lgkmcnt(0)
    buffer_store_dwordx4 v[52:55], v65, s[12:15], s27 offen sc1
    s_waitcnt lgkmcnt(0)
    s_barrier
    s_add_u32 s5, s5, 6
    s_cmp_lt_u32 s5, 128
    s_cbranch_scc1 Lst_192
    s_branch Lnext_92
Lh_105:
    s_load_dwordx4 s[40:43], s[0:1], 16
    s_load_dwordx2 s[44:45], s[0:1], 32
    s_mov_b32 s14, 4194304
    s_mov_b32 s15, 0x00020000
    s_mov_b32 s34, 4194304
    s_mov_b32 s35, 0x00020000
    v_lshlrev_b32 v232, 11, v3
    v_lshl_add_u32 v232, v2, 4, v232
    v_add_u32 v233, 65536, v232
    v_lshlrev_b32 v7, 13, v3
    v_lshl_add_u32 v7, v2, 4, v7
    s_lshl_b32 s24, s19, 18
    v_add_u32 v7, s24, v7
    s_lshl_b32 s39, s19, 13
    s_lshl_b32 s47, s5, 2
    s_add_u32 s47, s47, s19
    s_waitcnt lgkmcnt(0)
    s_lshr_b32 s26, s6, 5
    s_cmp_eq_u32 s26, 1
    s_cselect_b32 s12, s42, s40
    s_cselect_b32 s13, s43, s41
    s_cmp_eq_u32 s26, 2
    s_cselect_b32 s12, s44, s12
    s_cselect_b32 s13, s45, s13
    s_and_b32 s13, s13, 0xffff
    s_and_b32 s36, s6, 31
    s_lshl_b32 s36, s36, 8
    s_add_u32 m0, s39, 0
    s_add_u32 s38, s36, 0
    buffer_load_dwordx4 v7, s[12:15], s38 offen lds
    s_add_u32 m0, s39, 1024
    s_add_u32 s38, s36, 32768
    buffer_load_dwordx4 v7, s[12:15], s38 offen lds
    s_add_u32 m0, s39, 2048
    s_add_u32 s38, s36, 65536
    buffer_load_dwordx4 v7, s[12:15], s38 offen lds
    s_add_u32 m0, s39, 3072
    s_add_u32 s38, s36, 98304
    buffer_load_dwordx4 v7, s[12:15], s38 offen lds
    s_add_u32 m0, s39, 4096
    s_add_u32 s38, s36, 131072
    buffer_load_dwordx4 v7, s[12:15], s38 offen lds
    s_add_u32 m0, s39, 5120
    s_add_u32 s38, s36, 163840
    buffer_load_dwordx4 v7, s[12:15], s38 offen lds
    s_add_u32 m0, s39, 6144
    s_add_u32 s38, s36, 196608
    buffer_load_dwordx4 v7, s[12:15], s38 offen lds
    s_add_u32 m0, s39, 7168
    s_add_u32 s38, s36, 229376
    buffer_load_dwordx4 v7, s[12:15], s38 offen lds
    s_add_u32 m0, s39, 32768
    s_add_u32 s38, s36, 1048576
    buffer_load_dwordx4 v7, s[12:15], s38 offen lds
    s_add_u32 m0, s39, 33792
    s_add_u32 s38, s36, 1081344
    buffer_load_dwordx4 v7, s[12:15], s38 offen lds
    s_add_u32 m0, s39, 34816
    s_add_u32 s38, s36, 1114112
    buffer_load_dwordx4 v7, s[12:15], s38 offen lds
    s_add_u32 m0, s39, 35840
    s_add_u32 s38, s36, 1146880
    buffer_load_dwordx4 v7, s[12:15], s38 offen lds
    s_add_u32 m0, s39, 36864
    s_add_u32 s38, s36, 1179648
    buffer_load_dwordx4 v7, s[12:15], s38 offen lds
    s_add_u32 m0, s39, 37888
    s_add_u32 s38, s36, 1212416
    buffer_load_dwordx4 v7, s[12:15], s38 offen lds
    s_add_u32 m0, s39, 38912
    s_add_u32 s38, s36, 1245184
    buffer_load_dwordx4 v7, s[12:15], s38 offen lds
    s_add_u32 m0, s39, 39936
    s_add_u32 s38, s36, 1277952
    buffer_load_dwordx4 v7, s[12:15], s38 offen lds
    s_add_u32 m0, s39, 65536
    s_add_u32 s38, s36, 2097152
    buffer_load_dwordx4 v7, s[12:15], s38 offen lds
    s_add_u32 m0, s39, 66560
    s_add_u32 s38, s36, 2129920
    buffer_load_dwordx4 v7, s[12:15], s38 offen lds
    s_add_u32 m0, s39, 67584
    s_add_u32 s38, s36, 2162688
    buffer_load_dwordx4 v7, s[12:15], s38 offen lds
    s_add_u32 m0, s39, 68608
    s_add_u32 s38, s36, 2195456
    buffer_load_dwordx4 v7, s[12:15], s38 offen lds
    s_add_u32 m0, s39, 69632
    s_add_u32 s38, s36, 2228224
    buffer_load_dwordx4 v7, s[12:15], s38 offen lds
    s_add_u32 m0, s39, 70656
    s_add_u32 s38, s36, 2260992
    buffer_load_dwordx4 v7, s[12:15], s38 offen lds
    s_add_u32 m0, s39, 71680
    s_add_u32 s38, s36, 2293760
    buffer_load_dwordx4 v7, s[12:15], s38 offen lds
    s_add_u32 m0, s39, 72704
    s_add_u32 s38, s36, 2326528
    buffer_load_dwordx4 v7, s[12:15], s38 offen lds
    s_lshl_b32 s24, s5, 11
    s_add_u32 s24, s24, 159383552
    v_min_u32 v8, 15, v1
    v_mul_u32_u24 v8, 128, v8
    s_nop 1
Lw_198:
    buffer_load_dwordx2 v[10:11], v8, s[8:11], s24 offen sc1
    s_waitcnt vmcnt(0)
    v_cmp_ne_u64 vcc, s[62:63], v[10:11]
    s_nop 4
    s_cbranch_vccz Lwd_199
    s_sleep 2
    s_sub_u32 s21, s21, 1
    s_cbranch_scc0 Lw_198
    s_mov_b32 s21, 0
Lwd_199:
    s_lshl_b32 s24, s47, 15
    buffer_load_dwordx4 a[0:3], v4, s[8:11], s24 offen offset:0 sc1
    buffer_load_dwordx4 a[4:7], v4, s[8:11], s24 offen offset:1024 sc1
    buffer_load_dwordx4 a[8:11], v4, s[8:11], s24 offen offset:2048 sc1
    buffer_load_dwordx4 a[12:15], v4, s[8:11], s24 offen offset:3072 sc1
    s_add_u32 s24, s24, 4096
    buffer_load_dwordx4 a[16:19], v4, s[8:11], s24 offen offset:0 sc1
    buffer_load_dwordx4 a[20:23], v4, s[8:11], s24 offen offset:1024 sc1
    buffer_load_dwordx4 a[24:27], v4, s[8:11], s24 offen offset:2048 sc1
    buffer_load_dwordx4 a[28:31], v4, s[8:11], s24 offen offset:3072 sc1
    s_add_u32 s24, s24, 4096
    buffer_load_dwordx4 a[32:35], v4, s[8:11], s24 offen offset:0 sc1
    buffer_load_dwordx4 a[36:39], v4, s[8:11], s24 offen offset:1024 sc1
    buffer_load_dwordx4 a[40:43], v4, s[8:11], s24 offen offset:2048 sc1
    buffer_load_dwordx4 a[44:47], v4, s[8:11], s24 offen offset:3072 sc1
    s_add_u32 s24, s24, 4096
    buffer_load_dwordx4 a[48:51], v4, s[8:11], s24 offen offset:0 sc1
    buffer_load_dwordx4 a[52:55], v4, s[8:11], s24 offen offset:1024 sc1
    buffer_load_dwordx4 a[56:59], v4, s[8:11], s24 offen offset:2048 sc1
    buffer_load_dwordx4 a[60:63], v4, s[8:11], s24 offen offset:3072 sc1
    s_add_u32 s24, s24, 4096
    buffer_load_dwordx4 a[64:67], v4, s[8:11], s24 offen offset:0 sc1
    buffer_load_dwordx4 a[68:71], v4, s[8:11], s24 offen offset:1024 sc1
    buffer_load_dwordx4 a[72:75], v4, s[8:11], s24 offen offset:2048 sc1
    buffer_load_dwordx4 a[76:79], v4, s[8:11], s24 offen offset:3072 sc1
    s_add_u32 s24, s24, 4096
    buffer_load_dwordx4 a[80:83], v4, s[8:11], s24 offen offset:0 sc1
    buffer_load_dwordx4 a[84:87], v4, s[8:11], s24 offen offset:1024 sc1
    buffer_load_dwordx4 a[88:91], v4, s[8:11], s24 offen offset:2048 sc1
    buffer_load_dwordx4 a[92:95], v4, s[8:11], s24 offen offset:3072 sc1
    s_add_u32 s24, s24, 4096
    buffer_load_dwordx4 a[96:99], v4, s[8:11], s24 offen offset:0 sc1
    buffer_load_dwordx4 a[100:103], v4, s[8:11], s24 offen offset:1024 sc1
    buffer_load_dwordx4 a[104:107], v4, s[8:11], s24 offen offset:2048 sc1
    buffer_load_dwordx4 a[108:111], v4, s[8:11], s24 offen offset:3072 sc1
    s_add_u32 s24, s24, 4096
    buffer_load_dwordx4 a[112:115], v4, s[8:11], s24 offen offset:0 sc1
    buffer_load_dwordx4 a[116:119], v4, s[8:11], s24 offen offset:1024 sc1
    buffer_load_dwordx4 a[120:123], v4, s[8:11], s24 offen offset:2048 sc1
    buffer_load_dwordx4 a[124:127], v4, s[8:11], s24 offen offset:3072 sc1
    s_add_u32 s24, s24, 4096
    s_waitcnt vmcnt(0)
    s_mov_b32 s48, s7
Lnt_200:
    s_add_u32 s46, s6, 32
    s_cmp_ge_u32 s46, 96
    s_cselect_b32 s26, 96, 0
    s_sub_u32 s46, s46, s26
    s_lshr_b32 s26, s46, 5
    s_cmp_eq_u32 s26, 1
    s_cselect_b32 s32, s42, s40
    s_cselect_b32 s33, s43, s41
    s_cmp_eq_u32 s26, 2
    s_cselect_b32 s32, s44, s32
    s_cselect_b32 s33, s45, s33
    s_and_b32 s33, s33, 0xffff
    s_and_b32 s37, s46, 31
    s_lshl_b32 s37, s37, 8
    s_cmp_gt_u32 s48, 1
    s_cselect_b32 s34, 4194304, 0
    s_lshr_b32 s26, s6, 5
    s_and_b32 s27, s6, 31
    s_cmp_eq_u32 s26, 2
    s_cbranch_scc1 Lv_203
    s_waitcnt vmcnt(32)
    s_barrier
    ds_read_b128 v[136:139], v232 offset:0
    ds_read_b128 v[140:143], v232 offset:256
    ds_read_b128 v[144:147], v232 offset:512
    ds_read_b128 v[148:151], v232 offset:768
    ds_read_b128 v[152:155], v232 offset:1024
    ds_read_b128 v[156:159], v232 offset:1280
    ds_read_b128 v[160:163], v232 offset:1536
    ds_read_b128 v[164:167], v232 offset:1792
    s_waitcnt lgkmcnt(0)
    v_perm_b32 v200, v140, v136, s68
    v_perm_b32 v201, v148, v144, s68
    v_perm_b32 v202, v156, v152, s68
    v_perm_b32 v203, v164, v160, s68
    s_nop 1
    v_mfma_f32_16x16x32_bf16 v[8:11], v[200:203], a[0:3], 0
    v_perm_b32 v204, v140, v136, s69
    v_perm_b32 v205, v148, v144, s69
    v_perm_b32 v206, v156, v152, s69
    v_perm_b32 v207, v164, v160, s69
    v_mfma_f32_16x16x32_bf16 v[40:43], v[200:203], a[64:67], 0
    ds_read_b128 v[168:171], v232 offset:8192
    ds_read_b128 v[172:175], v232 offset:8448
    ds_read_b128 v[176:179], v232 offset:8704
    ds_read_b128 v[180:183], v232 offset:8960
    v_mfma_f32_16x16x32_bf16 v[12:15], v[204:207], a[0:3], 0
    v_perm_b32 v208, v141, v137, s68
    v_perm_b32 v209, v149, v145, s68
    v_perm_b32 v210, v157, v153, s68
    v_perm_b32 v211, v165, v161, s68
    v_mfma_f32_16x16x32_bf16 v[44:47], v[204:207], a[64:67], 0
    ds_read_b128 v[184:187], v232 offset:9216
    ds_read_b128 v[188:191], v232 offset:9472
    ds_read_b128 v[192:195], v232 offset:9728
    ds_read_b128 v[196:199], v232 offset:9984
    v_mfma_f32_16x16x32_bf16 v[16:19], v[208:211], a[0:3], 0
    v_perm_b32 v212, v141, v137, s69
    v_perm_b32 v213, v149, v145, s69
    v_perm_b32 v214, v157, v153, s69
    v_perm_b32 v215, v165, v161, s69
    v_mfma_f32_16x16x32_bf16 v[48:51], v[208:211], a[64:67], 0
    s_add_u32 m0, s39, 98304
    s_add_u32 s38, s36, 3145728
    buffer_load_dwordx4 v7, s[12:15], s38 offen lds
    s_add_u32 m0, s39, 99328
    v_mfma_f32_16x16x32_bf16 v[20:23], v[212:215], a[0:3], 0
    v_perm_b32 v216, v142, v138, s68
    v_perm_b32 v217, v150, v146, s68
    v_perm_b32 v218, v158, v154, s68
    v_perm_b32 v219, v166, v162, s68
    v_mfma_f32_16x16x32_bf16 v[52:55], v[212:215], a[64:67], 0
    s_add_u32 s38, s36, 3178496
    buffer_load_dwordx4 v7, s[12:15], s38 offen lds
    s_add_u32 m0, s39, 100352
    s_add_u32 s38, s36, 3211264
    v_mfma_f32_16x16x32_bf16 v[24:27], v[216:219], a[0:3], 0
    v_perm_b32 v220, v142, v138, s69
    v_perm_b32 v221, v150, v146, s69
    v_perm_b32 v222, v158, v154, s69
    v_perm_b32 v223, v166, v162, s69
    v_mfma_f32_16x16x32_bf16 v[56:59], v[216:219], a[64:67], 0
    buffer_load_dwordx4 v7, s[12:15], s38 offen lds
    s_add_u32 m0, s39, 101376
    s_add_u32 s38, s36, 3244032
    buffer_load_dwordx4 v7, s[12:15], s38 offen lds
    v_mfma_f32_16x16x32_bf16 v[28:31], v[220:223], a[0:3], 0
    v_perm_b32 v224, v143, v139, s68
    v_perm_b32 v225, v151, v147, s68
    v_perm_b32 v226, v159, v155, s68
    v_perm_b32 v227, v167, v163, s68
    v_mfma_f32_16x16x32_bf16 v[60:63], v[220:223], a[64:67], 0
    s_add_u32 m0, s39, 102400
    s_add_u32 s38, s36, 3276800
    buffer_load_dwordx4 v7, s[12:15], s38 offen lds
    s_add_u32 m0, s39, 103424
    v_mfma_f32_16x16x32_bf16 v[32:35], v[224:227], a[0:3], 0
    v_perm_b32 v228, v143, v139, s69
    v_perm_b32 v229, v151, v147, s69
    v_perm_b32 v230, v159, v155, s69
    v_perm_b32 v231, v167, v163, s69
    v_mfma_f32_16x16x32_bf16 v[64:67], v[224:227], a[64:67], 0
    s_add_u32 s38, s36, 3309568
    buffer_load_dwordx4 v7, s[12:15], s38 offen lds
    s_add_u32 m0, s39, 104448
    s_add_u32 s38, s36, 3342336
    v_mfma_f32_16x16x32_bf16 v[36:39], v[228:231], a[0:3], 0
    buffer_load_dwordx4 v7, s[12:15], s38 offen lds
    s_add_u32 m0, s39, 105472
    s_add_u32 s38, s36, 3375104
    buffer_load_dwordx4 v7, s[12:15], s38 offen lds
    v_mfma_f32_16x16x32_bf16 v[68:71], v[228:231], a[64:67], 0
    s_waitcnt lgkmcnt(0)
    v_perm_b32 v200, v172, v168, s68
    v_perm_b32 v201, v180, v176, s68
    v_perm_b32 v202, v188, v184, s68
    v_perm_b32 v203, v196, v192, s68
    s_nop 1
    v_mfma_f32_16x16x32_bf16 v[8:11], v[200:203], a[4:7], v[8:11]
    v_perm_b32 v204, v172, v168, s69
    v_perm_b32 v205, v180, v176, s69
    v_perm_b32 v206, v188, v184, s69
    v_perm_b32 v207, v196, v192, s69
    v_mfma_f32_16x16x32_bf16 v[40:43], v[200:203], a[68:71], v[40:43]
    ds_read_b128 v[136:139], v232 offset:16384
    ds_read_b128 v[140:143], v232 offset:16640
    ds_read_b128 v[144:147], v232 offset:16896
    ds_read_b128 v[148:151], v232 offset:17152
    v_mfma_f32_16x16x32_bf16 v[12:15], v[204:207], a[4:7], v[12:15]
    v_perm_b32 v208, v173, v169, s68
    v_perm_b32 v209, v181, v177, s68
    v_perm_b32 v210, v189, v185, s68
    v_perm_b32 v211, v197, v193, s68
    v_mfma_f32_16x16x32_bf16 v[44:47], v[204:207], a[68:71], v[44:47]
    ds_read_b128 v[152:155], v232 offset:17408
    ds_read_b128 v[156:159], v232 offset:17664
    ds_read_b128 v[160:163], v232 offset:17920
    ds_read_b128 v[164:167], v232 offset:18176
    v_mfma_f32_16x16x32_bf16 v[16:19], v[208:211], a[4:7], v[16:19]
    v_perm_b32 v212, v173, v169, s69
    v_perm_b32 v213, v181, v177, s69
    v_perm_b32 v214, v189, v185, s69
    v_perm_b32 v215, v197, v193, s69
    v_mfma_f32_16x16x32_bf16 v[48:51], v[208:211], a[68:71], v[48:51]
    s_nop 0
    v_mfma_f32_16x16x32_bf16 v[20:23], v[212:215], a[4:7], v[20:23]
    v_perm_b32 v216, v174, v170, s68
    v_perm_b32 v217, v182, v178, s68
    v_perm_b32 v218, v190, v186, s68
    v_perm_b32 v219, v198, v194, s68
    v_mfma_f32_16x16x32_bf16 v[52:55], v[212:215], a[68:71], v[52:55]
    s_nop 0
    v_mfma_f32_16x16x32_bf16 v[24:27], v[216:219], a[4:7], v[24:27]
    v_perm_b32 v220, v174, v170, s69
    v_perm_b32 v221, v182, v178, s69
    v_perm_b32 v222, v190, v186, s69
    v_perm_b32 v223, v198, v194, s69
    v_mfma_f32_16x16x32_bf16 v[56:59], v[216:219], a[68:71], v[56:59]
    s_nop 0
    v_mfma_f32_16x16x32_bf16 v[28:31], v[220:223], a[4:7], v[28:31]
    v_perm_b32 v224, v175, v171, s68
    v_perm_b32 v225, v183, v179, s68
    v_perm_b32 v226, v191, v187, s68
    v_perm_b32 v227, v199, v195, s68
    v_mfma_f32_16x16x32_bf16 v[60:63], v[220:223], a[68:71], v[60:63]
    s_nop 0
    v_mfma_f32_16x16x32_bf16 v[32:35], v[224:227], a[4:7], v[32:35]
    v_perm_b32 v228, v175, v171, s69
    v_perm_b32 v229, v183, v179, s69
    v_perm_b32 v230, v191, v187, s69
    v_perm_b32 v231, v199, v195, s69
    v_mfma_f32_16x16x32_bf16 v[64:67], v[224:227], a[68:71], v[64:67]
    s_nop 0
    v_mfma_f32_16x16x32_bf16 v[36:39], v[228:231], a[4:7], v[36:39]
    v_mfma_f32_16x16x32_bf16 v[68:71], v[228:231], a[68:71], v[68:71]
    s_waitcnt lgkmcnt(0)
    v_perm_b32 v200, v140, v136, s68
    v_perm_b32 v201, v148, v144, s68
    v_perm_b32 v202, v156, v152, s68
    v_perm_b32 v203, v164, v160, s68
    s_nop 1
    v_mfma_f32_16x16x32_bf16 v[8:11], v[200:203], a[8:11], v[8:11]
    v_perm_b32 v204, v140, v136, s69
    v_perm_b32 v205, v148, v144, s69
    v_perm_b32 v206, v156, v152, s69
    v_perm_b32 v207, v164, v160, s69
    v_mfma_f32_16x16x32_bf16 v[40:43], v[200:203], a[72:75], v[40:43]
    ds_read_b128 v[168:171], v232 offset:24576
    ds_read_b128 v[172:175], v232 offset:24832
    ds_read_b128 v[176:179], v232 offset:25088
    ds_read_b128 v[180:183], v232 offset:25344
    v_mfma_f32_16x16x32_bf16 v[12:15], v[204:207], a[8:11], v[12:15]
    v_perm_b32 v208, v141, v137, s68
    v_perm_b32 v209, v149, v145, s68
    v_perm_b32 v210, v157, v153, s68
    v_perm_b32 v211, v165, v161, s68
    v_mfma_f32_16x16x32_bf16 v[44:47], v[204:207], a[72:75], v[44:47]
    ds_read_b128 v[184:187], v232 offset:25600
    ds_read_b128 v[188:191], v232 offset:25856
    ds_read_b128 v[192:195], v232 offset:26112
    ds_read_b128 v[196:199], v232 offset:26368
    v_mfma_f32_16x16x32_bf16 v[16:19], v[208:211], a[8:11], v[16:19]
    v_perm_b32 v212, v141, v137, s69
    v_perm_b32 v213, v149, v145, s69
    v_perm_b32 v214, v157, v153, s69
    v_perm_b32 v215, v165, v161, s69
    v_mfma_f32_16x16x32_bf16 v[48:51], v[208:211], a[72:75], v[48:51]
    s_nop 0
    v_mfma_f32_16x16x32_bf16 v[20:23], v[212:215], a[8:11], v[20:23]
    v_perm_b32 v216, v142, v138, s68
    v_perm_b32 v217, v150, v146, s68
    v_perm_b32 v218, v158, v154, s68
    v_perm_b32 v219, v166, v162, s68
    v_mfma_f32_16x16x32_bf16 v[52:55], v[212:215], a[72:75], v[52:55]
    s_nop 0
    v_mfma_f32_16x16x32_bf16 v[24:27], v[216:219], a[8:11], v[24:27]
    v_perm_b32 v220, v142, v138, s69
    v_perm_b32 v221, v150, v146, s69
    v_perm_b32 v222, v158, v154, s69
    v_perm_b32 v223, v166, v162, s69
    v_mfma_f32_16x16x32_bf16 v[56:59], v[216:219], a[72:75], v[56:59]
    s_nop 0
    v_mfma_f32_16x16x32_bf16 v[28:31], v[220:223], a[8:11], v[28:31]
    v_perm_b32 v224, v143, v139, s68
    v_perm_b32 v225, v151, v147, s68
    v_perm_b32 v226, v159, v155, s68
    v_perm_b32 v227, v167, v163, s68
    v_mfma_f32_16x16x32_bf16 v[60:63], v[220:223], a[72:75], v[60:63]
    s_nop 0
    v_mfma_f32_16x16x32_bf16 v[32:35], v[224:227], a[8:11], v[32:35]
    v_perm_b32 v228, v143, v139, s69
    v_perm_b32 v229, v151, v147, s69
    v_perm_b32 v230, v159, v155, s69
    v_perm_b32 v231, v167, v163, s69
    v_mfma_f32_16x16x32_bf16 v[64:67], v[224:227], a[72:75], v[64:67]
    s_nop 0
    v_mfma_f32_16x16x32_bf16 v[36:39], v[228:231], a[8:11], v[36:39]
    v_mfma_f32_16x16x32_bf16 v[68:71], v[228:231], a[72:75], v[68:71]
    s_waitcnt lgkmcnt(0)
    v_perm_b32 v200, v172, v168, s68
    v_perm_b32 v201, v180, v176, s68
    v_perm_b32 v202, v188, v184, s68
    v_perm_b32 v203, v196, v192, s68
    s_nop 1
    v_mfma_f32_16x16x32_bf16 v[8:11], v[200:203], a[12:15], v[8:11]
    v_perm_b32 v204, v172, v168, s69
    v_perm_b32 v205, v180, v176, s69
    v_perm_b32 v206, v188, v184, s69
    v_perm_b32 v207, v196, v192, s69
    v_mfma_f32_16x16x32_bf16 v[40:43], v[200:203], a[76:79], v[40:43]
    s_nop 0
    v_mfma_f32_16x16x32_bf16 v[12:15], v[204:207], a[12:15], v[12:15]
    v_perm_b32 v208, v173, v169, s68
    v_perm_b32 v209, v181, v177, s68
    v_perm_b32 v210, v189, v185, s68
    v_perm_b32 v211, v197, v193, s68
    v_mfma_f32_16x16x32_bf16 v[44:47], v[204:207], a[76:79], v[44:47]
    s_nop 0
    v_mfma_f32_16x16x32_bf16 v[16:19], v[208:211], a[12:15], v[16:19]
    v_perm_b32 v212, v173, v169, s69
    v_perm_b32 v213, v181, v177, s69
    v_perm_b32 v214, v189, v185, s69
    v_perm_b32 v215, v197, v193, s69
    v_mfma_f32_16x16x32_bf16 v[48:51], v[208:211], a[76:79], v[48:51]
    s_nop 0
    v_mfma_f32_16x16x32_bf16 v[20:23], v[212:215], a[12:15], v[20:23]
    v_perm_b32 v216, v174, v170, s68
    v_perm_b32 v217, v182, v178, s68
    v_perm_b32 v218, v190, v186, s68
    v_perm_b32 v219, v198, v194, s68
    v_mfma_f32_16x16x32_bf16 v[52:55], v[212:215], a[76:79], v[52:55]
    s_nop 0
    v_mfma_f32_16x16x32_bf16 v[24:27], v[216:219], a[12:15], v[24:27]
    v_perm_b32 v220, v174, v170, s69
    v_perm_b32 v221, v182, v178, s69
    v_perm_b32 v222, v190, v186, s69
    v_perm_b32 v223, v198, v194, s69
    v_mfma_f32_16x16x32_bf16 v[56:59], v[216:219], a[76:79], v[56:59]
    s_nop 0
    v_mfma_f32_16x16x32_bf16 v[28:31], v[220:223], a[12:15], v[28:31]
    v_perm_b32 v224, v175, v171, s68
    v_perm_b32 v225, v183, v179, s68
    v_perm_b32 v226, v191, v187, s68
    v_perm_b32 v227, v199, v195, s68
    v_mfma_f32_16x16x32_bf16 v[60:63], v[220:223], a[76:79], v[60:63]
    s_nop 0
    v_mfma_f32_16x16x32_bf16 v[32:35], v[224:227], a[12:15], v[32:35]
    v_perm_b32 v228, v175, v171, s69
    v_perm_b32 v229, v183, v179, s69
    v_perm_b32 v230, v191, v187, s69
    v_perm_b32 v231, v199, v195, s69
    v_mfma_f32_16x16x32_bf16 v[64:67], v[224:227], a[76:79], v[64:67]
    s_nop 0
    v_mfma_f32_16x16x32_bf16 v[36:39], v[228:231], a[12:15], v[36:39]
    v_mfma_f32_16x16x32_bf16 v[68:71], v[228:231], a[76:79], v[68:71]
    s_waitcnt vmcnt(16)
    s_barrier
    ds_read_b128 v[136:139], v232 offset:32768
    ds_read_b128 v[140:143], v232 offset:33024
    ds_read_b128 v[144:147], v232 offset:33280
    ds_read_b128 v[148:151], v232 offset:33536
    ds_read_b128 v[152:155], v232 offset:33792
    ds_read_b128 v[156:159], v232 offset:34048
    ds_read_b128 v[160:163], v232 offset:34304
    ds_read_b128 v[164:167], v232 offset:34560
    s_waitcnt lgkmcnt(0)
    v_perm_b32 v200, v140, v136, s68
    v_perm_b32 v201, v148, v144, s68
    v_perm_b32 v202, v156, v152, s68
    v_perm_b32 v203, v164, v160, s68
    s_nop 1
    v_mfma_f32_16x16x32_bf16 v[8:11], v[200:203], a[16:19], v[8:11]
    v_perm_b32 v204, v140, v136, s69
    v_perm_b32 v205, v148, v144, s69
    v_perm_b32 v206, v156, v152, s69
    v_perm_b32 v207, v164, v160, s69
    v_mfma_f32_16x16x32_bf16 v[40:43], v[200:203], a[80:83], v[40:43]
    ds_read_b128 v[168:171], v232 offset:40960
    ds_read_b128 v[172:175], v232 offset:41216
    ds_read_b128 v[176:179], v232 offset:41472
    ds_read_b128 v[180:183], v232 offset:41728
    v_mfma_f32_16x16x32_bf16 v[12:15], v[204:207], a[16:19], v[12:15]
    v_perm_b32 v208, v141, v137, s68
    v_perm_b32 v209, v149, v145, s68
    v_perm_b32 v210, v157, v153, s68
    v_perm_b32 v211, v165, v161, s68
    v_mfma_f32_16x16x32_bf16 v[44:47], v[204:207], a[80:83], v[44:47]
    ds_read_b128 v[184:187], v232 offset:41984
    ds_read_b128 v[188:191], v232 offset:42240
    ds_read_b128 v[192:195], v232 offset:42496
    ds_read_b128 v[196:199], v232 offset:42752
    v_mfma_f32_16x16x32_bf16 v[16:19], v[208:211], a[16:19], v[16:19]
    v_perm_b32 v212, v141, v137, s69
    v_perm_b32 v213, v149, v145, s69
    v_perm_b32 v214, v157, v153, s69
    v_perm_b32 v215, v165, v161, s69
    v_mfma_f32_16x16x32_bf16 v[48:51], v[208:211], a[80:83], v[48:51]
    s_add_u32 m0, s39, 0
    s_add_u32 s38, s37, 0
    buffer_load_dwordx4 v7, s[32:35], s38 offen lds
    s_add_u32 m0, s39, 1024
    v_mfma_f32_16x16x32_bf16 v[20:23], v[212:215], a[16:19], v[20:23]
    v_perm_b32 v216, v142, v138, s68
    v_perm_b32 v217, v150, v146, s68
    v_perm_b32 v218, v158, v154, s68
    v_perm_b32 v219, v166, v162, s68
    v_mfma_f32_16x16x32_bf16 v[52:55], v[212:215], a[80:83], v[52:55]
    s_add_u32 s38, s37, 32768
    buffer_load_dwordx4 v7, s[32:35], s38 offen lds
    s_add_u32 m0, s39, 2048
    s_add_u32 s38, s37, 65536
    v_mfma_f32_16x16x32_bf16 v[24:27], v[216:219], a[16:19], v[24:27]
    v_perm_b32 v220, v142, v138, s69
    v_perm_b32 v221, v150, v146, s69
    v_perm_b32 v222, v158, v154, s69
    v_perm_b32 v223, v166, v162, s69
    v_mfma_f32_16x16x32_bf16 v[56:59], v[216:219], a[80:83], v[56:59]
    buffer_load_dwordx4 v7, s[32:35], s38 offen lds
    s_add_u32 m0, s39, 3072
    s_add_u32 s38, s37, 98304
    buffer_load_dwordx4 v7, s[32:35], s38 offen lds
    v_mfma_f32_16x16x32_bf16 v[28:31], v[220:223], a[16:19], v[28:31]
    v_perm_b32 v224, v143, v139, s68
    v_perm_b32 v225, v151, v147, s68
    v_perm_b32 v226, v159, v155, s68
    v_perm_b32 v227, v167, v163, s68
    v_mfma_f32_16x16x32_bf16 v[60:63], v[220:223], a[80:83], v[60:63]
    s_add_u32 m0, s39, 4096
    s_add_u32 s38, s37, 131072
    buffer_load_dwordx4 v7, s[32:35], s38 offen lds
    s_add_u32 m0, s39, 5120
    v_mfma_f32_16x16x32_bf16 v[32:35], v[224:227], a[16:19], v[32:35]
    v_perm_b32 v228, v143, v139, s69
    v_perm_b32 v229, v151, v147, s69
    v_perm_b32 v230, v159, v155, s69
    v_perm_b32 v231, v167, v163, s69
    v_mfma_f32_16x16x32_bf16 v[64:67], v[224:227], a[80:83], v[64:67]
    s_add_u32 s38, s37, 163840
    buffer_load_dwordx4 v7, s[32:35], s38 offen lds
    s_add_u32 m0, s39, 6144
    s_add_u32 s38, s37, 196608
    v_mfma_f32_16x16x32_bf16 v[36:39], v[228:231], a[16:19], v[36:39]
    buffer_load_dwordx4 v7, s[32:35], s38 offen lds
    s_add_u32 m0, s39, 7168
    s_add_u32 s38, s37, 229376
    buffer_load_dwordx4 v7, s[32:35], s38 offen lds
    v_mfma_f32_16x16x32_bf16 v[68:71], v[228:231], a[80:83], v[68:71]
    s_waitcnt lgkmcnt(0)
    v_perm_b32 v200, v172, v168, s68
    v_perm_b32 v201, v180, v176, s68
    v_perm_b32 v202, v188, v184, s68
    v_perm_b32 v203, v196, v192, s68
    s_nop 1
    v_mfma_f32_16x16x32_bf16 v[8:11], v[200:203], a[20:23], v[8:11]
    v_perm_b32 v204, v172, v168, s69
    v_perm_b32 v205, v180, v176, s69
    v_perm_b32 v206, v188, v184, s69
    v_perm_b32 v207, v196, v192, s69
    v_mfma_f32_16x16x32_bf16 v[40:43], v[200:203], a[84:87], v[40:43]
    ds_read_b128 v[136:139], v232 offset:49152
    ds_read_b128 v[140:143], v232 offset:49408
    ds_read_b128 v[144:147], v232 offset:49664
    ds_read_b128 v[148:151], v232 offset:49920
    v_mfma_f32_16x16x32_bf16 v[12:15], v[204:207], a[20:23], v[12:15]
    v_perm_b32 v208, v173, v169, s68
    v_perm_b32 v209, v181, v177, s68
    v_perm_b32 v210, v189, v185, s68
    v_perm_b32 v211, v197, v193, s68
    v_mfma_f32_16x16x32_bf16 v[44:47], v[204:207], a[84:87], v[44:47]
    ds_read_b128 v[152:155], v232 offset:50176
    ds_read_b128 v[156:159], v232 offset:50432
    ds_read_b128 v[160:163], v232 offset:50688
    ds_read_b128 v[164:167], v232 offset:50944
    v_mfma_f32_16x16x32_bf16 v[16:19], v[208:211], a[20:23], v[16:19]
    v_perm_b32 v212, v173, v169, s69
    v_perm_b32 v213, v181, v177, s69
    v_perm_b32 v214, v189, v185, s69
    v_perm_b32 v215, v197, v193, s69
    v_mfma_f32_16x16x32_bf16 v[48:51], v[208:211], a[84:87], v[48:51]
    s_nop 0
    v_mfma_f32_16x16x32_bf16 v[20:23], v[212:215], a[20:23], v[20:23]
    v_perm_b32 v216, v174, v170, s68
    v_perm_b32 v217, v182, v178, s68
    v_perm_b32 v218, v190, v186, s68
    v_perm_b32 v219, v198, v194, s68
    v_mfma_f32_16x16x32_bf16 v[52:55], v[212:215], a[84:87], v[52:55]
    s_nop 0
    v_mfma_f32_16x16x32_bf16 v[24:27], v[216:219], a[20:23], v[24:27]
    v_perm_b32 v220, v174, v170, s69
    v_perm_b32 v221, v182, v178, s69
    v_perm_b32 v222, v190, v186, s69
    v_perm_b32 v223, v198, v194, s69
    v_mfma_f32_16x16x32_bf16 v[56:59], v[216:219], a[84:87], v[56:59]
    s_nop 0
    v_mfma_f32_16x16x32_bf16 v[28:31], v[220:223], a[20:23], v[28:31]
    v_perm_b32 v224, v175, v171, s68
    v_perm_b32 v225, v183, v179, s68
    v_perm_b32 v226, v191, v187, s68
    v_perm_b32 v227, v199, v195, s68
    v_mfma_f32_16x16x32_bf16 v[60:63], v[220:223], a[84:87], v[60:63]
    s_nop 0
    v_mfma_f32_16x16x32_bf16 v[32:35], v[224:227], a[20:23], v[32:35]
    v_perm_b32 v228, v175, v171, s69
    v_perm_b32 v229, v183, v179, s69
    v_perm_b32 v230, v191, v187, s69
    v_perm_b32 v231, v199, v195, s69
    v_mfma_f32_16x16x32_bf16 v[64:67], v[224:227], a[84:87], v[64:67]
    s_nop 0
    v_mfma_f32_16x16x32_bf16 v[36:39], v[228:231], a[20:23], v[36:39]
    v_mfma_f32_16x16x32_bf16 v[68:71], v[228:231], a[84:87], v[68:71]
    s_waitcnt lgkmcnt(0)
    v_perm_b32 v200, v140, v136, s68
    v_perm_b32 v201, v148, v144, s68
    v_perm_b32 v202, v156, v152, s68
    v_perm_b32 v203, v164, v160, s68
    s_nop 1
    v_mfma_f32_16x16x32_bf16 v[8:11], v[200:203], a[24:27], v[8:11]
    v_perm_b32 v204, v140, v136, s69
    v_perm_b32 v205, v148, v144, s69
    v_perm_b32 v206, v156, v152, s69
    v_perm_b32 v207, v164, v160, s69
    v_mfma_f32_16x16x32_bf16 v[40:43], v[200:203], a[88:91], v[40:43]
    ds_read_b128 v[168:171], v232 offset:57344
    ds_read_b128 v[172:175], v232 offset:57600
    ds_read_b128 v[176:179], v232 offset:57856
    ds_read_b128 v[180:183], v232 offset:58112
    v_mfma_f32_16x16x32_bf16 v[12:15], v[204:207], a[24:27], v[12:15]
    v_perm_b32 v208, v141, v137, s68
    v_perm_b32 v209, v149, v145, s68
    v_perm_b32 v210, v157, v153, s68
    v_perm_b32 v211, v165, v161, s68
    v_mfma_f32_16x16x32_bf16 v[44:47], v[204:207], a[88:91], v[44:47]
    ds_read_b128 v[184:187], v232 offset:58368
    ds_read_b128 v[188:191], v232 offset:58624
    ds_read_b128 v[192:195], v232 offset:58880
    ds_read_b128 v[196:199], v232 offset:59136
    v_mfma_f32_16x16x32_bf16 v[16:19], v[208:211], a[24:27], v[16:19]
    v_perm_b32 v212, v141, v137, s69
    v_perm_b32 v213, v149, v145, s69
    v_perm_b32 v214, v157, v153, s69
    v_perm_b32 v215, v165, v161, s69
    v_mfma_f32_16x16x32_bf16 v[48:51], v[208:211], a[88:91], v[48:51]
    s_nop 0
    v_mfma_f32_16x16x32_bf16 v[20:23], v[212:215], a[24:27], v[20:23]
    v_perm_b32 v216, v142, v138, s68
    v_perm_b32 v217, v150, v146, s68
    v_perm_b32 v218, v158, v154, s68
    v_perm_b32 v219, v166, v162, s68
    v_mfma_f32_16x16x32_bf16 v[52:55], v[212:215], a[88:91], v[52:55]
    s_nop 0
    v_mfma_f32_16x16x32_bf16 v[24:27], v[216:219], a[24:27], v[24:27]
    v_perm_b32 v220, v142, v138, s69
    v_perm_b32 v221, v150, v146, s69
    v_perm_b32 v222, v158, v154, s69
    v_perm_b32 v223, v166, v162, s69
    v_mfma_f32_16x16x32_bf16 v[56:59], v[216:219], a[88:91], v[56:59]
    s_nop 0
    v_mfma_f32_16x16x32_bf16 v[28:31], v[220:223], a[24:27], v[28:31]
    v_perm_b32 v224, v143, v139, s68
    v_perm_b32 v225, v151, v147, s68
    v_perm_b32 v226, v159, v155, s68
    v_perm_b32 v227, v167, v163, s68
    v_mfma_f32_16x16x32_bf16 v[60:63], v[220:223], a[88:91], v[60:63]
    s_nop 0
    v_mfma_f32_16x16x32_bf16 v[32:35], v[224:227], a[24:27], v[32:35]
    v_perm_b32 v228, v143, v139, s69
    v_perm_b32 v229, v151, v147, s69
    v_perm_b32 v230, v159, v155, s69
    v_perm_b32 v231, v167, v163, s69
    v_mfma_f32_16x16x32_bf16 v[64:67], v[224:227], a[88:91], v[64:67]
    s_nop 0
    v_mfma_f32_16x16x32_bf16 v[36:39], v[228:231], a[24:27], v[36:39]
    v_mfma_f32_16x16x32_bf16 v[68:71], v[228:231], a[88:91], v[68:71]
    s_waitcnt lgkmcnt(0)
    v_perm_b32 v200, v172, v168, s68
    v_perm_b32 v201, v180, v176, s68
    v_perm_b32 v202, v188, v184, s68
    v_perm_b32 v203, v196, v192, s68
    s_nop 1
    v_mfma_f32_16x16x32_bf16 v[8:11], v[200:203], a[28:31], v[8:11]
    v_perm_b32 v204, v172, v168, s69
    v_perm_b32 v205, v180, v176, s69
    v_perm_b32 v206, v188, v184, s69
    v_perm_b32 v207, v196, v192, s69
    v_mfma_f32_16x16x32_bf16 v[40:43], v[200:203], a[92:95], v[40:43]
    s_nop 0
    v_mfma_f32_16x16x32_bf16 v[12:15], v[204:207], a[28:31], v[12:15]
    v_perm_b32 v208, v173, v169, s68
    v_perm_b32 v209, v181, v177, s68
    v_perm_b32 v210, v189, v185, s68
    v_perm_b32 v211, v197, v193, s68
    v_mfma_f32_16x16x32_bf16 v[44:47], v[204:207], a[92:95], v[44:47]
    s_nop 0
    v_mfma_f32_16x16x32_bf16 v[16:19], v[208:211], a[28:31], v[16:19]
    v_perm_b32 v212, v173, v169, s69
    v_perm_b32 v213, v181, v177, s69
    v_perm_b32 v214, v189, v185, s69
    v_perm_b32 v215, v197, v193, s69
    v_mfma_f32_16x16x32_bf16 v[48:51], v[208:211], a[92:95], v[48:51]
    s_nop 0
    v_mfma_f32_16x16x32_bf16 v[20:23], v[212:215], a[28:31], v[20:23]
    v_perm_b32 v216, v174, v170, s68
    v_perm_b32 v217, v182, v178, s68
    v_perm_b32 v218, v190, v186, s68
    v_perm_b32 v219, v198, v194, s68
    v_mfma_f32_16x16x32_bf16 v[52:55], v[212:215], a[92:95], v[52:55]
    s_nop 0
    v_mfma_f32_16x16x32_bf16 v[24:27], v[216:219], a[28:31], v[24:27]
    v_perm_b32 v220, v174, v170, s69
    v_perm_b32 v221, v182, v178, s69
    v_perm_b32 v222, v190, v186, s69
    v_perm_b32 v223, v198, v194, s69
    v_mfma_f32_16x16x32_bf16 v[56:59], v[216:219], a[92:95], v[56:59]
    s_nop 0
    v_mfma_f32_16x16x32_bf16 v[28:31], v[220:223], a[28:31], v[28:31]
    v_perm_b32 v224, v175, v171, s68
    v_perm_b32 v225, v183, v179, s68
    v_perm_b32 v226, v191, v187, s68
    v_perm_b32 v227, v199, v195, s68
    v_mfma_f32_16x16x32_bf16 v[60:63], v[220:223], a[92:95], v[60:63]
    s_nop 0
    v_mfma_f32_16x16x32_bf16 v[32:35], v[224:227], a[28:31], v[32:35]
    v_perm_b32 v228, v175, v171, s69
    v_perm_b32 v229, v183, v179, s69
    v_perm_b32 v230, v191, v187, s69
    v_perm_b32 v231, v199, v195, s69
    v_mfma_f32_16x16x32_bf16 v[64:67], v[224:227], a[92:95], v[64:67]
    s_nop 0
    v_mfma_f32_16x16x32_bf16 v[36:39], v[228:231], a[28:31], v[36:39]
    v_mfma_f32_16x16x32_bf16 v[68:71], v[228:231], a[92:95], v[68:71]
    s_waitcnt vmcnt(16)
    s_barrier
    ds_read_b128 v[136:139], v233 offset:0
    ds_read_b128 v[140:143], v233 offset:256
    ds_read_b128 v[144:147], v233 offset:512
    ds_read_b128 v[148:151], v233 offset:768
    ds_read_b128 v[152:155], v233 offset:1024
    ds_read_b128 v[156:159], v233 offset:1280
    ds_read_b128 v[160:163], v233 offset:1536
    ds_read_b128 v[164:167], v233 offset:1792
    s_waitcnt lgkmcnt(0)
    v_perm_b32 v200, v140, v136, s68
    v_perm_b32 v201, v148, v144, s68
    v_perm_b32 v202, v156, v152, s68
    v_perm_b32 v203, v164, v160, s68
    s_nop 1
    v_mfma_f32_16x16x32_bf16 v[8:11], v[200:203], a[32:35], v[8:11]
    v_perm_b32 v204, v140, v136, s69
    v_perm_b32 v205, v148, v144, s69
    v_perm_b32 v206, v156, v152, s69
    v_perm_b32 v207, v164, v160, s69
    v_mfma_f32_16x16x32_bf16 v[40:43], v[200:203], a[96:99], v[40:43]
    ds_read_b128 v[168:171], v233 offset:8192
    ds_read_b128 v[172:175], v233 offset:8448
    ds_read_b128 v[176:179], v233 offset:8704
    ds_read_b128 v[180:183], v233 offset:8960
    v_mfma_f32_16x16x32_bf16 v[12:15], v[204:207], a[32:35], v[12:15]
    v_perm_b32 v208, v141, v137, s68
    v_perm_b32 v209, v149, v145, s68
    v_perm_b32 v210, v157, v153, s68
    v_perm_b32 v211, v165, v161, s68
    v_mfma_f32_16x16x32_bf16 v[44:47], v[204:207], a[96:99], v[44:47]
    ds_read_b128 v[184:187], v233 offset:9216
    ds_read_b128 v[188:191], v233 offset:9472
    ds_read_b128 v[192:195], v233 offset:9728
    ds_read_b128 v[196:199], v233 offset:9984
    v_mfma_f32_16x16x32_bf16 v[16:19], v[208:211], a[32:35], v[16:19]
    v_perm_b32 v212, v141, v137, s69
    v_perm_b32 v213, v149, v145, s69
    v_perm_b32 v214, v157, v153, s69
    v_perm_b32 v215, v165, v161, s69
    v_mfma_f32_16x16x32_bf16 v[48:51], v[208:211], a[96:99], v[48:51]
    s_add_u32 m0, s39, 32768
    s_add_u32 s38, s37, 1048576
    buffer_load_dwordx4 v7, s[32:35], s38 offen lds
    s_add_u32 m0, s39, 33792
    v_mfma_f32_16x16x32_bf16 v[20:23], v[212:215], a[32:35], v[20:23]
    v_perm_b32 v216, v142, v138, s68
    v_perm_b32 v217, v150, v146, s68
    v_perm_b32 v218, v158, v154, s68
    v_perm_b32 v219, v166, v162, s68
    v_mfma_f32_16x16x32_bf16 v[52:55], v[212:215], a[96:99], v[52:55]
    s_add_u32 s38, s37, 1081344
    buffer_load_dwordx4 v7, s[32:35], s38 offen lds
    s_add_u32 m0, s39, 34816
    s_add_u32 s38, s37, 1114112
    v_mfma_f32_16x16x32_bf16 v[24:27], v[216:219], a[32:35], v[24:27]
    v_perm_b32 v220, v142, v138, s69
    v_perm_b32 v221, v150, v146, s69
    v_perm_b32 v222, v158, v154, s69
    v_perm_b32 v223, v166, v162, s69
    v_mfma_f32_16x16x32_bf16 v[56:59], v[216:219], a[96:99], v[56:59]
    buffer_load_dwordx4 v7, s[32:35], s38 offen lds
    s_add_u32 m0, s39, 35840
    s_add_u32 s38, s37, 1146880
    buffer_load_dwordx4 v7, s[32:35], s38 offen lds
    v_mfma_f32_16x16x32_bf16 v[28:31], v[220:223], a[32:35], v[28:31]
    v_perm_b32 v224, v143, v139, s68
    v_perm_b32 v225, v151, v147, s68
    v_perm_b32 v226, v159, v155, s68
    v_perm_b32 v227, v167, v163, s68
    v_mfma_f32_16x16x32_bf16 v[60:63], v[220:223], a[96:99], v[60:63]
    s_add_u32 m0, s39, 36864
    s_add_u32 s38, s37, 1179648
    buffer_load_dwordx4 v7, s[32:35], s38 offen lds
    s_add_u32 m0, s39, 37888
    v_mfma_f32_16x16x32_bf16 v[32:35], v[224:227], a[32:35], v[32:35]
    v_perm_b32 v228, v143, v139, s69
    v_perm_b32 v229, v151, v147, s69
    v_perm_b32 v230, v159, v155, s69
    v_perm_b32 v231, v167, v163, s69
    v_mfma_f32_16x16x32_bf16 v[64:67], v[224:227], a[96:99], v[64:67]
    s_add_u32 s38, s37, 1212416
    buffer_load_dwordx4 v7, s[32:35], s38 offen lds
    s_add_u32 m0, s39, 38912
    s_add_u32 s38, s37, 1245184
    v_mfma_f32_16x16x32_bf16 v[36:39], v[228:231], a[32:35], v[36:39]
    buffer_load_dwordx4 v7, s[32:35], s38 offen lds
    s_add_u32 m0, s39, 39936
    s_add_u32 s38, s37, 1277952
    buffer_load_dwordx4 v7, s[32:35], s38 offen lds
    v_mfma_f32_16x16x32_bf16 v[68:71], v[228:231], a[96:99], v[68:71]
    s_waitcnt lgkmcnt(0)
    v_perm_b32 v200, v172, v168, s68
    v_perm_b32 v201, v180, v176, s68
    v_perm_b32 v202, v188, v184, s68
    v_perm_b32 v203, v196, v192, s68
    s_nop 1
    v_mfma_f32_16x16x32_bf16 v[8:11], v[200:203], a[36:39], v[8:11]
    v_perm_b32 v204, v172, v168, s69
    v_perm_b32 v205, v180, v176, s69
    v_perm_b32 v206, v188, v184, s69
    v_perm_b32 v207, v196, v192, s69
    v_mfma_f32_16x16x32_bf16 v[40:43], v[200:203], a[100:103], v[40:43]
    ds_read_b128 v[136:139], v233 offset:16384
    ds_read_b128 v[140:143], v233 offset:16640
    ds_read_b128 v[144:147], v233 offset:16896
    ds_read_b128 v[148:151], v233 offset:17152
    v_mfma_f32_16x16x32_bf16 v[12:15], v[204:207], a[36:39], v[12:15]
    v_perm_b32 v208, v173, v169, s68
    v_perm_b32 v209, v181, v177, s68
    v_perm_b32 v210, v189, v185, s68
    v_perm_b32 v211, v197, v193, s68
    v_mfma_f32_16x16x32_bf16 v[44:47], v[204:207], a[100:103], v[44:47]
    ds_read_b128 v[152:155], v233 offset:17408
    ds_read_b128 v[156:159], v233 offset:17664
    ds_read_b128 v[160:163], v233 offset:17920
    ds_read_b128 v[164:167], v233 offset:18176
    v_mfma_f32_16x16x32_bf16 v[16:19], v[208:211], a[36:39], v[16:19]
    v_perm_b32 v212, v173, v169, s69
    v_perm_b32 v213, v181, v177, s69
    v_perm_b32 v214, v189, v185, s69
    v_perm_b32 v215, v197, v193, s69
    v_mfma_f32_16x16x32_bf16 v[48:51], v[208:211], a[100:103], v[48:51]
    s_nop 0
    v_mfma_f32_16x16x32_bf16 v[20:23], v[212:215], a[36:39], v[20:23]
    v_perm_b32 v216, v174, v170, s68
    v_perm_b32 v217, v182, v178, s68
    v_perm_b32 v218, v190, v186, s68
    v_perm_b32 v219, v198, v194, s68
    v_mfma_f32_16x16x32_bf16 v[52:55], v[212:215], a[100:103], v[52:55]
    s_nop 0
    v_mfma_f32_16x16x32_bf16 v[24:27], v[216:219], a[36:39], v[24:27]
    v_perm_b32 v220, v174, v170, s69
    v_perm_b32 v221, v182, v178, s69
    v_perm_b32 v222, v190, v186, s69
    v_perm_b32 v223, v198, v194, s69
    v_mfma_f32_16x16x32_bf16 v[56:59], v[216:219], a[100:103], v[56:59]
    s_nop 0
    v_mfma_f32_16x16x32_bf16 v[28:31], v[220:223], a[36:39], v[28:31]
    v_perm_b32 v224, v175, v171, s68
    v_perm_b32 v225, v183, v179, s68
    v_perm_b32 v226, v191, v187, s68
    v_perm_b32 v227, v199, v195, s68
    v_mfma_f32_16x16x32_bf16 v[60:63], v[220:223], a[100:103], v[60:63]
    s_nop 0
    v_mfma_f32_16x16x32_bf16 v[32:35], v[224:227], a[36:39], v[32:35]
    v_perm_b32 v228, v175, v171, s69
    v_perm_b32 v229, v183, v179, s69
    v_perm_b32 v230, v191, v187, s69
    v_perm_b32 v231, v199, v195, s69
    v_mfma_f32_16x16x32_bf16 v[64:67], v[224:227], a[100:103], v[64:67]
    s_nop 0
    v_mfma_f32_16x16x32_bf16 v[36:39], v[228:231], a[36:39], v[36:39]
    v_mfma_f32_16x16x32_bf16 v[68:71], v[228:231], a[100:103], v[68:71]
    s_waitcnt lgkmcnt(0)
    v_perm_b32 v200, v140, v136, s68
    v_perm_b32 v201, v148, v144, s68
    v_perm_b32 v202, v156, v152, s68
    v_perm_b32 v203, v164, v160, s68
    s_nop 1
    v_mfma_f32_16x16x32_bf16 v[8:11], v[200:203], a[40:43], v[8:11]
    v_perm_b32 v204, v140, v136, s69
    v_perm_b32 v205, v148, v144, s69
    v_perm_b32 v206, v156, v152, s69
    v_perm_b32 v207, v164, v160, s69
    v_mfma_f32_16x16x32_bf16 v[40:43], v[200:203], a[104:107], v[40:43]
    ds_read_b128 v[168:171], v233 offset:24576
    ds_read_b128 v[172:175], v233 offset:24832
    ds_read_b128 v[176:179], v233 offset:25088
    ds_read_b128 v[180:183], v233 offset:25344
    v_mfma_f32_16x16x32_bf16 v[12:15], v[204:207], a[40:43], v[12:15]
    v_perm_b32 v208, v141, v137, s68
    v_perm_b32 v209, v149, v145, s68
    v_perm_b32 v210, v157, v153, s68
    v_perm_b32 v211, v165, v161, s68
    v_mfma_f32_16x16x32_bf16 v[44:47], v[204:207], a[104:107], v[44:47]
    ds_read_b128 v[184:187], v233 offset:25600
    ds_read_b128 v[188:191], v233 offset:25856
    ds_read_b128 v[192:195], v233 offset:26112
    ds_read_b128 v[196:199], v233 offset:26368
    v_mfma_f32_16x16x32_bf16 v[16:19], v[208:211], a[40:43], v[16:19]
    v_perm_b32 v212, v141, v137, s69
    v_perm_b32 v213, v149, v145, s69
    v_perm_b32 v214, v157, v153, s69
    v_perm_b32 v215, v165, v161, s69
    v_mfma_f32_16x16x32_bf16 v[48:51], v[208:211], a[104:107], v[48:51]
    s_nop 0
    v_mfma_f32_16x16x32_bf16 v[20:23], v[212:215], a[40:43], v[20:23]
    v_perm_b32 v216, v142, v138, s68
    v_perm_b32 v217, v150, v146, s68
    v_perm_b32 v218, v158, v154, s68
    v_perm_b32 v219, v166, v162, s68
    v_mfma_f32_16x16x32_bf16 v[52:55], v[212:215], a[104:107], v[52:55]
    s_nop 0
    v_mfma_f32_16x16x32_bf16 v[24:27], v[216:219], a[40:43], v[24:27]
    v_perm_b32 v220, v142, v138, s69
    v_perm_b32 v221, v150, v146, s69
    v_perm_b32 v222, v158, v154, s69
    v_perm_b32 v223, v166, v162, s69
    v_mfma_f32_16x16x32_bf16 v[56:59], v[216:219], a[104:107], v[56:59]
    s_nop 0
    v_mfma_f32_16x16x32_bf16 v[28:31], v[220:223], a[40:43], v[28:31]
    v_perm_b32 v224, v143, v139, s68
    v_perm_b32 v225, v151, v147, s68
    v_perm_b32 v226, v159, v155, s68
    v_perm_b32 v227, v167, v163, s68
    v_mfma_f32_16x16x32_bf16 v[60:63], v[220:223], a[104:107], v[60:63]
    s_nop 0
    v_mfma_f32_16x16x32_bf16 v[32:35], v[224:227], a[40:43], v[32:35]
    v_perm_b32 v228, v143, v139, s69
    v_perm_b32 v229, v151, v147, s69
    v_perm_b32 v230, v159, v155, s69
    v_perm_b32 v231, v167, v163, s69
    v_mfma_f32_16x16x32_bf16 v[64:67], v[224:227], a[104:107], v[64:67]
    s_nop 0
    v_mfma_f32_16x16x32_bf16 v[36:39], v[228:231], a[40:43], v[36:39]
    v_mfma_f32_16x16x32_bf16 v[68:71], v[228:231], a[104:107], v[68:71]
    s_waitcnt lgkmcnt(0)
    v_perm_b32 v200, v172, v168, s68
    v_perm_b32 v201, v180, v176, s68
    v_perm_b32 v202, v188, v184, s68
    v_perm_b32 v203, v196, v192, s68
    s_nop 1
    v_mfma_f32_16x16x32_bf16 v[8:11], v[200:203], a[44:47], v[8:11]
    v_perm_b32 v204, v172, v168, s69
    v_perm_b32 v205, v180, v176, s69
    v_perm_b32 v206, v188, v184, s69
    v_perm_b32 v207, v196, v192, s69
    v_mfma_f32_16x16x32_bf16 v[40:43], v[200:203], a[108:111], v[40:43]
    s_nop 0
    v_mfma_f32_16x16x32_bf16 v[12:15], v[204:207], a[44:47], v[12:15]
    v_perm_b32 v208, v173, v169, s68
    v_perm_b32 v209, v181, v177, s68
    v_perm_b32 v210, v189, v185, s68
    v_perm_b32 v211, v197, v193, s68
    v_mfma_f32_16x16x32_bf16 v[44:47], v[204:207], a[108:111], v[44:47]
    s_nop 0
    v_mfma_f32_16x16x32_bf16 v[16:19], v[208:211], a[44:47], v[16:19]
    v_perm_b32 v212, v173, v169, s69
    v_perm_b32 v213, v181, v177, s69
    v_perm_b32 v214, v189, v185, s69
    v_perm_b32 v215, v197, v193, s69
    v_mfma_f32_16x16x32_bf16 v[48:51], v[208:211], a[108:111], v[48:51]
    s_nop 0
    v_mfma_f32_16x16x32_bf16 v[20:23], v[212:215], a[44:47], v[20:23]
    v_perm_b32 v216, v174, v170, s68
    v_perm_b32 v217, v182, v178, s68
    v_perm_b32 v218, v190, v186, s68
    v_perm_b32 v219, v198, v194, s68
    v_mfma_f32_16x16x32_bf16 v[52:55], v[212:215], a[108:111], v[52:55]
    s_nop 0
    v_mfma_f32_16x16x32_bf16 v[24:27], v[216:219], a[44:47], v[24:27]
    v_perm_b32 v220, v174, v170, s69
    v_perm_b32 v221, v182, v178, s69
    v_perm_b32 v222, v190, v186, s69
    v_perm_b32 v223, v198, v194, s69
    v_mfma_f32_16x16x32_bf16 v[56:59], v[216:219], a[108:111], v[56:59]
    s_nop 0
    v_mfma_f32_16x16x32_bf16 v[28:31], v[220:223], a[44:47], v[28:31]
    v_perm_b32 v224, v175, v171, s68
    v_perm_b32 v225, v183, v179, s68
    v_perm_b32 v226, v191, v187, s68
    v_perm_b32 v227, v199, v195, s68
    v_mfma_f32_16x16x32_bf16 v[60:63], v[220:223], a[108:111], v[60:63]
    s_nop 0
    v_mfma_f32_16x16x32_bf16 v[32:35], v[224:227], a[44:47], v[32:35]
    v_perm_b32 v228, v175, v171, s69
    v_perm_b32 v229, v183, v179, s69
    v_perm_b32 v230, v191, v187, s69
    v_perm_b32 v231, v199, v195, s69
    v_mfma_f32_16x16x32_bf16 v[64:67], v[224:227], a[108:111], v[64:67]
    s_nop 0
    v_mfma_f32_16x16x32_bf16 v[36:39], v[228:231], a[44:47], v[36:39]
    v_mfma_f32_16x16x32_bf16 v[68:71], v[228:231], a[108:111], v[68:71]
    s_waitcnt vmcnt(16)
    s_barrier
    ds_read_b128 v[136:139], v233 offset:32768
    ds_read_b128 v[140:143], v233 offset:33024
    ds_read_b128 v[144:147], v233 offset:33280
    ds_read_b128 v[148:151], v233 offset:33536
    ds_read_b128 v[152:155], v233 offset:33792
    ds_read_b128 v[156:159], v233 offset:34048
    ds_read_b128 v[160:163], v233 offset:34304
    ds_read_b128 v[164:167], v233 offset:34560
    s_waitcnt lgkmcnt(0)
    v_perm_b32 v200, v140, v136, s68
    v_perm_b32 v201, v148, v144, s68
    v_perm_b32 v202, v156, v152, s68
    v_perm_b32 v203, v164, v160, s68
    s_nop 1
    v_mfma_f32_16x16x32_bf16 v[8:11], v[200:203], a[48:51], v[8:11]
    v_perm_b32 v204, v140, v136, s69
    v_perm_b32 v205, v148, v144, s69
    v_perm_b32 v206, v156, v152, s69
    v_perm_b32 v207, v164, v160, s69
    v_mfma_f32_16x16x32_bf16 v[40:43], v[200:203], a[112:115], v[40:43]
    ds_read_b128 v[168:171], v233 offset:40960
    ds_read_b128 v[172:175], v233 offset:41216
    ds_read_b128 v[176:179], v233 offset:41472
    ds_read_b128 v[180:183], v233 offset:41728
    v_mfma_f32_16x16x32_bf16 v[12:15], v[204:207], a[48:51], v[12:15]
    v_perm_b32 v208, v141, v137, s68
    v_perm_b32 v209, v149, v145, s68
    v_perm_b32 v210, v157, v153, s68
    v_perm_b32 v211, v165, v161, s68
    v_mfma_f32_16x16x32_bf16 v[44:47], v[204:207], a[112:115], v[44:47]
    ds_read_b128 v[184:187], v233 offset:41984
    ds_read_b128 v[188:191], v233 offset:42240
    ds_read_b128 v[192:195], v233 offset:42496
    ds_read_b128 v[196:199], v233 offset:42752
    v_mfma_f32_16x16x32_bf16 v[16:19], v[208:211], a[48:51], v[16:19]
    v_perm_b32 v212, v141, v137, s69
    v_perm_b32 v213, v149, v145, s69
    v_perm_b32 v214, v157, v153, s69
    v_perm_b32 v215, v165, v161, s69
    v_mfma_f32_16x16x32_bf16 v[48:51], v[208:211], a[112:115], v[48:51]
    s_add_u32 m0, s39, 65536
    s_add_u32 s38, s37, 2097152
    buffer_load_dwordx4 v7, s[32:35], s38 offen lds
    s_add_u32 m0, s39, 66560
    v_mfma_f32_16x16x32_bf16 v[20:23], v[212:215], a[48:51], v[20:23]
    v_perm_b32 v216, v142, v138, s68
    v_perm_b32 v217, v150, v146, s68
    v_perm_b32 v218, v158, v154, s68
    v_perm_b32 v219, v166, v162, s68
    v_mfma_f32_16x16x32_bf16 v[52:55], v[212:215], a[112:115], v[52:55]
    s_add_u32 s38, s37, 2129920
    buffer_load_dwordx4 v7, s[32:35], s38 offen lds
    s_add_u32 m0, s39, 67584
    s_add_u32 s38, s37, 2162688
    v_mfma_f32_16x16x32_bf16 v[24:27], v[216:219], a[48:51], v[24:27]
    v_perm_b32 v220, v142, v138, s69
    v_perm_b32 v221, v150, v146, s69
    v_perm_b32 v222, v158, v154, s69
    v_perm_b32 v223, v166, v162, s69
    v_mfma_f32_16x16x32_bf16 v[56:59], v[216:219], a[112:115], v[56:59]
    buffer_load_dwordx4 v7, s[32:35], s38 offen lds
    s_add_u32 m0, s39, 68608
    s_add_u32 s38, s37, 2195456
    buffer_load_dwordx4 v7, s[32:35], s38 offen lds
    v_mfma_f32_16x16x32_bf16 v[28:31], v[220:223], a[48:51], v[28:31]
    v_perm_b32 v224, v143, v139, s68
    v_perm_b32 v225, v151, v147, s68
    v_perm_b32 v226, v159, v155, s68
    v_perm_b32 v227, v167, v163, s68
    v_mfma_f32_16x16x32_bf16 v[60:63], v[220:223], a[112:115], v[60:63]
    s_add_u32 m0, s39, 69632
    s_add_u32 s38, s37, 2228224
    buffer_load_dwordx4 v7, s[32:35], s38 offen lds
    s_add_u32 m0, s39, 70656
    v_mfma_f32_16x16x32_bf16 v[32:35], v[224:227], a[48:51], v[32:35]
    v_perm_b32 v228, v143, v139, s69
    v_perm_b32 v229, v151, v147, s69
    v_perm_b32 v230, v159, v155, s69
    v_perm_b32 v231, v167, v163, s69
    v_mfma_f32_16x16x32_bf16 v[64:67], v[224:227], a[112:115], v[64:67]
    s_add_u32 s38, s37, 2260992
    buffer_load_dwordx4 v7, s[32:35], s38 offen lds
    s_add_u32 m0, s39, 71680
    s_add_u32 s38, s37, 2293760
    v_mfma_f32_16x16x32_bf16 v[36:39], v[228:231], a[48:51], v[36:39]
    buffer_load_dwordx4 v7, s[32:35], s38 offen lds
    s_add_u32 m0, s39, 72704
    s_add_u32 s38, s37, 2326528
    buffer_load_dwordx4 v7, s[32:35], s38 offen lds
    v_mfma_f32_16x16x32_bf16 v[68:71], v[228:231], a[112:115], v[68:71]
    s_waitcnt lgkmcnt(0)
    v_perm_b32 v200, v172, v168, s68
    v_perm_b32 v201, v180, v176, s68
    v_perm_b32 v202, v188, v184, s68
    v_perm_b32 v203, v196, v192, s68
    s_nop 1
    v_mfma_f32_16x16x32_bf16 v[8:11], v[200:203], a[52:55], v[8:11]
    v_perm_b32 v204, v172, v168, s69
    v_perm_b32 v205, v180, v176, s69
    v_perm_b32 v206, v188, v184, s69
    v_perm_b32 v207, v196, v192, s69
    v_mfma_f32_16x16x32_bf16 v[40:43], v[200:203], a[116:119], v[40:43]
    ds_read_b128 v[136:139], v233 offset:49152
    ds_read_b128 v[140:143], v233 offset:49408
    ds_read_b128 v[144:147], v233 offset:49664
    ds_read_b128 v[148:151], v233 offset:49920
    v_mfma_f32_16x16x32_bf16 v[12:15], v[204:207], a[52:55], v[12:15]
    v_perm_b32 v208, v173, v169, s68
    v_perm_b32 v209, v181, v177, s68
    v_perm_b32 v210, v189, v185, s68
    v_perm_b32 v211, v197, v193, s68
    v_mfma_f32_16x16x32_bf16 v[44:47], v[204:207], a[116:119], v[44:47]
    ds_read_b128 v[152:155], v233 offset:50176
    ds_read_b128 v[156:159], v233 offset:50432
    ds_read_b128 v[160:163], v233 offset:50688
    ds_read_b128 v[164:167], v233 offset:50944
    v_mfma_f32_16x16x32_bf16 v[16:19], v[208:211], a[52:55], v[16:19]
    v_perm_b32 v212, v173, v169, s69
    v_perm_b32 v213, v181, v177, s69
    v_perm_b32 v214, v189, v185, s69
    v_perm_b32 v215, v197, v193, s69
    v_mfma_f32_16x16x32_bf16 v[48:51], v[208:211], a[116:119], v[48:51]
    s_nop 0
    v_mfma_f32_16x16x32_bf16 v[20:23], v[212:215], a[52:55], v[20:23]
    v_perm_b32 v216, v174, v170, s68
    v_perm_b32 v217, v182, v178, s68
    v_perm_b32 v218, v190, v186, s68
    v_perm_b32 v219, v198, v194, s68
    v_mfma_f32_16x16x32_bf16 v[52:55], v[212:215], a[116:119], v[52:55]
    s_nop 0
    v_mfma_f32_16x16x32_bf16 v[24:27], v[216:219], a[52:55], v[24:27]
    v_perm_b32 v220, v174, v170, s69
    v_perm_b32 v221, v182, v178, s69
    v_perm_b32 v222, v190, v186, s69
    v_perm_b32 v223, v198, v194, s69
    v_mfma_f32_16x16x32_bf16 v[56:59], v[216:219], a[116:119], v[56:59]
    s_nop 0
    v_mfma_f32_16x16x32_bf16 v[28:31], v[220:223], a[52:55], v[28:31]
    v_perm_b32 v224, v175, v171, s68
    v_perm_b32 v225, v183, v179, s68
    v_perm_b32 v226, v191, v187, s68
    v_perm_b32 v227, v199, v195, s68
    v_mfma_f32_16x16x32_bf16 v[60:63], v[220:223], a[116:119], v[60:63]
    s_nop 0
    v_mfma_f32_16x16x32_bf16 v[32:35], v[224:227], a[52:55], v[32:35]
    v_perm_b32 v228, v175, v171, s69
    v_perm_b32 v229, v183, v179, s69
    v_perm_b32 v230, v191, v187, s69
    v_perm_b32 v231, v199, v195, s69
    v_mfma_f32_16x16x32_bf16 v[64:67], v[224:227], a[116:119], v[64:67]
    s_nop 0
    v_mfma_f32_16x16x32_bf16 v[36:39], v[228:231], a[52:55], v[36:39]
    v_mfma_f32_16x16x32_bf16 v[68:71], v[228:231], a[116:119], v[68:71]
    s_waitcnt lgkmcnt(0)
    v_perm_b32 v200, v140, v136, s68
    v_perm_b32 v201, v148, v144, s68
    v_perm_b32 v202, v156, v152, s68
    v_perm_b32 v203, v164, v160, s68
    s_nop 1
    v_mfma_f32_16x16x32_bf16 v[8:11], v[200:203], a[56:59], v[8:11]
    v_perm_b32 v204, v140, v136, s69
    v_perm_b32 v205, v148, v144, s69
    v_perm_b32 v206, v156, v152, s69
    v_perm_b32 v207, v164, v160, s69
    v_mfma_f32_16x16x32_bf16 v[40:43], v[200:203], a[120:123], v[40:43]
    ds_read_b128 v[168:171], v233 offset:57344
    ds_read_b128 v[172:175], v233 offset:57600
    ds_read_b128 v[176:179], v233 offset:57856
    ds_read_b128 v[180:183], v233 offset:58112
    v_mfma_f32_16x16x32_bf16 v[12:15], v[204:207], a[56:59], v[12:15]
    v_perm_b32 v208, v141, v137, s68
    v_perm_b32 v209, v149, v145, s68
    v_perm_b32 v210, v157, v153, s68
    v_perm_b32 v211, v165, v161, s68
    v_mfma_f32_16x16x32_bf16 v[44:47], v[204:207], a[120:123], v[44:47]
    ds_read_b128 v[184:187], v233 offset:58368
    ds_read_b128 v[188:191], v233 offset:58624
    ds_read_b128 v[192:195], v233 offset:58880
    ds_read_b128 v[196:199], v233 offset:59136
    v_mfma_f32_16x16x32_bf16 v[16:19], v[208:211], a[56:59], v[16:19]
    v_perm_b32 v212, v141, v137, s69
    v_perm_b32 v213, v149, v145, s69
    v_perm_b32 v214, v157, v153, s69
    v_perm_b32 v215, v165, v161, s69
    v_mfma_f32_16x16x32_bf16 v[48:51], v[208:211], a[120:123], v[48:51]
    s_nop 0
    v_mfma_f32_16x16x32_bf16 v[20:23], v[212:215], a[56:59], v[20:23]
    v_perm_b32 v216, v142, v138, s68
    v_perm_b32 v217, v150, v146, s68
    v_perm_b32 v218, v158, v154, s68
    v_perm_b32 v219, v166, v162, s68
    v_mfma_f32_16x16x32_bf16 v[52:55], v[212:215], a[120:123], v[52:55]
    s_nop 0
    v_mfma_f32_16x16x32_bf16 v[24:27], v[216:219], a[56:59], v[24:27]
    v_perm_b32 v220, v142, v138, s69
    v_perm_b32 v221, v150, v146, s69
    v_perm_b32 v222, v158, v154, s69
    v_perm_b32 v223, v166, v162, s69
    v_mfma_f32_16x16x32_bf16 v[56:59], v[216:219], a[120:123], v[56:59]
    s_nop 0
    v_mfma_f32_16x16x32_bf16 v[28:31], v[220:223], a[56:59], v[28:31]
    v_perm_b32 v224, v143, v139, s68
    v_perm_b32 v225, v151, v147, s68
    v_perm_b32 v226, v159, v155, s68
    v_perm_b32 v227, v167, v163, s68
    v_mfma_f32_16x16x32_bf16 v[60:63], v[220:223], a[120:123], v[60:63]
    s_nop 0
    v_mfma_f32_16x16x32_bf16 v[32:35], v[224:227], a[56:59], v[32:35]
    v_perm_b32 v228, v143, v139, s69
    v_perm_b32 v229, v151, v147, s69
    v_perm_b32 v230, v159, v155, s69
    v_perm_b32 v231, v167, v163, s69
    v_mfma_f32_16x16x32_bf16 v[64:67], v[224:227], a[120:123], v[64:67]
    s_nop 0
    v_mfma_f32_16x16x32_bf16 v[36:39], v[228:231], a[56:59], v[36:39]
    v_mfma_f32_16x16x32_bf16 v[68:71], v[228:231], a[120:123], v[68:71]
    s_waitcnt lgkmcnt(0)
    v_perm_b32 v200, v172, v168, s68
    v_perm_b32 v201, v180, v176, s68
    v_perm_b32 v202, v188, v184, s68
    v_perm_b32 v203, v196, v192, s68
    s_nop 1
    v_mfma_f32_16x16x32_bf16 v[8:11], v[200:203], a[60:63], v[8:11]
    v_perm_b32 v204, v172, v168, s69
    v_perm_b32 v205, v180, v176, s69
    v_perm_b32 v206, v188, v184, s69
    v_perm_b32 v207, v196, v192, s69
    v_mfma_f32_16x16x32_bf16 v[40:43], v[200:203], a[124:127], v[40:43]
    s_nop 0
    v_mfma_f32_16x16x32_bf16 v[12:15], v[204:207], a[60:63], v[12:15]
    v_perm_b32 v208, v173, v169, s68
    v_perm_b32 v209, v181, v177, s68
    v_perm_b32 v210, v189, v185, s68
    v_perm_b32 v211, v197, v193, s68
    v_mfma_f32_16x16x32_bf16 v[44:47], v[204:207], a[124:127], v[44:47]
    s_nop 0
    v_mfma_f32_16x16x32_bf16 v[16:19], v[208:211], a[60:63], v[16:19]
    v_perm_b32 v212, v173, v169, s69
    v_perm_b32 v213, v181, v177, s69
    v_perm_b32 v214, v189, v185, s69
    v_perm_b32 v215, v197, v193, s69
    v_mfma_f32_16x16x32_bf16 v[48:51], v[208:211], a[124:127], v[48:51]
    s_nop 0
    v_mfma_f32_16x16x32_bf16 v[20:23], v[212:215], a[60:63], v[20:23]
    v_perm_b32 v216, v174, v170, s68
    v_perm_b32 v217, v182, v178, s68
    v_perm_b32 v218, v190, v186, s68
    v_perm_b32 v219, v198, v194, s68
    v_mfma_f32_16x16x32_bf16 v[52:55], v[212:215], a[124:127], v[52:55]
    s_nop 0
    v_mfma_f32_16x16x32_bf16 v[24:27], v[216:219], a[60:63], v[24:27]
    v_perm_b32 v220, v174, v170, s69
    v_perm_b32 v221, v182, v178, s69
    v_perm_b32 v222, v190, v186, s69
    v_perm_b32 v223, v198, v194, s69
    v_mfma_f32_16x16x32_bf16 v[56:59], v[216:219], a[124:127], v[56:59]
    s_nop 0
    v_mfma_f32_16x16x32_bf16 v[28:31], v[220:223], a[60:63], v[28:31]
    v_perm_b32 v224, v175, v171, s68
    v_perm_b32 v225, v183, v179, s68
    v_perm_b32 v226, v191, v187, s68
    v_perm_b32 v227, v199, v195, s68
    v_mfma_f32_16x16x32_bf16 v[60:63], v[220:223], a[124:127], v[60:63]
    s_nop 0
    v_mfma_f32_16x16x32_bf16 v[32:35], v[224:227], a[60:63], v[32:35]
    v_perm_b32 v228, v175, v171, s69
    v_perm_b32 v229, v183, v179, s69
    v_perm_b32 v230, v191, v187, s69
    v_perm_b32 v231, v199, v195, s69
    v_mfma_f32_16x16x32_bf16 v[64:67], v[224:227], a[124:127], v[64:67]
    s_nop 0
    v_mfma_f32_16x16x32_bf16 v[36:39], v[228:231], a[60:63], v[36:39]
    v_mfma_f32_16x16x32_bf16 v[68:71], v[228:231], a[124:127], v[68:71]
    s_lshl_b32 s28, s27, 13
    s_lshl_b32 s29, s47, 18
    s_add_u32 s28, s28, s29
    s_add_u32 s28, s28, 4194304
    s_mov_b32 s30, 262144
    s_lshl_b32 s29, s27, 20
    s_lshl_b32 s31, s47, 14
    s_add_u32 s29, s29, s31
    s_add_u32 s29, s29, 20971520
    s_cmp_eq_u32 s26, 1
    s_cselect_b32 s28, s29, s28
    s_cselect_b32 s30, 16384, s30
    v_cvt_pk_bf16_f32 v200, v8, v12
    v_cvt_pk_bf16_f32 v201, v16, v20
    v_cvt_pk_bf16_f32 v202, v24, v28
    v_cvt_pk_bf16_f32 v203, v32, v36
    buffer_store_dwordx4 v[200:203], v6, s[8:11], s28 offen offset:0 sc1
    v_cvt_pk_bf16_f32 v204, v9, v13
    v_cvt_pk_bf16_f32 v205, v17, v21
    v_cvt_pk_bf16_f32 v206, v25, v29
    v_cvt_pk_bf16_f32 v207, v33, v37
    buffer_store_dwordx4 v[204:207], v6, s[8:11], s28 offen offset:256 sc1
    v_cvt_pk_bf16_f32 v208, v10, v14
    v_cvt_pk_bf16_f32 v209, v18, v22
    v_cvt_pk_bf16_f32 v210, v26, v30
    v_cvt_pk_bf16_f32 v211, v34, v38
    buffer_store_dwordx4 v[208:211], v6, s[8:11], s28 offen offset:512 sc1
    v_cvt_pk_bf16_f32 v212, v11, v15
    v_cvt_pk_bf16_f32 v213, v19, v23
    v_cvt_pk_bf16_f32 v214, v27, v31
    v_cvt_pk_bf16_f32 v215, v35, v39
    buffer_store_dwordx4 v[212:215], v6, s[8:11], s28 offen offset:768 sc1
    s_add_u32 s29, s28, 4096
    v_cvt_pk_bf16_f32 v216, v40, v44
    v_cvt_pk_bf16_f32 v217, v48, v52
    v_cvt_pk_bf16_f32 v218, v56, v60
    v_cvt_pk_bf16_f32 v219, v64, v68
    buffer_store_dwordx4 v[216:219], v6, s[8:11], s29 offen offset:0 sc1
    v_cvt_pk_bf16_f32 v220, v41, v45
    v_cvt_pk_bf16_f32 v221, v49, v53
    v_cvt_pk_bf16_f32 v222, v57, v61
    v_cvt_pk_bf16_f32 v223, v65, v69
    buffer_store_dwordx4 v[220:223], v6, s[8:11], s29 offen offset:256 sc1
    v_cvt_pk_bf16_f32 v224, v42, v46
    v_cvt_pk_bf16_f32 v225, v50, v54
    v_cvt_pk_bf16_f32 v226, v58, v62
    v_cvt_pk_bf16_f32 v227, v66, v70
    buffer_store_dwordx4 v[224:227], v6, s[8:11], s29 offen offset:512 sc1
    v_cvt_pk_bf16_f32 v228, v43, v47
    v_cvt_pk_bf16_f32 v229, v51, v55
    v_cvt_pk_bf16_f32 v230, v59, v63
    v_cvt_pk_bf16_f32 v231, v67, v71
    buffer_store_dwordx4 v[228:231], v6, s[8:11], s29 offen offset:768 sc1
    s_nop 1
    s_branch Ltd_204
Lv_203:
    s_waitcnt vmcnt(32)
    s_barrier
    ds_read_b128 v[136:139], v232 offset:0
    ds_read_b128 v[140:143], v232 offset:256
    ds_read_b128 v[144:147], v232 offset:512
    ds_read_b128 v[148:151], v232 offset:768
    ds_read_b128 v[152:155], v232 offset:1024
    ds_read_b128 v[156:159], v232 offset:1280
    ds_read_b128 v[160:163], v232 offset:1536
    ds_read_b128 v[164:167], v232 offset:1792
    s_waitcnt lgkmcnt(0)
    v_perm_b32 v200, v140, v136, s68
    v_perm_b32 v201, v148, v144, s68
    v_perm_b32 v202, v156, v152, s68
    v_perm_b32 v203, v164, v160, s68
    s_nop 1
    v_mfma_f32_16x16x32_bf16 v[8:11], a[0:3], v[200:203], 0
    v_perm_b32 v204, v140, v136, s69
    v_perm_b32 v205, v148, v144, s69
    v_perm_b32 v206, v156, v152, s69
    v_perm_b32 v207, v164, v160, s69
    v_mfma_f32_16x16x32_bf16 v[40:43], a[64:67], v[200:203], 0
    ds_read_b128 v[168:171], v232 offset:8192
    ds_read_b128 v[172:175], v232 offset:8448
    ds_read_b128 v[176:179], v232 offset:8704
    ds_read_b128 v[180:183], v232 offset:8960
    v_mfma_f32_16x16x32_bf16 v[12:15], a[0:3], v[204:207], 0
    v_perm_b32 v208, v141, v137, s68
    v_perm_b32 v209, v149, v145, s68
    v_perm_b32 v210, v157, v153, s68
    v_perm_b32 v211, v165, v161, s68
    v_mfma_f32_16x16x32_bf16 v[44:47], a[64:67], v[204:207], 0
    ds_read_b128 v[184:187], v232 offset:9216
    ds_read_b128 v[188:191], v232 offset:9472
    ds_read_b128 v[192:195], v232 offset:9728
    ds_read_b128 v[196:199], v232 offset:9984
    v_mfma_f32_16x16x32_bf16 v[16:19], a[0:3], v[208:211], 0
    v_perm_b32 v212, v141, v137, s69
    v_perm_b32 v213, v149, v145, s69
    v_perm_b32 v214, v157, v153, s69
    v_perm_b32 v215, v165, v161, s69
    v_mfma_f32_16x16x32_bf16 v[48:51], a[64:67], v[208:211], 0
    s_add_u32 m0, s39, 98304
    s_add_u32 s38, s36, 3145728
    buffer_load_dwordx4 v7, s[12:15], s38 offen lds
    s_add_u32 m0, s39, 99328
    v_mfma_f32_16x16x32_bf16 v[20:23], a[0:3], v[212:215], 0
    v_perm_b32 v216, v142, v138, s68
    v_perm_b32 v217, v150, v146, s68
    v_perm_b32 v218, v158, v154, s68
    v_perm_b32 v219, v166, v162, s68
    v_mfma_f32_16x16x32_bf16 v[52:55], a[64:67], v[212:215], 0
    s_add_u32 s38, s36, 3178496
    buffer_load_dwordx4 v7, s[12:15], s38 offen lds
    s_add_u32 m0, s39, 100352
    s_add_u32 s38, s36, 3211264
    v_mfma_f32_16x16x32_bf16 v[24:27], a[0:3], v[216:219], 0
    v_perm_b32 v220, v142, v138, s69
    v_perm_b32 v221, v150, v146, s69
    v_perm_b32 v222, v158, v154, s69
    v_perm_b32 v223, v166, v162, s69
    v_mfma_f32_16x16x32_bf16 v[56:59], a[64:67], v[216:219], 0
    buffer_load_dwordx4 v7, s[12:15], s38 offen lds
    s_add_u32 m0, s39, 101376
    s_add_u32 s38, s36, 3244032
    buffer_load_dwordx4 v7, s[12:15], s38 offen lds
    v_mfma_f32_16x16x32_bf16 v[28:31], a[0:3], v[220:223], 0
    v_perm_b32 v224, v143, v139, s68
    v_perm_b32 v225, v151, v147, s68
    v_perm_b32 v226, v159, v155, s68
    v_perm_b32 v227, v167, v163, s68
    v_mfma_f32_16x16x32_bf16 v[60:63], a[64:67], v[220:223], 0
    s_add_u32 m0, s39, 102400
    s_add_u32 s38, s36, 3276800
    buffer_load_dwordx4 v7, s[12:15], s38 offen lds
    s_add_u32 m0, s39, 103424
    v_mfma_f32_16x16x32_bf16 v[32:35], a[0:3], v[224:227], 0
    v_perm_b32 v228, v143, v139, s69
    v_perm_b32 v229, v151, v147, s69
    v_perm_b32 v230, v159, v155, s69
    v_perm_b32 v231, v167, v163, s69
    v_mfma_f32_16x16x32_bf16 v[64:67], a[64:67], v[224:227], 0
    s_add_u32 s38, s36, 3309568
    buffer_load_dwordx4 v7, s[12:15], s38 offen lds
    s_add_u32 m0, s39, 104448
    s_add_u32 s38, s36, 3342336
    v_mfma_f32_16x16x32_bf16 v[36:39], a[0:3], v[228:231], 0
    buffer_load_dwordx4 v7, s[12:15], s38 offen lds
    s_add_u32 m0, s39, 105472
    s_add_u32 s38, s36, 3375104
    buffer_load_dwordx4 v7, s[12:15], s38 offen lds
    v_mfma_f32_16x16x32_bf16 v[68:71], a[64:67], v[228:231], 0
    s_waitcnt lgkmcnt(0)
    v_perm_b32 v200, v172, v168, s68
    v_perm_b32 v201, v180, v176, s68
    v_perm_b32 v202, v188, v184, s68
    v_perm_b32 v203, v196, v192, s68
    s_nop 1
    v_mfma_f32_16x16x32_bf16 v[8:11], a[4:7], v[200:203], v[8:11]
    v_perm_b32 v204, v172, v168, s69
    v_perm_b32 v205, v180, v176, s69
    v_perm_b32 v206, v188, v184, s69
    v_perm_b32 v207, v196, v192, s69
    v_mfma_f32_16x16x32_bf16 v[40:43], a[68:71], v[200:203], v[40:43]
    ds_read_b128 v[136:139], v232 offset:16384
    ds_read_b128 v[140:143], v232 offset:16640
    ds_read_b128 v[144:147], v232 offset:16896
    ds_read_b128 v[148:151], v232 offset:17152
    v_mfma_f32_16x16x32_bf16 v[12:15], a[4:7], v[204:207], v[12:15]
    v_perm_b32 v208, v173, v169, s68
    v_perm_b32 v209, v181, v177, s68
    v_perm_b32 v210, v189, v185, s68
    v_perm_b32 v211, v197, v193, s68
    v_mfma_f32_16x16x32_bf16 v[44:47], a[68:71], v[204:207], v[44:47]
    ds_read_b128 v[152:155], v232 offset:17408
    ds_read_b128 v[156:159], v232 offset:17664
    ds_read_b128 v[160:163], v232 offset:17920
    ds_read_b128 v[164:167], v232 offset:18176
    v_mfma_f32_16x16x32_bf16 v[16:19], a[4:7], v[208:211], v[16:19]
    v_perm_b32 v212, v173, v169, s69
    v_perm_b32 v213, v181, v177, s69
    v_perm_b32 v214, v189, v185, s69
    v_perm_b32 v215, v197, v193, s69
    v_mfma_f32_16x16x32_bf16 v[48:51], a[68:71], v[208:211], v[48:51]
    s_nop 0
    v_mfma_f32_16x16x32_bf16 v[20:23], a[4:7], v[212:215], v[20:23]
    v_perm_b32 v216, v174, v170, s68
    v_perm_b32 v217, v182, v178, s68
    v_perm_b32 v218, v190, v186, s68
    v_perm_b32 v219, v198, v194, s68
    v_mfma_f32_16x16x32_bf16 v[52:55], a[68:71], v[212:215], v[52:55]
    s_nop 0
    v_mfma_f32_16x16x32_bf16 v[24:27], a[4:7], v[216:219], v[24:27]
    v_perm_b32 v220, v174, v170, s69
    v_perm_b32 v221, v182, v178, s69
    v_perm_b32 v222, v190, v186, s69
    v_perm_b32 v223, v198, v194, s69
    v_mfma_f32_16x16x32_bf16 v[56:59], a[68:71], v[216:219], v[56:59]
    s_nop 0
    v_mfma_f32_16x16x32_bf16 v[28:31], a[4:7], v[220:223], v[28:31]
    v_perm_b32 v224, v175, v171, s68
    v_perm_b32 v225, v183, v179, s68
    v_perm_b32 v226, v191, v187, s68
    v_perm_b32 v227, v199, v195, s68
    v_mfma_f32_16x16x32_bf16 v[60:63], a[68:71], v[220:223], v[60:63]
    s_nop 0
    v_mfma_f32_16x16x32_bf16 v[32:35], a[4:7], v[224:227], v[32:35]
    v_perm_b32 v228, v175, v171, s69
    v_perm_b32 v229, v183, v179, s69
    v_perm_b32 v230, v191, v187, s69
    v_perm_b32 v231, v199, v195, s69
    v_mfma_f32_16x16x32_bf16 v[64:67], a[68:71], v[224:227], v[64:67]
    s_nop 0
    v_mfma_f32_16x16x32_bf16 v[36:39], a[4:7], v[228:231], v[36:39]
    v_mfma_f32_16x16x32_bf16 v[68:71], a[68:71], v[228:231], v[68:71]
    s_waitcnt lgkmcnt(0)
    v_perm_b32 v200, v140, v136, s68
    v_perm_b32 v201, v148, v144, s68
    v_perm_b32 v202, v156, v152, s68
    v_perm_b32 v203, v164, v160, s68
    s_nop 1
    v_mfma_f32_16x16x32_bf16 v[8:11], a[8:11], v[200:203], v[8:11]
    v_perm_b32 v204, v140, v136, s69
    v_perm_b32 v205, v148, v144, s69
    v_perm_b32 v206, v156, v152, s69
    v_perm_b32 v207, v164, v160, s69
    v_mfma_f32_16x16x32_bf16 v[40:43], a[72:75], v[200:203], v[40:43]
    ds_read_b128 v[168:171], v232 offset:24576
    ds_read_b128 v[172:175], v232 offset:24832
    ds_read_b128 v[176:179], v232 offset:25088
    ds_read_b128 v[180:183], v232 offset:25344
    v_mfma_f32_16x16x32_bf16 v[12:15], a[8:11], v[204:207], v[12:15]
    v_perm_b32 v208, v141, v137, s68
    v_perm_b32 v209, v149, v145, s68
    v_perm_b32 v210, v157, v153, s68
    v_perm_b32 v211, v165, v161, s68
    v_mfma_f32_16x16x32_bf16 v[44:47], a[72:75], v[204:207], v[44:47]
    ds_read_b128 v[184:187], v232 offset:25600
    ds_read_b128 v[188:191], v232 offset:25856
    ds_read_b128 v[192:195], v232 offset:26112
    ds_read_b128 v[196:199], v232 offset:26368
    v_mfma_f32_16x16x32_bf16 v[16:19], a[8:11], v[208:211], v[16:19]
    v_perm_b32 v212, v141, v137, s69
    v_perm_b32 v213, v149, v145, s69
    v_perm_b32 v214, v157, v153, s69
    v_perm_b32 v215, v165, v161, s69
    v_mfma_f32_16x16x32_bf16 v[48:51], a[72:75], v[208:211], v[48:51]
    s_nop 0
    v_mfma_f32_16x16x32_bf16 v[20:23], a[8:11], v[212:215], v[20:23]
    v_perm_b32 v216, v142, v138, s68
    v_perm_b32 v217, v150, v146, s68
    v_perm_b32 v218, v158, v154, s68
    v_perm_b32 v219, v166, v162, s68
    v_mfma_f32_16x16x32_bf16 v[52:55], a[72:75], v[212:215], v[52:55]
    s_nop 0
    v_mfma_f32_16x16x32_bf16 v[24:27], a[8:11], v[216:219], v[24:27]
    v_perm_b32 v220, v142, v138, s69
    v_perm_b32 v221, v150, v146, s69
    v_perm_b32 v222, v158, v154, s69
    v_perm_b32 v223, v166, v162, s69
    v_mfma_f32_16x16x32_bf16 v[56:59], a[72:75], v[216:219], v[56:59]
    s_nop 0
    v_mfma_f32_16x16x32_bf16 v[28:31], a[8:11], v[220:223], v[28:31]
    v_perm_b32 v224, v143, v139, s68
    v_perm_b32 v225, v151, v147, s68
    v_perm_b32 v226, v159, v155, s68
    v_perm_b32 v227, v167, v163, s68
    v_mfma_f32_16x16x32_bf16 v[60:63], a[72:75], v[220:223], v[60:63]
    s_nop 0
    v_mfma_f32_16x16x32_bf16 v[32:35], a[8:11], v[224:227], v[32:35]
    v_perm_b32 v228, v143, v139, s69
    v_perm_b32 v229, v151, v147, s69
    v_perm_b32 v230, v159, v155, s69
    v_perm_b32 v231, v167, v163, s69
    v_mfma_f32_16x16x32_bf16 v[64:67], a[72:75], v[224:227], v[64:67]
    s_nop 0
    v_mfma_f32_16x16x32_bf16 v[36:39], a[8:11], v[228:231], v[36:39]
    v_mfma_f32_16x16x32_bf16 v[68:71], a[72:75], v[228:231], v[68:71]
    s_waitcnt lgkmcnt(0)
    v_perm_b32 v200, v172, v168, s68
    v_perm_b32 v201, v180, v176, s68
    v_perm_b32 v202, v188, v184, s68
    v_perm_b32 v203, v196, v192, s68
    s_nop 1
    v_mfma_f32_16x16x32_bf16 v[8:11], a[12:15], v[200:203], v[8:11]
    v_perm_b32 v204, v172, v168, s69
    v_perm_b32 v205, v180, v176, s69
    v_perm_b32 v206, v188, v184, s69
    v_perm_b32 v207, v196, v192, s69
    v_mfma_f32_16x16x32_bf16 v[40:43], a[76:79], v[200:203], v[40:43]
    s_nop 0
    v_mfma_f32_16x16x32_bf16 v[12:15], a[12:15], v[204:207], v[12:15]
    v_perm_b32 v208, v173, v169, s68
    v_perm_b32 v209, v181, v177, s68
    v_perm_b32 v210, v189, v185, s68
    v_perm_b32 v211, v197, v193, s68
    v_mfma_f32_16x16x32_bf16 v[44:47], a[76:79], v[204:207], v[44:47]
    s_nop 0
    v_mfma_f32_16x16x32_bf16 v[16:19], a[12:15], v[208:211], v[16:19]
    v_perm_b32 v212, v173, v169, s69
    v_perm_b32 v213, v181, v177, s69
    v_perm_b32 v214, v189, v185, s69
    v_perm_b32 v215, v197, v193, s69
    v_mfma_f32_16x16x32_bf16 v[48:51], a[76:79], v[208:211], v[48:51]
    s_nop 0
    v_mfma_f32_16x16x32_bf16 v[20:23], a[12:15], v[212:215], v[20:23]
    v_perm_b32 v216, v174, v170, s68
    v_perm_b32 v217, v182, v178, s68
    v_perm_b32 v218, v190, v186, s68
    v_perm_b32 v219, v198, v194, s68
    v_mfma_f32_16x16x32_bf16 v[52:55], a[76:79], v[212:215], v[52:55]
    s_nop 0
    v_mfma_f32_16x16x32_bf16 v[24:27], a[12:15], v[216:219], v[24:27]
    v_perm_b32 v220, v174, v170, s69
    v_perm_b32 v221, v182, v178, s69
    v_perm_b32 v222, v190, v186, s69
    v_perm_b32 v223, v198, v194, s69
    v_mfma_f32_16x16x32_bf16 v[56:59], a[76:79], v[216:219], v[56:59]
    s_nop 0
    v_mfma_f32_16x16x32_bf16 v[28:31], a[12:15], v[220:223], v[28:31]
    v_perm_b32 v224, v175, v171, s68
    v_perm_b32 v225, v183, v179, s68
    v_perm_b32 v226, v191, v187, s68
    v_perm_b32 v227, v199, v195, s68
    v_mfma_f32_16x16x32_bf16 v[60:63], a[76:79], v[220:223], v[60:63]
    s_nop 0
    v_mfma_f32_16x16x32_bf16 v[32:35], a[12:15], v[224:227], v[32:35]
    v_perm_b32 v228, v175, v171, s69
    v_perm_b32 v229, v183, v179, s69
    v_perm_b32 v230, v191, v187, s69
    v_perm_b32 v231, v199, v195, s69
    v_mfma_f32_16x16x32_bf16 v[64:67], a[76:79], v[224:227], v[64:67]
    s_nop 0
    v_mfma_f32_16x16x32_bf16 v[36:39], a[12:15], v[228:231], v[36:39]
    v_mfma_f32_16x16x32_bf16 v[68:71], a[76:79], v[228:231], v[68:71]
    s_waitcnt vmcnt(16)
    s_barrier
    ds_read_b128 v[136:139], v232 offset:32768
    ds_read_b128 v[140:143], v232 offset:33024
    ds_read_b128 v[144:147], v232 offset:33280
    ds_read_b128 v[148:151], v232 offset:33536
    ds_read_b128 v[152:155], v232 offset:33792
    ds_read_b128 v[156:159], v232 offset:34048
    ds_read_b128 v[160:163], v232 offset:34304
    ds_read_b128 v[164:167], v232 offset:34560
    s_waitcnt lgkmcnt(0)
    v_perm_b32 v200, v140, v136, s68
    v_perm_b32 v201, v148, v144, s68
    v_perm_b32 v202, v156, v152, s68
    v_perm_b32 v203, v164, v160, s68
    s_nop 1
    v_mfma_f32_16x16x32_bf16 v[8:11], a[16:19], v[200:203], v[8:11]
    v_perm_b32 v204, v140, v136, s69
    v_perm_b32 v205, v148, v144, s69
    v_perm_b32 v206, v156, v152, s69
    v_perm_b32 v207, v164, v160, s69
    v_mfma_f32_16x16x32_bf16 v[40:43], a[80:83], v[200:203], v[40:43]
    ds_read_b128 v[168:171], v232 offset:40960
    ds_read_b128 v[172:175], v232 offset:41216
    ds_read_b128 v[176:179], v232 offset:41472
    ds_read_b128 v[180:183], v232 offset:41728
    v_mfma_f32_16x16x32_bf16 v[12:15], a[16:19], v[204:207], v[12:15]
    v_perm_b32 v208, v141, v137, s68
    v_perm_b32 v209, v149, v145, s68
    v_perm_b32 v210, v157, v153, s68
    v_perm_b32 v211, v165, v161, s68
    v_mfma_f32_16x16x32_bf16 v[44:47], a[80:83], v[204:207], v[44:47]
    ds_read_b128 v[184:187], v232 offset:41984
    ds_read_b128 v[188:191], v232 offset:42240
    ds_read_b128 v[192:195], v232 offset:42496
    ds_read_b128 v[196:199], v232 offset:42752
    v_mfma_f32_16x16x32_bf16 v[16:19], a[16:19], v[208:211], v[16:19]
    v_perm_b32 v212, v141, v137, s69
    v_perm_b32 v213, v149, v145, s69
    v_perm_b32 v214, v157, v153, s69
    v_perm_b32 v215, v165, v161, s69
    v_mfma_f32_16x16x32_bf16 v[48:51], a[80:83], v[208:211], v[48:51]
    s_add_u32 m0, s39, 0
    s_add_u32 s38, s37, 0
    buffer_load_dwordx4 v7, s[32:35], s38 offen lds
    s_add_u32 m0, s39, 1024
    v_mfma_f32_16x16x32_bf16 v[20:23], a[16:19], v[212:215], v[20:23]
    v_perm_b32 v216, v142, v138, s68
    v_perm_b32 v217, v150, v146, s68
    v_perm_b32 v218, v158, v154, s68
    v_perm_b32 v219, v166, v162, s68
    v_mfma_f32_16x16x32_bf16 v[52:55], a[80:83], v[212:215], v[52:55]
    s_add_u32 s38, s37, 32768
    buffer_load_dwordx4 v7, s[32:35], s38 offen lds
    s_add_u32 m0, s39, 2048
    s_add_u32 s38, s37, 65536
    v_mfma_f32_16x16x32_bf16 v[24:27], a[16:19], v[216:219], v[24:27]
    v_perm_b32 v220, v142, v138, s69
    v_perm_b32 v221, v150, v146, s69
    v_perm_b32 v222, v158, v154, s69
    v_perm_b32 v223, v166, v162, s69
    v_mfma_f32_16x16x32_bf16 v[56:59], a[80:83], v[216:219], v[56:59]
    buffer_load_dwordx4 v7, s[32:35], s38 offen lds
    s_add_u32 m0, s39, 3072
    s_add_u32 s38, s37, 98304
    buffer_load_dwordx4 v7, s[32:35], s38 offen lds
    v_mfma_f32_16x16x32_bf16 v[28:31], a[16:19], v[220:223], v[28:31]
    v_perm_b32 v224, v143, v139, s68
    v_perm_b32 v225, v151, v147, s68
    v_perm_b32 v226, v159, v155, s68
    v_perm_b32 v227, v167, v163, s68
    v_mfma_f32_16x16x32_bf16 v[60:63], a[80:83], v[220:223], v[60:63]
    s_add_u32 m0, s39, 4096
    s_add_u32 s38, s37, 131072
    buffer_load_dwordx4 v7, s[32:35], s38 offen lds
    s_add_u32 m0, s39, 5120
    v_mfma_f32_16x16x32_bf16 v[32:35], a[16:19], v[224:227], v[32:35]
    v_perm_b32 v228, v143, v139, s69
    v_perm_b32 v229, v151, v147, s69
    v_perm_b32 v230, v159, v155, s69
    v_perm_b32 v231, v167, v163, s69
    v_mfma_f32_16x16x32_bf16 v[64:67], a[80:83], v[224:227], v[64:67]
    s_add_u32 s38, s37, 163840
    buffer_load_dwordx4 v7, s[32:35], s38 offen lds
    s_add_u32 m0, s39, 6144
    s_add_u32 s38, s37, 196608
    v_mfma_f32_16x16x32_bf16 v[36:39], a[16:19], v[228:231], v[36:39]
    buffer_load_dwordx4 v7, s[32:35], s38 offen lds
    s_add_u32 m0, s39, 7168
    s_add_u32 s38, s37, 229376
    buffer_load_dwordx4 v7, s[32:35], s38 offen lds
    v_mfma_f32_16x16x32_bf16 v[68:71], a[80:83], v[228:231], v[68:71]
    s_waitcnt lgkmcnt(0)
    v_perm_b32 v200, v172, v168, s68
    v_perm_b32 v201, v180, v176, s68
    v_perm_b32 v202, v188, v184, s68
    v_perm_b32 v203, v196, v192, s68
    s_nop 1
    v_mfma_f32_16x16x32_bf16 v[8:11], a[20:23], v[200:203], v[8:11]
    v_perm_b32 v204, v172, v168, s69
    v_perm_b32 v205, v180, v176, s69
    v_perm_b32 v206, v188, v184, s69
    v_perm_b32 v207, v196, v192, s69
    v_mfma_f32_16x16x32_bf16 v[40:43], a[84:87], v[200:203], v[40:43]
    ds_read_b128 v[136:139], v232 offset:49152
    ds_read_b128 v[140:143], v232 offset:49408
    ds_read_b128 v[144:147], v232 offset:49664
    ds_read_b128 v[148:151], v232 offset:49920
    v_mfma_f32_16x16x32_bf16 v[12:15], a[20:23], v[204:207], v[12:15]
    v_perm_b32 v208, v173, v169, s68
    v_perm_b32 v209, v181, v177, s68
    v_perm_b32 v210, v189, v185, s68
    v_perm_b32 v211, v197, v193, s68
    v_mfma_f32_16x16x32_bf16 v[44:47], a[84:87], v[204:207], v[44:47]
    ds_read_b128 v[152:155], v232 offset:50176
    ds_read_b128 v[156:159], v232 offset:50432
    ds_read_b128 v[160:163], v232 offset:50688
    ds_read_b128 v[164:167], v232 offset:50944
    v_mfma_f32_16x16x32_bf16 v[16:19], a[20:23], v[208:211], v[16:19]
    v_perm_b32 v212, v173, v169, s69
    v_perm_b32 v213, v181, v177, s69
    v_perm_b32 v214, v189, v185, s69
    v_perm_b32 v215, v197, v193, s69
    v_mfma_f32_16x16x32_bf16 v[48:51], a[84:87], v[208:211], v[48:51]
    s_nop 0
    v_mfma_f32_16x16x32_bf16 v[20:23], a[20:23], v[212:215], v[20:23]
    v_perm_b32 v216, v174, v170, s68
    v_perm_b32 v217, v182, v178, s68
    v_perm_b32 v218, v190, v186, s68
    v_perm_b32 v219, v198, v194, s68
    v_mfma_f32_16x16x32_bf16 v[52:55], a[84:87], v[212:215], v[52:55]
    s_nop 0
    v_mfma_f32_16x16x32_bf16 v[24:27], a[20:23], v[216:219], v[24:27]
    v_perm_b32 v220, v174, v170, s69
    v_perm_b32 v221, v182, v178, s69
    v_perm_b32 v222, v190, v186, s69
    v_perm_b32 v223, v198, v194, s69
    v_mfma_f32_16x16x32_bf16 v[56:59], a[84:87], v[216:219], v[56:59]
    s_nop 0
    v_mfma_f32_16x16x32_bf16 v[28:31], a[20:23], v[220:223], v[28:31]
    v_perm_b32 v224, v175, v171, s68
    v_perm_b32 v225, v183, v179, s68
    v_perm_b32 v226, v191, v187, s68
    v_perm_b32 v227, v199, v195, s68
    v_mfma_f32_16x16x32_bf16 v[60:63], a[84:87], v[220:223], v[60:63]
    s_nop 0
    v_mfma_f32_16x16x32_bf16 v[32:35], a[20:23], v[224:227], v[32:35]
    v_perm_b32 v228, v175, v171, s69
    v_perm_b32 v229, v183, v179, s69
    v_perm_b32 v230, v191, v187, s69
    v_perm_b32 v231, v199, v195, s69
    v_mfma_f32_16x16x32_bf16 v[64:67], a[84:87], v[224:227], v[64:67]
    s_nop 0
    v_mfma_f32_16x16x32_bf16 v[36:39], a[20:23], v[228:231], v[36:39]
    v_mfma_f32_16x16x32_bf16 v[68:71], a[84:87], v[228:231], v[68:71]
    s_waitcnt lgkmcnt(0)
    v_perm_b32 v200, v140, v136, s68
    v_perm_b32 v201, v148, v144, s68
    v_perm_b32 v202, v156, v152, s68
    v_perm_b32 v203, v164, v160, s68
    s_nop 1
    v_mfma_f32_16x16x32_bf16 v[8:11], a[24:27], v[200:203], v[8:11]
    v_perm_b32 v204, v140, v136, s69
    v_perm_b32 v205, v148, v144, s69
    v_perm_b32 v206, v156, v152, s69
    v_perm_b32 v207, v164, v160, s69
    v_mfma_f32_16x16x32_bf16 v[40:43], a[88:91], v[200:203], v[40:43]
    ds_read_b128 v[168:171], v232 offset:57344
    ds_read_b128 v[172:175], v232 offset:57600
    ds_read_b128 v[176:179], v232 offset:57856
    ds_read_b128 v[180:183], v232 offset:58112
    v_mfma_f32_16x16x32_bf16 v[12:15], a[24:27], v[204:207], v[12:15]
    v_perm_b32 v208, v141, v137, s68
    v_perm_b32 v209, v149, v145, s68
    v_perm_b32 v210, v157, v153, s68
    v_perm_b32 v211, v165, v161, s68
    v_mfma_f32_16x16x32_bf16 v[44:47], a[88:91], v[204:207], v[44:47]
    ds_read_b128 v[184:187], v232 offset:58368
    ds_read_b128 v[188:191], v232 offset:58624
    ds_read_b128 v[192:195], v232 offset:58880
    ds_read_b128 v[196:199], v232 offset:59136
    v_mfma_f32_16x16x32_bf16 v[16:19], a[24:27], v[208:211], v[16:19]
    v_perm_b32 v212, v141, v137, s69
    v_perm_b32 v213, v149, v145, s69
    v_perm_b32 v214, v157, v153, s69
    v_perm_b32 v215, v165, v161, s69
    v_mfma_f32_16x16x32_bf16 v[48:51], a[88:91], v[208:211], v[48:51]
    s_nop 0
    v_mfma_f32_16x16x32_bf16 v[20:23], a[24:27], v[212:215], v[20:23]
    v_perm_b32 v216, v142, v138, s68
    v_perm_b32 v217, v150, v146, s68
    v_perm_b32 v218, v158, v154, s68
    v_perm_b32 v219, v166, v162, s68
    v_mfma_f32_16x16x32_bf16 v[52:55], a[88:91], v[212:215], v[52:55]
    s_nop 0
    v_mfma_f32_16x16x32_bf16 v[24:27], a[24:27], v[216:219], v[24:27]
    v_perm_b32 v220, v142, v138, s69
    v_perm_b32 v221, v150, v146, s69
    v_perm_b32 v222, v158, v154, s69
    v_perm_b32 v223, v166, v162, s69
    v_mfma_f32_16x16x32_bf16 v[56:59], a[88:91], v[216:219], v[56:59]
    s_nop 0
    v_mfma_f32_16x16x32_bf16 v[28:31], a[24:27], v[220:223], v[28:31]
    v_perm_b32 v224, v143, v139, s68
    v_perm_b32 v225, v151, v147, s68
    v_perm_b32 v226, v159, v155, s68
    v_perm_b32 v227, v167, v163, s68
    v_mfma_f32_16x16x32_bf16 v[60:63], a[88:91], v[220:223], v[60:63]
    s_nop 0
    v_mfma_f32_16x16x32_bf16 v[32:35], a[24:27], v[224:227], v[32:35]
    v_perm_b32 v228, v143, v139, s69
    v_perm_b32 v229, v151, v147, s69
    v_perm_b32 v230, v159, v155, s69
    v_perm_b32 v231, v167, v163, s69
    v_mfma_f32_16x16x32_bf16 v[64:67], a[88:91], v[224:227], v[64:67]
    s_nop 0
    v_mfma_f32_16x16x32_bf16 v[36:39], a[24:27], v[228:231], v[36:39]
    v_mfma_f32_16x16x32_bf16 v[68:71], a[88:91], v[228:231], v[68:71]
    s_waitcnt lgkmcnt(0)
    v_perm_b32 v200, v172, v168, s68
    v_perm_b32 v201, v180, v176, s68
    v_perm_b32 v202, v188, v184, s68
    v_perm_b32 v203, v196, v192, s68
    s_nop 1
    v_mfma_f32_16x16x32_bf16 v[8:11], a[28:31], v[200:203], v[8:11]
    v_perm_b32 v204, v172, v168, s69
    v_perm_b32 v205, v180, v176, s69
    v_perm_b32 v206, v188, v184, s69
    v_perm_b32 v207, v196, v192, s69
    v_mfma_f32_16x16x32_bf16 v[40:43], a[92:95], v[200:203], v[40:43]
    s_nop 0
    v_mfma_f32_16x16x32_bf16 v[12:15], a[28:31], v[204:207], v[12:15]
    v_perm_b32 v208, v173, v169, s68
    v_perm_b32 v209, v181, v177, s68
    v_perm_b32 v210, v189, v185, s68
    v_perm_b32 v211, v197, v193, s68
    v_mfma_f32_16x16x32_bf16 v[44:47], a[92:95], v[204:207], v[44:47]
    s_nop 0
    v_mfma_f32_16x16x32_bf16 v[16:19], a[28:31], v[208:211], v[16:19]
    v_perm_b32 v212, v173, v169, s69
    v_perm_b32 v213, v181, v177, s69
    v_perm_b32 v214, v189, v185, s69
    v_perm_b32 v215, v197, v193, s69
    v_mfma_f32_16x16x32_bf16 v[48:51], a[92:95], v[208:211], v[48:51]
    s_nop 0
    v_mfma_f32_16x16x32_bf16 v[20:23], a[28:31], v[212:215], v[20:23]
    v_perm_b32 v216, v174, v170, s68
    v_perm_b32 v217, v182, v178, s68
    v_perm_b32 v218, v190, v186, s68
    v_perm_b32 v219, v198, v194, s68
    v_mfma_f32_16x16x32_bf16 v[52:55], a[92:95], v[212:215], v[52:55]
    s_nop 0
    v_mfma_f32_16x16x32_bf16 v[24:27], a[28:31], v[216:219], v[24:27]
    v_perm_b32 v220, v174, v170, s69
    v_perm_b32 v221, v182, v178, s69
    v_perm_b32 v222, v190, v186, s69
    v_perm_b32 v223, v198, v194, s69
    v_mfma_f32_16x16x32_bf16 v[56:59], a[92:95], v[216:219], v[56:59]
    s_nop 0
    v_mfma_f32_16x16x32_bf16 v[28:31], a[28:31], v[220:223], v[28:31]
    v_perm_b32 v224, v175, v171, s68
    v_perm_b32 v225, v183, v179, s68
    v_perm_b32 v226, v191, v187, s68
    v_perm_b32 v227, v199, v195, s68
    v_mfma_f32_16x16x32_bf16 v[60:63], a[92:95], v[220:223], v[60:63]
    s_nop 0
    v_mfma_f32_16x16x32_bf16 v[32:35], a[28:31], v[224:227], v[32:35]
    v_perm_b32 v228, v175, v171, s69
    v_perm_b32 v229, v183, v179, s69
    v_perm_b32 v230, v191, v187, s69
    v_perm_b32 v231, v199, v195, s69
    v_mfma_f32_16x16x32_bf16 v[64:67], a[92:95], v[224:227], v[64:67]
    s_nop 0
    v_mfma_f32_16x16x32_bf16 v[36:39], a[28:31], v[228:231], v[36:39]
    v_mfma_f32_16x16x32_bf16 v[68:71], a[92:95], v[228:231], v[68:71]
    s_waitcnt vmcnt(16)
    s_barrier
    ds_read_b128 v[136:139], v233 offset:0
    ds_read_b128 v[140:143], v233 offset:256
    ds_read_b128 v[144:147], v233 offset:512
    ds_read_b128 v[148:151], v233 offset:768
    ds_read_b128 v[152:155], v233 offset:1024
    ds_read_b128 v[156:159], v233 offset:1280
    ds_read_b128 v[160:163], v233 offset:1536
    ds_read_b128 v[164:167], v233 offset:1792
    s_waitcnt lgkmcnt(0)
    v_perm_b32 v200, v140, v136, s68
    v_perm_b32 v201, v148, v144, s68
    v_perm_b32 v202, v156, v152, s68
    v_perm_b32 v203, v164, v160, s68
    s_nop 1
    v_mfma_f32_16x16x32_bf16 v[8:11], a[32:35], v[200:203], v[8:11]
    v_perm_b32 v204, v140, v136, s69
    v_perm_b32 v205, v148, v144, s69
    v_perm_b32 v206, v156, v152, s69
    v_perm_b32 v207, v164, v160, s69
    v_mfma_f32_16x16x32_bf16 v[40:43], a[96:99], v[200:203], v[40:43]
    ds_read_b128 v[168:171], v233 offset:8192
    ds_read_b128 v[172:175], v233 offset:8448
    ds_read_b128 v[176:179], v233 offset:8704
    ds_read_b128 v[180:183], v233 offset:8960
    v_mfma_f32_16x16x32_bf16 v[12:15], a[32:35], v[204:207], v[12:15]
    v_perm_b32 v208, v141, v137, s68
    v_perm_b32 v209, v149, v145, s68
    v_perm_b32 v210, v157, v153, s68
    v_perm_b32 v211, v165, v161, s68
    v_mfma_f32_16x16x32_bf16 v[44:47], a[96:99], v[204:207], v[44:47]
    ds_read_b128 v[184:187], v233 offset:9216
    ds_read_b128 v[188:191], v233 offset:9472
    ds_read_b128 v[192:195], v233 offset:9728
    ds_read_b128 v[196:199], v233 offset:9984
    v_mfma_f32_16x16x32_bf16 v[16:19], a[32:35], v[208:211], v[16:19]
    v_perm_b32 v212, v141, v137, s69
    v_perm_b32 v213, v149, v145, s69
    v_perm_b32 v214, v157, v153, s69
    v_perm_b32 v215, v165, v161, s69
    v_mfma_f32_16x16x32_bf16 v[48:51], a[96:99], v[208:211], v[48:51]
    s_add_u32 m0, s39, 32768
    s_add_u32 s38, s37, 1048576
    buffer_load_dwordx4 v7, s[32:35], s38 offen lds
    s_add_u32 m0, s39, 33792
    v_mfma_f32_16x16x32_bf16 v[20:23], a[32:35], v[212:215], v[20:23]
    v_perm_b32 v216, v142, v138, s68
    v_perm_b32 v217, v150, v146, s68
    v_perm_b32 v218, v158, v154, s68
    v_perm_b32 v219, v166, v162, s68
    v_mfma_f32_16x16x32_bf16 v[52:55], a[96:99], v[212:215], v[52:55]
    s_add_u32 s38, s37, 1081344
    buffer_load_dwordx4 v7, s[32:35], s38 offen lds
    s_add_u32 m0, s39, 34816
    s_add_u32 s38, s37, 1114112
    v_mfma_f32_16x16x32_bf16 v[24:27], a[32:35], v[216:219], v[24:27]
    v_perm_b32 v220, v142, v138, s69
    v_perm_b32 v221, v150, v146, s69
    v_perm_b32 v222, v158, v154, s69
    v_perm_b32 v223, v166, v162, s69
    v_mfma_f32_16x16x32_bf16 v[56:59], a[96:99], v[216:219], v[56:59]
    buffer_load_dwordx4 v7, s[32:35], s38 offen lds
    s_add_u32 m0, s39, 35840
    s_add_u32 s38, s37, 1146880
    buffer_load_dwordx4 v7, s[32:35], s38 offen lds
    v_mfma_f32_16x16x32_bf16 v[28:31], a[32:35], v[220:223], v[28:31]
    v_perm_b32 v224, v143, v139, s68
    v_perm_b32 v225, v151, v147, s68
    v_perm_b32 v226, v159, v155, s68
    v_perm_b32 v227, v167, v163, s68
    v_mfma_f32_16x16x32_bf16 v[60:63], a[96:99], v[220:223], v[60:63]
    s_add_u32 m0, s39, 36864
    s_add_u32 s38, s37, 1179648
    buffer_load_dwordx4 v7, s[32:35], s38 offen lds
    s_add_u32 m0, s39, 37888
    v_mfma_f32_16x16x32_bf16 v[32:35], a[32:35], v[224:227], v[32:35]
    v_perm_b32 v228, v143, v139, s69
    v_perm_b32 v229, v151, v147, s69
    v_perm_b32 v230, v159, v155, s69
    v_perm_b32 v231, v167, v163, s69
    v_mfma_f32_16x16x32_bf16 v[64:67], a[96:99], v[224:227], v[64:67]
    s_add_u32 s38, s37, 1212416
    buffer_load_dwordx4 v7, s[32:35], s38 offen lds
    s_add_u32 m0, s39, 38912
    s_add_u32 s38, s37, 1245184
    v_mfma_f32_16x16x32_bf16 v[36:39], a[32:35], v[228:231], v[36:39]
    buffer_load_dwordx4 v7, s[32:35], s38 offen lds
    s_add_u32 m0, s39, 39936
    s_add_u32 s38, s37, 1277952
    buffer_load_dwordx4 v7, s[32:35], s38 offen lds
    v_mfma_f32_16x16x32_bf16 v[68:71], a[96:99], v[228:231], v[68:71]
    s_waitcnt lgkmcnt(0)
    v_perm_b32 v200, v172, v168, s68
    v_perm_b32 v201, v180, v176, s68
    v_perm_b32 v202, v188, v184, s68
    v_perm_b32 v203, v196, v192, s68
    s_nop 1
    v_mfma_f32_16x16x32_bf16 v[8:11], a[36:39], v[200:203], v[8:11]
    v_perm_b32 v204, v172, v168, s69
    v_perm_b32 v205, v180, v176, s69
    v_perm_b32 v206, v188, v184, s69
    v_perm_b32 v207, v196, v192, s69
    v_mfma_f32_16x16x32_bf16 v[40:43], a[100:103], v[200:203], v[40:43]
    ds_read_b128 v[136:139], v233 offset:16384
    ds_read_b128 v[140:143], v233 offset:16640
    ds_read_b128 v[144:147], v233 offset:16896
    ds_read_b128 v[148:151], v233 offset:17152
    v_mfma_f32_16x16x32_bf16 v[12:15], a[36:39], v[204:207], v[12:15]
    v_perm_b32 v208, v173, v169, s68
    v_perm_b32 v209, v181, v177, s68
    v_perm_b32 v210, v189, v185, s68
    v_perm_b32 v211, v197, v193, s68
    v_mfma_f32_16x16x32_bf16 v[44:47], a[100:103], v[204:207], v[44:47]
    ds_read_b128 v[152:155], v233 offset:17408
    ds_read_b128 v[156:159], v233 offset:17664
    ds_read_b128 v[160:163], v233 offset:17920
    ds_read_b128 v[164:167], v233 offset:18176
    v_mfma_f32_16x16x32_bf16 v[16:19], a[36:39], v[208:211], v[16:19]
    v_perm_b32 v212, v173, v169, s69
    v_perm_b32 v213, v181, v177, s69
    v_perm_b32 v214, v189, v185, s69
    v_perm_b32 v215, v197, v193, s69
    v_mfma_f32_16x16x32_bf16 v[48:51], a[100:103], v[208:211], v[48:51]
    s_nop 0
    v_mfma_f32_16x16x32_bf16 v[20:23], a[36:39], v[212:215], v[20:23]
    v_perm_b32 v216, v174, v170, s68
    v_perm_b32 v217, v182, v178, s68
    v_perm_b32 v218, v190, v186, s68
    v_perm_b32 v219, v198, v194, s68
    v_mfma_f32_16x16x32_bf16 v[52:55], a[100:103], v[212:215], v[52:55]
    s_nop 0
    v_mfma_f32_16x16x32_bf16 v[24:27], a[36:39], v[216:219], v[24:27]
    v_perm_b32 v220, v174, v170, s69
    v_perm_b32 v221, v182, v178, s69
    v_perm_b32 v222, v190, v186, s69
    v_perm_b32 v223, v198, v194, s69
    v_mfma_f32_16x16x32_bf16 v[56:59], a[100:103], v[216:219], v[56:59]
    s_nop 0
    v_mfma_f32_16x16x32_bf16 v[28:31], a[36:39], v[220:223], v[28:31]
    v_perm_b32 v224, v175, v171, s68
    v_perm_b32 v225, v183, v179, s68
    v_perm_b32 v226, v191, v187, s68
    v_perm_b32 v227, v199, v195, s68
    v_mfma_f32_16x16x32_bf16 v[60:63], a[100:103], v[220:223], v[60:63]
    s_nop 0
    v_mfma_f32_16x16x32_bf16 v[32:35], a[36:39], v[224:227], v[32:35]
    v_perm_b32 v228, v175, v171, s69
    v_perm_b32 v229, v183, v179, s69
    v_perm_b32 v230, v191, v187, s69
    v_perm_b32 v231, v199, v195, s69
    v_mfma_f32_16x16x32_bf16 v[64:67], a[100:103], v[224:227], v[64:67]
    s_nop 0
    v_mfma_f32_16x16x32_bf16 v[36:39], a[36:39], v[228:231], v[36:39]
    v_mfma_f32_16x16x32_bf16 v[68:71], a[100:103], v[228:231], v[68:71]
    s_waitcnt lgkmcnt(0)
    v_perm_b32 v200, v140, v136, s68
    v_perm_b32 v201, v148, v144, s68
    v_perm_b32 v202, v156, v152, s68
    v_perm_b32 v203, v164, v160, s68
    s_nop 1
    v_mfma_f32_16x16x32_bf16 v[8:11], a[40:43], v[200:203], v[8:11]
    v_perm_b32 v204, v140, v136, s69
    v_perm_b32 v205, v148, v144, s69
    v_perm_b32 v206, v156, v152, s69
    v_perm_b32 v207, v164, v160, s69
    v_mfma_f32_16x16x32_bf16 v[40:43], a[104:107], v[200:203], v[40:43]
    ds_read_b128 v[168:171], v233 offset:24576
    ds_read_b128 v[172:175], v233 offset:24832
    ds_read_b128 v[176:179], v233 offset:25088
    ds_read_b128 v[180:183], v233 offset:25344
    v_mfma_f32_16x16x32_bf16 v[12:15], a[40:43], v[204:207], v[12:15]
    v_perm_b32 v208, v141, v137, s68
    v_perm_b32 v209, v149, v145, s68
    v_perm_b32 v210, v157, v153, s68
    v_perm_b32 v211, v165, v161, s68
    v_mfma_f32_16x16x32_bf16 v[44:47], a[104:107], v[204:207], v[44:47]
    ds_read_b128 v[184:187], v233 offset:25600
    ds_read_b128 v[188:191], v233 offset:25856
    ds_read_b128 v[192:195], v233 offset:26112
    ds_read_b128 v[196:199], v233 offset:26368
    v_mfma_f32_16x16x32_bf16 v[16:19], a[40:43], v[208:211], v[16:19]
    v_perm_b32 v212, v141, v137, s69
    v_perm_b32 v213, v149, v145, s69
    v_perm_b32 v214, v157, v153, s69
    v_perm_b32 v215, v165, v161, s69
    v_mfma_f32_16x16x32_bf16 v[48:51], a[104:107], v[208:211], v[48:51]
    s_nop 0
    v_mfma_f32_16x16x32_bf16 v[20:23], a[40:43], v[212:215], v[20:23]
    v_perm_b32 v216, v142, v138, s68
    v_perm_b32 v217, v150, v146, s68
    v_perm_b32 v218, v158, v154, s68
    v_perm_b32 v219, v166, v162, s68
    v_mfma_f32_16x16x32_bf16 v[52:55], a[104:107], v[212:215], v[52:55]
    s_nop 0
    v_mfma_f32_16x16x32_bf16 v[24:27], a[40:43], v[216:219], v[24:27]
    v_perm_b32 v220, v142, v138, s69
    v_perm_b32 v221, v150, v146, s69
    v_perm_b32 v222, v158, v154, s69
    v_perm_b32 v223, v166, v162, s69
    v_mfma_f32_16x16x32_bf16 v[56:59], a[104:107], v[216:219], v[56:59]
    s_nop 0
    v_mfma_f32_16x16x32_bf16 v[28:31], a[40:43], v[220:223], v[28:31]
    v_perm_b32 v224, v143, v139, s68
    v_perm_b32 v225, v151, v147, s68
    v_perm_b32 v226, v159, v155, s68
    v_perm_b32 v227, v167, v163, s68
    v_mfma_f32_16x16x32_bf16 v[60:63], a[104:107], v[220:223], v[60:63]
    s_nop 0
    v_mfma_f32_16x16x32_bf16 v[32:35], a[40:43], v[224:227], v[32:35]
    v_perm_b32 v228, v143, v139, s69
    v_perm_b32 v229, v151, v147, s69
    v_perm_b32 v230, v159, v155, s69
    v_perm_b32 v231, v167, v163, s69
    v_mfma_f32_16x16x32_bf16 v[64:67], a[104:107], v[224:227], v[64:67]
    s_nop 0
    v_mfma_f32_16x16x32_bf16 v[36:39], a[40:43], v[228:231], v[36:39]
    v_mfma_f32_16x16x32_bf16 v[68:71], a[104:107], v[228:231], v[68:71]
    s_waitcnt lgkmcnt(0)
    v_perm_b32 v200, v172, v168, s68
    v_perm_b32 v201, v180, v176, s68
    v_perm_b32 v202, v188, v184, s68
    v_perm_b32 v203, v196, v192, s68
    s_nop 1
    v_mfma_f32_16x16x32_bf16 v[8:11], a[44:47], v[200:203], v[8:11]
    v_perm_b32 v204, v172, v168, s69
    v_perm_b32 v205, v180, v176, s69
    v_perm_b32 v206, v188, v184, s69
    v_perm_b32 v207, v196, v192, s69
    v_mfma_f32_16x16x32_bf16 v[40:43], a[108:111], v[200:203], v[40:43]
    s_nop 0
    v_mfma_f32_16x16x32_bf16 v[12:15], a[44:47], v[204:207], v[12:15]
    v_perm_b32 v208, v173, v169, s68
    v_perm_b32 v209, v181, v177, s68
    v_perm_b32 v210, v189, v185, s68
    v_perm_b32 v211, v197, v193, s68
    v_mfma_f32_16x16x32_bf16 v[44:47], a[108:111], v[204:207], v[44:47]
    s_nop 0
    v_mfma_f32_16x16x32_bf16 v[16:19], a[44:47], v[208:211], v[16:19]
    v_perm_b32 v212, v173, v169, s69
    v_perm_b32 v213, v181, v177, s69
    v_perm_b32 v214, v189, v185, s69
    v_perm_b32 v215, v197, v193, s69
    v_mfma_f32_16x16x32_bf16 v[48:51], a[108:111], v[208:211], v[48:51]
    s_nop 0
    v_mfma_f32_16x16x32_bf16 v[20:23], a[44:47], v[212:215], v[20:23]
    v_perm_b32 v216, v174, v170, s68
    v_perm_b32 v217, v182, v178, s68
    v_perm_b32 v218, v190, v186, s68
    v_perm_b32 v219, v198, v194, s68
    v_mfma_f32_16x16x32_bf16 v[52:55], a[108:111], v[212:215], v[52:55]
    s_nop 0
    v_mfma_f32_16x16x32_bf16 v[24:27], a[44:47], v[216:219], v[24:27]
    v_perm_b32 v220, v174, v170, s69
    v_perm_b32 v221, v182, v178, s69
    v_perm_b32 v222, v190, v186, s69
    v_perm_b32 v223, v198, v194, s69
    v_mfma_f32_16x16x32_bf16 v[56:59], a[108:111], v[216:219], v[56:59]
    s_nop 0
    v_mfma_f32_16x16x32_bf16 v[28:31], a[44:47], v[220:223], v[28:31]
    v_perm_b32 v224, v175, v171, s68
    v_perm_b32 v225, v183, v179, s68
    v_perm_b32 v226, v191, v187, s68
    v_perm_b32 v227, v199, v195, s68
    v_mfma_f32_16x16x32_bf16 v[60:63], a[108:111], v[220:223], v[60:63]
    s_nop 0
    v_mfma_f32_16x16x32_bf16 v[32:35], a[44:47], v[224:227], v[32:35]
    v_perm_b32 v228, v175, v171, s69
    v_perm_b32 v229, v183, v179, s69
    v_perm_b32 v230, v191, v187, s69
    v_perm_b32 v231, v199, v195, s69
    v_mfma_f32_16x16x32_bf16 v[64:67], a[108:111], v[224:227], v[64:67]
    s_nop 0
    v_mfma_f32_16x16x32_bf16 v[36:39], a[44:47], v[228:231], v[36:39]
    v_mfma_f32_16x16x32_bf16 v[68:71], a[108:111], v[228:231], v[68:71]
    s_waitcnt vmcnt(16)
    s_barrier
    ds_read_b128 v[136:139], v233 offset:32768
    ds_read_b128 v[140:143], v233 offset:33024
    ds_read_b128 v[144:147], v233 offset:33280
    ds_read_b128 v[148:151], v233 offset:33536
    ds_read_b128 v[152:155], v233 offset:33792
    ds_read_b128 v[156:159], v233 offset:34048
    ds_read_b128 v[160:163], v233 offset:34304
    ds_read_b128 v[164:167], v233 offset:34560
    s_waitcnt lgkmcnt(0)
    v_perm_b32 v200, v140, v136, s68
    v_perm_b32 v201, v148, v144, s68
    v_perm_b32 v202, v156, v152, s68
    v_perm_b32 v203, v164, v160, s68
    s_nop 1
    v_mfma_f32_16x16x32_bf16 v[8:11], a[48:51], v[200:203], v[8:11]
    v_perm_b32 v204, v140, v136, s69
    v_perm_b32 v205, v148, v144, s69
    v_perm_b32 v206, v156, v152, s69
    v_perm_b32 v207, v164, v160, s69
    v_mfma_f32_16x16x32_bf16 v[40:43], a[112:115], v[200:203], v[40:43]
    ds_read_b128 v[168:171], v233 offset:40960
    ds_read_b128 v[172:175], v233 offset:41216
    ds_read_b128 v[176:179], v233 offset:41472
    ds_read_b128 v[180:183], v233 offset:41728
    v_mfma_f32_16x16x32_bf16 v[12:15], a[48:51], v[204:207], v[12:15]
    v_perm_b32 v208, v141, v137, s68
    v_perm_b32 v209, v149, v145, s68
    v_perm_b32 v210, v157, v153, s68
    v_perm_b32 v211, v165, v161, s68
    v_mfma_f32_16x16x32_bf16 v[44:47], a[112:115], v[204:207], v[44:47]
    ds_read_b128 v[184:187], v233 offset:41984
    ds_read_b128 v[188:191], v233 offset:42240
    ds_read_b128 v[192:195], v233 offset:42496
    ds_read_b128 v[196:199], v233 offset:42752
    v_mfma_f32_16x16x32_bf16 v[16:19], a[48:51], v[208:211], v[16:19]
    v_perm_b32 v212, v141, v137, s69
    v_perm_b32 v213, v149, v145, s69
    v_perm_b32 v214, v157, v153, s69
    v_perm_b32 v215, v165, v161, s69
    v_mfma_f32_16x16x32_bf16 v[48:51], a[112:115], v[208:211], v[48:51]
    s_add_u32 m0, s39, 65536
    s_add_u32 s38, s37, 2097152
    buffer_load_dwordx4 v7, s[32:35], s38 offen lds
    s_add_u32 m0, s39, 66560
    v_mfma_f32_16x16x32_bf16 v[20:23], a[48:51], v[212:215], v[20:23]
    v_perm_b32 v216, v142, v138, s68
    v_perm_b32 v217, v150, v146, s68
    v_perm_b32 v218, v158, v154, s68
    v_perm_b32 v219, v166, v162, s68
    v_mfma_f32_16x16x32_bf16 v[52:55], a[112:115], v[212:215], v[52:55]
    s_add_u32 s38, s37, 2129920
    buffer_load_dwordx4 v7, s[32:35], s38 offen lds
    s_add_u32 m0, s39, 67584
    s_add_u32 s38, s37, 2162688
    v_mfma_f32_16x16x32_bf16 v[24:27], a[48:51], v[216:219], v[24:27]
    v_perm_b32 v220, v142, v138, s69
    v_perm_b32 v221, v150, v146, s69
    v_perm_b32 v222, v158, v154, s69
    v_perm_b32 v223, v166, v162, s69
    v_mfma_f32_16x16x32_bf16 v[56:59], a[112:115], v[216:219], v[56:59]
    buffer_load_dwordx4 v7, s[32:35], s38 offen lds
    s_add_u32 m0, s39, 68608
    s_add_u32 s38, s37, 2195456
    buffer_load_dwordx4 v7, s[32:35], s38 offen lds
    v_mfma_f32_16x16x32_bf16 v[28:31], a[48:51], v[220:223], v[28:31]
    v_perm_b32 v224, v143, v139, s68
    v_perm_b32 v225, v151, v147, s68
    v_perm_b32 v226, v159, v155, s68
    v_perm_b32 v227, v167, v163, s68
    v_mfma_f32_16x16x32_bf16 v[60:63], a[112:115], v[220:223], v[60:63]
    s_add_u32 m0, s39, 69632
    s_add_u32 s38, s37, 2228224
    buffer_load_dwordx4 v7, s[32:35], s38 offen lds
    s_add_u32 m0, s39, 70656
    v_mfma_f32_16x16x32_bf16 v[32:35], a[48:51], v[224:227], v[32:35]
    v_perm_b32 v228, v143, v139, s69
    v_perm_b32 v229, v151, v147, s69
    v_perm_b32 v230, v159, v155, s69
    v_perm_b32 v231, v167, v163, s69
    v_mfma_f32_16x16x32_bf16 v[64:67], a[112:115], v[224:227], v[64:67]
    s_add_u32 s38, s37, 2260992
    buffer_load_dwordx4 v7, s[32:35], s38 offen lds
    s_add_u32 m0, s39, 71680
    s_add_u32 s38, s37, 2293760
    v_mfma_f32_16x16x32_bf16 v[36:39], a[48:51], v[228:231], v[36:39]
    buffer_load_dwordx4 v7, s[32:35], s38 offen lds
    s_add_u32 m0, s39, 72704
    s_add_u32 s38, s37, 2326528
    buffer_load_dwordx4 v7, s[32:35], s38 offen lds
    v_mfma_f32_16x16x32_bf16 v[68:71], a[112:115], v[228:231], v[68:71]
    s_waitcnt lgkmcnt(0)
    v_perm_b32 v200, v172, v168, s68
    v_perm_b32 v201, v180, v176, s68
    v_perm_b32 v202, v188, v184, s68
    v_perm_b32 v203, v196, v192, s68
    s_nop 1
    v_mfma_f32_16x16x32_bf16 v[8:11], a[52:55], v[200:203], v[8:11]
    v_perm_b32 v204, v172, v168, s69
    v_perm_b32 v205, v180, v176, s69
    v_perm_b32 v206, v188, v184, s69
    v_perm_b32 v207, v196, v192, s69
    v_mfma_f32_16x16x32_bf16 v[40:43], a[116:119], v[200:203], v[40:43]
    ds_read_b128 v[136:139], v233 offset:49152
    ds_read_b128 v[140:143], v233 offset:49408
    ds_read_b128 v[144:147], v233 offset:49664
    ds_read_b128 v[148:151], v233 offset:49920
    v_mfma_f32_16x16x32_bf16 v[12:15], a[52:55], v[204:207], v[12:15]
    v_perm_b32 v208, v173, v169, s68
    v_perm_b32 v209, v181, v177, s68
    v_perm_b32 v210, v189, v185, s68
    v_perm_b32 v211, v197, v193, s68
    v_mfma_f32_16x16x32_bf16 v[44:47], a[116:119], v[204:207], v[44:47]
    ds_read_b128 v[152:155], v233 offset:50176
    ds_read_b128 v[156:159], v233 offset:50432
    ds_read_b128 v[160:163], v233 offset:50688
    ds_read_b128 v[164:167], v233 offset:50944
    v_mfma_f32_16x16x32_bf16 v[16:19], a[52:55], v[208:211], v[16:19]
    v_perm_b32 v212, v173, v169, s69
    v_perm_b32 v213, v181, v177, s69
    v_perm_b32 v214, v189, v185, s69
    v_perm_b32 v215, v197, v193, s69
    v_mfma_f32_16x16x32_bf16 v[48:51], a[116:119], v[208:211], v[48:51]
    s_nop 0
    v_mfma_f32_16x16x32_bf16 v[20:23], a[52:55], v[212:215], v[20:23]
    v_perm_b32 v216, v174, v170, s68
    v_perm_b32 v217, v182, v178, s68
    v_perm_b32 v218, v190, v186, s68
    v_perm_b32 v219, v198, v194, s68
    v_mfma_f32_16x16x32_bf16 v[52:55], a[116:119], v[212:215], v[52:55]
    s_nop 0
    v_mfma_f32_16x16x32_bf16 v[24:27], a[52:55], v[216:219], v[24:27]
    v_perm_b32 v220, v174, v170, s69
    v_perm_b32 v221, v182, v178, s69
    v_perm_b32 v222, v190, v186, s69
    v_perm_b32 v223, v198, v194, s69
    v_mfma_f32_16x16x32_bf16 v[56:59], a[116:119], v[216:219], v[56:59]
    s_nop 0
    v_mfma_f32_16x16x32_bf16 v[28:31], a[52:55], v[220:223], v[28:31]
    v_perm_b32 v224, v175, v171, s68
    v_perm_b32 v225, v183, v179, s68
    v_perm_b32 v226, v191, v187, s68
    v_perm_b32 v227, v199, v195, s68
    v_mfma_f32_16x16x32_bf16 v[60:63], a[116:119], v[220:223], v[60:63]
    s_nop 0
    v_mfma_f32_16x16x32_bf16 v[32:35], a[52:55], v[224:227], v[32:35]
    v_perm_b32 v228, v175, v171, s69
    v_perm_b32 v229, v183, v179, s69
    v_perm_b32 v230, v191, v187, s69
    v_perm_b32 v231, v199, v195, s69
    v_mfma_f32_16x16x32_bf16 v[64:67], a[116:119], v[224:227], v[64:67]
    s_nop 0
    v_mfma_f32_16x16x32_bf16 v[36:39], a[52:55], v[228:231], v[36:39]
    v_mfma_f32_16x16x32_bf16 v[68:71], a[116:119], v[228:231], v[68:71]
    s_waitcnt lgkmcnt(0)
    v_perm_b32 v200, v140, v136, s68
    v_perm_b32 v201, v148, v144, s68
    v_perm_b32 v202, v156, v152, s68
    v_perm_b32 v203, v164, v160, s68
    s_nop 1
    v_mfma_f32_16x16x32_bf16 v[8:11], a[56:59], v[200:203], v[8:11]
    v_perm_b32 v204, v140, v136, s69
    v_perm_b32 v205, v148, v144, s69
    v_perm_b32 v206, v156, v152, s69
    v_perm_b32 v207, v164, v160, s69
    v_mfma_f32_16x16x32_bf16 v[40:43], a[120:123], v[200:203], v[40:43]
    ds_read_b128 v[168:171], v233 offset:57344
    ds_read_b128 v[172:175], v233 offset:57600
    ds_read_b128 v[176:179], v233 offset:57856
    ds_read_b128 v[180:183], v233 offset:58112
    v_mfma_f32_16x16x32_bf16 v[12:15], a[56:59], v[204:207], v[12:15]
    v_perm_b32 v208, v141, v137, s68
    v_perm_b32 v209, v149, v145, s68
    v_perm_b32 v210, v157, v153, s68
    v_perm_b32 v211, v165, v161, s68
    v_mfma_f32_16x16x32_bf16 v[44:47], a[120:123], v[204:207], v[44:47]
    ds_read_b128 v[184:187], v233 offset:58368
    ds_read_b128 v[188:191], v233 offset:58624
    ds_read_b128 v[192:195], v233 offset:58880
    ds_read_b128 v[196:199], v233 offset:59136
    v_mfma_f32_16x16x32_bf16 v[16:19], a[56:59], v[208:211], v[16:19]
    v_perm_b32 v212, v141, v137, s69
    v_perm_b32 v213, v149, v145, s69
    v_perm_b32 v214, v157, v153, s69
    v_perm_b32 v215, v165, v161, s69
    v_mfma_f32_16x16x32_bf16 v[48:51], a[120:123], v[208:211], v[48:51]
    s_nop 0
    v_mfma_f32_16x16x32_bf16 v[20:23], a[56:59], v[212:215], v[20:23]
    v_perm_b32 v216, v142, v138, s68
    v_perm_b32 v217, v150, v146, s68
    v_perm_b32 v218, v158, v154, s68
    v_perm_b32 v219, v166, v162, s68
    v_mfma_f32_16x16x32_bf16 v[52:55], a[120:123], v[212:215], v[52:55]
    s_nop 0
    v_mfma_f32_16x16x32_bf16 v[24:27], a[56:59], v[216:219], v[24:27]
    v_perm_b32 v220, v142, v138, s69
    v_perm_b32 v221, v150, v146, s69
    v_perm_b32 v222, v158, v154, s69
    v_perm_b32 v223, v166, v162, s69
    v_mfma_f32_16x16x32_bf16 v[56:59], a[120:123], v[216:219], v[56:59]
    s_nop 0
    v_mfma_f32_16x16x32_bf16 v[28:31], a[56:59], v[220:223], v[28:31]
    v_perm_b32 v224, v143, v139, s68
    v_perm_b32 v225, v151, v147, s68
    v_perm_b32 v226, v159, v155, s68
    v_perm_b32 v227, v167, v163, s68
    v_mfma_f32_16x16x32_bf16 v[60:63], a[120:123], v[220:223], v[60:63]
    s_nop 0
    v_mfma_f32_16x16x32_bf16 v[32:35], a[56:59], v[224:227], v[32:35]
    v_perm_b32 v228, v143, v139, s69
    v_perm_b32 v229, v151, v147, s69
    v_perm_b32 v230, v159, v155, s69
    v_perm_b32 v231, v167, v163, s69
    v_mfma_f32_16x16x32_bf16 v[64:67], a[120:123], v[224:227], v[64:67]
    s_nop 0
    v_mfma_f32_16x16x32_bf16 v[36:39], a[56:59], v[228:231], v[36:39]
    v_mfma_f32_16x16x32_bf16 v[68:71], a[120:123], v[228:231], v[68:71]
    s_waitcnt lgkmcnt(0)
    v_perm_b32 v200, v172, v168, s68
    v_perm_b32 v201, v180, v176, s68
    v_perm_b32 v202, v188, v184, s68
    v_perm_b32 v203, v196, v192, s68
    s_nop 1
    v_mfma_f32_16x16x32_bf16 v[8:11], a[60:63], v[200:203], v[8:11]
    v_perm_b32 v204, v172, v168, s69
    v_perm_b32 v205, v180, v176, s69
    v_perm_b32 v206, v188, v184, s69
    v_perm_b32 v207, v196, v192, s69
    v_mfma_f32_16x16x32_bf16 v[40:43], a[124:127], v[200:203], v[40:43]
    s_nop 0
    v_mfma_f32_16x16x32_bf16 v[12:15], a[60:63], v[204:207], v[12:15]
    v_perm_b32 v208, v173, v169, s68
    v_perm_b32 v209, v181, v177, s68
    v_perm_b32 v210, v189, v185, s68
    v_perm_b32 v211, v197, v193, s68
    v_mfma_f32_16x16x32_bf16 v[44:47], a[124:127], v[204:207], v[44:47]
    s_nop 0
    v_mfma_f32_16x16x32_bf16 v[16:19], a[60:63], v[208:211], v[16:19]
    v_perm_b32 v212, v173, v169, s69
    v_perm_b32 v213, v181, v177, s69
    v_perm_b32 v214, v189, v185, s69
    v_perm_b32 v215, v197, v193, s69
    v_mfma_f32_16x16x32_bf16 v[48:51], a[124:127], v[208:211], v[48:51]
    s_nop 0
    v_mfma_f32_16x16x32_bf16 v[20:23], a[60:63], v[212:215], v[20:23]
    v_perm_b32 v216, v174, v170, s68
    v_perm_b32 v217, v182, v178, s68
    v_perm_b32 v218, v190, v186, s68
    v_perm_b32 v219, v198, v194, s68
    v_mfma_f32_16x16x32_bf16 v[52:55], a[124:127], v[212:215], v[52:55]
    s_nop 0
    v_mfma_f32_16x16x32_bf16 v[24:27], a[60:63], v[216:219], v[24:27]
    v_perm_b32 v220, v174, v170, s69
    v_perm_b32 v221, v182, v178, s69
    v_perm_b32 v222, v190, v186, s69
    v_perm_b32 v223, v198, v194, s69
    v_mfma_f32_16x16x32_bf16 v[56:59], a[124:127], v[216:219], v[56:59]
    s_nop 0
    v_mfma_f32_16x16x32_bf16 v[28:31], a[60:63], v[220:223], v[28:31]
    v_perm_b32 v224, v175, v171, s68
    v_perm_b32 v225, v183, v179, s68
    v_perm_b32 v226, v191, v187, s68
    v_perm_b32 v227, v199, v195, s68
    v_mfma_f32_16x16x32_bf16 v[60:63], a[124:127], v[220:223], v[60:63]
    s_nop 0
    v_mfma_f32_16x16x32_bf16 v[32:35], a[60:63], v[224:227], v[32:35]
    v_perm_b32 v228, v175, v171, s69
    v_perm_b32 v229, v183, v179, s69
    v_perm_b32 v230, v191, v187, s69
    v_perm_b32 v231, v199, v195, s69
    v_mfma_f32_16x16x32_bf16 v[64:67], a[124:127], v[224:227], v[64:67]
    s_nop 0
    v_mfma_f32_16x16x32_bf16 v[36:39], a[60:63], v[228:231], v[36:39]
    v_mfma_f32_16x16x32_bf16 v[68:71], a[124:127], v[228:231], v[68:71]
    s_lshl_b32 s28, s27, 20
    s_lshl_b32 s29, s47, 14
    s_add_u32 s28, s28, s29
    s_add_u32 s28, s28, 20979712
    v_cvt_pk_bf16_f32 v200, v8, v9
    v_cvt_pk_bf16_f32 v201, v10, v11
    v_cvt_pk_bf16_f32 v202, v40, v41
    v_cvt_pk_bf16_f32 v203, v42, v43
    buffer_store_dwordx4 v[200:203], v4, s[8:11], s28 offen offset:0 sc1
    v_cvt_pk_bf16_f32 v204, v12, v13
    v_cvt_pk_bf16_f32 v205, v14, v15
    v_cvt_pk_bf16_f32 v206, v44, v45
    v_cvt_pk_bf16_f32 v207, v46, v47
    buffer_store_dwordx4 v[204:207], v4, s[8:11], s28 offen offset:1024 sc1
    v_cvt_pk_bf16_f32 v208, v16, v17
    v_cvt_pk_bf16_f32 v209, v18, v19
    v_cvt_pk_bf16_f32 v210, v48, v49
    v_cvt_pk_bf16_f32 v211, v50, v51
    buffer_store_dwordx4 v[208:211], v4, s[8:11], s28 offen offset:2048 sc1
    v_cvt_pk_bf16_f32 v212, v20, v21
    v_cvt_pk_bf16_f32 v213, v22, v23
    v_cvt_pk_bf16_f32 v214, v52, v53
    v_cvt_pk_bf16_f32 v215, v54, v55
    buffer_store_dwordx4 v[212:215], v4, s[8:11], s28 offen offset:3072 sc1
    s_add_u32 s28, s28, 4096
    v_cvt_pk_bf16_f32 v216, v24, v25
    v_cvt_pk_bf16_f32 v217, v26, v27
    v_cvt_pk_bf16_f32 v218, v56, v57
    v_cvt_pk_bf16_f32 v219, v58, v59
    buffer_store_dwordx4 v[216:219], v4, s[8:11], s28 offen offset:0 sc1
    v_cvt_pk_bf16_f32 v220, v28, v29
    v_cvt_pk_bf16_f32 v221, v30, v31
    v_cvt_pk_bf16_f32 v222, v60, v61
    v_cvt_pk_bf16_f32 v223, v62, v63
    buffer_store_dwordx4 v[220:223], v4, s[8:11], s28 offen offset:1024 sc1
    v_cvt_pk_bf16_f32 v224, v32, v33
    v_cvt_pk_bf16_f32 v225, v34, v35
    v_cvt_pk_bf16_f32 v226, v64, v65
    v_cvt_pk_bf16_f32 v227, v66, v67
    buffer_store_dwordx4 v[224:227], v4, s[8:11], s28 offen offset:2048 sc1
    v_cvt_pk_bf16_f32 v228, v36, v37
    v_cvt_pk_bf16_f32 v229, v38, v39
    v_cvt_pk_bf16_f32 v230, v68, v69
    v_cvt_pk_bf16_f32 v231, v70, v71
    buffer_store_dwordx4 v[228:231], v4, s[8:11], s28 offen offset:3072 sc1
    s_add_u32 s28, s28, 12288
    s_nop 0
Ltd_204:
    s_and_b32 s24, s6, 31
    s_lshl_b32 s24, s24, 10
    s_lshr_b32 s25, s6, 5
    s_sub_u32 s26, s25, 1
    s_lshl_b32 s26, s26, 7
    s_cmp_eq_u32 s25, 0
    s_cselect_b32 s25, 512, s26
    s_add_u32 s24, s24, s25
    s_lshl_b32 s25, s5, 8
    s_add_u32 s24, s24, s25
    s_add_u32 s24, s24, 159449088
    s_waitcnt vmcnt(0) lgkmcnt(0)
    s_barrier
    s_cmp_lg_u32 s19, 0
    s_cbranch_scc1 Lsig_207
    v_mov_b64 v[236:237], s[62:63]
    v_mov_b64 v[238:239], s[62:63]
    s_mov_b64 exec, 0xff
    buffer_store_dwordx4 v[236:239], v4, s[8:11], s24 offen sc1
    s_mov_b64 exec, -1
    s_nop 0
Lsig_207:
    s_mov_b32 s6, s46
    s_mov_b32 s12, s32
    s_mov_b32 s13, s33
    s_mov_b32 s36, s37
    s_sub_u32 s48, s48, 1
    s_cmp_gt_u32 s48, 0
    s_cbranch_scc1 Lnt_200
    s_branch Lnext_92
main_kernel_fin:
    s_waitcnt vmcnt(0) lgkmcnt(0)
main_kernel_exit:
    s_endpgm
.p2align 6
.type main_kernel_table,@object
main_kernel_table:
    .long 1179657, 1183753, 1187849, 1191945, 1196041, 1200137, 1204233, 1208329, 1212425, 1216521, 1220617, 1224713, 1228809, 1232905, 1237001, 1241097
    .long 1245193, 1249289, 1253385, 1257481, 1261577, 1265673, 1269769, 1273865, 1277961, 1282057, 1286153, 1290249, 1294345, 1298441, 1302537, 1306633
    .long 1310729, 1314825, 1318921, 1323017, 1327113, 1331209, 1335305, 1339401, 1343497, 1347593, 1351689, 1355785, 1359881, 1363977, 1368073, 1372169
    .long 1376265, 1380361, 1384457, 1388553, 1392649, 1396745, 1400841, 1404937, 1409033, 1413129, 1417225, 1421321, 1425417, 1429513, 1433609, 1437705
    .long 1179673, 1183769, 1187865, 1191961, 1196057, 1200153, 1204249, 1208345, 1212441, 1216537, 1220633, 1224729, 1228825, 1232921, 1237017, 1241113
    .long 1245209, 1249305, 1253401, 1257497, 1261593, 1265689, 1269785, 1273881, 1277977, 1282073, 1286169, 1290265, 1294361, 1298457, 1302553, 1306649
    .long 1310745, 1314841, 1318937, 1323033, 1327129, 1331225, 1335321, 1339417, 1343513, 1347609, 1351705, 1355801, 1359897, 1363993, 1368089, 1372185
    .long 1376281, 1380377, 1384473, 1388569, 1392665, 1396761, 1400857, 1404953, 1409049, 1413145, 1417241, 1421337, 1425433, 1429529, 1433625, 1437721
    .long 1179665, 1183761, 1187857, 1191953, 1196049, 1200145, 1204241, 1208337, 1212433, 1216529, 1220625, 1224721, 1228817, 1232913, 1237009, 1241105
    .long 1245201, 1249297, 1253393, 1257489, 1261585, 1265681, 1269777, 1273873, 1277969, 1282065, 1286161, 1290257, 1294353, 1298449, 1302545, 1306641
    .long 1310737, 1314833, 1318929, 1323025, 1327121, 1331217, 1335313, 1339409, 1343505, 1347601, 1351697, 1355793, 1359889, 1363985, 1368081, 1372177
    .long 1376273, 1380369, 1384465, 1388561, 1392657, 1396753, 1400849, 1404945, 1409041, 1413137, 1417233, 1421329, 1425425, 1429521, 1433617, 1437713
    .long 2228257, 2232353, 2236449, 2240545, 2244641, 2248737, 2252833, 2256929, 2261025, 2265121, 2269217, 2273313, 2277409, 2281505, 2285601, 2289697
    .long 2293793, 2297889, 2301985, 2306081, 2310177, 2314273, 2318369, 2322465, 2326561, 2330657, 2334753, 2338849, 2342945, 2347041, 2351137, 2355233
    .long 1048577, 1052673, 1056769, 1060865, 1064961, 1069057, 1073153, 1077249, 1081345, 1085441, 1089537, 1093633, 1097729, 1101825, 1105921, 1110017
    .long 1114113, 1118209, 1122305, 1126401, 1130497, 1134593, 1138689, 1142785, 1146881, 1150977, 1155073, 1159169, 1163265, 1167361, 1171457, 1175553
    .long 3276849, 3280945, 3285041, 3289137, 3293233, 3297329, 3301425, 3305521, 3309617, 3313713, 3317809, 3321905, 3326001, 3330097, 3334193, 3338289
    .long 3342385, 3346481, 3350577, 3354673, 3358769, 3362865, 3366961, 3371057, 3375153, 3379249, 3383345, 3387441, 3391537, 3395633, 3399729, 3403825
    .long 3276865, 3280961, 3285057, 3289153, 3293249, 3297345, 3301441, 3305537, 3309633, 3313729, 3317825, 3321921, 3326017, 3330113, 3334209, 3338305
    .long 3342401, 3346497, 3350593, 3354689, 3358785, 3362881, 3366977, 3371073, 3375169, 3379265, 3383361, 3387457, 3391553, 3395649, 3399745, 3403841
    .long 2, 1048594, 2097186, 3145778, 4194370, 5242962, 6291554, 7340146, 8388738, 9437330, 10485922, 11534514, 12583106, 13631698, 14680290, 15728882
    .long 16777474, 17826066, 18874658, 19923250, 20971842, 22020434, 23069026, 24117618, 25166210, 26214802, 27263394, 28311986, 29360578, 30409170, 31457762, 32506354
    .long 4610, 1053202, 2101794, 3150386, 8770, 1057362, 2105954, 3154546, 12930, 1061522, 2110114, 3158706, 4207298, 5255890, 6304482, 7353074
    .long 8401666, 9450258, 10498850, 11547442, 12596034, 13644626, 17250, 1065842, 2114434, 3163026, 4211618, 5260210, 6308802, 7357394, 8405986, 9454578
    .long 10503170, 11551762, 12600354, 13648946, 1048593, 1052689, 1056785, 1060881, 1064977, 1069073, 1073169, 1077265, 1081361, 1085457, 1089553, 1093649
    .long 1097745, 1101841, 1105937, 1110033, 1114129, 1118225, 1122321, 1126417, 1130513, 1134609, 1138705, 1142801, 1146897, 1150993, 1155089, 1159185
    .long 1163281, 1167377, 1171473, 1175569, 3276881, 3280977, 3285073, 3289169, 3293265, 3297361, 3301457, 3305553, 3309649, 3313745, 3317841, 3321937
    .long 3326033, 3330129, 3334225, 3338321, 3342417, 3346513, 3350609, 3354705, 3358801, 3362897, 3366993, 3371089, 3375185, 3379281, 3383377, 3387473
    .long 3391569, 3395665, 3399761, 3403857, 1048609, 1052705, 1056801, 1060897, 1064993, 1069089, 1073185, 1077281, 1081377, 1085473, 1089569, 1093665
    .long 1097761, 1101857, 1105953, 1110049, 1114145, 1118241, 1122337, 1126433, 1130529, 1134625, 1138721, 1142817, 1146913, 1151009, 1155105, 1159201
    .long 1163297, 1167393, 1171489, 1175585, 3276897, 3280993, 3285089, 3289185, 3293281, 3297377, 3301473, 3305569, 3309665, 3313761, 3317857, 3321953
    .long 3326049, 3330145, 3334241, 3338337, 3342433, 3346529, 3350625, 3354721, 3358817, 3362913, 3367009, 3371105, 3375201, 3379297, 3383393, 3387489
    .long 3391585, 3395681, 3399777, 3403873, 3276913, 3281009, 3285105, 3289201, 3293297, 3297393, 3301489, 3305585, 3309681, 3313777, 3317873, 3321969
    .long 3326065, 3330161, 3334257, 3338353, 3342449, 3346545, 3350641, 3354737, 3358833, 3362929, 3367025, 3371121, 3375217, 3379313, 3383409, 3387505
    .long 3391601, 3395697, 3399793, 3403889, 3, 4099, 8195, 12291, 16387, 20483, 24579, 28675, 19, 4115, 8211, 12307
    .long 16403, 20499, 24595, 28691, 35, 4131, 8227, 12323, 16419, 20515, 24611, 28707, 51, 4147, 8243, 12339
    .long 16435, 20531, 24627, 28723, 4, 4100, 8196, 12292, 1048580, 1052676, 1056772, 1060868, 2097156, 2101252, 2105348, 2109444
    .long 3145732, 3149828, 3153924, 3158020, 20, 4116, 8212, 12308, 1048596, 1052692, 1056788, 1060884, 2097172, 2101268, 2105364, 2109460
    .long 3145748, 3149844, 3153940, 3158036, 36, 4132, 8228, 12324, 1048612, 1052708, 1056804, 1060900, 2097188, 2101284, 2105380, 2109476
    .long 3145764, 3149860, 3153956, 3158052, 52, 4148, 8244, 12340, 1048628, 1052724, 1056820, 1060916, 2097204, 2101300, 2105396, 2109492
    .long 3145780, 3149876, 3153972, 3158068, 5, 21, 37, 53, 69, 85, 101, 117, 133, 149, 165, 181
    .long 6, 22, 38, 54, 70, 86, 102, 118, 7, 4103, 8199, 12295, 23, 4119, 8215, 12311
    .long 39, 4135, 8231, 12327, 55, 4151, 8247, 12343, 71, 4167, 8263, 12359, 87, 4183, 8279, 12375
    .long 8, 4104, 8200, 12296, 24, 4120, 8216, 12312, 40, 4136, 8232, 12328, 56, 4152, 8248, 12344
    .long 72, 4168, 8264, 12360, 88, 4184, 8280, 12376
.section .rodata,"a"
.p2align 6
.amdhsa_kernel main_kernel
  .amdhsa_next_free_vgpr 512
  .amdhsa_next_free_sgpr 102
  .amdhsa_accum_offset 256
  .amdhsa_group_segment_fixed_size 0
  .amdhsa_kernarg_size 120
  .amdhsa_user_sgpr_count 2
  .amdhsa_user_sgpr_kernarg_segment_ptr 1
  .amdhsa_system_sgpr_workgroup_id_x 1
.end_amdhsa_kernel
```
